```python
import torch

def _softmax(x, axis=-1):
    return torch.softmax(x, dim=axis)
def _gelu(x):
    return torch.nn.functional.gelu(x, approximate="tanh")
def _silu(x):
    return torch.nn.functional.silu(x)
def _sigmoid(x):
    return torch.sigmoid(x)
def _layernorm(x, axis=-1, eps=1e-5):
    m = x.mean(dim=axis, keepdim=True)
    v = x.var(dim=axis, keepdim=True, unbiased=False)
    return (x - m) / torch.sqrt(v + eps)
def _scatter_add(tgt, idx, src, axis=0):
    return tgt.clone().index_add_(axis, idx, src)
def _segment_sum(src, seg, n):
    out = torch.zeros((n,) + src.shape[1:], dtype=src.dtype)
    return out.index_add_(0, seg, src)
def _pad(x, pw):
    flat = tuple(v for pair in reversed(pw) for v in pair)
    return torch.nn.functional.pad(x, flat)

kernel_name = 'concat_heads__mha_block_cached__mha_block_cached__near_ridge'

def setup_inputs():

    _w = (lambda a: (lambda t: t.to(torch.bfloat16) if t.is_floating_point() else t)(torch.as_tensor(a)))
    def _A_setup():
        B, Sq, D = 8, 192, 512
        H, Sk, Dh = 32, 1024, 128
        return {
            "x": _w((lambda *s: torch.randn(*s, dtype=torch.bfloat16) * 0.8)(B, Sq, D)),
            "k_cache": _w((lambda *s: torch.randn(*s, dtype=torch.bfloat16) * 0.8)(B, H, Sk, Dh)),
            "v_cache": _w((lambda *s: torch.randn(*s, dtype=torch.bfloat16) * 0.05)(B, H, Sk, Dh)),
            "wq": _w((lambda *s: torch.randn(*s, dtype=torch.bfloat16) * 0.8)(D, H * Dh) * (D ** -0.5)),
            "wo": _w((lambda *s: torch.randn(*s, dtype=torch.bfloat16) * 0.05)(H * Dh, D) * ((H * Dh) ** -0.5)),
        }
    _A_in = _A_setup()

    def _B_setup():
        B, Sq, D = 8, 192, 512
        H, Sk, Dh = 32, 1024, 128
        return {
            "x": _w((lambda *s: torch.randn(*s, dtype=torch.bfloat16) * 0.8)(B, Sq, D)),
            "k_cache": _w((lambda *s: torch.randn(*s, dtype=torch.bfloat16) * 0.8)(B, H, Sk, Dh)),
            "v_cache": _w((lambda *s: torch.randn(*s, dtype=torch.bfloat16) * 0.05)(B, H, Sk, Dh)),
            "wq": _w((lambda *s: torch.randn(*s, dtype=torch.bfloat16) * 0.8)(D, H * Dh) * (D ** -0.5)),
            "wo": _w((lambda *s: torch.randn(*s, dtype=torch.bfloat16) * 0.05)(H * Dh, D) * ((H * Dh) ** -0.5)),
        }
    _B_in = _B_setup()

    return {
        "A_x": _A_in["x"],
        "A_k_cache": _A_in["k_cache"],
        "A_v_cache": _A_in["v_cache"],
        "A_wq": _A_in["wq"],
        "A_wo": _A_in["wo"],
        "B_x": _B_in["x"],
        "B_k_cache": _B_in["k_cache"],
        "B_v_cache": _B_in["v_cache"],
        "B_wq": _B_in["wq"],
        "B_wo": _B_in["wo"],
    }

def reference(A_x, A_k_cache, A_v_cache, A_wq, A_wo, B_x, B_k_cache, B_v_cache, B_wq, B_wo):
    def _A_ref(x, k_cache, v_cache, wq, wo):
        B, Sq, D = x.shape
        H, Dh = 32, 128
        q = (lambda x, *d: x.permute(*d))((x @ wq).reshape(B, Sq, H, Dh), 0, 2, 1, 3)
        scores = torch.einsum("bhqd,bhkd->bhqk", q, k_cache) * (Dh ** -0.5)
        p = _softmax(scores, axis=-1)
        o = torch.einsum("bhqk,bhkd->bhqd", p, v_cache)
        return (lambda x, *d: x.permute(*d))(o, 0, 2, 1, 3).reshape(B, Sq, H * Dh) @ wo

    def _B_ref(x, k_cache, v_cache, wq, wo):
        B, Sq, D = x.shape
        H, Dh = 32, 128
        q = (lambda x, *d: x.permute(*d))((x @ wq).reshape(B, Sq, H, Dh), 0, 2, 1, 3)
        scores = torch.einsum("bhqd,bhkd->bhqk", q, k_cache) * (Dh ** -0.5)
        p = _softmax(scores, axis=-1)
        o = torch.einsum("bhqk,bhkd->bhqd", p, v_cache)
        return (lambda x, *d: x.permute(*d))(o, 0, 2, 1, 3).reshape(B, Sq, H * Dh) @ wo

    a = _A_ref(A_x, A_k_cache, A_v_cache, A_wq, A_wo)
    b = _B_ref(B_x, B_k_cache, B_v_cache, B_wq, B_wo)
    return torch.concatenate([a, b], axis=-1)
```

```asm
; @launch kernel=attn_kernel grid=(256,1,1) block=(768,1,1) lds=163840
; @launch kernel=oproj_kernel grid=(256,1,1) block=(512,1,1) lds=131072
.amdgcn_target "amdgcn-amd-amdhsa--gfx950"
.text
.globl attn_kernel
.p2align 8
.type attn_kernel,@function
attn_kernel:
    s_cmp_ge_u32 s2, 256
    s_cbranch_scc1 K1_END
    s_and_b32 s3, s2, 7
    s_lshr_b32 s4, s2, 3
    s_and_b32 s64, s3, 1
    s_lshr_b32 s5, s3, 1
    s_lshl_b32 s5, s5, 2
    s_and_b32 s6, s4, 3
    s_add_u32 s66, s5, s6
    s_lshr_b32 s65, s4, 2
    s_and_b32 s66, s4, 15
    s_lshr_b32 s5, s3, 1
    s_lshl_b32 s5, s5, 1
    s_lshr_b32 s6, s4, 4
    s_add_u32 s65, s5, s6
    s_mul_i32 s5, s64, 40
    s_add_u32 s6, s0, s5
    s_addc_u32 s7, s1, 0
    s_load_dwordx8 s[56:63], s[6:7], 0
    s_load_dwordx2 s[4:5], s[0:1], 96
    s_load_dwordx2 s[52:53], s[6:7], 32
    v_and_b32 v166, 63, v0
    v_lshrrev_b32 v167, 6, v0
    s_nop 0
    v_readfirstlane_b32 s28, v167
    s_mov_b32 s31, 0x3e0293ee
    s_mov_b32 s67, 0x427af233
    s_cmp_ge_u32 s28, 6
    s_cselect_b32 s29, 1, 0
    s_mul_i32 s3, s29, 6
    s_sub_u32 s30, s28, s3
    s_and_b32 s68, s28, 3
    s_waitcnt lgkmcnt(0)
    s_mul_i32 s3, s65, 196608
    s_add_u32 s8, s56, s3
    s_addc_u32 s9, s57, 0
    s_mov_b32 s10, 196608
    s_mov_b32 s11, 0x00020000
    s_lshl_b32 s3, s66, 9
    s_add_u32 s12, s62, s3
    s_addc_u32 s13, s63, 0
    s_sub_u32 s14, 4194304, s3
    s_mov_b32 s15, 0x00020000
    s_lshl_b32 s3, s65, 4
    s_add_u32 s3, s3, s66
    s_lshr_b32 s6, s3, 13
    s_lshl_b32 s3, s3, 19
    s_add_u32 s16, s58, s3
    s_addc_u32 s17, s59, s6
    s_mov_b32 s18, 524288
    s_mov_b32 s19, 0x00020000
    s_add_u32 s20, s60, s3
    s_addc_u32 s21, s61, s6
    s_mov_b32 s22, 524288
    s_mov_b32 s23, 0x00020000
    s_lshl_b32 s3, s64, 3
    s_add_u32 s3, s3, s65
    s_mul_i32 s3, s3, 6
    s_add_u32 s3, s3, s30
    s_lshl_b32 s3, s3, 5
    s_lshl_b32 s6, s66, 1
    s_add_u32 s3, s3, s6
    s_add_u32 s3, s3, s29
    s_lshl_b32 s3, s3, 13
    s_add_u32 s24, s4, s3
    s_addc_u32 s25, s5, 0
    s_mov_b32 s26, 8192
    s_mov_b32 s27, 0x00020000
    s_lshr_b32 s3, s2, 1
    s_and_b32 s3, s3, 3
    s_lshl_b32 s3, s3, 5
    s_lshr_b32 s6, s2, 3
    s_add_u32 s3, s3, s6
    s_lshl_b32 s3, s3, 15
    s_add_u32 s52, s52, s3
    s_addc_u32 s53, s53, 0
    s_mov_b32 s54, 32768
    s_mov_b32 s55, 0x00020000
    v_lshrrev_b32 v0, 4, v166
    v_and_b32 v1, 15, v166
    v_lshlrev_b32 v2, 2, v0
    v_xor_b32 v2, v2, v1
    v_lshlrev_b32 v2, 4, v2
    v_lshl_add_u32 v164, v0, 8, v2
    s_lshl_b32 s6, s68, 2
    v_add_u32 v3, s6, v0
    v_xor_b32 v3, v3, v1
    v_lshlrev_b32 v3, 4, v3
    v_lshl_add_u32 v163, v0, 8, v3
    v_lshl_add_u32 v165, v0, 13, v2
    v_and_b32 v5, 3, v166
    v_xor_b32 v5, v5, v0
    v_lshlrev_b32 v5, 4, v5
    v_lshrrev_b32 v6, 2, v166
    v_lshl_add_u32 v108, v6, 10, v5
    s_lshr_b32 s6, s28, 2
    s_and_b32 s6, s6, 1
    s_lshl_b32 s7, s6, 18
    s_lshl_b32 s69, s68, 10
    s_add_u32 s45, s7, s69
    s_lshl_b32 s7, s6, 16
    s_add_u32 s46, s7, s69
    s_lshl_b32 s3, s68, 15
    s_lshl_b32 s4, s6, 8
    s_add_u32 s33, s3, s4
    s_mov_b32 s32, s46
    s_lshl_b32 s34, s28, 14
    s_lshl_b32 s4, s28, 10
    s_add_u32 s5, s4, 16384
    s_add_u32 s6, s4, 147456
    s_cmp_ge_u32 s28, 8
    s_cselect_b32 s36, s6, s5
    s_add_u32 s5, s4, 81920
    s_add_u32 s6, s4, 151552
    s_cmp_ge_u32 s28, 8
    s_cselect_b32 s37, s6, s5
    s_add_u32 s38, s4, 131072
    s_add_u32 s39, s4, 143360
    s_and_b32 s3, s66, 3
    s_lshl_b32 s3, s3, 2
    s_lshl_b32 s4, s65, 1
    s_add_u32 s3, s3, s4
    s_and_b32 s3, s3, 15
    s_and_b32 s3, s3, 3
    s_lshl_b32 s40, s3, 18
    s_lshl_b32 s41, s3, 6
    v_and_b32 v8, 31, v166
    v_lshrrev_b32 v9, 5, v166
    v_bfe_u32 v10, v166, 4, 1
    v_bfe_u32 v11, v166, 2, 2
    v_and_b32 v12, 3, v166
    s_lshl_b32 s3, s29, 16
    v_lshl_add_u32 v13, v9, 3, v11
    v_lshlrev_b32 v13, 8, v13
    v_lshl_add_u32 v13, v11, 6, v13
    v_lshl_add_u32 v13, v10, 5, v13
    v_and_b32 v14, 1, v12
    v_lshl_add_u32 v13, v14, 4, v13
    v_lshrrev_b32 v14, 1, v12
    v_lshl_add_u32 v13, v14, 3, v13
    v_add_u32 v13, s3, v13
    v_xor_b32 v96, 0, v13
    v_xor_b32 v97, 64, v13
    v_xor_b32 v98, 128, v13
    v_xor_b32 v99, 192, v13
    v_bfe_u32 v13, v8, 2, 2
    v_xor_b32 v13, v13, v9
    v_lshlrev_b32 v13, 4, v13
    v_lshl_add_u32 v13, v8, 6, v13
    s_lshl_b32 s4, s30, 11
    s_add_u32 s5, s4, 16384
    s_add_u32 s6, s4, 147456
    s_cmp_ge_u32 s30, 4
    s_cselect_b32 s5, s6, s5
    v_add_u32 v100, s5, v13
    v_xor_b32 v101, 32, v100
    s_add_u32 s5, s4, 81920
    s_add_u32 s6, s4, 151552
    s_cmp_ge_u32 s30, 4
    s_cselect_b32 s5, s6, s5
    v_add_u32 v102, s5, v13
    v_xor_b32 v103, 32, v102
    s_add_u32 s5, s4, 131072
    v_add_u32 v104, s5, v13
    v_xor_b32 v105, 32, v104
    s_add_u32 s5, s4, 143360
    v_add_u32 v106, s5, v13
    v_xor_b32 v107, 32, v106
    s_cmp_ge_u32 s28, 8
    s_cbranch_scc1 K1_ROLE2
    s_cmp_ge_u32 s28, 4
    s_cbranch_scc1 K1_ROLE1
    s_add_u32 s48, s45, 8192
    s_add_u32 s47, s45, 16384
    s_add_u32 s49, s34, s41
    s_mov_b32 m0, s36
    s_nop 0
    buffer_load_dwordx4 v108, s[8:11], s49 offen lds
    s_add_u32 s41, s41, 64
    s_and_b32 s41, s41, 1023
    s_add_u32 s49, s33, s40
    s_add_u32 m0, s32, 40960
    s_nop 0
    buffer_load_dwordx4 v165, s[12:15], s49 offen lds
    s_add_u32 s49, s33, s40
    s_add_u32 s49, s49, 131072
    s_add_u32 m0, s32, 45056
    s_nop 0
    buffer_load_dwordx4 v165, s[12:15], s49 offen lds
    s_add_u32 s40, s40, 262144
    s_and_b32 s40, s40, 4194303
    s_add_u32 s49, s34, s41
    s_mov_b32 m0, s37
    s_nop 0
    buffer_load_dwordx4 v108, s[8:11], s49 offen lds
    s_add_u32 s41, s41, 64
    s_and_b32 s41, s41, 1023
    s_add_u32 s49, s33, s40
    s_add_u32 m0, s32, 49152
    s_nop 0
    buffer_load_dwordx4 v165, s[12:15], s49 offen lds
    s_add_u32 s49, s33, s40
    s_add_u32 s49, s49, 131072
    s_add_u32 m0, s32, 53248
    s_nop 0
    buffer_load_dwordx4 v165, s[12:15], s49 offen lds
    s_add_u32 s40, s40, 262144
    s_and_b32 s40, s40, 4194303
    s_add_u32 s49, s34, s41
    s_mov_b32 m0, s38
    s_nop 0
    buffer_load_dwordx4 v108, s[8:11], s49 offen lds
    s_add_u32 s41, s41, 64
    s_and_b32 s41, s41, 1023
    s_add_u32 s49, s33, s40
    s_add_u32 m0, s32, 24576
    s_nop 0
    buffer_load_dwordx4 v165, s[12:15], s49 offen lds
    s_add_u32 s49, s33, s40
    s_add_u32 s49, s49, 131072
    s_add_u32 m0, s32, 28672
    s_nop 0
    buffer_load_dwordx4 v165, s[12:15], s49 offen lds
    s_add_u32 s40, s40, 262144
    s_and_b32 s40, s40, 4194303
    s_add_u32 s49, s34, s41
    s_mov_b32 m0, s39
    s_nop 0
    buffer_load_dwordx4 v108, s[8:11], s49 offen lds
    s_add_u32 s41, s41, 64
    s_and_b32 s41, s41, 1023
    s_add_u32 s49, s33, s40
    s_add_u32 m0, s32, 57344
    s_nop 0
    buffer_load_dwordx4 v165, s[12:15], s49 offen lds
    s_add_u32 s49, s33, s40
    s_add_u32 s49, s49, 131072
    s_add_u32 m0, s32, 61440
    s_nop 0
    buffer_load_dwordx4 v165, s[12:15], s49 offen lds
    s_add_u32 s40, s40, 262144
    s_and_b32 s40, s40, 4194303
    s_waitcnt vmcnt(6) lgkmcnt(0)
    s_barrier
    ds_read_b128 v[144:147], v100 offset:0
    ds_read_b64_tr_b16 v[112:113], v96 offset:40960
    ds_read_b64_tr_b16 v[114:115], v96 offset:41984
    ds_read_b64_tr_b16 v[116:117], v97 offset:40960
    ds_read_b64_tr_b16 v[118:119], v97 offset:41984
    ds_read_b64_tr_b16 v[120:121], v98 offset:40960
    ds_read_b64_tr_b16 v[122:123], v98 offset:41984
    ds_read_b64_tr_b16 v[124:125], v99 offset:40960
    ds_read_b64_tr_b16 v[126:127], v99 offset:41984
    ds_read_b128 v[148:151], v101 offset:0
    ds_read_b64_tr_b16 v[128:129], v96 offset:45056
    ds_read_b64_tr_b16 v[130:131], v96 offset:46080
    ds_read_b64_tr_b16 v[132:133], v97 offset:45056
    ds_read_b64_tr_b16 v[134:135], v97 offset:46080
    ds_read_b64_tr_b16 v[136:137], v98 offset:45056
    ds_read_b64_tr_b16 v[138:139], v98 offset:46080
    ds_read_b64_tr_b16 v[140:141], v99 offset:45056
    ds_read_b64_tr_b16 v[142:143], v99 offset:46080
    s_waitcnt lgkmcnt(0)
    s_barrier
    v_mfma_f32_32x32x16_bf16 v[0:15], v[112:115], v[144:147], 0
    ds_read_b128 v[152:155], v102 offset:0
    ds_read_b64_tr_b16 v[64:65], v96 offset:49152
    ds_read_b64_tr_b16 v[66:67], v96 offset:50176
    s_add_u32 s49, s34, s41
    s_mov_b32 m0, s36
    s_nop 0
    buffer_load_dwordx4 v108, s[8:11], s49 offen lds
    s_add_u32 s41, s41, 64
    s_and_b32 s41, s41, 1023
    v_mfma_f32_32x32x16_bf16 v[16:31], v[116:119], v[144:147], 0
    ds_read_b64_tr_b16 v[68:69], v97 offset:49152
    ds_read_b64_tr_b16 v[70:71], v97 offset:50176
    ds_read_b64_tr_b16 v[72:73], v98 offset:49152
    v_mfma_f32_32x32x16_bf16 v[32:47], v[120:123], v[144:147], 0
    ds_read_b64_tr_b16 v[74:75], v98 offset:50176
    ds_read_b64_tr_b16 v[76:77], v99 offset:49152
    ds_read_b64_tr_b16 v[78:79], v99 offset:50176
    s_add_u32 s49, s33, s40
    s_add_u32 m0, s32, 40960
    s_nop 0
    buffer_load_dwordx4 v165, s[12:15], s49 offen lds
    v_mfma_f32_32x32x16_bf16 v[48:63], v[124:127], v[144:147], 0
    ds_read_b128 v[156:159], v103 offset:0
    ds_read_b64_tr_b16 v[80:81], v96 offset:53248
    ds_read_b64_tr_b16 v[82:83], v96 offset:54272
    v_mfma_f32_32x32x16_bf16 v[0:15], v[128:131], v[148:151], v[0:15]
    ds_read_b64_tr_b16 v[84:85], v97 offset:53248
    ds_read_b64_tr_b16 v[86:87], v97 offset:54272
    ds_read_b64_tr_b16 v[88:89], v98 offset:53248
    s_add_u32 s49, s33, s40
    s_add_u32 s49, s49, 131072
    s_add_u32 m0, s32, 45056
    s_nop 0
    buffer_load_dwordx4 v165, s[12:15], s49 offen lds
    s_add_u32 s40, s40, 262144
    s_and_b32 s40, s40, 4194303
    v_mfma_f32_32x32x16_bf16 v[16:31], v[132:135], v[148:151], v[16:31]
    ds_read_b64_tr_b16 v[90:91], v98 offset:54272
    ds_read_b64_tr_b16 v[92:93], v99 offset:53248
    ds_read_b64_tr_b16 v[94:95], v99 offset:54272
    v_mfma_f32_32x32x16_bf16 v[32:47], v[136:139], v[148:151], v[32:47]
    v_mfma_f32_32x32x16_bf16 v[48:63], v[140:143], v[148:151], v[48:63]
    s_waitcnt vmcnt(6) lgkmcnt(0)
    s_barrier
    v_mfma_f32_32x32x16_bf16 v[0:15], v[64:67], v[152:155], v[0:15]
    ds_read_b128 v[144:147], v104 offset:0
    ds_read_b64_tr_b16 v[112:113], v96 offset:24576
    ds_read_b64_tr_b16 v[114:115], v96 offset:25600
    s_add_u32 s49, s34, s41
    s_mov_b32 m0, s37
    s_nop 0
    buffer_load_dwordx4 v108, s[8:11], s49 offen lds
    s_add_u32 s41, s41, 64
    s_and_b32 s41, s41, 1023
    v_mfma_f32_32x32x16_bf16 v[16:31], v[68:71], v[152:155], v[16:31]
    ds_read_b64_tr_b16 v[116:117], v97 offset:24576
    ds_read_b64_tr_b16 v[118:119], v97 offset:25600
    ds_read_b64_tr_b16 v[120:121], v98 offset:24576
    v_mfma_f32_32x32x16_bf16 v[32:47], v[72:75], v[152:155], v[32:47]
    ds_read_b64_tr_b16 v[122:123], v98 offset:25600
    ds_read_b64_tr_b16 v[124:125], v99 offset:24576
    ds_read_b64_tr_b16 v[126:127], v99 offset:25600
    s_add_u32 s49, s33, s40
    s_add_u32 m0, s32, 49152
    s_nop 0
    buffer_load_dwordx4 v165, s[12:15], s49 offen lds
    v_mfma_f32_32x32x16_bf16 v[48:63], v[76:79], v[152:155], v[48:63]
    ds_read_b128 v[148:151], v105 offset:0
    ds_read_b64_tr_b16 v[128:129], v96 offset:28672
    ds_read_b64_tr_b16 v[130:131], v96 offset:29696
    v_mfma_f32_32x32x16_bf16 v[0:15], v[80:83], v[156:159], v[0:15]
    ds_read_b64_tr_b16 v[132:133], v97 offset:28672
    ds_read_b64_tr_b16 v[134:135], v97 offset:29696
    ds_read_b64_tr_b16 v[136:137], v98 offset:28672
    s_add_u32 s49, s33, s40
    s_add_u32 s49, s49, 131072
    s_add_u32 m0, s32, 53248
    s_nop 0
    buffer_load_dwordx4 v165, s[12:15], s49 offen lds
    s_add_u32 s40, s40, 262144
    s_and_b32 s40, s40, 4194303
    v_mfma_f32_32x32x16_bf16 v[16:31], v[84:87], v[156:159], v[16:31]
    ds_read_b64_tr_b16 v[138:139], v98 offset:29696
    ds_read_b64_tr_b16 v[140:141], v99 offset:28672
    ds_read_b64_tr_b16 v[142:143], v99 offset:29696
    v_mfma_f32_32x32x16_bf16 v[32:47], v[88:91], v[156:159], v[32:47]
    v_mfma_f32_32x32x16_bf16 v[48:63], v[92:95], v[156:159], v[48:63]
    s_waitcnt vmcnt(6) lgkmcnt(0)
    s_barrier
    v_mfma_f32_32x32x16_bf16 v[0:15], v[112:115], v[144:147], v[0:15]
    ds_read_b128 v[152:155], v106 offset:0
    ds_read_b64_tr_b16 v[64:65], v96 offset:57344
    ds_read_b64_tr_b16 v[66:67], v96 offset:58368
    s_add_u32 s49, s34, s41
    s_mov_b32 m0, s38
    s_nop 0
    buffer_load_dwordx4 v108, s[8:11], s49 offen lds
    s_add_u32 s41, s41, 64
    s_and_b32 s41, s41, 1023
    v_mfma_f32_32x32x16_bf16 v[16:31], v[116:119], v[144:147], v[16:31]
    ds_read_b64_tr_b16 v[68:69], v97 offset:57344
    ds_read_b64_tr_b16 v[70:71], v97 offset:58368
    ds_read_b64_tr_b16 v[72:73], v98 offset:57344
    v_mfma_f32_32x32x16_bf16 v[32:47], v[120:123], v[144:147], v[32:47]
    ds_read_b64_tr_b16 v[74:75], v98 offset:58368
    ds_read_b64_tr_b16 v[76:77], v99 offset:57344
    ds_read_b64_tr_b16 v[78:79], v99 offset:58368
    s_add_u32 s49, s33, s40
    s_add_u32 m0, s32, 24576
    s_nop 0
    buffer_load_dwordx4 v165, s[12:15], s49 offen lds
    v_mfma_f32_32x32x16_bf16 v[48:63], v[124:127], v[144:147], v[48:63]
    ds_read_b128 v[156:159], v107 offset:0
    ds_read_b64_tr_b16 v[80:81], v96 offset:61440
    ds_read_b64_tr_b16 v[82:83], v96 offset:62464
    v_mfma_f32_32x32x16_bf16 v[0:15], v[128:131], v[148:151], v[0:15]
    ds_read_b64_tr_b16 v[84:85], v97 offset:61440
    ds_read_b64_tr_b16 v[86:87], v97 offset:62464
    ds_read_b64_tr_b16 v[88:89], v98 offset:61440
    s_add_u32 s49, s33, s40
    s_add_u32 s49, s49, 131072
    s_add_u32 m0, s32, 28672
    s_nop 0
    buffer_load_dwordx4 v165, s[12:15], s49 offen lds
    s_add_u32 s40, s40, 262144
    s_and_b32 s40, s40, 4194303
    v_mfma_f32_32x32x16_bf16 v[16:31], v[132:135], v[148:151], v[16:31]
    ds_read_b64_tr_b16 v[90:91], v98 offset:62464
    ds_read_b64_tr_b16 v[92:93], v99 offset:61440
    ds_read_b64_tr_b16 v[94:95], v99 offset:62464
    v_mfma_f32_32x32x16_bf16 v[32:47], v[136:139], v[148:151], v[32:47]
    v_mfma_f32_32x32x16_bf16 v[48:63], v[140:143], v[148:151], v[48:63]
    s_waitcnt vmcnt(6) lgkmcnt(0)
    s_barrier
    v_mfma_f32_32x32x16_bf16 v[0:15], v[64:67], v[152:155], v[0:15]
    ds_read_b128 v[144:147], v100 offset:0
    ds_read_b64_tr_b16 v[112:113], v96 offset:40960
    ds_read_b64_tr_b16 v[114:115], v96 offset:41984
    s_add_u32 s49, s34, s41
    s_mov_b32 m0, s39
    s_nop 0
    buffer_load_dwordx4 v108, s[8:11], s49 offen lds
    s_add_u32 s41, s41, 64
    s_and_b32 s41, s41, 1023
    v_mfma_f32_32x32x16_bf16 v[16:31], v[68:71], v[152:155], v[16:31]
    ds_read_b64_tr_b16 v[116:117], v97 offset:40960
    ds_read_b64_tr_b16 v[118:119], v97 offset:41984
    ds_read_b64_tr_b16 v[120:121], v98 offset:40960
    v_mfma_f32_32x32x16_bf16 v[32:47], v[72:75], v[152:155], v[32:47]
    ds_read_b64_tr_b16 v[122:123], v98 offset:41984
    ds_read_b64_tr_b16 v[124:125], v99 offset:40960
    ds_read_b64_tr_b16 v[126:127], v99 offset:41984
    s_add_u32 s49, s33, s40
    s_add_u32 m0, s32, 57344
    s_nop 0
    buffer_load_dwordx4 v165, s[12:15], s49 offen lds
    v_mfma_f32_32x32x16_bf16 v[48:63], v[76:79], v[152:155], v[48:63]
    ds_read_b128 v[148:151], v101 offset:0
    ds_read_b64_tr_b16 v[128:129], v96 offset:45056
    ds_read_b64_tr_b16 v[130:131], v96 offset:46080
    v_mfma_f32_32x32x16_bf16 v[0:15], v[80:83], v[156:159], v[0:15]
    ds_read_b64_tr_b16 v[132:133], v97 offset:45056
    ds_read_b64_tr_b16 v[134:135], v97 offset:46080
    ds_read_b64_tr_b16 v[136:137], v98 offset:45056
    s_add_u32 s49, s33, s40
    s_add_u32 s49, s49, 131072
    s_add_u32 m0, s32, 61440
    s_nop 0
    buffer_load_dwordx4 v165, s[12:15], s49 offen lds
    s_add_u32 s40, s40, 262144
    s_and_b32 s40, s40, 4194303
    v_mfma_f32_32x32x16_bf16 v[16:31], v[84:87], v[156:159], v[16:31]
    ds_read_b64_tr_b16 v[138:139], v98 offset:46080
    ds_read_b64_tr_b16 v[140:141], v99 offset:45056
    ds_read_b64_tr_b16 v[142:143], v99 offset:46080
    v_mfma_f32_32x32x16_bf16 v[32:47], v[88:91], v[156:159], v[32:47]
    v_mfma_f32_32x32x16_bf16 v[48:63], v[92:95], v[156:159], v[48:63]
    s_waitcnt vmcnt(6) lgkmcnt(0)
    s_barrier
    v_mfma_f32_32x32x16_bf16 v[0:15], v[112:115], v[144:147], v[0:15]
    ds_read_b128 v[152:155], v102 offset:0
    ds_read_b64_tr_b16 v[64:65], v96 offset:49152
    ds_read_b64_tr_b16 v[66:67], v96 offset:50176
    s_add_u32 s49, s34, s41
    s_mov_b32 m0, s36
    s_nop 0
    buffer_load_dwordx4 v108, s[8:11], s49 offen lds
    s_add_u32 s41, s41, 64
    s_and_b32 s41, s41, 1023
    v_mfma_f32_32x32x16_bf16 v[16:31], v[116:119], v[144:147], v[16:31]
    ds_read_b64_tr_b16 v[68:69], v97 offset:49152
    ds_read_b64_tr_b16 v[70:71], v97 offset:50176
    ds_read_b64_tr_b16 v[72:73], v98 offset:49152
    v_mfma_f32_32x32x16_bf16 v[32:47], v[120:123], v[144:147], v[32:47]
    ds_read_b64_tr_b16 v[74:75], v98 offset:50176
    ds_read_b64_tr_b16 v[76:77], v99 offset:49152
    ds_read_b64_tr_b16 v[78:79], v99 offset:50176
    s_add_u32 s49, s33, s40
    s_add_u32 m0, s32, 40960
    s_nop 0
    buffer_load_dwordx4 v165, s[12:15], s49 offen lds
    v_mfma_f32_32x32x16_bf16 v[48:63], v[124:127], v[144:147], v[48:63]
    ds_read_b128 v[156:159], v103 offset:0
    ds_read_b64_tr_b16 v[80:81], v96 offset:53248
    ds_read_b64_tr_b16 v[82:83], v96 offset:54272
    v_mfma_f32_32x32x16_bf16 v[0:15], v[128:131], v[148:151], v[0:15]
    ds_read_b64_tr_b16 v[84:85], v97 offset:53248
    ds_read_b64_tr_b16 v[86:87], v97 offset:54272
    ds_read_b64_tr_b16 v[88:89], v98 offset:53248
    s_add_u32 s49, s33, s40
    s_add_u32 s49, s49, 131072
    s_add_u32 m0, s32, 45056
    s_nop 0
    buffer_load_dwordx4 v165, s[12:15], s49 offen lds
    s_add_u32 s40, s40, 262144
    s_and_b32 s40, s40, 4194303
    v_mfma_f32_32x32x16_bf16 v[16:31], v[132:135], v[148:151], v[16:31]
    ds_read_b64_tr_b16 v[90:91], v98 offset:54272
    ds_read_b64_tr_b16 v[92:93], v99 offset:53248
    ds_read_b64_tr_b16 v[94:95], v99 offset:54272
    v_mfma_f32_32x32x16_bf16 v[32:47], v[136:139], v[148:151], v[32:47]
    v_mfma_f32_32x32x16_bf16 v[48:63], v[140:143], v[148:151], v[48:63]
    s_waitcnt vmcnt(6) lgkmcnt(0)
    s_barrier
    v_mfma_f32_32x32x16_bf16 v[0:15], v[64:67], v[152:155], v[0:15]
    ds_read_b128 v[144:147], v104 offset:0
    ds_read_b64_tr_b16 v[112:113], v96 offset:24576
    ds_read_b64_tr_b16 v[114:115], v96 offset:25600
    s_add_u32 s49, s34, s41
    s_mov_b32 m0, s37
    s_nop 0
    buffer_load_dwordx4 v108, s[8:11], s49 offen lds
    s_add_u32 s41, s41, 64
    s_and_b32 s41, s41, 1023
    v_mfma_f32_32x32x16_bf16 v[16:31], v[68:71], v[152:155], v[16:31]
    ds_read_b64_tr_b16 v[116:117], v97 offset:24576
    ds_read_b64_tr_b16 v[118:119], v97 offset:25600
    ds_read_b64_tr_b16 v[120:121], v98 offset:24576
    v_mfma_f32_32x32x16_bf16 v[32:47], v[72:75], v[152:155], v[32:47]
    ds_read_b64_tr_b16 v[122:123], v98 offset:25600
    ds_read_b64_tr_b16 v[124:125], v99 offset:24576
    ds_read_b64_tr_b16 v[126:127], v99 offset:25600
    s_add_u32 s49, s33, s40
    s_add_u32 m0, s32, 49152
    s_nop 0
    buffer_load_dwordx4 v165, s[12:15], s49 offen lds
    v_mfma_f32_32x32x16_bf16 v[48:63], v[76:79], v[152:155], v[48:63]
    ds_read_b128 v[148:151], v105 offset:0
    ds_read_b64_tr_b16 v[128:129], v96 offset:28672
    ds_read_b64_tr_b16 v[130:131], v96 offset:29696
    v_mfma_f32_32x32x16_bf16 v[0:15], v[80:83], v[156:159], v[0:15]
    ds_read_b64_tr_b16 v[132:133], v97 offset:28672
    ds_read_b64_tr_b16 v[134:135], v97 offset:29696
    ds_read_b64_tr_b16 v[136:137], v98 offset:28672
    s_add_u32 s49, s33, s40
    s_add_u32 s49, s49, 131072
    s_add_u32 m0, s32, 53248
    s_nop 0
    buffer_load_dwordx4 v165, s[12:15], s49 offen lds
    s_add_u32 s40, s40, 262144
    s_and_b32 s40, s40, 4194303
    v_mfma_f32_32x32x16_bf16 v[16:31], v[84:87], v[156:159], v[16:31]
    ds_read_b64_tr_b16 v[138:139], v98 offset:29696
    ds_read_b64_tr_b16 v[140:141], v99 offset:28672
    ds_read_b64_tr_b16 v[142:143], v99 offset:29696
    v_mfma_f32_32x32x16_bf16 v[32:47], v[88:91], v[156:159], v[32:47]
    v_mfma_f32_32x32x16_bf16 v[48:63], v[92:95], v[156:159], v[48:63]
    s_waitcnt vmcnt(6) lgkmcnt(0)
    s_barrier
    v_mfma_f32_32x32x16_bf16 v[0:15], v[112:115], v[144:147], v[0:15]
    ds_read_b128 v[152:155], v106 offset:0
    ds_read_b64_tr_b16 v[64:65], v96 offset:57344
    ds_read_b64_tr_b16 v[66:67], v96 offset:58368
    s_add_u32 s49, s34, s41
    s_mov_b32 m0, s38
    s_nop 0
    buffer_load_dwordx4 v108, s[8:11], s49 offen lds
    s_add_u32 s41, s41, 64
    s_and_b32 s41, s41, 1023
    v_mfma_f32_32x32x16_bf16 v[16:31], v[116:119], v[144:147], v[16:31]
    ds_read_b64_tr_b16 v[68:69], v97 offset:57344
    ds_read_b64_tr_b16 v[70:71], v97 offset:58368
    ds_read_b64_tr_b16 v[72:73], v98 offset:57344
    v_mfma_f32_32x32x16_bf16 v[32:47], v[120:123], v[144:147], v[32:47]
    ds_read_b64_tr_b16 v[74:75], v98 offset:58368
    ds_read_b64_tr_b16 v[76:77], v99 offset:57344
    ds_read_b64_tr_b16 v[78:79], v99 offset:58368
    s_add_u32 s49, s33, s40
    s_add_u32 m0, s32, 24576
    s_nop 0
    buffer_load_dwordx4 v165, s[12:15], s49 offen lds
    v_mfma_f32_32x32x16_bf16 v[48:63], v[124:127], v[144:147], v[48:63]
    ds_read_b128 v[156:159], v107 offset:0
    ds_read_b64_tr_b16 v[80:81], v96 offset:61440
    ds_read_b64_tr_b16 v[82:83], v96 offset:62464
    v_mfma_f32_32x32x16_bf16 v[0:15], v[128:131], v[148:151], v[0:15]
    ds_read_b64_tr_b16 v[84:85], v97 offset:61440
    ds_read_b64_tr_b16 v[86:87], v97 offset:62464
    ds_read_b64_tr_b16 v[88:89], v98 offset:61440
    s_add_u32 s49, s33, s40
    s_add_u32 s49, s49, 131072
    s_add_u32 m0, s32, 28672
    s_nop 0
    buffer_load_dwordx4 v165, s[12:15], s49 offen lds
    s_add_u32 s40, s40, 262144
    s_and_b32 s40, s40, 4194303
    v_mfma_f32_32x32x16_bf16 v[16:31], v[132:135], v[148:151], v[16:31]
    ds_read_b64_tr_b16 v[90:91], v98 offset:62464
    ds_read_b64_tr_b16 v[92:93], v99 offset:61440
    ds_read_b64_tr_b16 v[94:95], v99 offset:62464
    v_mfma_f32_32x32x16_bf16 v[32:47], v[136:139], v[148:151], v[32:47]
    v_mfma_f32_32x32x16_bf16 v[48:63], v[140:143], v[148:151], v[48:63]
    s_waitcnt vmcnt(6) lgkmcnt(0)
    s_barrier
    v_mfma_f32_32x32x16_bf16 v[0:15], v[64:67], v[152:155], v[0:15]
    ds_read_b128 v[144:147], v100 offset:0
    ds_read_b64_tr_b16 v[112:113], v96 offset:40960
    ds_read_b64_tr_b16 v[114:115], v96 offset:41984
    s_add_u32 s49, s34, s41
    s_mov_b32 m0, s39
    s_nop 0
    buffer_load_dwordx4 v108, s[8:11], s49 offen lds
    s_add_u32 s41, s41, 64
    s_and_b32 s41, s41, 1023
    v_mfma_f32_32x32x16_bf16 v[16:31], v[68:71], v[152:155], v[16:31]
    ds_read_b64_tr_b16 v[116:117], v97 offset:40960
    ds_read_b64_tr_b16 v[118:119], v97 offset:41984
    ds_read_b64_tr_b16 v[120:121], v98 offset:40960
    v_mfma_f32_32x32x16_bf16 v[32:47], v[72:75], v[152:155], v[32:47]
    ds_read_b64_tr_b16 v[122:123], v98 offset:41984
    ds_read_b64_tr_b16 v[124:125], v99 offset:40960
    ds_read_b64_tr_b16 v[126:127], v99 offset:41984
    s_add_u32 s49, s33, s40
    s_add_u32 m0, s32, 57344
    s_nop 0
    buffer_load_dwordx4 v165, s[12:15], s49 offen lds
    v_mfma_f32_32x32x16_bf16 v[48:63], v[76:79], v[152:155], v[48:63]
    ds_read_b128 v[148:151], v101 offset:0
    ds_read_b64_tr_b16 v[128:129], v96 offset:45056
    ds_read_b64_tr_b16 v[130:131], v96 offset:46080
    v_mfma_f32_32x32x16_bf16 v[0:15], v[80:83], v[156:159], v[0:15]
    ds_read_b64_tr_b16 v[132:133], v97 offset:45056
    ds_read_b64_tr_b16 v[134:135], v97 offset:46080
    ds_read_b64_tr_b16 v[136:137], v98 offset:45056
    s_add_u32 s49, s33, s40
    s_add_u32 s49, s49, 131072
    s_add_u32 m0, s32, 61440
    s_nop 0
    buffer_load_dwordx4 v165, s[12:15], s49 offen lds
    s_add_u32 s40, s40, 262144
    s_and_b32 s40, s40, 4194303
    v_mfma_f32_32x32x16_bf16 v[16:31], v[84:87], v[156:159], v[16:31]
    ds_read_b64_tr_b16 v[138:139], v98 offset:46080
    ds_read_b64_tr_b16 v[140:141], v99 offset:45056
    ds_read_b64_tr_b16 v[142:143], v99 offset:46080
    v_mfma_f32_32x32x16_bf16 v[32:47], v[88:91], v[156:159], v[32:47]
    v_mfma_f32_32x32x16_bf16 v[48:63], v[92:95], v[156:159], v[48:63]
    s_waitcnt vmcnt(6) lgkmcnt(0)
    s_barrier
    v_mfma_f32_32x32x16_bf16 v[0:15], v[112:115], v[144:147], v[0:15]
    ds_read_b128 v[152:155], v102 offset:0
    ds_read_b64_tr_b16 v[64:65], v96 offset:49152
    ds_read_b64_tr_b16 v[66:67], v96 offset:50176
    s_add_u32 s49, s34, s41
    s_mov_b32 m0, s36
    s_nop 0
    buffer_load_dwordx4 v108, s[8:11], s49 offen lds
    s_add_u32 s41, s41, 64
    s_and_b32 s41, s41, 1023
    v_mfma_f32_32x32x16_bf16 v[16:31], v[116:119], v[144:147], v[16:31]
    ds_read_b64_tr_b16 v[68:69], v97 offset:49152
    ds_read_b64_tr_b16 v[70:71], v97 offset:50176
    ds_read_b64_tr_b16 v[72:73], v98 offset:49152
    v_mfma_f32_32x32x16_bf16 v[32:47], v[120:123], v[144:147], v[32:47]
    ds_read_b64_tr_b16 v[74:75], v98 offset:50176
    ds_read_b64_tr_b16 v[76:77], v99 offset:49152
    ds_read_b64_tr_b16 v[78:79], v99 offset:50176
    s_add_u32 s49, s33, s40
    s_add_u32 m0, s32, 40960
    s_nop 0
    buffer_load_dwordx4 v165, s[12:15], s49 offen lds
    v_mfma_f32_32x32x16_bf16 v[48:63], v[124:127], v[144:147], v[48:63]
    ds_read_b128 v[156:159], v103 offset:0
    ds_read_b64_tr_b16 v[80:81], v96 offset:53248
    ds_read_b64_tr_b16 v[82:83], v96 offset:54272
    v_mfma_f32_32x32x16_bf16 v[0:15], v[128:131], v[148:151], v[0:15]
    ds_read_b64_tr_b16 v[84:85], v97 offset:53248
    ds_read_b64_tr_b16 v[86:87], v97 offset:54272
    ds_read_b64_tr_b16 v[88:89], v98 offset:53248
    s_add_u32 s49, s33, s40
    s_add_u32 s49, s49, 131072
    s_add_u32 m0, s32, 45056
    s_nop 0
    buffer_load_dwordx4 v165, s[12:15], s49 offen lds
    s_add_u32 s40, s40, 262144
    s_and_b32 s40, s40, 4194303
    v_mfma_f32_32x32x16_bf16 v[16:31], v[132:135], v[148:151], v[16:31]
    ds_read_b64_tr_b16 v[90:91], v98 offset:54272
    ds_read_b64_tr_b16 v[92:93], v99 offset:53248
    ds_read_b64_tr_b16 v[94:95], v99 offset:54272
    v_mfma_f32_32x32x16_bf16 v[32:47], v[136:139], v[148:151], v[32:47]
    v_mfma_f32_32x32x16_bf16 v[48:63], v[140:143], v[148:151], v[48:63]
    s_waitcnt vmcnt(6) lgkmcnt(0)
    s_barrier
    v_mfma_f32_32x32x16_bf16 v[0:15], v[64:67], v[152:155], v[0:15]
    ds_read_b128 v[144:147], v104 offset:0
    ds_read_b64_tr_b16 v[112:113], v96 offset:24576
    ds_read_b64_tr_b16 v[114:115], v96 offset:25600
    s_add_u32 s49, s34, s41
    s_mov_b32 m0, s37
    s_nop 0
    buffer_load_dwordx4 v108, s[8:11], s49 offen lds
    s_add_u32 s41, s41, 64
    s_and_b32 s41, s41, 1023
    v_mfma_f32_32x32x16_bf16 v[16:31], v[68:71], v[152:155], v[16:31]
    ds_read_b64_tr_b16 v[116:117], v97 offset:24576
    ds_read_b64_tr_b16 v[118:119], v97 offset:25600
    ds_read_b64_tr_b16 v[120:121], v98 offset:24576
    v_mfma_f32_32x32x16_bf16 v[32:47], v[72:75], v[152:155], v[32:47]
    ds_read_b64_tr_b16 v[122:123], v98 offset:25600
    ds_read_b64_tr_b16 v[124:125], v99 offset:24576
    ds_read_b64_tr_b16 v[126:127], v99 offset:25600
    s_add_u32 s49, s33, s40
    s_add_u32 m0, s32, 49152
    s_nop 0
    buffer_load_dwordx4 v165, s[12:15], s49 offen lds
    v_mfma_f32_32x32x16_bf16 v[48:63], v[76:79], v[152:155], v[48:63]
    ds_read_b128 v[148:151], v105 offset:0
    ds_read_b64_tr_b16 v[128:129], v96 offset:28672
    ds_read_b64_tr_b16 v[130:131], v96 offset:29696
    v_mfma_f32_32x32x16_bf16 v[0:15], v[80:83], v[156:159], v[0:15]
    ds_read_b64_tr_b16 v[132:133], v97 offset:28672
    ds_read_b64_tr_b16 v[134:135], v97 offset:29696
    ds_read_b64_tr_b16 v[136:137], v98 offset:28672
    s_add_u32 s49, s33, s40
    s_add_u32 s49, s49, 131072
    s_add_u32 m0, s32, 53248
    s_nop 0
    buffer_load_dwordx4 v165, s[12:15], s49 offen lds
    s_add_u32 s40, s40, 262144
    s_and_b32 s40, s40, 4194303
    v_mfma_f32_32x32x16_bf16 v[16:31], v[84:87], v[156:159], v[16:31]
    ds_read_b64_tr_b16 v[138:139], v98 offset:29696
    ds_read_b64_tr_b16 v[140:141], v99 offset:28672
    ds_read_b64_tr_b16 v[142:143], v99 offset:29696
    v_mfma_f32_32x32x16_bf16 v[32:47], v[88:91], v[156:159], v[32:47]
    v_mfma_f32_32x32x16_bf16 v[48:63], v[92:95], v[156:159], v[48:63]
    s_waitcnt vmcnt(6) lgkmcnt(0)
    s_barrier
    v_mfma_f32_32x32x16_bf16 v[0:15], v[112:115], v[144:147], v[0:15]
    ds_read_b128 v[152:155], v106 offset:0
    ds_read_b64_tr_b16 v[64:65], v96 offset:57344
    ds_read_b64_tr_b16 v[66:67], v96 offset:58368
    s_add_u32 s49, s34, s41
    s_mov_b32 m0, s38
    s_nop 0
    buffer_load_dwordx4 v108, s[8:11], s49 offen lds
    s_add_u32 s41, s41, 64
    s_and_b32 s41, s41, 1023
    v_mfma_f32_32x32x16_bf16 v[16:31], v[116:119], v[144:147], v[16:31]
    ds_read_b64_tr_b16 v[68:69], v97 offset:57344
    ds_read_b64_tr_b16 v[70:71], v97 offset:58368
    ds_read_b64_tr_b16 v[72:73], v98 offset:57344
    v_mfma_f32_32x32x16_bf16 v[32:47], v[120:123], v[144:147], v[32:47]
    ds_read_b64_tr_b16 v[74:75], v98 offset:58368
    ds_read_b64_tr_b16 v[76:77], v99 offset:57344
    ds_read_b64_tr_b16 v[78:79], v99 offset:58368
    s_add_u32 s49, s33, s40
    s_add_u32 m0, s32, 24576
    s_nop 0
    buffer_load_dwordx4 v165, s[12:15], s49 offen lds
    v_mfma_f32_32x32x16_bf16 v[48:63], v[124:127], v[144:147], v[48:63]
    ds_read_b128 v[156:159], v107 offset:0
    ds_read_b64_tr_b16 v[80:81], v96 offset:61440
    ds_read_b64_tr_b16 v[82:83], v96 offset:62464
    v_mfma_f32_32x32x16_bf16 v[0:15], v[128:131], v[148:151], v[0:15]
    ds_read_b64_tr_b16 v[84:85], v97 offset:61440
    ds_read_b64_tr_b16 v[86:87], v97 offset:62464
    ds_read_b64_tr_b16 v[88:89], v98 offset:61440
    s_add_u32 s49, s33, s40
    s_add_u32 s49, s49, 131072
    s_add_u32 m0, s32, 28672
    s_nop 0
    buffer_load_dwordx4 v165, s[12:15], s49 offen lds
    s_add_u32 s40, s40, 262144
    s_and_b32 s40, s40, 4194303
    v_mfma_f32_32x32x16_bf16 v[16:31], v[132:135], v[148:151], v[16:31]
    ds_read_b64_tr_b16 v[90:91], v98 offset:62464
    ds_read_b64_tr_b16 v[92:93], v99 offset:61440
    ds_read_b64_tr_b16 v[94:95], v99 offset:62464
    v_mfma_f32_32x32x16_bf16 v[32:47], v[136:139], v[148:151], v[32:47]
    v_mfma_f32_32x32x16_bf16 v[48:63], v[140:143], v[148:151], v[48:63]
    s_waitcnt vmcnt(6) lgkmcnt(0)
    s_barrier
    v_mfma_f32_32x32x16_bf16 v[0:15], v[64:67], v[152:155], v[0:15]
    ds_read_b128 v[144:147], v100 offset:0
    ds_read_b64_tr_b16 v[112:113], v96 offset:40960
    ds_read_b64_tr_b16 v[114:115], v96 offset:41984
    s_add_u32 s49, s34, s41
    s_mov_b32 m0, s39
    s_nop 0
    buffer_load_dwordx4 v108, s[8:11], s49 offen lds
    s_add_u32 s41, s41, 64
    s_and_b32 s41, s41, 1023
    v_mfma_f32_32x32x16_bf16 v[16:31], v[68:71], v[152:155], v[16:31]
    ds_read_b64_tr_b16 v[116:117], v97 offset:40960
    ds_read_b64_tr_b16 v[118:119], v97 offset:41984
    ds_read_b64_tr_b16 v[120:121], v98 offset:40960
    v_mfma_f32_32x32x16_bf16 v[32:47], v[72:75], v[152:155], v[32:47]
    ds_read_b64_tr_b16 v[122:123], v98 offset:41984
    ds_read_b64_tr_b16 v[124:125], v99 offset:40960
    ds_read_b64_tr_b16 v[126:127], v99 offset:41984
    s_add_u32 s49, s33, s40
    s_add_u32 m0, s32, 57344
    s_nop 0
    buffer_load_dwordx4 v165, s[12:15], s49 offen lds
    v_mfma_f32_32x32x16_bf16 v[48:63], v[76:79], v[152:155], v[48:63]
    ds_read_b128 v[148:151], v101 offset:0
    ds_read_b64_tr_b16 v[128:129], v96 offset:45056
    ds_read_b64_tr_b16 v[130:131], v96 offset:46080
    v_mfma_f32_32x32x16_bf16 v[0:15], v[80:83], v[156:159], v[0:15]
    ds_read_b64_tr_b16 v[132:133], v97 offset:45056
    ds_read_b64_tr_b16 v[134:135], v97 offset:46080
    ds_read_b64_tr_b16 v[136:137], v98 offset:45056
    s_add_u32 s49, s33, s40
    s_add_u32 s49, s49, 131072
    s_add_u32 m0, s32, 61440
    s_nop 0
    buffer_load_dwordx4 v165, s[12:15], s49 offen lds
    s_add_u32 s40, s40, 262144
    s_and_b32 s40, s40, 4194303
    v_mfma_f32_32x32x16_bf16 v[16:31], v[84:87], v[156:159], v[16:31]
    ds_read_b64_tr_b16 v[138:139], v98 offset:46080
    ds_read_b64_tr_b16 v[140:141], v99 offset:45056
    ds_read_b64_tr_b16 v[142:143], v99 offset:46080
    v_mfma_f32_32x32x16_bf16 v[32:47], v[88:91], v[156:159], v[32:47]
    v_mfma_f32_32x32x16_bf16 v[48:63], v[92:95], v[156:159], v[48:63]
    s_waitcnt vmcnt(6) lgkmcnt(0)
    s_barrier
    v_mfma_f32_32x32x16_bf16 v[0:15], v[112:115], v[144:147], v[0:15]
    ds_read_b128 v[152:155], v102 offset:0
    ds_read_b64_tr_b16 v[64:65], v96 offset:49152
    ds_read_b64_tr_b16 v[66:67], v96 offset:50176
    s_add_u32 m0, s46, 40960
    s_add_u32 s49, s48, 0
    buffer_load_dwordx4 v164, s[20:23], s49 offen nt lds
    v_mfma_f32_32x32x16_bf16 v[16:31], v[116:119], v[144:147], v[16:31]
    ds_read_b64_tr_b16 v[68:69], v97 offset:49152
    ds_read_b64_tr_b16 v[70:71], v97 offset:50176
    ds_read_b64_tr_b16 v[72:73], v98 offset:49152
    v_mfma_f32_32x32x16_bf16 v[32:47], v[120:123], v[144:147], v[32:47]
    ds_read_b64_tr_b16 v[74:75], v98 offset:50176
    ds_read_b64_tr_b16 v[76:77], v99 offset:49152
    ds_read_b64_tr_b16 v[78:79], v99 offset:50176
    s_add_u32 m0, s46, 45056
    s_add_u32 s49, s48, 4096
    buffer_load_dwordx4 v164, s[20:23], s49 offen nt lds
    s_add_u32 s48, s48, 8192
    v_mfma_f32_32x32x16_bf16 v[48:63], v[124:127], v[144:147], v[48:63]
    ds_read_b128 v[156:159], v103 offset:0
    ds_read_b64_tr_b16 v[80:81], v96 offset:53248
    ds_read_b64_tr_b16 v[82:83], v96 offset:54272
    v_mfma_f32_32x32x16_bf16 v[0:15], v[128:131], v[148:151], v[0:15]
    ds_read_b64_tr_b16 v[84:85], v97 offset:53248
    ds_read_b64_tr_b16 v[86:87], v97 offset:54272
    ds_read_b64_tr_b16 v[88:89], v98 offset:53248
    v_mfma_f32_32x32x16_bf16 v[16:31], v[132:135], v[148:151], v[16:31]
    ds_read_b64_tr_b16 v[90:91], v98 offset:54272
    ds_read_b64_tr_b16 v[92:93], v99 offset:53248
    ds_read_b64_tr_b16 v[94:95], v99 offset:54272
    v_mfma_f32_32x32x16_bf16 v[32:47], v[136:139], v[148:151], v[32:47]
    v_mfma_f32_32x32x16_bf16 v[48:63], v[140:143], v[148:151], v[48:63]
    s_waitcnt vmcnt(5) lgkmcnt(0)
    s_barrier
    v_mfma_f32_32x32x16_bf16 v[0:15], v[64:67], v[152:155], v[0:15]
    ds_read_b128 v[144:147], v104 offset:0
    ds_read_b64_tr_b16 v[112:113], v96 offset:24576
    ds_read_b64_tr_b16 v[114:115], v96 offset:25600
    s_add_u32 m0, s46, 16384
    s_add_u32 s49, s47, 0
    buffer_load_dwordx4 v163, s[16:19], s49 offen nt lds
    v_mfma_f32_32x32x16_bf16 v[16:31], v[68:71], v[152:155], v[16:31]
    ds_read_b64_tr_b16 v[116:117], v97 offset:24576
    ds_read_b64_tr_b16 v[118:119], v97 offset:25600
    ds_read_b64_tr_b16 v[120:121], v98 offset:24576
    v_mfma_f32_32x32x16_bf16 v[32:47], v[72:75], v[152:155], v[32:47]
    ds_read_b64_tr_b16 v[122:123], v98 offset:25600
    ds_read_b64_tr_b16 v[124:125], v99 offset:24576
    ds_read_b64_tr_b16 v[126:127], v99 offset:25600
    s_add_u32 m0, s46, 20480
    s_add_u32 s49, s47, 4096
    buffer_load_dwordx4 v163, s[16:19], s49 offen nt lds
    s_add_u32 s47, s47, 8192
    v_mfma_f32_32x32x16_bf16 v[48:63], v[76:79], v[152:155], v[48:63]
    ds_read_b128 v[148:151], v105 offset:0
    ds_read_b64_tr_b16 v[128:129], v96 offset:28672
    ds_read_b64_tr_b16 v[130:131], v96 offset:29696
    v_mfma_f32_32x32x16_bf16 v[0:15], v[80:83], v[156:159], v[0:15]
    ds_read_b64_tr_b16 v[132:133], v97 offset:28672
    ds_read_b64_tr_b16 v[134:135], v97 offset:29696
    ds_read_b64_tr_b16 v[136:137], v98 offset:28672
    s_add_u32 m0, s46, 49152
    s_add_u32 s49, s48, 0
    buffer_load_dwordx4 v164, s[20:23], s49 offen nt lds
    v_mfma_f32_32x32x16_bf16 v[16:31], v[84:87], v[156:159], v[16:31]
    ds_read_b64_tr_b16 v[138:139], v98 offset:29696
    ds_read_b64_tr_b16 v[140:141], v99 offset:28672
    ds_read_b64_tr_b16 v[142:143], v99 offset:29696
    v_mfma_f32_32x32x16_bf16 v[32:47], v[88:91], v[156:159], v[32:47]
    s_add_u32 m0, s46, 53248
    s_add_u32 s49, s48, 4096
    buffer_load_dwordx4 v164, s[20:23], s49 offen nt lds
    s_add_u32 s48, s48, 8192
    v_mfma_f32_32x32x16_bf16 v[48:63], v[92:95], v[156:159], v[48:63]
    s_waitcnt vmcnt(6) lgkmcnt(0)
    s_barrier
    v_mfma_f32_32x32x16_bf16 v[0:15], v[112:115], v[144:147], v[0:15]
    ds_read_b128 v[152:155], v106 offset:0
    ds_read_b64_tr_b16 v[64:65], v96 offset:57344
    ds_read_b64_tr_b16 v[66:67], v96 offset:58368
    v_mfma_f32_32x32x16_bf16 v[16:31], v[116:119], v[144:147], v[16:31]
    ds_read_b64_tr_b16 v[68:69], v97 offset:57344
    ds_read_b64_tr_b16 v[70:71], v97 offset:58368
    ds_read_b64_tr_b16 v[72:73], v98 offset:57344
    v_mfma_f32_32x32x16_bf16 v[32:47], v[120:123], v[144:147], v[32:47]
    ds_read_b64_tr_b16 v[74:75], v98 offset:58368
    ds_read_b64_tr_b16 v[76:77], v99 offset:57344
    ds_read_b64_tr_b16 v[78:79], v99 offset:58368
    v_mfma_f32_32x32x16_bf16 v[48:63], v[124:127], v[144:147], v[48:63]
    ds_read_b128 v[156:159], v107 offset:0
    ds_read_b64_tr_b16 v[80:81], v96 offset:61440
    ds_read_b64_tr_b16 v[82:83], v96 offset:62464
    v_mfma_f32_32x32x16_bf16 v[0:15], v[128:131], v[148:151], v[0:15]
    ds_read_b64_tr_b16 v[84:85], v97 offset:61440
    ds_read_b64_tr_b16 v[86:87], v97 offset:62464
    ds_read_b64_tr_b16 v[88:89], v98 offset:61440
    v_mfma_f32_32x32x16_bf16 v[16:31], v[132:135], v[148:151], v[16:31]
    ds_read_b64_tr_b16 v[90:91], v98 offset:62464
    ds_read_b64_tr_b16 v[92:93], v99 offset:61440
    ds_read_b64_tr_b16 v[94:95], v99 offset:62464
    v_mfma_f32_32x32x16_bf16 v[32:47], v[136:139], v[148:151], v[32:47]
    v_mfma_f32_32x32x16_bf16 v[48:63], v[140:143], v[148:151], v[48:63]
    s_waitcnt lgkmcnt(0)
    s_barrier
    v_mfma_f32_32x32x16_bf16 v[0:15], v[64:67], v[152:155], v[0:15]
    v_mfma_f32_32x32x16_bf16 v[16:31], v[68:71], v[152:155], v[16:31]
    v_mfma_f32_32x32x16_bf16 v[32:47], v[72:75], v[152:155], v[32:47]
    v_mfma_f32_32x32x16_bf16 v[48:63], v[76:79], v[152:155], v[48:63]
    v_mfma_f32_32x32x16_bf16 v[0:15], v[80:83], v[156:159], v[0:15]
    v_mfma_f32_32x32x16_bf16 v[16:31], v[84:87], v[156:159], v[16:31]
    v_mfma_f32_32x32x16_bf16 v[32:47], v[88:91], v[156:159], v[32:47]
    v_mfma_f32_32x32x16_bf16 v[48:63], v[92:95], v[156:159], v[48:63]
    s_waitcnt lgkmcnt(0)
    s_nop 7
    v_cvt_pk_bf16_f32 v64, v0, v1
    v_cvt_pk_bf16_f32 v65, v2, v3
    v_cvt_pk_bf16_f32 v66, v4, v5
    v_cvt_pk_bf16_f32 v67, v6, v7
    v_cvt_pk_bf16_f32 v68, v8, v9
    v_cvt_pk_bf16_f32 v69, v10, v11
    v_cvt_pk_bf16_f32 v70, v12, v13
    v_cvt_pk_bf16_f32 v71, v14, v15
    v_cvt_pk_bf16_f32 v72, v16, v17
    v_cvt_pk_bf16_f32 v73, v18, v19
    v_cvt_pk_bf16_f32 v74, v20, v21
    v_cvt_pk_bf16_f32 v75, v22, v23
    v_cvt_pk_bf16_f32 v76, v24, v25
    v_cvt_pk_bf16_f32 v77, v26, v27
    v_cvt_pk_bf16_f32 v78, v28, v29
    v_cvt_pk_bf16_f32 v79, v30, v31
    v_cvt_pk_bf16_f32 v80, v32, v33
    v_cvt_pk_bf16_f32 v81, v34, v35
    v_cvt_pk_bf16_f32 v82, v36, v37
    v_cvt_pk_bf16_f32 v83, v38, v39
    v_cvt_pk_bf16_f32 v84, v40, v41
    v_cvt_pk_bf16_f32 v85, v42, v43
    v_cvt_pk_bf16_f32 v86, v44, v45
    v_cvt_pk_bf16_f32 v87, v46, v47
    v_cvt_pk_bf16_f32 v88, v48, v49
    v_cvt_pk_bf16_f32 v89, v50, v51
    v_cvt_pk_bf16_f32 v90, v52, v53
    v_cvt_pk_bf16_f32 v91, v54, v55
    v_cvt_pk_bf16_f32 v92, v56, v57
    v_cvt_pk_bf16_f32 v93, v58, v59
    v_cvt_pk_bf16_f32 v94, v60, v61
    v_cvt_pk_bf16_f32 v95, v62, v63
    v_and_b32 v8, 31, v166
    v_lshrrev_b32 v9, 5, v166
    v_bfe_u32 v10, v166, 4, 1
    v_bfe_u32 v11, v166, 2, 2
    v_and_b32 v12, 3, v166
    s_lshl_b32 s3, s29, 16
    v_and_b32 v13, 15, v8
    v_xor_b32 v13, v13, v9
    v_lshlrev_b32 v13, 4, v13
    v_lshl_add_u32 v13, v8, 8, v13
    v_add_u32 v13, s3, v13
    v_xor_b32 v144, 0, v13
    v_xor_b32 v145, 32, v13
    v_xor_b32 v146, 64, v13
    v_xor_b32 v147, 96, v13
    v_xor_b32 v148, 128, v13
    v_xor_b32 v149, 160, v13
    v_xor_b32 v150, 192, v13
    v_xor_b32 v151, 224, v13
    v_lshl_add_u32 v13, v9, 2, v11
    v_lshlrev_b32 v13, 8, v13
    v_lshl_add_u32 v13, v11, 6, v13
    v_lshl_add_u32 v13, v10, 5, v13
    v_lshl_add_u32 v13, v12, 3, v13
    v_add_u32 v13, s3, v13
    v_xor_b32 v152, 0, v13
    v_xor_b32 v153, 64, v13
    v_xor_b32 v154, 128, v13
    v_xor_b32 v155, 192, v13
    v_mov_b32 v156, 0xf149f2ca
    v_mov_b32 v157, 0xf149f2ca
    v_mov_b32 v158, 0
    v_mov_b32 v159, 0
    v_mov_b32 v160, 0
    s_waitcnt lgkmcnt(0)
    s_barrier
    s_barrier
    ds_read_b128 v[112:115], v144 offset:0
    ds_read_b128 v[116:119], v145 offset:0
    ds_read_b128 v[120:123], v146 offset:0
    ds_read_b128 v[124:127], v147 offset:0
    ds_read_b128 v[128:131], v148 offset:0
    ds_read_b128 v[132:135], v149 offset:0
    ds_read_b128 v[136:139], v150 offset:0
    ds_read_b128 v[140:143], v151 offset:0
    s_cmp_lg_u32 s68, 0
    s_cbranch_scc1 K1_SP0
    s_add_u32 m0, s46, 24576
    s_add_u32 s49, s47, 0
    buffer_load_dwordx4 v163, s[16:19], s49 offen nt lds
K1_SP0:
    s_waitcnt lgkmcnt(7)
    v_mfma_f32_32x32x16_bf16 v[96:111], v[112:115], v[64:67], 0
    ds_read_b64_tr_b16 v[112:113], v152 offset:32768
    ds_read_b64_tr_b16 v[114:115], v152 offset:34816
    s_cmp_lg_u32 s68, 1
    s_cbranch_scc1 K1_SP1
    s_add_u32 m0, s46, 24576
    s_add_u32 s49, s47, 0
    buffer_load_dwordx4 v163, s[16:19], s49 offen nt lds
K1_SP1:
    s_waitcnt lgkmcnt(8)
    v_mfma_f32_32x32x16_bf16 v[96:111], v[116:119], v[68:71], v[96:111]
    ds_read_b64_tr_b16 v[116:117], v153 offset:32768
    ds_read_b64_tr_b16 v[118:119], v153 offset:34816
    s_cmp_lg_u32 s68, 2
    s_cbranch_scc1 K1_SP2
    s_add_u32 m0, s46, 24576
    s_add_u32 s49, s47, 0
    buffer_load_dwordx4 v163, s[16:19], s49 offen nt lds
K1_SP2:
    s_waitcnt lgkmcnt(9)
    v_mfma_f32_32x32x16_bf16 v[96:111], v[120:123], v[72:75], v[96:111]
    ds_read_b64_tr_b16 v[120:121], v154 offset:32768
    ds_read_b64_tr_b16 v[122:123], v154 offset:34816
    s_cmp_lg_u32 s68, 3
    s_cbranch_scc1 K1_SP3
    s_add_u32 m0, s46, 24576
    s_add_u32 s49, s47, 0
    buffer_load_dwordx4 v163, s[16:19], s49 offen nt lds
K1_SP3:
    s_waitcnt lgkmcnt(10)
    v_mfma_f32_32x32x16_bf16 v[96:111], v[124:127], v[76:79], v[96:111]
    ds_read_b64_tr_b16 v[124:125], v155 offset:32768
    ds_read_b64_tr_b16 v[126:127], v155 offset:34816
    s_cmp_lg_u32 s68, 0
    s_cbranch_scc1 K1_SP4
    s_add_u32 m0, s46, 28672
    s_add_u32 s49, s47, 4096
    buffer_load_dwordx4 v163, s[16:19], s49 offen nt lds
    s_add_u32 s47, s47, 8192
K1_SP4:
    s_waitcnt lgkmcnt(11)
    v_mfma_f32_32x32x16_bf16 v[96:111], v[128:131], v[80:83], v[96:111]
    ds_read_b64_tr_b16 v[128:129], v152 offset:36864
    ds_read_b64_tr_b16 v[130:131], v152 offset:38912
    s_cmp_lg_u32 s68, 1
    s_cbranch_scc1 K1_SP5
    s_add_u32 m0, s46, 28672
    s_add_u32 s49, s47, 4096
    buffer_load_dwordx4 v163, s[16:19], s49 offen nt lds
    s_add_u32 s47, s47, 8192
K1_SP5:
    s_waitcnt lgkmcnt(12)
    v_mfma_f32_32x32x16_bf16 v[96:111], v[132:135], v[84:87], v[96:111]
    ds_read_b64_tr_b16 v[132:133], v153 offset:36864
    ds_read_b64_tr_b16 v[134:135], v153 offset:38912
    s_cmp_lg_u32 s68, 2
    s_cbranch_scc1 K1_SP6
    s_add_u32 m0, s46, 28672
    s_add_u32 s49, s47, 4096
    buffer_load_dwordx4 v163, s[16:19], s49 offen nt lds
    s_add_u32 s47, s47, 8192
K1_SP6:
    s_waitcnt lgkmcnt(13)
    v_mfma_f32_32x32x16_bf16 v[96:111], v[136:139], v[88:91], v[96:111]
    ds_read_b64_tr_b16 v[136:137], v154 offset:36864
    ds_read_b64_tr_b16 v[138:139], v154 offset:38912
    s_cmp_lg_u32 s68, 3
    s_cbranch_scc1 K1_SP7
    s_add_u32 m0, s46, 28672
    s_add_u32 s49, s47, 4096
    buffer_load_dwordx4 v163, s[16:19], s49 offen nt lds
    s_add_u32 s47, s47, 8192
K1_SP7:
    s_waitcnt lgkmcnt(14)
    v_mfma_f32_32x32x16_bf16 v[96:111], v[140:143], v[92:95], v[96:111]
    ds_read_b64_tr_b16 v[140:141], v155 offset:36864
    ds_read_b64_tr_b16 v[142:143], v155 offset:38912
    s_nop 9
    v_max3_f32 v161, v96, v97, v98
    v_max3_f32 v162, v99, v100, v101
    v_max3_f32 v161, v161, v102, v103
    v_max3_f32 v162, v162, v104, v105
    v_max3_f32 v161, v161, v106, v107
    v_max3_f32 v162, v162, v108, v109
    v_max3_f32 v161, v161, v110, v111
    v_max_f32 v161, v161, v162
    v_cmp_gt_f32 vcc, v161, v157
    s_cbranch_vccnz K1_SLOWr0p0
K1_RETr0p0:
    v_fma_f32 v96, v96, s31, v158
    v_fma_f32 v97, v97, s31, v158
    v_fma_f32 v98, v98, s31, v158
    v_fma_f32 v99, v99, s31, v158
    v_fma_f32 v100, v100, s31, v158
    v_fma_f32 v101, v101, s31, v158
    v_fma_f32 v102, v102, s31, v158
    v_fma_f32 v103, v103, s31, v158
    v_fma_f32 v104, v104, s31, v158
    v_fma_f32 v105, v105, s31, v158
    v_fma_f32 v106, v106, s31, v158
    v_fma_f32 v107, v107, s31, v158
    v_fma_f32 v108, v108, s31, v158
    v_fma_f32 v109, v109, s31, v158
    v_fma_f32 v110, v110, s31, v158
    v_fma_f32 v111, v111, s31, v158
    v_exp_f32 v96, v96
    v_exp_f32 v97, v97
    v_exp_f32 v98, v98
    v_exp_f32 v99, v99
    v_exp_f32 v100, v100
    v_exp_f32 v101, v101
    v_exp_f32 v102, v102
    v_exp_f32 v103, v103
    v_exp_f32 v104, v104
    v_exp_f32 v105, v105
    v_exp_f32 v106, v106
    v_exp_f32 v107, v107
    v_exp_f32 v108, v108
    v_exp_f32 v109, v109
    v_exp_f32 v110, v110
    v_exp_f32 v111, v111
    v_add_f32 v159, v159, v96
    v_add_f32 v160, v160, v97
    v_cvt_pk_bf16_f32 v96, v96, v97
    v_add_f32 v159, v159, v98
    v_add_f32 v160, v160, v99
    v_cvt_pk_bf16_f32 v97, v98, v99
    v_add_f32 v159, v159, v100
    v_add_f32 v160, v160, v101
    v_cvt_pk_bf16_f32 v98, v100, v101
    v_add_f32 v159, v159, v102
    v_add_f32 v160, v160, v103
    v_cvt_pk_bf16_f32 v99, v102, v103
    v_add_f32 v159, v159, v104
    v_add_f32 v160, v160, v105
    v_cvt_pk_bf16_f32 v100, v104, v105
    v_add_f32 v159, v159, v106
    v_add_f32 v160, v160, v107
    v_cvt_pk_bf16_f32 v101, v106, v107
    v_add_f32 v159, v159, v108
    v_add_f32 v160, v160, v109
    v_cvt_pk_bf16_f32 v102, v108, v109
    v_add_f32 v159, v159, v110
    v_add_f32 v160, v160, v111
    v_cvt_pk_bf16_f32 v103, v110, v111
    s_cmp_lg_u32 s68, 0
    s_cbranch_scc1 K1_SP8
    s_add_u32 m0, s46, 57344
    s_add_u32 s49, s48, 0
    buffer_load_dwordx4 v164, s[20:23], s49 offen nt lds
K1_SP8:
    s_waitcnt lgkmcnt(14)
    v_mfma_f32_32x32x16_bf16 v[0:15], v[112:115], v[96:99], 0
    s_cmp_lg_u32 s68, 1
    s_cbranch_scc1 K1_SP9
    s_add_u32 m0, s46, 57344
    s_add_u32 s49, s48, 0
    buffer_load_dwordx4 v164, s[20:23], s49 offen nt lds
K1_SP9:
    s_waitcnt lgkmcnt(12)
    v_mfma_f32_32x32x16_bf16 v[16:31], v[116:119], v[96:99], 0
    s_cmp_lg_u32 s68, 2
    s_cbranch_scc1 K1_SP10
    s_add_u32 m0, s46, 57344
    s_add_u32 s49, s48, 0
    buffer_load_dwordx4 v164, s[20:23], s49 offen nt lds
K1_SP10:
    s_waitcnt lgkmcnt(10)
    v_mfma_f32_32x32x16_bf16 v[32:47], v[120:123], v[96:99], 0
    s_cmp_lg_u32 s68, 3
    s_cbranch_scc1 K1_SP11
    s_add_u32 m0, s46, 57344
    s_add_u32 s49, s48, 0
    buffer_load_dwordx4 v164, s[20:23], s49 offen nt lds
K1_SP11:
    s_waitcnt lgkmcnt(8)
    v_mfma_f32_32x32x16_bf16 v[48:63], v[124:127], v[96:99], 0
    s_cmp_lg_u32 s68, 0
    s_cbranch_scc1 K1_SP12
    s_add_u32 m0, s46, 61440
    s_add_u32 s49, s48, 4096
    buffer_load_dwordx4 v164, s[20:23], s49 offen nt lds
    s_add_u32 s48, s48, 8192
K1_SP12:
    s_waitcnt lgkmcnt(6)
    v_mfma_f32_32x32x16_bf16 v[0:15], v[128:131], v[100:103], v[0:15]
    s_cmp_lg_u32 s68, 1
    s_cbranch_scc1 K1_SP13
    s_add_u32 m0, s46, 61440
    s_add_u32 s49, s48, 4096
    buffer_load_dwordx4 v164, s[20:23], s49 offen nt lds
    s_add_u32 s48, s48, 8192
K1_SP13:
    s_waitcnt lgkmcnt(4)
    v_mfma_f32_32x32x16_bf16 v[16:31], v[132:135], v[100:103], v[16:31]
    s_cmp_lg_u32 s68, 2
    s_cbranch_scc1 K1_SP14
    s_add_u32 m0, s46, 61440
    s_add_u32 s49, s48, 4096
    buffer_load_dwordx4 v164, s[20:23], s49 offen nt lds
    s_add_u32 s48, s48, 8192
K1_SP14:
    s_waitcnt lgkmcnt(2)
    v_mfma_f32_32x32x16_bf16 v[32:47], v[136:139], v[100:103], v[32:47]
    s_cmp_lg_u32 s68, 3
    s_cbranch_scc1 K1_SP15
    s_add_u32 m0, s46, 61440
    s_add_u32 s49, s48, 4096
    buffer_load_dwordx4 v164, s[20:23], s49 offen nt lds
    s_add_u32 s48, s48, 8192
K1_SP15:
    s_waitcnt lgkmcnt(0)
    v_mfma_f32_32x32x16_bf16 v[48:63], v[140:143], v[100:103], v[48:63]
    s_waitcnt vmcnt(8) lgkmcnt(0)
    s_barrier
    ds_read_b128 v[112:115], v144 offset:8192
    ds_read_b128 v[116:119], v145 offset:8192
    ds_read_b128 v[120:123], v146 offset:8192
    ds_read_b128 v[124:127], v147 offset:8192
    ds_read_b128 v[128:131], v148 offset:8192
    ds_read_b128 v[132:135], v149 offset:8192
    ds_read_b128 v[136:139], v150 offset:8192
    ds_read_b128 v[140:143], v151 offset:8192
    s_cmp_lg_u32 s68, 0
    s_cbranch_scc1 K1_SP16
    s_add_u32 m0, s46, 0
    s_add_u32 s49, s47, 0
    buffer_load_dwordx4 v163, s[16:19], s49 offen nt lds
K1_SP16:
    s_waitcnt lgkmcnt(7)
    v_mfma_f32_32x32x16_bf16 v[96:111], v[112:115], v[64:67], 0
    ds_read_b64_tr_b16 v[112:113], v152 offset:40960
    ds_read_b64_tr_b16 v[114:115], v152 offset:43008
    s_cmp_lg_u32 s68, 1
    s_cbranch_scc1 K1_SP17
    s_add_u32 m0, s46, 0
    s_add_u32 s49, s47, 0
    buffer_load_dwordx4 v163, s[16:19], s49 offen nt lds
K1_SP17:
    s_waitcnt lgkmcnt(8)
    v_mfma_f32_32x32x16_bf16 v[96:111], v[116:119], v[68:71], v[96:111]
    ds_read_b64_tr_b16 v[116:117], v153 offset:40960
    ds_read_b64_tr_b16 v[118:119], v153 offset:43008
    s_cmp_lg_u32 s68, 2
    s_cbranch_scc1 K1_SP18
    s_add_u32 m0, s46, 0
    s_add_u32 s49, s47, 0
    buffer_load_dwordx4 v163, s[16:19], s49 offen nt lds
K1_SP18:
    s_waitcnt lgkmcnt(9)
    v_mfma_f32_32x32x16_bf16 v[96:111], v[120:123], v[72:75], v[96:111]
    ds_read_b64_tr_b16 v[120:121], v154 offset:40960
    ds_read_b64_tr_b16 v[122:123], v154 offset:43008
    s_cmp_lg_u32 s68, 3
    s_cbranch_scc1 K1_SP19
    s_add_u32 m0, s46, 0
    s_add_u32 s49, s47, 0
    buffer_load_dwordx4 v163, s[16:19], s49 offen nt lds
K1_SP19:
    s_waitcnt lgkmcnt(10)
    v_mfma_f32_32x32x16_bf16 v[96:111], v[124:127], v[76:79], v[96:111]
    ds_read_b64_tr_b16 v[124:125], v155 offset:40960
    ds_read_b64_tr_b16 v[126:127], v155 offset:43008
    s_cmp_lg_u32 s68, 0
    s_cbranch_scc1 K1_SP20
    s_add_u32 m0, s46, 4096
    s_add_u32 s49, s47, 4096
    buffer_load_dwordx4 v163, s[16:19], s49 offen nt lds
    s_add_u32 s47, s47, 8192
K1_SP20:
    s_waitcnt lgkmcnt(11)
    v_mfma_f32_32x32x16_bf16 v[96:111], v[128:131], v[80:83], v[96:111]
    ds_read_b64_tr_b16 v[128:129], v152 offset:45056
    ds_read_b64_tr_b16 v[130:131], v152 offset:47104
    s_cmp_lg_u32 s68, 1
    s_cbranch_scc1 K1_SP21
    s_add_u32 m0, s46, 4096
    s_add_u32 s49, s47, 4096
    buffer_load_dwordx4 v163, s[16:19], s49 offen nt lds
    s_add_u32 s47, s47, 8192
K1_SP21:
    s_waitcnt lgkmcnt(12)
    v_mfma_f32_32x32x16_bf16 v[96:111], v[132:135], v[84:87], v[96:111]
    ds_read_b64_tr_b16 v[132:133], v153 offset:45056
    ds_read_b64_tr_b16 v[134:135], v153 offset:47104
    s_cmp_lg_u32 s68, 2
    s_cbranch_scc1 K1_SP22
    s_add_u32 m0, s46, 4096
    s_add_u32 s49, s47, 4096
    buffer_load_dwordx4 v163, s[16:19], s49 offen nt lds
    s_add_u32 s47, s47, 8192
K1_SP22:
    s_waitcnt lgkmcnt(13)
    v_mfma_f32_32x32x16_bf16 v[96:111], v[136:139], v[88:91], v[96:111]
    ds_read_b64_tr_b16 v[136:137], v154 offset:45056
    ds_read_b64_tr_b16 v[138:139], v154 offset:47104
    s_cmp_lg_u32 s68, 3
    s_cbranch_scc1 K1_SP23
    s_add_u32 m0, s46, 4096
    s_add_u32 s49, s47, 4096
    buffer_load_dwordx4 v163, s[16:19], s49 offen nt lds
    s_add_u32 s47, s47, 8192
K1_SP23:
    s_waitcnt lgkmcnt(14)
    v_mfma_f32_32x32x16_bf16 v[96:111], v[140:143], v[92:95], v[96:111]
    ds_read_b64_tr_b16 v[140:141], v155 offset:45056
    ds_read_b64_tr_b16 v[142:143], v155 offset:47104
    s_nop 9
    v_max3_f32 v161, v96, v97, v98
    v_max3_f32 v162, v99, v100, v101
    v_max3_f32 v161, v161, v102, v103
    v_max3_f32 v162, v162, v104, v105
    v_max3_f32 v161, v161, v106, v107
    v_max3_f32 v162, v162, v108, v109
    v_max3_f32 v161, v161, v110, v111
    v_max_f32 v161, v161, v162
    v_cmp_gt_f32 vcc, v161, v157
    s_cbranch_vccnz K1_SLOWr0p1
K1_RETr0p1:
    v_fma_f32 v96, v96, s31, v158
    v_fma_f32 v97, v97, s31, v158
    v_fma_f32 v98, v98, s31, v158
    v_fma_f32 v99, v99, s31, v158
    v_fma_f32 v100, v100, s31, v158
    v_fma_f32 v101, v101, s31, v158
    v_fma_f32 v102, v102, s31, v158
    v_fma_f32 v103, v103, s31, v158
    v_fma_f32 v104, v104, s31, v158
    v_fma_f32 v105, v105, s31, v158
    v_fma_f32 v106, v106, s31, v158
    v_fma_f32 v107, v107, s31, v158
    v_fma_f32 v108, v108, s31, v158
    v_fma_f32 v109, v109, s31, v158
    v_fma_f32 v110, v110, s31, v158
    v_fma_f32 v111, v111, s31, v158
    v_exp_f32 v96, v96
    v_exp_f32 v97, v97
    v_exp_f32 v98, v98
    v_exp_f32 v99, v99
    v_exp_f32 v100, v100
    v_exp_f32 v101, v101
    v_exp_f32 v102, v102
    v_exp_f32 v103, v103
    v_exp_f32 v104, v104
    v_exp_f32 v105, v105
    v_exp_f32 v106, v106
    v_exp_f32 v107, v107
    v_exp_f32 v108, v108
    v_exp_f32 v109, v109
    v_exp_f32 v110, v110
    v_exp_f32 v111, v111
    v_add_f32 v159, v159, v96
    v_add_f32 v160, v160, v97
    v_cvt_pk_bf16_f32 v96, v96, v97
    v_add_f32 v159, v159, v98
    v_add_f32 v160, v160, v99
    v_cvt_pk_bf16_f32 v97, v98, v99
    v_add_f32 v159, v159, v100
    v_add_f32 v160, v160, v101
    v_cvt_pk_bf16_f32 v98, v100, v101
    v_add_f32 v159, v159, v102
    v_add_f32 v160, v160, v103
    v_cvt_pk_bf16_f32 v99, v102, v103
    v_add_f32 v159, v159, v104
    v_add_f32 v160, v160, v105
    v_cvt_pk_bf16_f32 v100, v104, v105
    v_add_f32 v159, v159, v106
    v_add_f32 v160, v160, v107
    v_cvt_pk_bf16_f32 v101, v106, v107
    v_add_f32 v159, v159, v108
    v_add_f32 v160, v160, v109
    v_cvt_pk_bf16_f32 v102, v108, v109
    v_add_f32 v159, v159, v110
    v_add_f32 v160, v160, v111
    v_cvt_pk_bf16_f32 v103, v110, v111
    s_cmp_lg_u32 s68, 0
    s_cbranch_scc1 K1_SP24
    s_add_u32 m0, s46, 32768
    s_add_u32 s49, s48, 0
    buffer_load_dwordx4 v164, s[20:23], s49 offen nt lds
K1_SP24:
    s_waitcnt lgkmcnt(14)
    v_mfma_f32_32x32x16_bf16 v[0:15], v[112:115], v[96:99], v[0:15]
    s_cmp_lg_u32 s68, 1
    s_cbranch_scc1 K1_SP25
    s_add_u32 m0, s46, 32768
    s_add_u32 s49, s48, 0
    buffer_load_dwordx4 v164, s[20:23], s49 offen nt lds
K1_SP25:
    s_waitcnt lgkmcnt(12)
    v_mfma_f32_32x32x16_bf16 v[16:31], v[116:119], v[96:99], v[16:31]
    s_cmp_lg_u32 s68, 2
    s_cbranch_scc1 K1_SP26
    s_add_u32 m0, s46, 32768
    s_add_u32 s49, s48, 0
    buffer_load_dwordx4 v164, s[20:23], s49 offen nt lds
K1_SP26:
    s_waitcnt lgkmcnt(10)
    v_mfma_f32_32x32x16_bf16 v[32:47], v[120:123], v[96:99], v[32:47]
    s_cmp_lg_u32 s68, 3
    s_cbranch_scc1 K1_SP27
    s_add_u32 m0, s46, 32768
    s_add_u32 s49, s48, 0
    buffer_load_dwordx4 v164, s[20:23], s49 offen nt lds
K1_SP27:
    s_waitcnt lgkmcnt(8)
    v_mfma_f32_32x32x16_bf16 v[48:63], v[124:127], v[96:99], v[48:63]
    s_cmp_lg_u32 s68, 0
    s_cbranch_scc1 K1_SP28
    s_add_u32 m0, s46, 36864
    s_add_u32 s49, s48, 4096
    buffer_load_dwordx4 v164, s[20:23], s49 offen nt lds
    s_add_u32 s48, s48, 8192
K1_SP28:
    s_waitcnt lgkmcnt(6)
    v_mfma_f32_32x32x16_bf16 v[0:15], v[128:131], v[100:103], v[0:15]
    s_cmp_lg_u32 s68, 1
    s_cbranch_scc1 K1_SP29
    s_add_u32 m0, s46, 36864
    s_add_u32 s49, s48, 4096
    buffer_load_dwordx4 v164, s[20:23], s49 offen nt lds
    s_add_u32 s48, s48, 8192
K1_SP29:
    s_waitcnt lgkmcnt(4)
    v_mfma_f32_32x32x16_bf16 v[16:31], v[132:135], v[100:103], v[16:31]
    s_cmp_lg_u32 s68, 2
    s_cbranch_scc1 K1_SP30
    s_add_u32 m0, s46, 36864
    s_add_u32 s49, s48, 4096
    buffer_load_dwordx4 v164, s[20:23], s49 offen nt lds
    s_add_u32 s48, s48, 8192
K1_SP30:
    s_waitcnt lgkmcnt(2)
    v_mfma_f32_32x32x16_bf16 v[32:47], v[136:139], v[100:103], v[32:47]
    s_cmp_lg_u32 s68, 3
    s_cbranch_scc1 K1_SP31
    s_add_u32 m0, s46, 36864
    s_add_u32 s49, s48, 4096
    buffer_load_dwordx4 v164, s[20:23], s49 offen nt lds
    s_add_u32 s48, s48, 8192
K1_SP31:
    s_waitcnt lgkmcnt(0)
    v_mfma_f32_32x32x16_bf16 v[48:63], v[140:143], v[100:103], v[48:63]
    s_waitcnt vmcnt(8) lgkmcnt(0)
    s_barrier
    ds_read_b128 v[112:115], v144 offset:16384
    ds_read_b128 v[116:119], v145 offset:16384
    ds_read_b128 v[120:123], v146 offset:16384
    ds_read_b128 v[124:127], v147 offset:16384
    ds_read_b128 v[128:131], v148 offset:16384
    ds_read_b128 v[132:135], v149 offset:16384
    ds_read_b128 v[136:139], v150 offset:16384
    ds_read_b128 v[140:143], v151 offset:16384
    s_cmp_lg_u32 s68, 0
    s_cbranch_scc1 K1_SP32
    s_add_u32 m0, s46, 8192
    s_add_u32 s49, s47, 0
    buffer_load_dwordx4 v163, s[16:19], s49 offen nt lds
K1_SP32:
    s_waitcnt lgkmcnt(7)
    v_mfma_f32_32x32x16_bf16 v[96:111], v[112:115], v[64:67], 0
    ds_read_b64_tr_b16 v[112:113], v152 offset:49152
    ds_read_b64_tr_b16 v[114:115], v152 offset:51200
    s_cmp_lg_u32 s68, 1
    s_cbranch_scc1 K1_SP33
    s_add_u32 m0, s46, 8192
    s_add_u32 s49, s47, 0
    buffer_load_dwordx4 v163, s[16:19], s49 offen nt lds
K1_SP33:
    s_waitcnt lgkmcnt(8)
    v_mfma_f32_32x32x16_bf16 v[96:111], v[116:119], v[68:71], v[96:111]
    ds_read_b64_tr_b16 v[116:117], v153 offset:49152
    ds_read_b64_tr_b16 v[118:119], v153 offset:51200
    s_cmp_lg_u32 s68, 2
    s_cbranch_scc1 K1_SP34
    s_add_u32 m0, s46, 8192
    s_add_u32 s49, s47, 0
    buffer_load_dwordx4 v163, s[16:19], s49 offen nt lds
K1_SP34:
    s_waitcnt lgkmcnt(9)
    v_mfma_f32_32x32x16_bf16 v[96:111], v[120:123], v[72:75], v[96:111]
    ds_read_b64_tr_b16 v[120:121], v154 offset:49152
    ds_read_b64_tr_b16 v[122:123], v154 offset:51200
    s_cmp_lg_u32 s68, 3
    s_cbranch_scc1 K1_SP35
    s_add_u32 m0, s46, 8192
    s_add_u32 s49, s47, 0
    buffer_load_dwordx4 v163, s[16:19], s49 offen nt lds
K1_SP35:
    s_waitcnt lgkmcnt(10)
    v_mfma_f32_32x32x16_bf16 v[96:111], v[124:127], v[76:79], v[96:111]
    ds_read_b64_tr_b16 v[124:125], v155 offset:49152
    ds_read_b64_tr_b16 v[126:127], v155 offset:51200
    s_cmp_lg_u32 s68, 0
    s_cbranch_scc1 K1_SP36
    s_add_u32 m0, s46, 12288
    s_add_u32 s49, s47, 4096
    buffer_load_dwordx4 v163, s[16:19], s49 offen nt lds
    s_add_u32 s47, s47, 8192
K1_SP36:
    s_waitcnt lgkmcnt(11)
    v_mfma_f32_32x32x16_bf16 v[96:111], v[128:131], v[80:83], v[96:111]
    ds_read_b64_tr_b16 v[128:129], v152 offset:53248
    ds_read_b64_tr_b16 v[130:131], v152 offset:55296
    s_cmp_lg_u32 s68, 1
    s_cbranch_scc1 K1_SP37
    s_add_u32 m0, s46, 12288
    s_add_u32 s49, s47, 4096
    buffer_load_dwordx4 v163, s[16:19], s49 offen nt lds
    s_add_u32 s47, s47, 8192
K1_SP37:
    s_waitcnt lgkmcnt(12)
    v_mfma_f32_32x32x16_bf16 v[96:111], v[132:135], v[84:87], v[96:111]
    ds_read_b64_tr_b16 v[132:133], v153 offset:53248
    ds_read_b64_tr_b16 v[134:135], v153 offset:55296
    s_cmp_lg_u32 s68, 2
    s_cbranch_scc1 K1_SP38
    s_add_u32 m0, s46, 12288
    s_add_u32 s49, s47, 4096
    buffer_load_dwordx4 v163, s[16:19], s49 offen nt lds
    s_add_u32 s47, s47, 8192
K1_SP38:
    s_waitcnt lgkmcnt(13)
    v_mfma_f32_32x32x16_bf16 v[96:111], v[136:139], v[88:91], v[96:111]
    ds_read_b64_tr_b16 v[136:137], v154 offset:53248
    ds_read_b64_tr_b16 v[138:139], v154 offset:55296
    s_cmp_lg_u32 s68, 3
    s_cbranch_scc1 K1_SP39
    s_add_u32 m0, s46, 12288
    s_add_u32 s49, s47, 4096
    buffer_load_dwordx4 v163, s[16:19], s49 offen nt lds
    s_add_u32 s47, s47, 8192
K1_SP39:
    s_waitcnt lgkmcnt(14)
    v_mfma_f32_32x32x16_bf16 v[96:111], v[140:143], v[92:95], v[96:111]
    ds_read_b64_tr_b16 v[140:141], v155 offset:53248
    ds_read_b64_tr_b16 v[142:143], v155 offset:55296
    s_nop 9
    v_max3_f32 v161, v96, v97, v98
    v_max3_f32 v162, v99, v100, v101
    v_max3_f32 v161, v161, v102, v103
    v_max3_f32 v162, v162, v104, v105
    v_max3_f32 v161, v161, v106, v107
    v_max3_f32 v162, v162, v108, v109
    v_max3_f32 v161, v161, v110, v111
    v_max_f32 v161, v161, v162
    v_cmp_gt_f32 vcc, v161, v157
    s_cbranch_vccnz K1_SLOWr0p2
K1_RETr0p2:
    v_fma_f32 v96, v96, s31, v158
    v_fma_f32 v97, v97, s31, v158
    v_fma_f32 v98, v98, s31, v158
    v_fma_f32 v99, v99, s31, v158
    v_fma_f32 v100, v100, s31, v158
    v_fma_f32 v101, v101, s31, v158
    v_fma_f32 v102, v102, s31, v158
    v_fma_f32 v103, v103, s31, v158
    v_fma_f32 v104, v104, s31, v158
    v_fma_f32 v105, v105, s31, v158
    v_fma_f32 v106, v106, s31, v158
    v_fma_f32 v107, v107, s31, v158
    v_fma_f32 v108, v108, s31, v158
    v_fma_f32 v109, v109, s31, v158
    v_fma_f32 v110, v110, s31, v158
    v_fma_f32 v111, v111, s31, v158
    v_exp_f32 v96, v96
    v_exp_f32 v97, v97
    v_exp_f32 v98, v98
    v_exp_f32 v99, v99
    v_exp_f32 v100, v100
    v_exp_f32 v101, v101
    v_exp_f32 v102, v102
    v_exp_f32 v103, v103
    v_exp_f32 v104, v104
    v_exp_f32 v105, v105
    v_exp_f32 v106, v106
    v_exp_f32 v107, v107
    v_exp_f32 v108, v108
    v_exp_f32 v109, v109
    v_exp_f32 v110, v110
    v_exp_f32 v111, v111
    v_add_f32 v159, v159, v96
    v_add_f32 v160, v160, v97
    v_cvt_pk_bf16_f32 v96, v96, v97
    v_add_f32 v159, v159, v98
    v_add_f32 v160, v160, v99
    v_cvt_pk_bf16_f32 v97, v98, v99
    v_add_f32 v159, v159, v100
    v_add_f32 v160, v160, v101
    v_cvt_pk_bf16_f32 v98, v100, v101
    v_add_f32 v159, v159, v102
    v_add_f32 v160, v160, v103
    v_cvt_pk_bf16_f32 v99, v102, v103
    v_add_f32 v159, v159, v104
    v_add_f32 v160, v160, v105
    v_cvt_pk_bf16_f32 v100, v104, v105
    v_add_f32 v159, v159, v106
    v_add_f32 v160, v160, v107
    v_cvt_pk_bf16_f32 v101, v106, v107
    v_add_f32 v159, v159, v108
    v_add_f32 v160, v160, v109
    v_cvt_pk_bf16_f32 v102, v108, v109
    v_add_f32 v159, v159, v110
    v_add_f32 v160, v160, v111
    v_cvt_pk_bf16_f32 v103, v110, v111
    s_cmp_lg_u32 s68, 0
    s_cbranch_scc1 K1_SP40
    s_add_u32 m0, s46, 40960
    s_add_u32 s49, s48, 0
    buffer_load_dwordx4 v164, s[20:23], s49 offen nt lds
K1_SP40:
    s_waitcnt lgkmcnt(14)
    v_mfma_f32_32x32x16_bf16 v[0:15], v[112:115], v[96:99], v[0:15]
    s_cmp_lg_u32 s68, 1
    s_cbranch_scc1 K1_SP41
    s_add_u32 m0, s46, 40960
    s_add_u32 s49, s48, 0
    buffer_load_dwordx4 v164, s[20:23], s49 offen nt lds
K1_SP41:
    s_waitcnt lgkmcnt(12)
    v_mfma_f32_32x32x16_bf16 v[16:31], v[116:119], v[96:99], v[16:31]
    s_cmp_lg_u32 s68, 2
    s_cbranch_scc1 K1_SP42
    s_add_u32 m0, s46, 40960
    s_add_u32 s49, s48, 0
    buffer_load_dwordx4 v164, s[20:23], s49 offen nt lds
K1_SP42:
    s_waitcnt lgkmcnt(10)
    v_mfma_f32_32x32x16_bf16 v[32:47], v[120:123], v[96:99], v[32:47]
    s_cmp_lg_u32 s68, 3
    s_cbranch_scc1 K1_SP43
    s_add_u32 m0, s46, 40960
    s_add_u32 s49, s48, 0
    buffer_load_dwordx4 v164, s[20:23], s49 offen nt lds
K1_SP43:
    s_waitcnt lgkmcnt(8)
    v_mfma_f32_32x32x16_bf16 v[48:63], v[124:127], v[96:99], v[48:63]
    s_cmp_lg_u32 s68, 0
    s_cbranch_scc1 K1_SP44
    s_add_u32 m0, s46, 45056
    s_add_u32 s49, s48, 4096
    buffer_load_dwordx4 v164, s[20:23], s49 offen nt lds
    s_add_u32 s48, s48, 8192
K1_SP44:
    s_waitcnt lgkmcnt(6)
    v_mfma_f32_32x32x16_bf16 v[0:15], v[128:131], v[100:103], v[0:15]
    s_cmp_lg_u32 s68, 1
    s_cbranch_scc1 K1_SP45
    s_add_u32 m0, s46, 45056
    s_add_u32 s49, s48, 4096
    buffer_load_dwordx4 v164, s[20:23], s49 offen nt lds
    s_add_u32 s48, s48, 8192
K1_SP45:
    s_waitcnt lgkmcnt(4)
    v_mfma_f32_32x32x16_bf16 v[16:31], v[132:135], v[100:103], v[16:31]
    s_cmp_lg_u32 s68, 2
    s_cbranch_scc1 K1_SP46
    s_add_u32 m0, s46, 45056
    s_add_u32 s49, s48, 4096
    buffer_load_dwordx4 v164, s[20:23], s49 offen nt lds
    s_add_u32 s48, s48, 8192
K1_SP46:
    s_waitcnt lgkmcnt(2)
    v_mfma_f32_32x32x16_bf16 v[32:47], v[136:139], v[100:103], v[32:47]
    s_cmp_lg_u32 s68, 3
    s_cbranch_scc1 K1_SP47
    s_add_u32 m0, s46, 45056
    s_add_u32 s49, s48, 4096
    buffer_load_dwordx4 v164, s[20:23], s49 offen nt lds
    s_add_u32 s48, s48, 8192
K1_SP47:
    s_waitcnt lgkmcnt(0)
    v_mfma_f32_32x32x16_bf16 v[48:63], v[140:143], v[100:103], v[48:63]
    s_waitcnt vmcnt(8) lgkmcnt(0)
    s_barrier
    ds_read_b128 v[112:115], v144 offset:24576
    ds_read_b128 v[116:119], v145 offset:24576
    ds_read_b128 v[120:123], v146 offset:24576
    ds_read_b128 v[124:127], v147 offset:24576
    ds_read_b128 v[128:131], v148 offset:24576
    ds_read_b128 v[132:135], v149 offset:24576
    ds_read_b128 v[136:139], v150 offset:24576
    ds_read_b128 v[140:143], v151 offset:24576
    s_cmp_lg_u32 s68, 0
    s_cbranch_scc1 K1_SP48
    s_add_u32 m0, s46, 16384
    s_add_u32 s49, s47, 0
    buffer_load_dwordx4 v163, s[16:19], s49 offen nt lds
K1_SP48:
    s_waitcnt lgkmcnt(7)
    v_mfma_f32_32x32x16_bf16 v[96:111], v[112:115], v[64:67], 0
    ds_read_b64_tr_b16 v[112:113], v152 offset:57344
    ds_read_b64_tr_b16 v[114:115], v152 offset:59392
    s_cmp_lg_u32 s68, 1
    s_cbranch_scc1 K1_SP49
    s_add_u32 m0, s46, 16384
    s_add_u32 s49, s47, 0
    buffer_load_dwordx4 v163, s[16:19], s49 offen nt lds
K1_SP49:
    s_waitcnt lgkmcnt(8)
    v_mfma_f32_32x32x16_bf16 v[96:111], v[116:119], v[68:71], v[96:111]
    ds_read_b64_tr_b16 v[116:117], v153 offset:57344
    ds_read_b64_tr_b16 v[118:119], v153 offset:59392
    s_cmp_lg_u32 s68, 2
    s_cbranch_scc1 K1_SP50
    s_add_u32 m0, s46, 16384
    s_add_u32 s49, s47, 0
    buffer_load_dwordx4 v163, s[16:19], s49 offen nt lds
K1_SP50:
    s_waitcnt lgkmcnt(9)
    v_mfma_f32_32x32x16_bf16 v[96:111], v[120:123], v[72:75], v[96:111]
    ds_read_b64_tr_b16 v[120:121], v154 offset:57344
    ds_read_b64_tr_b16 v[122:123], v154 offset:59392
    s_cmp_lg_u32 s68, 3
    s_cbranch_scc1 K1_SP51
    s_add_u32 m0, s46, 16384
    s_add_u32 s49, s47, 0
    buffer_load_dwordx4 v163, s[16:19], s49 offen nt lds
K1_SP51:
    s_waitcnt lgkmcnt(10)
    v_mfma_f32_32x32x16_bf16 v[96:111], v[124:127], v[76:79], v[96:111]
    ds_read_b64_tr_b16 v[124:125], v155 offset:57344
    ds_read_b64_tr_b16 v[126:127], v155 offset:59392
    s_cmp_lg_u32 s68, 0
    s_cbranch_scc1 K1_SP52
    s_add_u32 m0, s46, 20480
    s_add_u32 s49, s47, 4096
    buffer_load_dwordx4 v163, s[16:19], s49 offen nt lds
    s_add_u32 s47, s47, 8192
K1_SP52:
    s_waitcnt lgkmcnt(11)
    v_mfma_f32_32x32x16_bf16 v[96:111], v[128:131], v[80:83], v[96:111]
    ds_read_b64_tr_b16 v[128:129], v152 offset:61440
    ds_read_b64_tr_b16 v[130:131], v152 offset:63488
    s_cmp_lg_u32 s68, 1
    s_cbranch_scc1 K1_SP53
    s_add_u32 m0, s46, 20480
    s_add_u32 s49, s47, 4096
    buffer_load_dwordx4 v163, s[16:19], s49 offen nt lds
    s_add_u32 s47, s47, 8192
K1_SP53:
    s_waitcnt lgkmcnt(12)
    v_mfma_f32_32x32x16_bf16 v[96:111], v[132:135], v[84:87], v[96:111]
    ds_read_b64_tr_b16 v[132:133], v153 offset:61440
    ds_read_b64_tr_b16 v[134:135], v153 offset:63488
    s_cmp_lg_u32 s68, 2
    s_cbranch_scc1 K1_SP54
    s_add_u32 m0, s46, 20480
    s_add_u32 s49, s47, 4096
    buffer_load_dwordx4 v163, s[16:19], s49 offen nt lds
    s_add_u32 s47, s47, 8192
K1_SP54:
    s_waitcnt lgkmcnt(13)
    v_mfma_f32_32x32x16_bf16 v[96:111], v[136:139], v[88:91], v[96:111]
    ds_read_b64_tr_b16 v[136:137], v154 offset:61440
    ds_read_b64_tr_b16 v[138:139], v154 offset:63488
    s_cmp_lg_u32 s68, 3
    s_cbranch_scc1 K1_SP55
    s_add_u32 m0, s46, 20480
    s_add_u32 s49, s47, 4096
    buffer_load_dwordx4 v163, s[16:19], s49 offen nt lds
    s_add_u32 s47, s47, 8192
K1_SP55:
    s_waitcnt lgkmcnt(14)
    v_mfma_f32_32x32x16_bf16 v[96:111], v[140:143], v[92:95], v[96:111]
    ds_read_b64_tr_b16 v[140:141], v155 offset:61440
    ds_read_b64_tr_b16 v[142:143], v155 offset:63488
    s_nop 9
    v_max3_f32 v161, v96, v97, v98
    v_max3_f32 v162, v99, v100, v101
    v_max3_f32 v161, v161, v102, v103
    v_max3_f32 v162, v162, v104, v105
    v_max3_f32 v161, v161, v106, v107
    v_max3_f32 v162, v162, v108, v109
    v_max3_f32 v161, v161, v110, v111
    v_max_f32 v161, v161, v162
    v_cmp_gt_f32 vcc, v161, v157
    s_cbranch_vccnz K1_SLOWr0p3
K1_RETr0p3:
    v_fma_f32 v96, v96, s31, v158
    v_fma_f32 v97, v97, s31, v158
    v_fma_f32 v98, v98, s31, v158
    v_fma_f32 v99, v99, s31, v158
    v_fma_f32 v100, v100, s31, v158
    v_fma_f32 v101, v101, s31, v158
    v_fma_f32 v102, v102, s31, v158
    v_fma_f32 v103, v103, s31, v158
    v_fma_f32 v104, v104, s31, v158
    v_fma_f32 v105, v105, s31, v158
    v_fma_f32 v106, v106, s31, v158
    v_fma_f32 v107, v107, s31, v158
    v_fma_f32 v108, v108, s31, v158
    v_fma_f32 v109, v109, s31, v158
    v_fma_f32 v110, v110, s31, v158
    v_fma_f32 v111, v111, s31, v158
    v_exp_f32 v96, v96
    v_exp_f32 v97, v97
    v_exp_f32 v98, v98
    v_exp_f32 v99, v99
    v_exp_f32 v100, v100
    v_exp_f32 v101, v101
    v_exp_f32 v102, v102
    v_exp_f32 v103, v103
    v_exp_f32 v104, v104
    v_exp_f32 v105, v105
    v_exp_f32 v106, v106
    v_exp_f32 v107, v107
    v_exp_f32 v108, v108
    v_exp_f32 v109, v109
    v_exp_f32 v110, v110
    v_exp_f32 v111, v111
    v_add_f32 v159, v159, v96
    v_add_f32 v160, v160, v97
    v_cvt_pk_bf16_f32 v96, v96, v97
    v_add_f32 v159, v159, v98
    v_add_f32 v160, v160, v99
    v_cvt_pk_bf16_f32 v97, v98, v99
    v_add_f32 v159, v159, v100
    v_add_f32 v160, v160, v101
    v_cvt_pk_bf16_f32 v98, v100, v101
    v_add_f32 v159, v159, v102
    v_add_f32 v160, v160, v103
    v_cvt_pk_bf16_f32 v99, v102, v103
    v_add_f32 v159, v159, v104
    v_add_f32 v160, v160, v105
    v_cvt_pk_bf16_f32 v100, v104, v105
    v_add_f32 v159, v159, v106
    v_add_f32 v160, v160, v107
    v_cvt_pk_bf16_f32 v101, v106, v107
    v_add_f32 v159, v159, v108
    v_add_f32 v160, v160, v109
    v_cvt_pk_bf16_f32 v102, v108, v109
    v_add_f32 v159, v159, v110
    v_add_f32 v160, v160, v111
    v_cvt_pk_bf16_f32 v103, v110, v111
    s_cmp_lg_u32 s68, 0
    s_cbranch_scc1 K1_SP56
    s_add_u32 m0, s46, 49152
    s_add_u32 s49, s48, 0
    buffer_load_dwordx4 v164, s[20:23], s49 offen nt lds
K1_SP56:
    s_waitcnt lgkmcnt(14)
    v_mfma_f32_32x32x16_bf16 v[0:15], v[112:115], v[96:99], v[0:15]
    s_cmp_lg_u32 s68, 1
    s_cbranch_scc1 K1_SP57
    s_add_u32 m0, s46, 49152
    s_add_u32 s49, s48, 0
    buffer_load_dwordx4 v164, s[20:23], s49 offen nt lds
K1_SP57:
    s_waitcnt lgkmcnt(12)
    v_mfma_f32_32x32x16_bf16 v[16:31], v[116:119], v[96:99], v[16:31]
    s_cmp_lg_u32 s68, 2
    s_cbranch_scc1 K1_SP58
    s_add_u32 m0, s46, 49152
    s_add_u32 s49, s48, 0
    buffer_load_dwordx4 v164, s[20:23], s49 offen nt lds
K1_SP58:
    s_waitcnt lgkmcnt(10)
    v_mfma_f32_32x32x16_bf16 v[32:47], v[120:123], v[96:99], v[32:47]
    s_cmp_lg_u32 s68, 3
    s_cbranch_scc1 K1_SP59
    s_add_u32 m0, s46, 49152
    s_add_u32 s49, s48, 0
    buffer_load_dwordx4 v164, s[20:23], s49 offen nt lds
K1_SP59:
    s_waitcnt lgkmcnt(8)
    v_mfma_f32_32x32x16_bf16 v[48:63], v[124:127], v[96:99], v[48:63]
    s_cmp_lg_u32 s68, 0
    s_cbranch_scc1 K1_SP60
    s_add_u32 m0, s46, 53248
    s_add_u32 s49, s48, 4096
    buffer_load_dwordx4 v164, s[20:23], s49 offen nt lds
    s_add_u32 s48, s48, 8192
K1_SP60:
    s_waitcnt lgkmcnt(6)
    v_mfma_f32_32x32x16_bf16 v[0:15], v[128:131], v[100:103], v[0:15]
    s_cmp_lg_u32 s68, 1
    s_cbranch_scc1 K1_SP61
    s_add_u32 m0, s46, 53248
    s_add_u32 s49, s48, 4096
    buffer_load_dwordx4 v164, s[20:23], s49 offen nt lds
    s_add_u32 s48, s48, 8192
K1_SP61:
    s_waitcnt lgkmcnt(4)
    v_mfma_f32_32x32x16_bf16 v[16:31], v[132:135], v[100:103], v[16:31]
    s_cmp_lg_u32 s68, 2
    s_cbranch_scc1 K1_SP62
    s_add_u32 m0, s46, 53248
    s_add_u32 s49, s48, 4096
    buffer_load_dwordx4 v164, s[20:23], s49 offen nt lds
    s_add_u32 s48, s48, 8192
K1_SP62:
    s_waitcnt lgkmcnt(2)
    v_mfma_f32_32x32x16_bf16 v[32:47], v[136:139], v[100:103], v[32:47]
    s_cmp_lg_u32 s68, 3
    s_cbranch_scc1 K1_SP63
    s_add_u32 m0, s46, 53248
    s_add_u32 s49, s48, 4096
    buffer_load_dwordx4 v164, s[20:23], s49 offen nt lds
    s_add_u32 s48, s48, 8192
K1_SP63:
    s_waitcnt lgkmcnt(0)
    v_mfma_f32_32x32x16_bf16 v[48:63], v[140:143], v[100:103], v[48:63]
    s_waitcnt vmcnt(8) lgkmcnt(0)
    s_mov_b32 s50, 0
K1_LOOPr0:
    s_barrier
    ds_read_b128 v[112:115], v144 offset:0
    ds_read_b128 v[116:119], v145 offset:0
    ds_read_b128 v[120:123], v146 offset:0
    ds_read_b128 v[124:127], v147 offset:0
    ds_read_b128 v[128:131], v148 offset:0
    ds_read_b128 v[132:135], v149 offset:0
    ds_read_b128 v[136:139], v150 offset:0
    ds_read_b128 v[140:143], v151 offset:0
    s_cmp_lg_u32 s68, 0
    s_cbranch_scc1 K1_SP64
    s_add_u32 m0, s46, 24576
    s_add_u32 s49, s47, 0
    buffer_load_dwordx4 v163, s[16:19], s49 offen nt lds
K1_SP64:
    s_waitcnt lgkmcnt(7)
    v_mfma_f32_32x32x16_bf16 v[96:111], v[112:115], v[64:67], 0
    ds_read_b64_tr_b16 v[112:113], v152 offset:32768
    ds_read_b64_tr_b16 v[114:115], v152 offset:34816
    s_cmp_lg_u32 s68, 1
    s_cbranch_scc1 K1_SP65
    s_add_u32 m0, s46, 24576
    s_add_u32 s49, s47, 0
    buffer_load_dwordx4 v163, s[16:19], s49 offen nt lds
K1_SP65:
    s_waitcnt lgkmcnt(8)
    v_mfma_f32_32x32x16_bf16 v[96:111], v[116:119], v[68:71], v[96:111]
    ds_read_b64_tr_b16 v[116:117], v153 offset:32768
    ds_read_b64_tr_b16 v[118:119], v153 offset:34816
    s_cmp_lg_u32 s68, 2
    s_cbranch_scc1 K1_SP66
    s_add_u32 m0, s46, 24576
    s_add_u32 s49, s47, 0
    buffer_load_dwordx4 v163, s[16:19], s49 offen nt lds
K1_SP66:
    s_waitcnt lgkmcnt(9)
    v_mfma_f32_32x32x16_bf16 v[96:111], v[120:123], v[72:75], v[96:111]
    ds_read_b64_tr_b16 v[120:121], v154 offset:32768
    ds_read_b64_tr_b16 v[122:123], v154 offset:34816
    s_cmp_lg_u32 s68, 3
    s_cbranch_scc1 K1_SP67
    s_add_u32 m0, s46, 24576
    s_add_u32 s49, s47, 0
    buffer_load_dwordx4 v163, s[16:19], s49 offen nt lds
K1_SP67:
    s_waitcnt lgkmcnt(10)
    v_mfma_f32_32x32x16_bf16 v[96:111], v[124:127], v[76:79], v[96:111]
    ds_read_b64_tr_b16 v[124:125], v155 offset:32768
    ds_read_b64_tr_b16 v[126:127], v155 offset:34816
    s_cmp_lg_u32 s68, 0
    s_cbranch_scc1 K1_SP68
    s_add_u32 m0, s46, 28672
    s_add_u32 s49, s47, 4096
    buffer_load_dwordx4 v163, s[16:19], s49 offen nt lds
    s_add_u32 s47, s47, 8192
K1_SP68:
    s_waitcnt lgkmcnt(11)
    v_mfma_f32_32x32x16_bf16 v[96:111], v[128:131], v[80:83], v[96:111]
    ds_read_b64_tr_b16 v[128:129], v152 offset:36864
    ds_read_b64_tr_b16 v[130:131], v152 offset:38912
    s_cmp_lg_u32 s68, 1
    s_cbranch_scc1 K1_SP69
    s_add_u32 m0, s46, 28672
    s_add_u32 s49, s47, 4096
    buffer_load_dwordx4 v163, s[16:19], s49 offen nt lds
    s_add_u32 s47, s47, 8192
K1_SP69:
    s_waitcnt lgkmcnt(12)
    v_mfma_f32_32x32x16_bf16 v[96:111], v[132:135], v[84:87], v[96:111]
    ds_read_b64_tr_b16 v[132:133], v153 offset:36864
    ds_read_b64_tr_b16 v[134:135], v153 offset:38912
    s_cmp_lg_u32 s68, 2
    s_cbranch_scc1 K1_SP70
    s_add_u32 m0, s46, 28672
    s_add_u32 s49, s47, 4096
    buffer_load_dwordx4 v163, s[16:19], s49 offen nt lds
    s_add_u32 s47, s47, 8192
K1_SP70:
    s_waitcnt lgkmcnt(13)
    v_mfma_f32_32x32x16_bf16 v[96:111], v[136:139], v[88:91], v[96:111]
    ds_read_b64_tr_b16 v[136:137], v154 offset:36864
    ds_read_b64_tr_b16 v[138:139], v154 offset:38912
    s_cmp_lg_u32 s68, 3
    s_cbranch_scc1 K1_SP71
    s_add_u32 m0, s46, 28672
    s_add_u32 s49, s47, 4096
    buffer_load_dwordx4 v163, s[16:19], s49 offen nt lds
    s_add_u32 s47, s47, 8192
K1_SP71:
    s_waitcnt lgkmcnt(14)
    v_mfma_f32_32x32x16_bf16 v[96:111], v[140:143], v[92:95], v[96:111]
    ds_read_b64_tr_b16 v[140:141], v155 offset:36864
    ds_read_b64_tr_b16 v[142:143], v155 offset:38912
    s_nop 9
    v_max3_f32 v161, v96, v97, v98
    v_max3_f32 v162, v99, v100, v101
    v_max3_f32 v161, v161, v102, v103
    v_max3_f32 v162, v162, v104, v105
    v_max3_f32 v161, v161, v106, v107
    v_max3_f32 v162, v162, v108, v109
    v_max3_f32 v161, v161, v110, v111
    v_max_f32 v161, v161, v162
    v_cmp_gt_f32 vcc, v161, v157
    s_cbranch_vccnz K1_SLOWr0a0
K1_RETr0a0:
    v_fma_f32 v96, v96, s31, v158
    v_fma_f32 v97, v97, s31, v158
    v_fma_f32 v98, v98, s31, v158
    v_fma_f32 v99, v99, s31, v158
    v_fma_f32 v100, v100, s31, v158
    v_fma_f32 v101, v101, s31, v158
    v_fma_f32 v102, v102, s31, v158
    v_fma_f32 v103, v103, s31, v158
    v_fma_f32 v104, v104, s31, v158
    v_fma_f32 v105, v105, s31, v158
    v_fma_f32 v106, v106, s31, v158
    v_fma_f32 v107, v107, s31, v158
    v_fma_f32 v108, v108, s31, v158
    v_fma_f32 v109, v109, s31, v158
    v_fma_f32 v110, v110, s31, v158
    v_fma_f32 v111, v111, s31, v158
    v_exp_f32 v96, v96
    v_exp_f32 v97, v97
    v_exp_f32 v98, v98
    v_exp_f32 v99, v99
    v_exp_f32 v100, v100
    v_exp_f32 v101, v101
    v_exp_f32 v102, v102
    v_exp_f32 v103, v103
    v_exp_f32 v104, v104
    v_exp_f32 v105, v105
    v_exp_f32 v106, v106
    v_exp_f32 v107, v107
    v_exp_f32 v108, v108
    v_exp_f32 v109, v109
    v_exp_f32 v110, v110
    v_exp_f32 v111, v111
    v_add_f32 v159, v159, v96
    v_add_f32 v160, v160, v97
    v_cvt_pk_bf16_f32 v96, v96, v97
    v_add_f32 v159, v159, v98
    v_add_f32 v160, v160, v99
    v_cvt_pk_bf16_f32 v97, v98, v99
    v_add_f32 v159, v159, v100
    v_add_f32 v160, v160, v101
    v_cvt_pk_bf16_f32 v98, v100, v101
    v_add_f32 v159, v159, v102
    v_add_f32 v160, v160, v103
    v_cvt_pk_bf16_f32 v99, v102, v103
    v_add_f32 v159, v159, v104
    v_add_f32 v160, v160, v105
    v_cvt_pk_bf16_f32 v100, v104, v105
    v_add_f32 v159, v159, v106
    v_add_f32 v160, v160, v107
    v_cvt_pk_bf16_f32 v101, v106, v107
    v_add_f32 v159, v159, v108
    v_add_f32 v160, v160, v109
    v_cvt_pk_bf16_f32 v102, v108, v109
    v_add_f32 v159, v159, v110
    v_add_f32 v160, v160, v111
    v_cvt_pk_bf16_f32 v103, v110, v111
    s_cmp_lg_u32 s68, 0
    s_cbranch_scc1 K1_SP72
    s_add_u32 m0, s46, 57344
    s_add_u32 s49, s48, 0
    buffer_load_dwordx4 v164, s[20:23], s49 offen nt lds
K1_SP72:
    s_waitcnt lgkmcnt(14)
    v_mfma_f32_32x32x16_bf16 v[0:15], v[112:115], v[96:99], v[0:15]
    s_cmp_lg_u32 s68, 1
    s_cbranch_scc1 K1_SP73
    s_add_u32 m0, s46, 57344
    s_add_u32 s49, s48, 0
    buffer_load_dwordx4 v164, s[20:23], s49 offen nt lds
K1_SP73:
    s_waitcnt lgkmcnt(12)
    v_mfma_f32_32x32x16_bf16 v[16:31], v[116:119], v[96:99], v[16:31]
    s_cmp_lg_u32 s68, 2
    s_cbranch_scc1 K1_SP74
    s_add_u32 m0, s46, 57344
    s_add_u32 s49, s48, 0
    buffer_load_dwordx4 v164, s[20:23], s49 offen nt lds
K1_SP74:
    s_waitcnt lgkmcnt(10)
    v_mfma_f32_32x32x16_bf16 v[32:47], v[120:123], v[96:99], v[32:47]
    s_cmp_lg_u32 s68, 3
    s_cbranch_scc1 K1_SP75
    s_add_u32 m0, s46, 57344
    s_add_u32 s49, s48, 0
    buffer_load_dwordx4 v164, s[20:23], s49 offen nt lds
K1_SP75:
    s_waitcnt lgkmcnt(8)
    v_mfma_f32_32x32x16_bf16 v[48:63], v[124:127], v[96:99], v[48:63]
    s_cmp_lg_u32 s68, 0
    s_cbranch_scc1 K1_SP76
    s_add_u32 m0, s46, 61440
    s_add_u32 s49, s48, 4096
    buffer_load_dwordx4 v164, s[20:23], s49 offen nt lds
    s_add_u32 s48, s48, 8192
K1_SP76:
    s_waitcnt lgkmcnt(6)
    v_mfma_f32_32x32x16_bf16 v[0:15], v[128:131], v[100:103], v[0:15]
    s_cmp_lg_u32 s68, 1
    s_cbranch_scc1 K1_SP77
    s_add_u32 m0, s46, 61440
    s_add_u32 s49, s48, 4096
    buffer_load_dwordx4 v164, s[20:23], s49 offen nt lds
    s_add_u32 s48, s48, 8192
K1_SP77:
    s_waitcnt lgkmcnt(4)
    v_mfma_f32_32x32x16_bf16 v[16:31], v[132:135], v[100:103], v[16:31]
    s_cmp_lg_u32 s68, 2
    s_cbranch_scc1 K1_SP78
    s_add_u32 m0, s46, 61440
    s_add_u32 s49, s48, 4096
    buffer_load_dwordx4 v164, s[20:23], s49 offen nt lds
    s_add_u32 s48, s48, 8192
K1_SP78:
    s_waitcnt lgkmcnt(2)
    v_mfma_f32_32x32x16_bf16 v[32:47], v[136:139], v[100:103], v[32:47]
    s_cmp_lg_u32 s68, 3
    s_cbranch_scc1 K1_SP79
    s_add_u32 m0, s46, 61440
    s_add_u32 s49, s48, 4096
    buffer_load_dwordx4 v164, s[20:23], s49 offen nt lds
    s_add_u32 s48, s48, 8192
K1_SP79:
    s_waitcnt lgkmcnt(0)
    v_mfma_f32_32x32x16_bf16 v[48:63], v[140:143], v[100:103], v[48:63]
    s_waitcnt vmcnt(8) lgkmcnt(0)
    s_barrier
    ds_read_b128 v[112:115], v144 offset:8192
    ds_read_b128 v[116:119], v145 offset:8192
    ds_read_b128 v[120:123], v146 offset:8192
    ds_read_b128 v[124:127], v147 offset:8192
    ds_read_b128 v[128:131], v148 offset:8192
    ds_read_b128 v[132:135], v149 offset:8192
    ds_read_b128 v[136:139], v150 offset:8192
    ds_read_b128 v[140:143], v151 offset:8192
    s_cmp_lg_u32 s68, 0
    s_cbranch_scc1 K1_SP80
    s_add_u32 m0, s46, 0
    s_add_u32 s49, s47, 0
    buffer_load_dwordx4 v163, s[16:19], s49 offen nt lds
K1_SP80:
    s_waitcnt lgkmcnt(7)
    v_mfma_f32_32x32x16_bf16 v[96:111], v[112:115], v[64:67], 0
    ds_read_b64_tr_b16 v[112:113], v152 offset:40960
    ds_read_b64_tr_b16 v[114:115], v152 offset:43008
    s_cmp_lg_u32 s68, 1
    s_cbranch_scc1 K1_SP81
    s_add_u32 m0, s46, 0
    s_add_u32 s49, s47, 0
    buffer_load_dwordx4 v163, s[16:19], s49 offen nt lds
K1_SP81:
    s_waitcnt lgkmcnt(8)
    v_mfma_f32_32x32x16_bf16 v[96:111], v[116:119], v[68:71], v[96:111]
    ds_read_b64_tr_b16 v[116:117], v153 offset:40960
    ds_read_b64_tr_b16 v[118:119], v153 offset:43008
    s_cmp_lg_u32 s68, 2
    s_cbranch_scc1 K1_SP82
    s_add_u32 m0, s46, 0
    s_add_u32 s49, s47, 0
    buffer_load_dwordx4 v163, s[16:19], s49 offen nt lds
K1_SP82:
    s_waitcnt lgkmcnt(9)
    v_mfma_f32_32x32x16_bf16 v[96:111], v[120:123], v[72:75], v[96:111]
    ds_read_b64_tr_b16 v[120:121], v154 offset:40960
    ds_read_b64_tr_b16 v[122:123], v154 offset:43008
    s_cmp_lg_u32 s68, 3
    s_cbranch_scc1 K1_SP83
    s_add_u32 m0, s46, 0
    s_add_u32 s49, s47, 0
    buffer_load_dwordx4 v163, s[16:19], s49 offen nt lds
K1_SP83:
    s_waitcnt lgkmcnt(10)
    v_mfma_f32_32x32x16_bf16 v[96:111], v[124:127], v[76:79], v[96:111]
    ds_read_b64_tr_b16 v[124:125], v155 offset:40960
    ds_read_b64_tr_b16 v[126:127], v155 offset:43008
    s_cmp_lg_u32 s68, 0
    s_cbranch_scc1 K1_SP84
    s_add_u32 m0, s46, 4096
    s_add_u32 s49, s47, 4096
    buffer_load_dwordx4 v163, s[16:19], s49 offen nt lds
    s_add_u32 s47, s47, 8192
K1_SP84:
    s_waitcnt lgkmcnt(11)
    v_mfma_f32_32x32x16_bf16 v[96:111], v[128:131], v[80:83], v[96:111]
    ds_read_b64_tr_b16 v[128:129], v152 offset:45056
    ds_read_b64_tr_b16 v[130:131], v152 offset:47104
    s_cmp_lg_u32 s68, 1
    s_cbranch_scc1 K1_SP85
    s_add_u32 m0, s46, 4096
    s_add_u32 s49, s47, 4096
    buffer_load_dwordx4 v163, s[16:19], s49 offen nt lds
    s_add_u32 s47, s47, 8192
K1_SP85:
    s_waitcnt lgkmcnt(12)
    v_mfma_f32_32x32x16_bf16 v[96:111], v[132:135], v[84:87], v[96:111]
    ds_read_b64_tr_b16 v[132:133], v153 offset:45056
    ds_read_b64_tr_b16 v[134:135], v153 offset:47104
    s_cmp_lg_u32 s68, 2
    s_cbranch_scc1 K1_SP86
    s_add_u32 m0, s46, 4096
    s_add_u32 s49, s47, 4096
    buffer_load_dwordx4 v163, s[16:19], s49 offen nt lds
    s_add_u32 s47, s47, 8192
K1_SP86:
    s_waitcnt lgkmcnt(13)
    v_mfma_f32_32x32x16_bf16 v[96:111], v[136:139], v[88:91], v[96:111]
    ds_read_b64_tr_b16 v[136:137], v154 offset:45056
    ds_read_b64_tr_b16 v[138:139], v154 offset:47104
    s_cmp_lg_u32 s68, 3
    s_cbranch_scc1 K1_SP87
    s_add_u32 m0, s46, 4096
    s_add_u32 s49, s47, 4096
    buffer_load_dwordx4 v163, s[16:19], s49 offen nt lds
    s_add_u32 s47, s47, 8192
K1_SP87:
    s_waitcnt lgkmcnt(14)
    v_mfma_f32_32x32x16_bf16 v[96:111], v[140:143], v[92:95], v[96:111]
    ds_read_b64_tr_b16 v[140:141], v155 offset:45056
    ds_read_b64_tr_b16 v[142:143], v155 offset:47104
    s_nop 9
    v_max3_f32 v161, v96, v97, v98
    v_max3_f32 v162, v99, v100, v101
    v_max3_f32 v161, v161, v102, v103
    v_max3_f32 v162, v162, v104, v105
    v_max3_f32 v161, v161, v106, v107
    v_max3_f32 v162, v162, v108, v109
    v_max3_f32 v161, v161, v110, v111
    v_max_f32 v161, v161, v162
    v_cmp_gt_f32 vcc, v161, v157
    s_cbranch_vccnz K1_SLOWr0a1
K1_RETr0a1:
    v_fma_f32 v96, v96, s31, v158
    v_fma_f32 v97, v97, s31, v158
    v_fma_f32 v98, v98, s31, v158
    v_fma_f32 v99, v99, s31, v158
    v_fma_f32 v100, v100, s31, v158
    v_fma_f32 v101, v101, s31, v158
    v_fma_f32 v102, v102, s31, v158
    v_fma_f32 v103, v103, s31, v158
    v_fma_f32 v104, v104, s31, v158
    v_fma_f32 v105, v105, s31, v158
    v_fma_f32 v106, v106, s31, v158
    v_fma_f32 v107, v107, s31, v158
    v_fma_f32 v108, v108, s31, v158
    v_fma_f32 v109, v109, s31, v158
    v_fma_f32 v110, v110, s31, v158
    v_fma_f32 v111, v111, s31, v158
    v_exp_f32 v96, v96
    v_exp_f32 v97, v97
    v_exp_f32 v98, v98
    v_exp_f32 v99, v99
    v_exp_f32 v100, v100
    v_exp_f32 v101, v101
    v_exp_f32 v102, v102
    v_exp_f32 v103, v103
    v_exp_f32 v104, v104
    v_exp_f32 v105, v105
    v_exp_f32 v106, v106
    v_exp_f32 v107, v107
    v_exp_f32 v108, v108
    v_exp_f32 v109, v109
    v_exp_f32 v110, v110
    v_exp_f32 v111, v111
    v_add_f32 v159, v159, v96
    v_add_f32 v160, v160, v97
    v_cvt_pk_bf16_f32 v96, v96, v97
    v_add_f32 v159, v159, v98
    v_add_f32 v160, v160, v99
    v_cvt_pk_bf16_f32 v97, v98, v99
    v_add_f32 v159, v159, v100
    v_add_f32 v160, v160, v101
    v_cvt_pk_bf16_f32 v98, v100, v101
    v_add_f32 v159, v159, v102
    v_add_f32 v160, v160, v103
    v_cvt_pk_bf16_f32 v99, v102, v103
    v_add_f32 v159, v159, v104
    v_add_f32 v160, v160, v105
    v_cvt_pk_bf16_f32 v100, v104, v105
    v_add_f32 v159, v159, v106
    v_add_f32 v160, v160, v107
    v_cvt_pk_bf16_f32 v101, v106, v107
    v_add_f32 v159, v159, v108
    v_add_f32 v160, v160, v109
    v_cvt_pk_bf16_f32 v102, v108, v109
    v_add_f32 v159, v159, v110
    v_add_f32 v160, v160, v111
    v_cvt_pk_bf16_f32 v103, v110, v111
    s_cmp_lg_u32 s68, 0
    s_cbranch_scc1 K1_SP88
    s_add_u32 m0, s46, 32768
    s_add_u32 s49, s48, 0
    buffer_load_dwordx4 v164, s[20:23], s49 offen nt lds
K1_SP88:
    s_waitcnt lgkmcnt(14)
    v_mfma_f32_32x32x16_bf16 v[0:15], v[112:115], v[96:99], v[0:15]
    s_cmp_lg_u32 s68, 1
    s_cbranch_scc1 K1_SP89
    s_add_u32 m0, s46, 32768
    s_add_u32 s49, s48, 0
    buffer_load_dwordx4 v164, s[20:23], s49 offen nt lds
K1_SP89:
    s_waitcnt lgkmcnt(12)
    v_mfma_f32_32x32x16_bf16 v[16:31], v[116:119], v[96:99], v[16:31]
    s_cmp_lg_u32 s68, 2
    s_cbranch_scc1 K1_SP90
    s_add_u32 m0, s46, 32768
    s_add_u32 s49, s48, 0
    buffer_load_dwordx4 v164, s[20:23], s49 offen nt lds
K1_SP90:
    s_waitcnt lgkmcnt(10)
    v_mfma_f32_32x32x16_bf16 v[32:47], v[120:123], v[96:99], v[32:47]
    s_cmp_lg_u32 s68, 3
    s_cbranch_scc1 K1_SP91
    s_add_u32 m0, s46, 32768
    s_add_u32 s49, s48, 0
    buffer_load_dwordx4 v164, s[20:23], s49 offen nt lds
K1_SP91:
    s_waitcnt lgkmcnt(8)
    v_mfma_f32_32x32x16_bf16 v[48:63], v[124:127], v[96:99], v[48:63]
    s_cmp_lg_u32 s68, 0
    s_cbranch_scc1 K1_SP92
    s_add_u32 m0, s46, 36864
    s_add_u32 s49, s48, 4096
    buffer_load_dwordx4 v164, s[20:23], s49 offen nt lds
    s_add_u32 s48, s48, 8192
K1_SP92:
    s_waitcnt lgkmcnt(6)
    v_mfma_f32_32x32x16_bf16 v[0:15], v[128:131], v[100:103], v[0:15]
    s_cmp_lg_u32 s68, 1
    s_cbranch_scc1 K1_SP93
    s_add_u32 m0, s46, 36864
    s_add_u32 s49, s48, 4096
    buffer_load_dwordx4 v164, s[20:23], s49 offen nt lds
    s_add_u32 s48, s48, 8192
K1_SP93:
    s_waitcnt lgkmcnt(4)
    v_mfma_f32_32x32x16_bf16 v[16:31], v[132:135], v[100:103], v[16:31]
    s_cmp_lg_u32 s68, 2
    s_cbranch_scc1 K1_SP94
    s_add_u32 m0, s46, 36864
    s_add_u32 s49, s48, 4096
    buffer_load_dwordx4 v164, s[20:23], s49 offen nt lds
    s_add_u32 s48, s48, 8192
K1_SP94:
    s_waitcnt lgkmcnt(2)
    v_mfma_f32_32x32x16_bf16 v[32:47], v[136:139], v[100:103], v[32:47]
    s_cmp_lg_u32 s68, 3
    s_cbranch_scc1 K1_SP95
    s_add_u32 m0, s46, 36864
    s_add_u32 s49, s48, 4096
    buffer_load_dwordx4 v164, s[20:23], s49 offen nt lds
    s_add_u32 s48, s48, 8192
K1_SP95:
    s_waitcnt lgkmcnt(0)
    v_mfma_f32_32x32x16_bf16 v[48:63], v[140:143], v[100:103], v[48:63]
    s_waitcnt vmcnt(8) lgkmcnt(0)
    s_barrier
    ds_read_b128 v[112:115], v144 offset:16384
    ds_read_b128 v[116:119], v145 offset:16384
    ds_read_b128 v[120:123], v146 offset:16384
    ds_read_b128 v[124:127], v147 offset:16384
    ds_read_b128 v[128:131], v148 offset:16384
    ds_read_b128 v[132:135], v149 offset:16384
    ds_read_b128 v[136:139], v150 offset:16384
    ds_read_b128 v[140:143], v151 offset:16384
    s_cmp_lg_u32 s68, 0
    s_cbranch_scc1 K1_SP96
    s_add_u32 m0, s46, 8192
    s_add_u32 s49, s47, 0
    buffer_load_dwordx4 v163, s[16:19], s49 offen nt lds
K1_SP96:
    s_waitcnt lgkmcnt(7)
    v_mfma_f32_32x32x16_bf16 v[96:111], v[112:115], v[64:67], 0
    ds_read_b64_tr_b16 v[112:113], v152 offset:49152
    ds_read_b64_tr_b16 v[114:115], v152 offset:51200
    s_cmp_lg_u32 s68, 1
    s_cbranch_scc1 K1_SP97
    s_add_u32 m0, s46, 8192
    s_add_u32 s49, s47, 0
    buffer_load_dwordx4 v163, s[16:19], s49 offen nt lds
K1_SP97:
    s_waitcnt lgkmcnt(8)
    v_mfma_f32_32x32x16_bf16 v[96:111], v[116:119], v[68:71], v[96:111]
    ds_read_b64_tr_b16 v[116:117], v153 offset:49152
    ds_read_b64_tr_b16 v[118:119], v153 offset:51200
    s_cmp_lg_u32 s68, 2
    s_cbranch_scc1 K1_SP98
    s_add_u32 m0, s46, 8192
    s_add_u32 s49, s47, 0
    buffer_load_dwordx4 v163, s[16:19], s49 offen nt lds
K1_SP98:
    s_waitcnt lgkmcnt(9)
    v_mfma_f32_32x32x16_bf16 v[96:111], v[120:123], v[72:75], v[96:111]
    ds_read_b64_tr_b16 v[120:121], v154 offset:49152
    ds_read_b64_tr_b16 v[122:123], v154 offset:51200
    s_cmp_lg_u32 s68, 3
    s_cbranch_scc1 K1_SP99
    s_add_u32 m0, s46, 8192
    s_add_u32 s49, s47, 0
    buffer_load_dwordx4 v163, s[16:19], s49 offen nt lds
K1_SP99:
    s_waitcnt lgkmcnt(10)
    v_mfma_f32_32x32x16_bf16 v[96:111], v[124:127], v[76:79], v[96:111]
    ds_read_b64_tr_b16 v[124:125], v155 offset:49152
    ds_read_b64_tr_b16 v[126:127], v155 offset:51200
    s_cmp_lg_u32 s68, 0
    s_cbranch_scc1 K1_SP100
    s_add_u32 m0, s46, 12288
    s_add_u32 s49, s47, 4096
    buffer_load_dwordx4 v163, s[16:19], s49 offen nt lds
    s_add_u32 s47, s47, 8192
K1_SP100:
    s_waitcnt lgkmcnt(11)
    v_mfma_f32_32x32x16_bf16 v[96:111], v[128:131], v[80:83], v[96:111]
    ds_read_b64_tr_b16 v[128:129], v152 offset:53248
    ds_read_b64_tr_b16 v[130:131], v152 offset:55296
    s_cmp_lg_u32 s68, 1
    s_cbranch_scc1 K1_SP101
    s_add_u32 m0, s46, 12288
    s_add_u32 s49, s47, 4096
    buffer_load_dwordx4 v163, s[16:19], s49 offen nt lds
    s_add_u32 s47, s47, 8192
K1_SP101:
    s_waitcnt lgkmcnt(12)
    v_mfma_f32_32x32x16_bf16 v[96:111], v[132:135], v[84:87], v[96:111]
    ds_read_b64_tr_b16 v[132:133], v153 offset:53248
    ds_read_b64_tr_b16 v[134:135], v153 offset:55296
    s_cmp_lg_u32 s68, 2
    s_cbranch_scc1 K1_SP102
    s_add_u32 m0, s46, 12288
    s_add_u32 s49, s47, 4096
    buffer_load_dwordx4 v163, s[16:19], s49 offen nt lds
    s_add_u32 s47, s47, 8192
K1_SP102:
    s_waitcnt lgkmcnt(13)
    v_mfma_f32_32x32x16_bf16 v[96:111], v[136:139], v[88:91], v[96:111]
    ds_read_b64_tr_b16 v[136:137], v154 offset:53248
    ds_read_b64_tr_b16 v[138:139], v154 offset:55296
    s_cmp_lg_u32 s68, 3
    s_cbranch_scc1 K1_SP103
    s_add_u32 m0, s46, 12288
    s_add_u32 s49, s47, 4096
    buffer_load_dwordx4 v163, s[16:19], s49 offen nt lds
    s_add_u32 s47, s47, 8192
K1_SP103:
    s_waitcnt lgkmcnt(14)
    v_mfma_f32_32x32x16_bf16 v[96:111], v[140:143], v[92:95], v[96:111]
    ds_read_b64_tr_b16 v[140:141], v155 offset:53248
    ds_read_b64_tr_b16 v[142:143], v155 offset:55296
    s_nop 9
    v_max3_f32 v161, v96, v97, v98
    v_max3_f32 v162, v99, v100, v101
    v_max3_f32 v161, v161, v102, v103
    v_max3_f32 v162, v162, v104, v105
    v_max3_f32 v161, v161, v106, v107
    v_max3_f32 v162, v162, v108, v109
    v_max3_f32 v161, v161, v110, v111
    v_max_f32 v161, v161, v162
    v_cmp_gt_f32 vcc, v161, v157
    s_cbranch_vccnz K1_SLOWr0a2
K1_RETr0a2:
    v_fma_f32 v96, v96, s31, v158
    v_fma_f32 v97, v97, s31, v158
    v_fma_f32 v98, v98, s31, v158
    v_fma_f32 v99, v99, s31, v158
    v_fma_f32 v100, v100, s31, v158
    v_fma_f32 v101, v101, s31, v158
    v_fma_f32 v102, v102, s31, v158
    v_fma_f32 v103, v103, s31, v158
    v_fma_f32 v104, v104, s31, v158
    v_fma_f32 v105, v105, s31, v158
    v_fma_f32 v106, v106, s31, v158
    v_fma_f32 v107, v107, s31, v158
    v_fma_f32 v108, v108, s31, v158
    v_fma_f32 v109, v109, s31, v158
    v_fma_f32 v110, v110, s31, v158
    v_fma_f32 v111, v111, s31, v158
    v_exp_f32 v96, v96
    v_exp_f32 v97, v97
    v_exp_f32 v98, v98
    v_exp_f32 v99, v99
    v_exp_f32 v100, v100
    v_exp_f32 v101, v101
    v_exp_f32 v102, v102
    v_exp_f32 v103, v103
    v_exp_f32 v104, v104
    v_exp_f32 v105, v105
    v_exp_f32 v106, v106
    v_exp_f32 v107, v107
    v_exp_f32 v108, v108
    v_exp_f32 v109, v109
    v_exp_f32 v110, v110
    v_exp_f32 v111, v111
    v_add_f32 v159, v159, v96
    v_add_f32 v160, v160, v97
    v_cvt_pk_bf16_f32 v96, v96, v97
    v_add_f32 v159, v159, v98
    v_add_f32 v160, v160, v99
    v_cvt_pk_bf16_f32 v97, v98, v99
    v_add_f32 v159, v159, v100
    v_add_f32 v160, v160, v101
    v_cvt_pk_bf16_f32 v98, v100, v101
    v_add_f32 v159, v159, v102
    v_add_f32 v160, v160, v103
    v_cvt_pk_bf16_f32 v99, v102, v103
    v_add_f32 v159, v159, v104
    v_add_f32 v160, v160, v105
    v_cvt_pk_bf16_f32 v100, v104, v105
    v_add_f32 v159, v159, v106
    v_add_f32 v160, v160, v107
    v_cvt_pk_bf16_f32 v101, v106, v107
    v_add_f32 v159, v159, v108
    v_add_f32 v160, v160, v109
    v_cvt_pk_bf16_f32 v102, v108, v109
    v_add_f32 v159, v159, v110
    v_add_f32 v160, v160, v111
    v_cvt_pk_bf16_f32 v103, v110, v111
    s_cmp_lg_u32 s68, 0
    s_cbranch_scc1 K1_SP104
    s_add_u32 m0, s46, 40960
    s_add_u32 s49, s48, 0
    buffer_load_dwordx4 v164, s[20:23], s49 offen nt lds
K1_SP104:
    s_waitcnt lgkmcnt(14)
    v_mfma_f32_32x32x16_bf16 v[0:15], v[112:115], v[96:99], v[0:15]
    s_cmp_lg_u32 s68, 1
    s_cbranch_scc1 K1_SP105
    s_add_u32 m0, s46, 40960
    s_add_u32 s49, s48, 0
    buffer_load_dwordx4 v164, s[20:23], s49 offen nt lds
K1_SP105:
    s_waitcnt lgkmcnt(12)
    v_mfma_f32_32x32x16_bf16 v[16:31], v[116:119], v[96:99], v[16:31]
    s_cmp_lg_u32 s68, 2
    s_cbranch_scc1 K1_SP106
    s_add_u32 m0, s46, 40960
    s_add_u32 s49, s48, 0
    buffer_load_dwordx4 v164, s[20:23], s49 offen nt lds
K1_SP106:
    s_waitcnt lgkmcnt(10)
    v_mfma_f32_32x32x16_bf16 v[32:47], v[120:123], v[96:99], v[32:47]
    s_cmp_lg_u32 s68, 3
    s_cbranch_scc1 K1_SP107
    s_add_u32 m0, s46, 40960
    s_add_u32 s49, s48, 0
    buffer_load_dwordx4 v164, s[20:23], s49 offen nt lds
K1_SP107:
    s_waitcnt lgkmcnt(8)
    v_mfma_f32_32x32x16_bf16 v[48:63], v[124:127], v[96:99], v[48:63]
    s_cmp_lg_u32 s68, 0
    s_cbranch_scc1 K1_SP108
    s_add_u32 m0, s46, 45056
    s_add_u32 s49, s48, 4096
    buffer_load_dwordx4 v164, s[20:23], s49 offen nt lds
    s_add_u32 s48, s48, 8192
K1_SP108:
    s_waitcnt lgkmcnt(6)
    v_mfma_f32_32x32x16_bf16 v[0:15], v[128:131], v[100:103], v[0:15]
    s_cmp_lg_u32 s68, 1
    s_cbranch_scc1 K1_SP109
    s_add_u32 m0, s46, 45056
    s_add_u32 s49, s48, 4096
    buffer_load_dwordx4 v164, s[20:23], s49 offen nt lds
    s_add_u32 s48, s48, 8192
K1_SP109:
    s_waitcnt lgkmcnt(4)
    v_mfma_f32_32x32x16_bf16 v[16:31], v[132:135], v[100:103], v[16:31]
    s_cmp_lg_u32 s68, 2
    s_cbranch_scc1 K1_SP110
    s_add_u32 m0, s46, 45056
    s_add_u32 s49, s48, 4096
    buffer_load_dwordx4 v164, s[20:23], s49 offen nt lds
    s_add_u32 s48, s48, 8192
K1_SP110:
    s_waitcnt lgkmcnt(2)
    v_mfma_f32_32x32x16_bf16 v[32:47], v[136:139], v[100:103], v[32:47]
    s_cmp_lg_u32 s68, 3
    s_cbranch_scc1 K1_SP111
    s_add_u32 m0, s46, 45056
    s_add_u32 s49, s48, 4096
    buffer_load_dwordx4 v164, s[20:23], s49 offen nt lds
    s_add_u32 s48, s48, 8192
K1_SP111:
    s_waitcnt lgkmcnt(0)
    v_mfma_f32_32x32x16_bf16 v[48:63], v[140:143], v[100:103], v[48:63]
    s_waitcnt vmcnt(8) lgkmcnt(0)
    s_barrier
    ds_read_b128 v[112:115], v144 offset:24576
    ds_read_b128 v[116:119], v145 offset:24576
    ds_read_b128 v[120:123], v146 offset:24576
    ds_read_b128 v[124:127], v147 offset:24576
    ds_read_b128 v[128:131], v148 offset:24576
    ds_read_b128 v[132:135], v149 offset:24576
    ds_read_b128 v[136:139], v150 offset:24576
    ds_read_b128 v[140:143], v151 offset:24576
    s_cmp_lg_u32 s68, 0
    s_cbranch_scc1 K1_SP112
    s_add_u32 m0, s46, 16384
    s_add_u32 s49, s47, 0
    buffer_load_dwordx4 v163, s[16:19], s49 offen nt lds
K1_SP112:
    s_waitcnt lgkmcnt(7)
    v_mfma_f32_32x32x16_bf16 v[96:111], v[112:115], v[64:67], 0
    ds_read_b64_tr_b16 v[112:113], v152 offset:57344
    ds_read_b64_tr_b16 v[114:115], v152 offset:59392
    s_cmp_lg_u32 s68, 1
    s_cbranch_scc1 K1_SP113
    s_add_u32 m0, s46, 16384
    s_add_u32 s49, s47, 0
    buffer_load_dwordx4 v163, s[16:19], s49 offen nt lds
K1_SP113:
    s_waitcnt lgkmcnt(8)
    v_mfma_f32_32x32x16_bf16 v[96:111], v[116:119], v[68:71], v[96:111]
    ds_read_b64_tr_b16 v[116:117], v153 offset:57344
    ds_read_b64_tr_b16 v[118:119], v153 offset:59392
    s_cmp_lg_u32 s68, 2
    s_cbranch_scc1 K1_SP114
    s_add_u32 m0, s46, 16384
    s_add_u32 s49, s47, 0
    buffer_load_dwordx4 v163, s[16:19], s49 offen nt lds
K1_SP114:
    s_waitcnt lgkmcnt(9)
    v_mfma_f32_32x32x16_bf16 v[96:111], v[120:123], v[72:75], v[96:111]
    ds_read_b64_tr_b16 v[120:121], v154 offset:57344
    ds_read_b64_tr_b16 v[122:123], v154 offset:59392
    s_cmp_lg_u32 s68, 3
    s_cbranch_scc1 K1_SP115
    s_add_u32 m0, s46, 16384
    s_add_u32 s49, s47, 0
    buffer_load_dwordx4 v163, s[16:19], s49 offen nt lds
K1_SP115:
    s_waitcnt lgkmcnt(10)
    v_mfma_f32_32x32x16_bf16 v[96:111], v[124:127], v[76:79], v[96:111]
    ds_read_b64_tr_b16 v[124:125], v155 offset:57344
    ds_read_b64_tr_b16 v[126:127], v155 offset:59392
    s_cmp_lg_u32 s68, 0
    s_cbranch_scc1 K1_SP116
    s_add_u32 m0, s46, 20480
    s_add_u32 s49, s47, 4096
    buffer_load_dwordx4 v163, s[16:19], s49 offen nt lds
    s_add_u32 s47, s47, 8192
K1_SP116:
    s_waitcnt lgkmcnt(11)
    v_mfma_f32_32x32x16_bf16 v[96:111], v[128:131], v[80:83], v[96:111]
    ds_read_b64_tr_b16 v[128:129], v152 offset:61440
    ds_read_b64_tr_b16 v[130:131], v152 offset:63488
    s_cmp_lg_u32 s68, 1
    s_cbranch_scc1 K1_SP117
    s_add_u32 m0, s46, 20480
    s_add_u32 s49, s47, 4096
    buffer_load_dwordx4 v163, s[16:19], s49 offen nt lds
    s_add_u32 s47, s47, 8192
K1_SP117:
    s_waitcnt lgkmcnt(12)
    v_mfma_f32_32x32x16_bf16 v[96:111], v[132:135], v[84:87], v[96:111]
    ds_read_b64_tr_b16 v[132:133], v153 offset:61440
    ds_read_b64_tr_b16 v[134:135], v153 offset:63488
    s_cmp_lg_u32 s68, 2
    s_cbranch_scc1 K1_SP118
    s_add_u32 m0, s46, 20480
    s_add_u32 s49, s47, 4096
    buffer_load_dwordx4 v163, s[16:19], s49 offen nt lds
    s_add_u32 s47, s47, 8192
K1_SP118:
    s_waitcnt lgkmcnt(13)
    v_mfma_f32_32x32x16_bf16 v[96:111], v[136:139], v[88:91], v[96:111]
    ds_read_b64_tr_b16 v[136:137], v154 offset:61440
    ds_read_b64_tr_b16 v[138:139], v154 offset:63488
    s_cmp_lg_u32 s68, 3
    s_cbranch_scc1 K1_SP119
    s_add_u32 m0, s46, 20480
    s_add_u32 s49, s47, 4096
    buffer_load_dwordx4 v163, s[16:19], s49 offen nt lds
    s_add_u32 s47, s47, 8192
K1_SP119:
    s_waitcnt lgkmcnt(14)
    v_mfma_f32_32x32x16_bf16 v[96:111], v[140:143], v[92:95], v[96:111]
    ds_read_b64_tr_b16 v[140:141], v155 offset:61440
    ds_read_b64_tr_b16 v[142:143], v155 offset:63488
    s_nop 9
    v_max3_f32 v161, v96, v97, v98
    v_max3_f32 v162, v99, v100, v101
    v_max3_f32 v161, v161, v102, v103
    v_max3_f32 v162, v162, v104, v105
    v_max3_f32 v161, v161, v106, v107
    v_max3_f32 v162, v162, v108, v109
    v_max3_f32 v161, v161, v110, v111
    v_max_f32 v161, v161, v162
    v_cmp_gt_f32 vcc, v161, v157
    s_cbranch_vccnz K1_SLOWr0a3
K1_RETr0a3:
    v_fma_f32 v96, v96, s31, v158
    v_fma_f32 v97, v97, s31, v158
    v_fma_f32 v98, v98, s31, v158
    v_fma_f32 v99, v99, s31, v158
    v_fma_f32 v100, v100, s31, v158
    v_fma_f32 v101, v101, s31, v158
    v_fma_f32 v102, v102, s31, v158
    v_fma_f32 v103, v103, s31, v158
    v_fma_f32 v104, v104, s31, v158
    v_fma_f32 v105, v105, s31, v158
    v_fma_f32 v106, v106, s31, v158
    v_fma_f32 v107, v107, s31, v158
    v_fma_f32 v108, v108, s31, v158
    v_fma_f32 v109, v109, s31, v158
    v_fma_f32 v110, v110, s31, v158
    v_fma_f32 v111, v111, s31, v158
    v_exp_f32 v96, v96
    v_exp_f32 v97, v97
    v_exp_f32 v98, v98
    v_exp_f32 v99, v99
    v_exp_f32 v100, v100
    v_exp_f32 v101, v101
    v_exp_f32 v102, v102
    v_exp_f32 v103, v103
    v_exp_f32 v104, v104
    v_exp_f32 v105, v105
    v_exp_f32 v106, v106
    v_exp_f32 v107, v107
    v_exp_f32 v108, v108
    v_exp_f32 v109, v109
    v_exp_f32 v110, v110
    v_exp_f32 v111, v111
    v_add_f32 v159, v159, v96
    v_add_f32 v160, v160, v97
    v_cvt_pk_bf16_f32 v96, v96, v97
    v_add_f32 v159, v159, v98
    v_add_f32 v160, v160, v99
    v_cvt_pk_bf16_f32 v97, v98, v99
    v_add_f32 v159, v159, v100
    v_add_f32 v160, v160, v101
    v_cvt_pk_bf16_f32 v98, v100, v101
    v_add_f32 v159, v159, v102
    v_add_f32 v160, v160, v103
    v_cvt_pk_bf16_f32 v99, v102, v103
    v_add_f32 v159, v159, v104
    v_add_f32 v160, v160, v105
    v_cvt_pk_bf16_f32 v100, v104, v105
    v_add_f32 v159, v159, v106
    v_add_f32 v160, v160, v107
    v_cvt_pk_bf16_f32 v101, v106, v107
    v_add_f32 v159, v159, v108
    v_add_f32 v160, v160, v109
    v_cvt_pk_bf16_f32 v102, v108, v109
    v_add_f32 v159, v159, v110
    v_add_f32 v160, v160, v111
    v_cvt_pk_bf16_f32 v103, v110, v111
    s_cmp_lg_u32 s68, 0
    s_cbranch_scc1 K1_SP120
    s_add_u32 m0, s46, 49152
    s_add_u32 s49, s48, 0
    buffer_load_dwordx4 v164, s[20:23], s49 offen nt lds
K1_SP120:
    s_waitcnt lgkmcnt(14)
    v_mfma_f32_32x32x16_bf16 v[0:15], v[112:115], v[96:99], v[0:15]
    s_cmp_lg_u32 s68, 1
    s_cbranch_scc1 K1_SP121
    s_add_u32 m0, s46, 49152
    s_add_u32 s49, s48, 0
    buffer_load_dwordx4 v164, s[20:23], s49 offen nt lds
K1_SP121:
    s_waitcnt lgkmcnt(12)
    v_mfma_f32_32x32x16_bf16 v[16:31], v[116:119], v[96:99], v[16:31]
    s_cmp_lg_u32 s68, 2
    s_cbranch_scc1 K1_SP122
    s_add_u32 m0, s46, 49152
    s_add_u32 s49, s48, 0
    buffer_load_dwordx4 v164, s[20:23], s49 offen nt lds
K1_SP122:
    s_waitcnt lgkmcnt(10)
    v_mfma_f32_32x32x16_bf16 v[32:47], v[120:123], v[96:99], v[32:47]
    s_cmp_lg_u32 s68, 3
    s_cbranch_scc1 K1_SP123
    s_add_u32 m0, s46, 49152
    s_add_u32 s49, s48, 0
    buffer_load_dwordx4 v164, s[20:23], s49 offen nt lds
K1_SP123:
    s_waitcnt lgkmcnt(8)
    v_mfma_f32_32x32x16_bf16 v[48:63], v[124:127], v[96:99], v[48:63]
    s_cmp_lg_u32 s68, 0
    s_cbranch_scc1 K1_SP124
    s_add_u32 m0, s46, 53248
    s_add_u32 s49, s48, 4096
    buffer_load_dwordx4 v164, s[20:23], s49 offen nt lds
    s_add_u32 s48, s48, 8192
K1_SP124:
    s_waitcnt lgkmcnt(6)
    v_mfma_f32_32x32x16_bf16 v[0:15], v[128:131], v[100:103], v[0:15]
    s_cmp_lg_u32 s68, 1
    s_cbranch_scc1 K1_SP125
    s_add_u32 m0, s46, 53248
    s_add_u32 s49, s48, 4096
    buffer_load_dwordx4 v164, s[20:23], s49 offen nt lds
    s_add_u32 s48, s48, 8192
K1_SP125:
    s_waitcnt lgkmcnt(4)
    v_mfma_f32_32x32x16_bf16 v[16:31], v[132:135], v[100:103], v[16:31]
    s_cmp_lg_u32 s68, 2
    s_cbranch_scc1 K1_SP126
    s_add_u32 m0, s46, 53248
    s_add_u32 s49, s48, 4096
    buffer_load_dwordx4 v164, s[20:23], s49 offen nt lds
    s_add_u32 s48, s48, 8192
K1_SP126:
    s_waitcnt lgkmcnt(2)
    v_mfma_f32_32x32x16_bf16 v[32:47], v[136:139], v[100:103], v[32:47]
    s_cmp_lg_u32 s68, 3
    s_cbranch_scc1 K1_SP127
    s_add_u32 m0, s46, 53248
    s_add_u32 s49, s48, 4096
    buffer_load_dwordx4 v164, s[20:23], s49 offen nt lds
    s_add_u32 s48, s48, 8192
K1_SP127:
    s_waitcnt lgkmcnt(0)
    v_mfma_f32_32x32x16_bf16 v[48:63], v[140:143], v[100:103], v[48:63]
    s_waitcnt vmcnt(8) lgkmcnt(0)
    s_add_u32 s50, s50, 1
    s_cmp_lt_u32 s50, 6
    s_cbranch_scc1 K1_LOOPr0
    s_barrier
    ds_read_b128 v[112:115], v144 offset:0
    ds_read_b128 v[116:119], v145 offset:0
    ds_read_b128 v[120:123], v146 offset:0
    ds_read_b128 v[124:127], v147 offset:0
    ds_read_b128 v[128:131], v148 offset:0
    ds_read_b128 v[132:135], v149 offset:0
    ds_read_b128 v[136:139], v150 offset:0
    ds_read_b128 v[140:143], v151 offset:0
    s_cmp_lg_u32 s68, 0
    s_cbranch_scc1 K1_SP128
    s_add_u32 m0, s46, 24576
    s_add_u32 s49, s47, 0
    buffer_load_dwordx4 v163, s[16:19], s49 offen nt lds
K1_SP128:
    s_waitcnt lgkmcnt(7)
    v_mfma_f32_32x32x16_bf16 v[96:111], v[112:115], v[64:67], 0
    ds_read_b64_tr_b16 v[112:113], v152 offset:32768
    ds_read_b64_tr_b16 v[114:115], v152 offset:34816
    s_cmp_lg_u32 s68, 1
    s_cbranch_scc1 K1_SP129
    s_add_u32 m0, s46, 24576
    s_add_u32 s49, s47, 0
    buffer_load_dwordx4 v163, s[16:19], s49 offen nt lds
K1_SP129:
    s_waitcnt lgkmcnt(8)
    v_mfma_f32_32x32x16_bf16 v[96:111], v[116:119], v[68:71], v[96:111]
    ds_read_b64_tr_b16 v[116:117], v153 offset:32768
    ds_read_b64_tr_b16 v[118:119], v153 offset:34816
    s_cmp_lg_u32 s68, 2
    s_cbranch_scc1 K1_SP130
    s_add_u32 m0, s46, 24576
    s_add_u32 s49, s47, 0
    buffer_load_dwordx4 v163, s[16:19], s49 offen nt lds
K1_SP130:
    s_waitcnt lgkmcnt(9)
    v_mfma_f32_32x32x16_bf16 v[96:111], v[120:123], v[72:75], v[96:111]
    ds_read_b64_tr_b16 v[120:121], v154 offset:32768
    ds_read_b64_tr_b16 v[122:123], v154 offset:34816
    s_cmp_lg_u32 s68, 3
    s_cbranch_scc1 K1_SP131
    s_add_u32 m0, s46, 24576
    s_add_u32 s49, s47, 0
    buffer_load_dwordx4 v163, s[16:19], s49 offen nt lds
K1_SP131:
    s_waitcnt lgkmcnt(10)
    v_mfma_f32_32x32x16_bf16 v[96:111], v[124:127], v[76:79], v[96:111]
    ds_read_b64_tr_b16 v[124:125], v155 offset:32768
    ds_read_b64_tr_b16 v[126:127], v155 offset:34816
    s_cmp_lg_u32 s68, 0
    s_cbranch_scc1 K1_SP132
    s_add_u32 m0, s46, 28672
    s_add_u32 s49, s47, 4096
    buffer_load_dwordx4 v163, s[16:19], s49 offen nt lds
    s_add_u32 s47, s47, 8192
K1_SP132:
    s_waitcnt lgkmcnt(11)
    v_mfma_f32_32x32x16_bf16 v[96:111], v[128:131], v[80:83], v[96:111]
    ds_read_b64_tr_b16 v[128:129], v152 offset:36864
    ds_read_b64_tr_b16 v[130:131], v152 offset:38912
    s_cmp_lg_u32 s68, 1
    s_cbranch_scc1 K1_SP133
    s_add_u32 m0, s46, 28672
    s_add_u32 s49, s47, 4096
    buffer_load_dwordx4 v163, s[16:19], s49 offen nt lds
    s_add_u32 s47, s47, 8192
K1_SP133:
    s_waitcnt lgkmcnt(12)
    v_mfma_f32_32x32x16_bf16 v[96:111], v[132:135], v[84:87], v[96:111]
    ds_read_b64_tr_b16 v[132:133], v153 offset:36864
    ds_read_b64_tr_b16 v[134:135], v153 offset:38912
    s_cmp_lg_u32 s68, 2
    s_cbranch_scc1 K1_SP134
    s_add_u32 m0, s46, 28672
    s_add_u32 s49, s47, 4096
    buffer_load_dwordx4 v163, s[16:19], s49 offen nt lds
    s_add_u32 s47, s47, 8192
K1_SP134:
    s_waitcnt lgkmcnt(13)
    v_mfma_f32_32x32x16_bf16 v[96:111], v[136:139], v[88:91], v[96:111]
    ds_read_b64_tr_b16 v[136:137], v154 offset:36864
    ds_read_b64_tr_b16 v[138:139], v154 offset:38912
    s_cmp_lg_u32 s68, 3
    s_cbranch_scc1 K1_SP135
    s_add_u32 m0, s46, 28672
    s_add_u32 s49, s47, 4096
    buffer_load_dwordx4 v163, s[16:19], s49 offen nt lds
    s_add_u32 s47, s47, 8192
K1_SP135:
    s_waitcnt lgkmcnt(14)
    v_mfma_f32_32x32x16_bf16 v[96:111], v[140:143], v[92:95], v[96:111]
    ds_read_b64_tr_b16 v[140:141], v155 offset:36864
    ds_read_b64_tr_b16 v[142:143], v155 offset:38912
    s_nop 9
    v_max3_f32 v161, v96, v97, v98
    v_max3_f32 v162, v99, v100, v101
    v_max3_f32 v161, v161, v102, v103
    v_max3_f32 v162, v162, v104, v105
    v_max3_f32 v161, v161, v106, v107
    v_max3_f32 v162, v162, v108, v109
    v_max3_f32 v161, v161, v110, v111
    v_max_f32 v161, v161, v162
    v_cmp_gt_f32 vcc, v161, v157
    s_cbranch_vccnz K1_SLOWr0b0
K1_RETr0b0:
    v_fma_f32 v96, v96, s31, v158
    v_fma_f32 v97, v97, s31, v158
    v_fma_f32 v98, v98, s31, v158
    v_fma_f32 v99, v99, s31, v158
    v_fma_f32 v100, v100, s31, v158
    v_fma_f32 v101, v101, s31, v158
    v_fma_f32 v102, v102, s31, v158
    v_fma_f32 v103, v103, s31, v158
    v_fma_f32 v104, v104, s31, v158
    v_fma_f32 v105, v105, s31, v158
    v_fma_f32 v106, v106, s31, v158
    v_fma_f32 v107, v107, s31, v158
    v_fma_f32 v108, v108, s31, v158
    v_fma_f32 v109, v109, s31, v158
    v_fma_f32 v110, v110, s31, v158
    v_fma_f32 v111, v111, s31, v158
    v_exp_f32 v96, v96
    v_exp_f32 v97, v97
    v_exp_f32 v98, v98
    v_exp_f32 v99, v99
    v_exp_f32 v100, v100
    v_exp_f32 v101, v101
    v_exp_f32 v102, v102
    v_exp_f32 v103, v103
    v_exp_f32 v104, v104
    v_exp_f32 v105, v105
    v_exp_f32 v106, v106
    v_exp_f32 v107, v107
    v_exp_f32 v108, v108
    v_exp_f32 v109, v109
    v_exp_f32 v110, v110
    v_exp_f32 v111, v111
    v_add_f32 v159, v159, v96
    v_add_f32 v160, v160, v97
    v_cvt_pk_bf16_f32 v96, v96, v97
    v_add_f32 v159, v159, v98
    v_add_f32 v160, v160, v99
    v_cvt_pk_bf16_f32 v97, v98, v99
    v_add_f32 v159, v159, v100
    v_add_f32 v160, v160, v101
    v_cvt_pk_bf16_f32 v98, v100, v101
    v_add_f32 v159, v159, v102
    v_add_f32 v160, v160, v103
    v_cvt_pk_bf16_f32 v99, v102, v103
    v_add_f32 v159, v159, v104
    v_add_f32 v160, v160, v105
    v_cvt_pk_bf16_f32 v100, v104, v105
    v_add_f32 v159, v159, v106
    v_add_f32 v160, v160, v107
    v_cvt_pk_bf16_f32 v101, v106, v107
    v_add_f32 v159, v159, v108
    v_add_f32 v160, v160, v109
    v_cvt_pk_bf16_f32 v102, v108, v109
    v_add_f32 v159, v159, v110
    v_add_f32 v160, v160, v111
    v_cvt_pk_bf16_f32 v103, v110, v111
    s_cmp_lg_u32 s68, 0
    s_cbranch_scc1 K1_SP136
    s_add_u32 m0, s46, 57344
    s_add_u32 s49, s48, 0
    buffer_load_dwordx4 v164, s[20:23], s49 offen nt lds
K1_SP136:
    s_waitcnt lgkmcnt(14)
    v_mfma_f32_32x32x16_bf16 v[0:15], v[112:115], v[96:99], v[0:15]
    s_cmp_lg_u32 s68, 1
    s_cbranch_scc1 K1_SP137
    s_add_u32 m0, s46, 57344
    s_add_u32 s49, s48, 0
    buffer_load_dwordx4 v164, s[20:23], s49 offen nt lds
K1_SP137:
    s_waitcnt lgkmcnt(12)
    v_mfma_f32_32x32x16_bf16 v[16:31], v[116:119], v[96:99], v[16:31]
    s_cmp_lg_u32 s68, 2
    s_cbranch_scc1 K1_SP138
    s_add_u32 m0, s46, 57344
    s_add_u32 s49, s48, 0
    buffer_load_dwordx4 v164, s[20:23], s49 offen nt lds
K1_SP138:
    s_waitcnt lgkmcnt(10)
    v_mfma_f32_32x32x16_bf16 v[32:47], v[120:123], v[96:99], v[32:47]
    s_cmp_lg_u32 s68, 3
    s_cbranch_scc1 K1_SP139
    s_add_u32 m0, s46, 57344
    s_add_u32 s49, s48, 0
    buffer_load_dwordx4 v164, s[20:23], s49 offen nt lds
K1_SP139:
    s_waitcnt lgkmcnt(8)
    v_mfma_f32_32x32x16_bf16 v[48:63], v[124:127], v[96:99], v[48:63]
    s_cmp_lg_u32 s68, 0
    s_cbranch_scc1 K1_SP140
    s_add_u32 m0, s46, 61440
    s_add_u32 s49, s48, 4096
    buffer_load_dwordx4 v164, s[20:23], s49 offen nt lds
    s_add_u32 s48, s48, 8192
K1_SP140:
    s_waitcnt lgkmcnt(6)
    v_mfma_f32_32x32x16_bf16 v[0:15], v[128:131], v[100:103], v[0:15]
    s_cmp_lg_u32 s68, 1
    s_cbranch_scc1 K1_SP141
    s_add_u32 m0, s46, 61440
    s_add_u32 s49, s48, 4096
    buffer_load_dwordx4 v164, s[20:23], s49 offen nt lds
    s_add_u32 s48, s48, 8192
K1_SP141:
    s_waitcnt lgkmcnt(4)
    v_mfma_f32_32x32x16_bf16 v[16:31], v[132:135], v[100:103], v[16:31]
    s_cmp_lg_u32 s68, 2
    s_cbranch_scc1 K1_SP142
    s_add_u32 m0, s46, 61440
    s_add_u32 s49, s48, 4096
    buffer_load_dwordx4 v164, s[20:23], s49 offen nt lds
    s_add_u32 s48, s48, 8192
K1_SP142:
    s_waitcnt lgkmcnt(2)
    v_mfma_f32_32x32x16_bf16 v[32:47], v[136:139], v[100:103], v[32:47]
    s_cmp_lg_u32 s68, 3
    s_cbranch_scc1 K1_SP143
    s_add_u32 m0, s46, 61440
    s_add_u32 s49, s48, 4096
    buffer_load_dwordx4 v164, s[20:23], s49 offen nt lds
    s_add_u32 s48, s48, 8192
K1_SP143:
    s_waitcnt lgkmcnt(0)
    v_mfma_f32_32x32x16_bf16 v[48:63], v[140:143], v[100:103], v[48:63]
    s_waitcnt vmcnt(8) lgkmcnt(0)
    s_barrier
    ds_read_b128 v[112:115], v144 offset:8192
    ds_read_b128 v[116:119], v145 offset:8192
    ds_read_b128 v[120:123], v146 offset:8192
    ds_read_b128 v[124:127], v147 offset:8192
    ds_read_b128 v[128:131], v148 offset:8192
    ds_read_b128 v[132:135], v149 offset:8192
    ds_read_b128 v[136:139], v150 offset:8192
    ds_read_b128 v[140:143], v151 offset:8192
    s_cmp_lg_u32 s68, 0
    s_cbranch_scc1 K1_SP144
    s_lshl_b32 s49, s28, 12
    s_add_u32 s49, s49, 0
    s_add_u32 m0, s49, 131072
    s_nop 0
    buffer_load_dwordx4 v164, s[52:55], s49 offen lds
K1_SP144:
    s_waitcnt lgkmcnt(7)
    v_mfma_f32_32x32x16_bf16 v[96:111], v[112:115], v[64:67], 0
    ds_read_b64_tr_b16 v[112:113], v152 offset:40960
    ds_read_b64_tr_b16 v[114:115], v152 offset:43008
    s_cmp_lg_u32 s68, 1
    s_cbranch_scc1 K1_SP145
    s_lshl_b32 s49, s28, 12
    s_add_u32 s49, s49, 0
    s_add_u32 m0, s49, 131072
    s_nop 0
    buffer_load_dwordx4 v164, s[52:55], s49 offen lds
K1_SP145:
    s_waitcnt lgkmcnt(8)
    v_mfma_f32_32x32x16_bf16 v[96:111], v[116:119], v[68:71], v[96:111]
    ds_read_b64_tr_b16 v[116:117], v153 offset:40960
    ds_read_b64_tr_b16 v[118:119], v153 offset:43008
    s_cmp_lg_u32 s68, 2
    s_cbranch_scc1 K1_SP146
    s_lshl_b32 s49, s28, 12
    s_add_u32 s49, s49, 0
    s_add_u32 m0, s49, 131072
    s_nop 0
    buffer_load_dwordx4 v164, s[52:55], s49 offen lds
K1_SP146:
    s_waitcnt lgkmcnt(9)
    v_mfma_f32_32x32x16_bf16 v[96:111], v[120:123], v[72:75], v[96:111]
    ds_read_b64_tr_b16 v[120:121], v154 offset:40960
    ds_read_b64_tr_b16 v[122:123], v154 offset:43008
    s_cmp_lg_u32 s68, 3
    s_cbranch_scc1 K1_SP147
    s_lshl_b32 s49, s28, 12
    s_add_u32 s49, s49, 0
    s_add_u32 m0, s49, 131072
    s_nop 0
    buffer_load_dwordx4 v164, s[52:55], s49 offen lds
K1_SP147:
    s_waitcnt lgkmcnt(10)
    v_mfma_f32_32x32x16_bf16 v[96:111], v[124:127], v[76:79], v[96:111]
    ds_read_b64_tr_b16 v[124:125], v155 offset:40960
    ds_read_b64_tr_b16 v[126:127], v155 offset:43008
    s_cmp_lg_u32 s68, 0
    s_cbranch_scc1 K1_SP148
    s_lshl_b32 s49, s28, 12
    s_add_u32 s49, s49, 1024
    s_add_u32 m0, s49, 131072
    s_nop 0
    buffer_load_dwordx4 v164, s[52:55], s49 offen lds
K1_SP148:
    s_waitcnt lgkmcnt(11)
    v_mfma_f32_32x32x16_bf16 v[96:111], v[128:131], v[80:83], v[96:111]
    ds_read_b64_tr_b16 v[128:129], v152 offset:45056
    ds_read_b64_tr_b16 v[130:131], v152 offset:47104
    s_cmp_lg_u32 s68, 1
    s_cbranch_scc1 K1_SP149
    s_lshl_b32 s49, s28, 12
    s_add_u32 s49, s49, 1024
    s_add_u32 m0, s49, 131072
    s_nop 0
    buffer_load_dwordx4 v164, s[52:55], s49 offen lds
K1_SP149:
    s_waitcnt lgkmcnt(12)
    v_mfma_f32_32x32x16_bf16 v[96:111], v[132:135], v[84:87], v[96:111]
    ds_read_b64_tr_b16 v[132:133], v153 offset:45056
    ds_read_b64_tr_b16 v[134:135], v153 offset:47104
    s_cmp_lg_u32 s68, 2
    s_cbranch_scc1 K1_SP150
    s_lshl_b32 s49, s28, 12
    s_add_u32 s49, s49, 1024
    s_add_u32 m0, s49, 131072
    s_nop 0
    buffer_load_dwordx4 v164, s[52:55], s49 offen lds
K1_SP150:
    s_waitcnt lgkmcnt(13)
    v_mfma_f32_32x32x16_bf16 v[96:111], v[136:139], v[88:91], v[96:111]
    ds_read_b64_tr_b16 v[136:137], v154 offset:45056
    ds_read_b64_tr_b16 v[138:139], v154 offset:47104
    s_cmp_lg_u32 s68, 3
    s_cbranch_scc1 K1_SP151
    s_lshl_b32 s49, s28, 12
    s_add_u32 s49, s49, 1024
    s_add_u32 m0, s49, 131072
    s_nop 0
    buffer_load_dwordx4 v164, s[52:55], s49 offen lds
K1_SP151:
    s_waitcnt lgkmcnt(14)
    v_mfma_f32_32x32x16_bf16 v[96:111], v[140:143], v[92:95], v[96:111]
    ds_read_b64_tr_b16 v[140:141], v155 offset:45056
    ds_read_b64_tr_b16 v[142:143], v155 offset:47104
    s_nop 9
    v_max3_f32 v161, v96, v97, v98
    v_max3_f32 v162, v99, v100, v101
    v_max3_f32 v161, v161, v102, v103
    v_max3_f32 v162, v162, v104, v105
    v_max3_f32 v161, v161, v106, v107
    v_max3_f32 v162, v162, v108, v109
    v_max3_f32 v161, v161, v110, v111
    v_max_f32 v161, v161, v162
    v_cmp_gt_f32 vcc, v161, v157
    s_cbranch_vccnz K1_SLOWr0b1
K1_RETr0b1:
    v_fma_f32 v96, v96, s31, v158
    v_fma_f32 v97, v97, s31, v158
    v_fma_f32 v98, v98, s31, v158
    v_fma_f32 v99, v99, s31, v158
    v_fma_f32 v100, v100, s31, v158
    v_fma_f32 v101, v101, s31, v158
    v_fma_f32 v102, v102, s31, v158
    v_fma_f32 v103, v103, s31, v158
    v_fma_f32 v104, v104, s31, v158
    v_fma_f32 v105, v105, s31, v158
    v_fma_f32 v106, v106, s31, v158
    v_fma_f32 v107, v107, s31, v158
    v_fma_f32 v108, v108, s31, v158
    v_fma_f32 v109, v109, s31, v158
    v_fma_f32 v110, v110, s31, v158
    v_fma_f32 v111, v111, s31, v158
    v_exp_f32 v96, v96
    v_exp_f32 v97, v97
    v_exp_f32 v98, v98
    v_exp_f32 v99, v99
    v_exp_f32 v100, v100
    v_exp_f32 v101, v101
    v_exp_f32 v102, v102
    v_exp_f32 v103, v103
    v_exp_f32 v104, v104
    v_exp_f32 v105, v105
    v_exp_f32 v106, v106
    v_exp_f32 v107, v107
    v_exp_f32 v108, v108
    v_exp_f32 v109, v109
    v_exp_f32 v110, v110
    v_exp_f32 v111, v111
    v_add_f32 v159, v159, v96
    v_add_f32 v160, v160, v97
    v_cvt_pk_bf16_f32 v96, v96, v97
    v_add_f32 v159, v159, v98
    v_add_f32 v160, v160, v99
    v_cvt_pk_bf16_f32 v97, v98, v99
    v_add_f32 v159, v159, v100
    v_add_f32 v160, v160, v101
    v_cvt_pk_bf16_f32 v98, v100, v101
    v_add_f32 v159, v159, v102
    v_add_f32 v160, v160, v103
    v_cvt_pk_bf16_f32 v99, v102, v103
    v_add_f32 v159, v159, v104
    v_add_f32 v160, v160, v105
    v_cvt_pk_bf16_f32 v100, v104, v105
    v_add_f32 v159, v159, v106
    v_add_f32 v160, v160, v107
    v_cvt_pk_bf16_f32 v101, v106, v107
    v_add_f32 v159, v159, v108
    v_add_f32 v160, v160, v109
    v_cvt_pk_bf16_f32 v102, v108, v109
    v_add_f32 v159, v159, v110
    v_add_f32 v160, v160, v111
    v_cvt_pk_bf16_f32 v103, v110, v111
    s_cmp_lg_u32 s68, 0
    s_cbranch_scc1 K1_SP152
    s_lshl_b32 s49, s28, 12
    s_add_u32 s49, s49, 2048
    s_add_u32 m0, s49, 131072
    s_nop 0
    buffer_load_dwordx4 v164, s[52:55], s49 offen lds
K1_SP152:
    s_waitcnt lgkmcnt(14)
    v_mfma_f32_32x32x16_bf16 v[0:15], v[112:115], v[96:99], v[0:15]
    s_cmp_lg_u32 s68, 1
    s_cbranch_scc1 K1_SP153
    s_lshl_b32 s49, s28, 12
    s_add_u32 s49, s49, 2048
    s_add_u32 m0, s49, 131072
    s_nop 0
    buffer_load_dwordx4 v164, s[52:55], s49 offen lds
K1_SP153:
    s_waitcnt lgkmcnt(12)
    v_mfma_f32_32x32x16_bf16 v[16:31], v[116:119], v[96:99], v[16:31]
    s_cmp_lg_u32 s68, 2
    s_cbranch_scc1 K1_SP154
    s_lshl_b32 s49, s28, 12
    s_add_u32 s49, s49, 2048
    s_add_u32 m0, s49, 131072
    s_nop 0
    buffer_load_dwordx4 v164, s[52:55], s49 offen lds
K1_SP154:
    s_waitcnt lgkmcnt(10)
    v_mfma_f32_32x32x16_bf16 v[32:47], v[120:123], v[96:99], v[32:47]
    s_cmp_lg_u32 s68, 3
    s_cbranch_scc1 K1_SP155
    s_lshl_b32 s49, s28, 12
    s_add_u32 s49, s49, 2048
    s_add_u32 m0, s49, 131072
    s_nop 0
    buffer_load_dwordx4 v164, s[52:55], s49 offen lds
K1_SP155:
    s_waitcnt lgkmcnt(8)
    v_mfma_f32_32x32x16_bf16 v[48:63], v[124:127], v[96:99], v[48:63]
    s_cmp_lg_u32 s68, 0
    s_cbranch_scc1 K1_SP156
    s_lshl_b32 s49, s28, 12
    s_add_u32 s49, s49, 3072
    s_add_u32 m0, s49, 131072
    s_nop 0
    buffer_load_dwordx4 v164, s[52:55], s49 offen lds
K1_SP156:
    s_waitcnt lgkmcnt(6)
    v_mfma_f32_32x32x16_bf16 v[0:15], v[128:131], v[100:103], v[0:15]
    s_cmp_lg_u32 s68, 1
    s_cbranch_scc1 K1_SP157
    s_lshl_b32 s49, s28, 12
    s_add_u32 s49, s49, 3072
    s_add_u32 m0, s49, 131072
    s_nop 0
    buffer_load_dwordx4 v164, s[52:55], s49 offen lds
K1_SP157:
    s_waitcnt lgkmcnt(4)
    v_mfma_f32_32x32x16_bf16 v[16:31], v[132:135], v[100:103], v[16:31]
    s_cmp_lg_u32 s68, 2
    s_cbranch_scc1 K1_SP158
    s_lshl_b32 s49, s28, 12
    s_add_u32 s49, s49, 3072
    s_add_u32 m0, s49, 131072
    s_nop 0
    buffer_load_dwordx4 v164, s[52:55], s49 offen lds
K1_SP158:
    s_waitcnt lgkmcnt(2)
    v_mfma_f32_32x32x16_bf16 v[32:47], v[136:139], v[100:103], v[32:47]
    s_cmp_lg_u32 s68, 3
    s_cbranch_scc1 K1_SP159
    s_lshl_b32 s49, s28, 12
    s_add_u32 s49, s49, 3072
    s_add_u32 m0, s49, 131072
    s_nop 0
    buffer_load_dwordx4 v164, s[52:55], s49 offen lds
K1_SP159:
    s_waitcnt lgkmcnt(0)
    v_mfma_f32_32x32x16_bf16 v[48:63], v[140:143], v[100:103], v[48:63]
    s_waitcnt vmcnt(4) lgkmcnt(0)
    s_barrier
    ds_read_b128 v[112:115], v144 offset:16384
    ds_read_b128 v[116:119], v145 offset:16384
    ds_read_b128 v[120:123], v146 offset:16384
    ds_read_b128 v[124:127], v147 offset:16384
    ds_read_b128 v[128:131], v148 offset:16384
    ds_read_b128 v[132:135], v149 offset:16384
    ds_read_b128 v[136:139], v150 offset:16384
    ds_read_b128 v[140:143], v151 offset:16384
    s_waitcnt lgkmcnt(7)
    v_mfma_f32_32x32x16_bf16 v[96:111], v[112:115], v[64:67], 0
    ds_read_b64_tr_b16 v[112:113], v152 offset:49152
    ds_read_b64_tr_b16 v[114:115], v152 offset:51200
    s_waitcnt lgkmcnt(8)
    v_mfma_f32_32x32x16_bf16 v[96:111], v[116:119], v[68:71], v[96:111]
    ds_read_b64_tr_b16 v[116:117], v153 offset:49152
    ds_read_b64_tr_b16 v[118:119], v153 offset:51200
    s_waitcnt lgkmcnt(9)
    v_mfma_f32_32x32x16_bf16 v[96:111], v[120:123], v[72:75], v[96:111]
    ds_read_b64_tr_b16 v[120:121], v154 offset:49152
    ds_read_b64_tr_b16 v[122:123], v154 offset:51200
    s_waitcnt lgkmcnt(10)
    v_mfma_f32_32x32x16_bf16 v[96:111], v[124:127], v[76:79], v[96:111]
    ds_read_b64_tr_b16 v[124:125], v155 offset:49152
    ds_read_b64_tr_b16 v[126:127], v155 offset:51200
    s_waitcnt lgkmcnt(11)
    v_mfma_f32_32x32x16_bf16 v[96:111], v[128:131], v[80:83], v[96:111]
    ds_read_b64_tr_b16 v[128:129], v152 offset:53248
    ds_read_b64_tr_b16 v[130:131], v152 offset:55296
    s_waitcnt lgkmcnt(12)
    v_mfma_f32_32x32x16_bf16 v[96:111], v[132:135], v[84:87], v[96:111]
    ds_read_b64_tr_b16 v[132:133], v153 offset:53248
    ds_read_b64_tr_b16 v[134:135], v153 offset:55296
    s_waitcnt lgkmcnt(13)
    v_mfma_f32_32x32x16_bf16 v[96:111], v[136:139], v[88:91], v[96:111]
    ds_read_b64_tr_b16 v[136:137], v154 offset:53248
    ds_read_b64_tr_b16 v[138:139], v154 offset:55296
    s_waitcnt lgkmcnt(14)
    v_mfma_f32_32x32x16_bf16 v[96:111], v[140:143], v[92:95], v[96:111]
    ds_read_b64_tr_b16 v[140:141], v155 offset:53248
    ds_read_b64_tr_b16 v[142:143], v155 offset:55296
    s_nop 9
    v_max3_f32 v161, v96, v97, v98
    v_max3_f32 v162, v99, v100, v101
    v_max3_f32 v161, v161, v102, v103
    v_max3_f32 v162, v162, v104, v105
    v_max3_f32 v161, v161, v106, v107
    v_max3_f32 v162, v162, v108, v109
    v_max3_f32 v161, v161, v110, v111
    v_max_f32 v161, v161, v162
    v_cmp_gt_f32 vcc, v161, v157
    s_cbranch_vccnz K1_SLOWr0b2
K1_RETr0b2:
    v_fma_f32 v96, v96, s31, v158
    v_fma_f32 v97, v97, s31, v158
    v_fma_f32 v98, v98, s31, v158
    v_fma_f32 v99, v99, s31, v158
    v_fma_f32 v100, v100, s31, v158
    v_fma_f32 v101, v101, s31, v158
    v_fma_f32 v102, v102, s31, v158
    v_fma_f32 v103, v103, s31, v158
    v_fma_f32 v104, v104, s31, v158
    v_fma_f32 v105, v105, s31, v158
    v_fma_f32 v106, v106, s31, v158
    v_fma_f32 v107, v107, s31, v158
    v_fma_f32 v108, v108, s31, v158
    v_fma_f32 v109, v109, s31, v158
    v_fma_f32 v110, v110, s31, v158
    v_fma_f32 v111, v111, s31, v158
    v_exp_f32 v96, v96
    v_exp_f32 v97, v97
    v_exp_f32 v98, v98
    v_exp_f32 v99, v99
    v_exp_f32 v100, v100
    v_exp_f32 v101, v101
    v_exp_f32 v102, v102
    v_exp_f32 v103, v103
    v_exp_f32 v104, v104
    v_exp_f32 v105, v105
    v_exp_f32 v106, v106
    v_exp_f32 v107, v107
    v_exp_f32 v108, v108
    v_exp_f32 v109, v109
    v_exp_f32 v110, v110
    v_exp_f32 v111, v111
    v_add_f32 v159, v159, v96
    v_add_f32 v160, v160, v97
    v_cvt_pk_bf16_f32 v96, v96, v97
    v_add_f32 v159, v159, v98
    v_add_f32 v160, v160, v99
    v_cvt_pk_bf16_f32 v97, v98, v99
    v_add_f32 v159, v159, v100
    v_add_f32 v160, v160, v101
    v_cvt_pk_bf16_f32 v98, v100, v101
    v_add_f32 v159, v159, v102
    v_add_f32 v160, v160, v103
    v_cvt_pk_bf16_f32 v99, v102, v103
    v_add_f32 v159, v159, v104
    v_add_f32 v160, v160, v105
    v_cvt_pk_bf16_f32 v100, v104, v105
    v_add_f32 v159, v159, v106
    v_add_f32 v160, v160, v107
    v_cvt_pk_bf16_f32 v101, v106, v107
    v_add_f32 v159, v159, v108
    v_add_f32 v160, v160, v109
    v_cvt_pk_bf16_f32 v102, v108, v109
    v_add_f32 v159, v159, v110
    v_add_f32 v160, v160, v111
    v_cvt_pk_bf16_f32 v103, v110, v111
    s_waitcnt lgkmcnt(14)
    v_mfma_f32_32x32x16_bf16 v[0:15], v[112:115], v[96:99], v[0:15]
    s_waitcnt lgkmcnt(12)
    v_mfma_f32_32x32x16_bf16 v[16:31], v[116:119], v[96:99], v[16:31]
    s_waitcnt lgkmcnt(10)
    v_mfma_f32_32x32x16_bf16 v[32:47], v[120:123], v[96:99], v[32:47]
    s_waitcnt lgkmcnt(8)
    v_mfma_f32_32x32x16_bf16 v[48:63], v[124:127], v[96:99], v[48:63]
    s_waitcnt lgkmcnt(6)
    v_mfma_f32_32x32x16_bf16 v[0:15], v[128:131], v[100:103], v[0:15]
    s_waitcnt lgkmcnt(4)
    v_mfma_f32_32x32x16_bf16 v[16:31], v[132:135], v[100:103], v[16:31]
    s_waitcnt lgkmcnt(2)
    v_mfma_f32_32x32x16_bf16 v[32:47], v[136:139], v[100:103], v[32:47]
    s_waitcnt lgkmcnt(0)
    v_mfma_f32_32x32x16_bf16 v[48:63], v[140:143], v[100:103], v[48:63]
    s_waitcnt vmcnt(0) lgkmcnt(0)
    s_barrier
    ds_read_b128 v[112:115], v144 offset:24576
    ds_read_b128 v[116:119], v145 offset:24576
    ds_read_b128 v[120:123], v146 offset:24576
    ds_read_b128 v[124:127], v147 offset:24576
    ds_read_b128 v[128:131], v148 offset:24576
    ds_read_b128 v[132:135], v149 offset:24576
    ds_read_b128 v[136:139], v150 offset:24576
    ds_read_b128 v[140:143], v151 offset:24576
    s_waitcnt lgkmcnt(7)
    v_mfma_f32_32x32x16_bf16 v[96:111], v[112:115], v[64:67], 0
    ds_read_b64_tr_b16 v[112:113], v152 offset:57344
    ds_read_b64_tr_b16 v[114:115], v152 offset:59392
    s_waitcnt lgkmcnt(8)
    v_mfma_f32_32x32x16_bf16 v[96:111], v[116:119], v[68:71], v[96:111]
    ds_read_b64_tr_b16 v[116:117], v153 offset:57344
    ds_read_b64_tr_b16 v[118:119], v153 offset:59392
    s_waitcnt lgkmcnt(9)
    v_mfma_f32_32x32x16_bf16 v[96:111], v[120:123], v[72:75], v[96:111]
    ds_read_b64_tr_b16 v[120:121], v154 offset:57344
    ds_read_b64_tr_b16 v[122:123], v154 offset:59392
    s_waitcnt lgkmcnt(10)
    v_mfma_f32_32x32x16_bf16 v[96:111], v[124:127], v[76:79], v[96:111]
    ds_read_b64_tr_b16 v[124:125], v155 offset:57344
    ds_read_b64_tr_b16 v[126:127], v155 offset:59392
    s_waitcnt lgkmcnt(11)
    v_mfma_f32_32x32x16_bf16 v[96:111], v[128:131], v[80:83], v[96:111]
    ds_read_b64_tr_b16 v[128:129], v152 offset:61440
    ds_read_b64_tr_b16 v[130:131], v152 offset:63488
    s_waitcnt lgkmcnt(12)
    v_mfma_f32_32x32x16_bf16 v[96:111], v[132:135], v[84:87], v[96:111]
    ds_read_b64_tr_b16 v[132:133], v153 offset:61440
    ds_read_b64_tr_b16 v[134:135], v153 offset:63488
    s_waitcnt lgkmcnt(13)
    v_mfma_f32_32x32x16_bf16 v[96:111], v[136:139], v[88:91], v[96:111]
    ds_read_b64_tr_b16 v[136:137], v154 offset:61440
    ds_read_b64_tr_b16 v[138:139], v154 offset:63488
    s_waitcnt lgkmcnt(14)
    v_mfma_f32_32x32x16_bf16 v[96:111], v[140:143], v[92:95], v[96:111]
    ds_read_b64_tr_b16 v[140:141], v155 offset:61440
    ds_read_b64_tr_b16 v[142:143], v155 offset:63488
    s_nop 9
    v_max3_f32 v161, v96, v97, v98
    v_max3_f32 v162, v99, v100, v101
    v_max3_f32 v161, v161, v102, v103
    v_max3_f32 v162, v162, v104, v105
    v_max3_f32 v161, v161, v106, v107
    v_max3_f32 v162, v162, v108, v109
    v_max3_f32 v161, v161, v110, v111
    v_max_f32 v161, v161, v162
    v_cmp_gt_f32 vcc, v161, v157
    s_cbranch_vccnz K1_SLOWr0b3
K1_RETr0b3:
    v_fma_f32 v96, v96, s31, v158
    v_fma_f32 v97, v97, s31, v158
    v_fma_f32 v98, v98, s31, v158
    v_fma_f32 v99, v99, s31, v158
    v_fma_f32 v100, v100, s31, v158
    v_fma_f32 v101, v101, s31, v158
    v_fma_f32 v102, v102, s31, v158
    v_fma_f32 v103, v103, s31, v158
    v_fma_f32 v104, v104, s31, v158
    v_fma_f32 v105, v105, s31, v158
    v_fma_f32 v106, v106, s31, v158
    v_fma_f32 v107, v107, s31, v158
    v_fma_f32 v108, v108, s31, v158
    v_fma_f32 v109, v109, s31, v158
    v_fma_f32 v110, v110, s31, v158
    v_fma_f32 v111, v111, s31, v158
    v_exp_f32 v96, v96
    v_exp_f32 v97, v97
    v_exp_f32 v98, v98
    v_exp_f32 v99, v99
    v_exp_f32 v100, v100
    v_exp_f32 v101, v101
    v_exp_f32 v102, v102
    v_exp_f32 v103, v103
    v_exp_f32 v104, v104
    v_exp_f32 v105, v105
    v_exp_f32 v106, v106
    v_exp_f32 v107, v107
    v_exp_f32 v108, v108
    v_exp_f32 v109, v109
    v_exp_f32 v110, v110
    v_exp_f32 v111, v111
    v_add_f32 v159, v159, v96
    v_add_f32 v160, v160, v97
    v_cvt_pk_bf16_f32 v96, v96, v97
    v_add_f32 v159, v159, v98
    v_add_f32 v160, v160, v99
    v_cvt_pk_bf16_f32 v97, v98, v99
    v_add_f32 v159, v159, v100
    v_add_f32 v160, v160, v101
    v_cvt_pk_bf16_f32 v98, v100, v101
    v_add_f32 v159, v159, v102
    v_add_f32 v160, v160, v103
    v_cvt_pk_bf16_f32 v99, v102, v103
    v_add_f32 v159, v159, v104
    v_add_f32 v160, v160, v105
    v_cvt_pk_bf16_f32 v100, v104, v105
    v_add_f32 v159, v159, v106
    v_add_f32 v160, v160, v107
    v_cvt_pk_bf16_f32 v101, v106, v107
    v_add_f32 v159, v159, v108
    v_add_f32 v160, v160, v109
    v_cvt_pk_bf16_f32 v102, v108, v109
    v_add_f32 v159, v159, v110
    v_add_f32 v160, v160, v111
    v_cvt_pk_bf16_f32 v103, v110, v111
    s_waitcnt lgkmcnt(14)
    v_mfma_f32_32x32x16_bf16 v[0:15], v[112:115], v[96:99], v[0:15]
    s_waitcnt lgkmcnt(12)
    v_mfma_f32_32x32x16_bf16 v[16:31], v[116:119], v[96:99], v[16:31]
    s_waitcnt lgkmcnt(10)
    v_mfma_f32_32x32x16_bf16 v[32:47], v[120:123], v[96:99], v[32:47]
    s_waitcnt lgkmcnt(8)
    v_mfma_f32_32x32x16_bf16 v[48:63], v[124:127], v[96:99], v[48:63]
    s_waitcnt lgkmcnt(6)
    v_mfma_f32_32x32x16_bf16 v[0:15], v[128:131], v[100:103], v[0:15]
    s_waitcnt lgkmcnt(4)
    v_mfma_f32_32x32x16_bf16 v[16:31], v[132:135], v[100:103], v[16:31]
    s_waitcnt lgkmcnt(2)
    v_mfma_f32_32x32x16_bf16 v[32:47], v[136:139], v[100:103], v[32:47]
    s_waitcnt lgkmcnt(0)
    v_mfma_f32_32x32x16_bf16 v[48:63], v[140:143], v[100:103], v[48:63]
    s_waitcnt lgkmcnt(0)
    s_nop 10
    s_branch K1_EPI
K1_ROLE1:
    s_add_u32 s48, s45, 8192
    s_add_u32 s47, s45, 16384
    s_add_u32 s49, s34, s41
    s_mov_b32 m0, s36
    s_nop 0
    buffer_load_dwordx4 v108, s[8:11], s49 offen lds
    s_add_u32 s41, s41, 64
    s_and_b32 s41, s41, 1023
    s_add_u32 s49, s33, s40
    s_add_u32 m0, s32, 40960
    s_nop 0
    buffer_load_dwordx4 v165, s[12:15], s49 offen lds
    s_add_u32 s49, s33, s40
    s_add_u32 s49, s49, 131072
    s_add_u32 m0, s32, 45056
    s_nop 0
    buffer_load_dwordx4 v165, s[12:15], s49 offen lds
    s_add_u32 s40, s40, 262144
    s_and_b32 s40, s40, 4194303
    s_add_u32 s49, s34, s41
    s_mov_b32 m0, s37
    s_nop 0
    buffer_load_dwordx4 v108, s[8:11], s49 offen lds
    s_add_u32 s41, s41, 64
    s_and_b32 s41, s41, 1023
    s_add_u32 s49, s33, s40
    s_add_u32 m0, s32, 49152
    s_nop 0
    buffer_load_dwordx4 v165, s[12:15], s49 offen lds
    s_add_u32 s49, s33, s40
    s_add_u32 s49, s49, 131072
    s_add_u32 m0, s32, 53248
    s_nop 0
    buffer_load_dwordx4 v165, s[12:15], s49 offen lds
    s_add_u32 s40, s40, 262144
    s_and_b32 s40, s40, 4194303
    s_add_u32 s49, s34, s41
    s_mov_b32 m0, s38
    s_nop 0
    buffer_load_dwordx4 v108, s[8:11], s49 offen lds
    s_add_u32 s41, s41, 64
    s_and_b32 s41, s41, 1023
    s_add_u32 s49, s33, s40
    s_add_u32 m0, s32, 24576
    s_nop 0
    buffer_load_dwordx4 v165, s[12:15], s49 offen lds
    s_add_u32 s49, s33, s40
    s_add_u32 s49, s49, 131072
    s_add_u32 m0, s32, 28672
    s_nop 0
    buffer_load_dwordx4 v165, s[12:15], s49 offen lds
    s_add_u32 s40, s40, 262144
    s_and_b32 s40, s40, 4194303
    s_add_u32 s49, s34, s41
    s_mov_b32 m0, s39
    s_nop 0
    buffer_load_dwordx4 v108, s[8:11], s49 offen lds
    s_add_u32 s41, s41, 64
    s_and_b32 s41, s41, 1023
    s_add_u32 s49, s33, s40
    s_add_u32 m0, s32, 57344
    s_nop 0
    buffer_load_dwordx4 v165, s[12:15], s49 offen lds
    s_add_u32 s49, s33, s40
    s_add_u32 s49, s49, 131072
    s_add_u32 m0, s32, 61440
    s_nop 0
    buffer_load_dwordx4 v165, s[12:15], s49 offen lds
    s_add_u32 s40, s40, 262144
    s_and_b32 s40, s40, 4194303
    s_waitcnt vmcnt(6) lgkmcnt(0)
    s_barrier
    ds_read_b128 v[144:147], v100 offset:0
    ds_read_b64_tr_b16 v[112:113], v96 offset:40960
    ds_read_b64_tr_b16 v[114:115], v96 offset:41984
    ds_read_b64_tr_b16 v[116:117], v97 offset:40960
    ds_read_b64_tr_b16 v[118:119], v97 offset:41984
    ds_read_b64_tr_b16 v[120:121], v98 offset:40960
    ds_read_b64_tr_b16 v[122:123], v98 offset:41984
    ds_read_b64_tr_b16 v[124:125], v99 offset:40960
    ds_read_b64_tr_b16 v[126:127], v99 offset:41984
    ds_read_b128 v[148:151], v101 offset:0
    ds_read_b64_tr_b16 v[128:129], v96 offset:45056
    ds_read_b64_tr_b16 v[130:131], v96 offset:46080
    ds_read_b64_tr_b16 v[132:133], v97 offset:45056
    ds_read_b64_tr_b16 v[134:135], v97 offset:46080
    ds_read_b64_tr_b16 v[136:137], v98 offset:45056
    ds_read_b64_tr_b16 v[138:139], v98 offset:46080
    ds_read_b64_tr_b16 v[140:141], v99 offset:45056
    ds_read_b64_tr_b16 v[142:143], v99 offset:46080
    s_waitcnt lgkmcnt(0)
    s_barrier
    v_mfma_f32_32x32x16_bf16 v[0:15], v[112:115], v[144:147], 0
    ds_read_b128 v[152:155], v102 offset:0
    ds_read_b64_tr_b16 v[64:65], v96 offset:49152
    ds_read_b64_tr_b16 v[66:67], v96 offset:50176
    v_mfma_f32_32x32x16_bf16 v[16:31], v[116:119], v[144:147], 0
    ds_read_b64_tr_b16 v[68:69], v97 offset:49152
    ds_read_b64_tr_b16 v[70:71], v97 offset:50176
    ds_read_b64_tr_b16 v[72:73], v98 offset:49152
    s_add_u32 s49, s34, s41
    s_mov_b32 m0, s36
    s_nop 0
    buffer_load_dwordx4 v108, s[8:11], s49 offen lds
    s_add_u32 s41, s41, 64
    s_and_b32 s41, s41, 1023
    v_mfma_f32_32x32x16_bf16 v[32:47], v[120:123], v[144:147], 0
    ds_read_b64_tr_b16 v[74:75], v98 offset:50176
    ds_read_b64_tr_b16 v[76:77], v99 offset:49152
    ds_read_b64_tr_b16 v[78:79], v99 offset:50176
    v_mfma_f32_32x32x16_bf16 v[48:63], v[124:127], v[144:147], 0
    ds_read_b128 v[156:159], v103 offset:0
    ds_read_b64_tr_b16 v[80:81], v96 offset:53248
    ds_read_b64_tr_b16 v[82:83], v96 offset:54272
    s_add_u32 s49, s33, s40
    s_add_u32 m0, s32, 40960
    s_nop 0
    buffer_load_dwordx4 v165, s[12:15], s49 offen lds
    v_mfma_f32_32x32x16_bf16 v[0:15], v[128:131], v[148:151], v[0:15]
    ds_read_b64_tr_b16 v[84:85], v97 offset:53248
    ds_read_b64_tr_b16 v[86:87], v97 offset:54272
    ds_read_b64_tr_b16 v[88:89], v98 offset:53248
    v_mfma_f32_32x32x16_bf16 v[16:31], v[132:135], v[148:151], v[16:31]
    ds_read_b64_tr_b16 v[90:91], v98 offset:54272
    ds_read_b64_tr_b16 v[92:93], v99 offset:53248
    ds_read_b64_tr_b16 v[94:95], v99 offset:54272
    s_add_u32 s49, s33, s40
    s_add_u32 s49, s49, 131072
    s_add_u32 m0, s32, 45056
    s_nop 0
    buffer_load_dwordx4 v165, s[12:15], s49 offen lds
    s_add_u32 s40, s40, 262144
    s_and_b32 s40, s40, 4194303
    v_mfma_f32_32x32x16_bf16 v[32:47], v[136:139], v[148:151], v[32:47]
    v_mfma_f32_32x32x16_bf16 v[48:63], v[140:143], v[148:151], v[48:63]
    s_waitcnt vmcnt(6) lgkmcnt(0)
    s_barrier
    v_mfma_f32_32x32x16_bf16 v[0:15], v[64:67], v[152:155], v[0:15]
    ds_read_b128 v[144:147], v104 offset:0
    ds_read_b64_tr_b16 v[112:113], v96 offset:24576
    ds_read_b64_tr_b16 v[114:115], v96 offset:25600
    v_mfma_f32_32x32x16_bf16 v[16:31], v[68:71], v[152:155], v[16:31]
    ds_read_b64_tr_b16 v[116:117], v97 offset:24576
    ds_read_b64_tr_b16 v[118:119], v97 offset:25600
    ds_read_b64_tr_b16 v[120:121], v98 offset:24576
    s_add_u32 s49, s34, s41
    s_mov_b32 m0, s37
    s_nop 0
    buffer_load_dwordx4 v108, s[8:11], s49 offen lds
    s_add_u32 s41, s41, 64
    s_and_b32 s41, s41, 1023
    v_mfma_f32_32x32x16_bf16 v[32:47], v[72:75], v[152:155], v[32:47]
    ds_read_b64_tr_b16 v[122:123], v98 offset:25600
    ds_read_b64_tr_b16 v[124:125], v99 offset:24576
    ds_read_b64_tr_b16 v[126:127], v99 offset:25600
    v_mfma_f32_32x32x16_bf16 v[48:63], v[76:79], v[152:155], v[48:63]
    ds_read_b128 v[148:151], v105 offset:0
    ds_read_b64_tr_b16 v[128:129], v96 offset:28672
    ds_read_b64_tr_b16 v[130:131], v96 offset:29696
    s_add_u32 s49, s33, s40
    s_add_u32 m0, s32, 49152
    s_nop 0
    buffer_load_dwordx4 v165, s[12:15], s49 offen lds
    v_mfma_f32_32x32x16_bf16 v[0:15], v[80:83], v[156:159], v[0:15]
    ds_read_b64_tr_b16 v[132:133], v97 offset:28672
    ds_read_b64_tr_b16 v[134:135], v97 offset:29696
    ds_read_b64_tr_b16 v[136:137], v98 offset:28672
    v_mfma_f32_32x32x16_bf16 v[16:31], v[84:87], v[156:159], v[16:31]
    ds_read_b64_tr_b16 v[138:139], v98 offset:29696
    ds_read_b64_tr_b16 v[140:141], v99 offset:28672
    ds_read_b64_tr_b16 v[142:143], v99 offset:29696
    s_add_u32 s49, s33, s40
    s_add_u32 s49, s49, 131072
    s_add_u32 m0, s32, 53248
    s_nop 0
    buffer_load_dwordx4 v165, s[12:15], s49 offen lds
    s_add_u32 s40, s40, 262144
    s_and_b32 s40, s40, 4194303
    v_mfma_f32_32x32x16_bf16 v[32:47], v[88:91], v[156:159], v[32:47]
    v_mfma_f32_32x32x16_bf16 v[48:63], v[92:95], v[156:159], v[48:63]
    s_waitcnt vmcnt(6) lgkmcnt(0)
    s_barrier
    v_mfma_f32_32x32x16_bf16 v[0:15], v[112:115], v[144:147], v[0:15]
    ds_read_b128 v[152:155], v106 offset:0
    ds_read_b64_tr_b16 v[64:65], v96 offset:57344
    ds_read_b64_tr_b16 v[66:67], v96 offset:58368
    v_mfma_f32_32x32x16_bf16 v[16:31], v[116:119], v[144:147], v[16:31]
    ds_read_b64_tr_b16 v[68:69], v97 offset:57344
    ds_read_b64_tr_b16 v[70:71], v97 offset:58368
    ds_read_b64_tr_b16 v[72:73], v98 offset:57344
    s_add_u32 s49, s34, s41
    s_mov_b32 m0, s38
    s_nop 0
    buffer_load_dwordx4 v108, s[8:11], s49 offen lds
    s_add_u32 s41, s41, 64
    s_and_b32 s41, s41, 1023
    v_mfma_f32_32x32x16_bf16 v[32:47], v[120:123], v[144:147], v[32:47]
    ds_read_b64_tr_b16 v[74:75], v98 offset:58368
    ds_read_b64_tr_b16 v[76:77], v99 offset:57344
    ds_read_b64_tr_b16 v[78:79], v99 offset:58368
    v_mfma_f32_32x32x16_bf16 v[48:63], v[124:127], v[144:147], v[48:63]
    ds_read_b128 v[156:159], v107 offset:0
    ds_read_b64_tr_b16 v[80:81], v96 offset:61440
    ds_read_b64_tr_b16 v[82:83], v96 offset:62464
    s_add_u32 s49, s33, s40
    s_add_u32 m0, s32, 24576
    s_nop 0
    buffer_load_dwordx4 v165, s[12:15], s49 offen lds
    v_mfma_f32_32x32x16_bf16 v[0:15], v[128:131], v[148:151], v[0:15]
    ds_read_b64_tr_b16 v[84:85], v97 offset:61440
    ds_read_b64_tr_b16 v[86:87], v97 offset:62464
    ds_read_b64_tr_b16 v[88:89], v98 offset:61440
    v_mfma_f32_32x32x16_bf16 v[16:31], v[132:135], v[148:151], v[16:31]
    ds_read_b64_tr_b16 v[90:91], v98 offset:62464
    ds_read_b64_tr_b16 v[92:93], v99 offset:61440
    ds_read_b64_tr_b16 v[94:95], v99 offset:62464
    s_add_u32 s49, s33, s40
    s_add_u32 s49, s49, 131072
    s_add_u32 m0, s32, 28672
    s_nop 0
    buffer_load_dwordx4 v165, s[12:15], s49 offen lds
    s_add_u32 s40, s40, 262144
    s_and_b32 s40, s40, 4194303
    v_mfma_f32_32x32x16_bf16 v[32:47], v[136:139], v[148:151], v[32:47]
    v_mfma_f32_32x32x16_bf16 v[48:63], v[140:143], v[148:151], v[48:63]
    s_waitcnt vmcnt(6) lgkmcnt(0)
    s_barrier
    v_mfma_f32_32x32x16_bf16 v[0:15], v[64:67], v[152:155], v[0:15]
    ds_read_b128 v[144:147], v100 offset:0
    ds_read_b64_tr_b16 v[112:113], v96 offset:40960
    ds_read_b64_tr_b16 v[114:115], v96 offset:41984
    v_mfma_f32_32x32x16_bf16 v[16:31], v[68:71], v[152:155], v[16:31]
    ds_read_b64_tr_b16 v[116:117], v97 offset:40960
    ds_read_b64_tr_b16 v[118:119], v97 offset:41984
    ds_read_b64_tr_b16 v[120:121], v98 offset:40960
    s_add_u32 s49, s34, s41
    s_mov_b32 m0, s39
    s_nop 0
    buffer_load_dwordx4 v108, s[8:11], s49 offen lds
    s_add_u32 s41, s41, 64
    s_and_b32 s41, s41, 1023
    v_mfma_f32_32x32x16_bf16 v[32:47], v[72:75], v[152:155], v[32:47]
    ds_read_b64_tr_b16 v[122:123], v98 offset:41984
    ds_read_b64_tr_b16 v[124:125], v99 offset:40960
    ds_read_b64_tr_b16 v[126:127], v99 offset:41984
    v_mfma_f32_32x32x16_bf16 v[48:63], v[76:79], v[152:155], v[48:63]
    ds_read_b128 v[148:151], v101 offset:0
    ds_read_b64_tr_b16 v[128:129], v96 offset:45056
    ds_read_b64_tr_b16 v[130:131], v96 offset:46080
    s_add_u32 s49, s33, s40
    s_add_u32 m0, s32, 57344
    s_nop 0
    buffer_load_dwordx4 v165, s[12:15], s49 offen lds
    v_mfma_f32_32x32x16_bf16 v[0:15], v[80:83], v[156:159], v[0:15]
    ds_read_b64_tr_b16 v[132:133], v97 offset:45056
    ds_read_b64_tr_b16 v[134:135], v97 offset:46080
    ds_read_b64_tr_b16 v[136:137], v98 offset:45056
    v_mfma_f32_32x32x16_bf16 v[16:31], v[84:87], v[156:159], v[16:31]
    ds_read_b64_tr_b16 v[138:139], v98 offset:46080
    ds_read_b64_tr_b16 v[140:141], v99 offset:45056
    ds_read_b64_tr_b16 v[142:143], v99 offset:46080
    s_add_u32 s49, s33, s40
    s_add_u32 s49, s49, 131072
    s_add_u32 m0, s32, 61440
    s_nop 0
    buffer_load_dwordx4 v165, s[12:15], s49 offen lds
    s_add_u32 s40, s40, 262144
    s_and_b32 s40, s40, 4194303
    v_mfma_f32_32x32x16_bf16 v[32:47], v[88:91], v[156:159], v[32:47]
    v_mfma_f32_32x32x16_bf16 v[48:63], v[92:95], v[156:159], v[48:63]
    s_waitcnt vmcnt(6) lgkmcnt(0)
    s_barrier
    v_mfma_f32_32x32x16_bf16 v[0:15], v[112:115], v[144:147], v[0:15]
    ds_read_b128 v[152:155], v102 offset:0
    ds_read_b64_tr_b16 v[64:65], v96 offset:49152
    ds_read_b64_tr_b16 v[66:67], v96 offset:50176
    v_mfma_f32_32x32x16_bf16 v[16:31], v[116:119], v[144:147], v[16:31]
    ds_read_b64_tr_b16 v[68:69], v97 offset:49152
    ds_read_b64_tr_b16 v[70:71], v97 offset:50176
    ds_read_b64_tr_b16 v[72:73], v98 offset:49152
    s_add_u32 s49, s34, s41
    s_mov_b32 m0, s36
    s_nop 0
    buffer_load_dwordx4 v108, s[8:11], s49 offen lds
    s_add_u32 s41, s41, 64
    s_and_b32 s41, s41, 1023
    v_mfma_f32_32x32x16_bf16 v[32:47], v[120:123], v[144:147], v[32:47]
    ds_read_b64_tr_b16 v[74:75], v98 offset:50176
    ds_read_b64_tr_b16 v[76:77], v99 offset:49152
    ds_read_b64_tr_b16 v[78:79], v99 offset:50176
    v_mfma_f32_32x32x16_bf16 v[48:63], v[124:127], v[144:147], v[48:63]
    ds_read_b128 v[156:159], v103 offset:0
    ds_read_b64_tr_b16 v[80:81], v96 offset:53248
    ds_read_b64_tr_b16 v[82:83], v96 offset:54272
    s_add_u32 s49, s33, s40
    s_add_u32 m0, s32, 40960
    s_nop 0
    buffer_load_dwordx4 v165, s[12:15], s49 offen lds
    v_mfma_f32_32x32x16_bf16 v[0:15], v[128:131], v[148:151], v[0:15]
    ds_read_b64_tr_b16 v[84:85], v97 offset:53248
    ds_read_b64_tr_b16 v[86:87], v97 offset:54272
    ds_read_b64_tr_b16 v[88:89], v98 offset:53248
    v_mfma_f32_32x32x16_bf16 v[16:31], v[132:135], v[148:151], v[16:31]
    ds_read_b64_tr_b16 v[90:91], v98 offset:54272
    ds_read_b64_tr_b16 v[92:93], v99 offset:53248
    ds_read_b64_tr_b16 v[94:95], v99 offset:54272
    s_add_u32 s49, s33, s40
    s_add_u32 s49, s49, 131072
    s_add_u32 m0, s32, 45056
    s_nop 0
    buffer_load_dwordx4 v165, s[12:15], s49 offen lds
    s_add_u32 s40, s40, 262144
    s_and_b32 s40, s40, 4194303
    v_mfma_f32_32x32x16_bf16 v[32:47], v[136:139], v[148:151], v[32:47]
    v_mfma_f32_32x32x16_bf16 v[48:63], v[140:143], v[148:151], v[48:63]
    s_waitcnt vmcnt(6) lgkmcnt(0)
    s_barrier
    v_mfma_f32_32x32x16_bf16 v[0:15], v[64:67], v[152:155], v[0:15]
    ds_read_b128 v[144:147], v104 offset:0
    ds_read_b64_tr_b16 v[112:113], v96 offset:24576
    ds_read_b64_tr_b16 v[114:115], v96 offset:25600
    v_mfma_f32_32x32x16_bf16 v[16:31], v[68:71], v[152:155], v[16:31]
    ds_read_b64_tr_b16 v[116:117], v97 offset:24576
    ds_read_b64_tr_b16 v[118:119], v97 offset:25600
    ds_read_b64_tr_b16 v[120:121], v98 offset:24576
    s_add_u32 s49, s34, s41
    s_mov_b32 m0, s37
    s_nop 0
    buffer_load_dwordx4 v108, s[8:11], s49 offen lds
    s_add_u32 s41, s41, 64
    s_and_b32 s41, s41, 1023
    v_mfma_f32_32x32x16_bf16 v[32:47], v[72:75], v[152:155], v[32:47]
    ds_read_b64_tr_b16 v[122:123], v98 offset:25600
    ds_read_b64_tr_b16 v[124:125], v99 offset:24576
    ds_read_b64_tr_b16 v[126:127], v99 offset:25600
    v_mfma_f32_32x32x16_bf16 v[48:63], v[76:79], v[152:155], v[48:63]
    ds_read_b128 v[148:151], v105 offset:0
    ds_read_b64_tr_b16 v[128:129], v96 offset:28672
    ds_read_b64_tr_b16 v[130:131], v96 offset:29696
    s_add_u32 s49, s33, s40
    s_add_u32 m0, s32, 49152
    s_nop 0
    buffer_load_dwordx4 v165, s[12:15], s49 offen lds
    v_mfma_f32_32x32x16_bf16 v[0:15], v[80:83], v[156:159], v[0:15]
    ds_read_b64_tr_b16 v[132:133], v97 offset:28672
    ds_read_b64_tr_b16 v[134:135], v97 offset:29696
    ds_read_b64_tr_b16 v[136:137], v98 offset:28672
    v_mfma_f32_32x32x16_bf16 v[16:31], v[84:87], v[156:159], v[16:31]
    ds_read_b64_tr_b16 v[138:139], v98 offset:29696
    ds_read_b64_tr_b16 v[140:141], v99 offset:28672
    ds_read_b64_tr_b16 v[142:143], v99 offset:29696
    s_add_u32 s49, s33, s40
    s_add_u32 s49, s49, 131072
    s_add_u32 m0, s32, 53248
    s_nop 0
    buffer_load_dwordx4 v165, s[12:15], s49 offen lds
    s_add_u32 s40, s40, 262144
    s_and_b32 s40, s40, 4194303
    v_mfma_f32_32x32x16_bf16 v[32:47], v[88:91], v[156:159], v[32:47]
    v_mfma_f32_32x32x16_bf16 v[48:63], v[92:95], v[156:159], v[48:63]
    s_waitcnt vmcnt(6) lgkmcnt(0)
    s_barrier
    v_mfma_f32_32x32x16_bf16 v[0:15], v[112:115], v[144:147], v[0:15]
    ds_read_b128 v[152:155], v106 offset:0
    ds_read_b64_tr_b16 v[64:65], v96 offset:57344
    ds_read_b64_tr_b16 v[66:67], v96 offset:58368
    v_mfma_f32_32x32x16_bf16 v[16:31], v[116:119], v[144:147], v[16:31]
    ds_read_b64_tr_b16 v[68:69], v97 offset:57344
    ds_read_b64_tr_b16 v[70:71], v97 offset:58368
    ds_read_b64_tr_b16 v[72:73], v98 offset:57344
    s_add_u32 s49, s34, s41
    s_mov_b32 m0, s38
    s_nop 0
    buffer_load_dwordx4 v108, s[8:11], s49 offen lds
    s_add_u32 s41, s41, 64
    s_and_b32 s41, s41, 1023
    v_mfma_f32_32x32x16_bf16 v[32:47], v[120:123], v[144:147], v[32:47]
    ds_read_b64_tr_b16 v[74:75], v98 offset:58368
    ds_read_b64_tr_b16 v[76:77], v99 offset:57344
    ds_read_b64_tr_b16 v[78:79], v99 offset:58368
    v_mfma_f32_32x32x16_bf16 v[48:63], v[124:127], v[144:147], v[48:63]
    ds_read_b128 v[156:159], v107 offset:0
    ds_read_b64_tr_b16 v[80:81], v96 offset:61440
    ds_read_b64_tr_b16 v[82:83], v96 offset:62464
    s_add_u32 s49, s33, s40
    s_add_u32 m0, s32, 24576
    s_nop 0
    buffer_load_dwordx4 v165, s[12:15], s49 offen lds
    v_mfma_f32_32x32x16_bf16 v[0:15], v[128:131], v[148:151], v[0:15]
    ds_read_b64_tr_b16 v[84:85], v97 offset:61440
    ds_read_b64_tr_b16 v[86:87], v97 offset:62464
    ds_read_b64_tr_b16 v[88:89], v98 offset:61440
    v_mfma_f32_32x32x16_bf16 v[16:31], v[132:135], v[148:151], v[16:31]
    ds_read_b64_tr_b16 v[90:91], v98 offset:62464
    ds_read_b64_tr_b16 v[92:93], v99 offset:61440
    ds_read_b64_tr_b16 v[94:95], v99 offset:62464
    s_add_u32 s49, s33, s40
    s_add_u32 s49, s49, 131072
    s_add_u32 m0, s32, 28672
    s_nop 0
    buffer_load_dwordx4 v165, s[12:15], s49 offen lds
    s_add_u32 s40, s40, 262144
    s_and_b32 s40, s40, 4194303
    v_mfma_f32_32x32x16_bf16 v[32:47], v[136:139], v[148:151], v[32:47]
    v_mfma_f32_32x32x16_bf16 v[48:63], v[140:143], v[148:151], v[48:63]
    s_waitcnt vmcnt(6) lgkmcnt(0)
    s_barrier
    v_mfma_f32_32x32x16_bf16 v[0:15], v[64:67], v[152:155], v[0:15]
    ds_read_b128 v[144:147], v100 offset:0
    ds_read_b64_tr_b16 v[112:113], v96 offset:40960
    ds_read_b64_tr_b16 v[114:115], v96 offset:41984
    v_mfma_f32_32x32x16_bf16 v[16:31], v[68:71], v[152:155], v[16:31]
    ds_read_b64_tr_b16 v[116:117], v97 offset:40960
    ds_read_b64_tr_b16 v[118:119], v97 offset:41984
    ds_read_b64_tr_b16 v[120:121], v98 offset:40960
    s_add_u32 s49, s34, s41
    s_mov_b32 m0, s39
    s_nop 0
    buffer_load_dwordx4 v108, s[8:11], s49 offen lds
    s_add_u32 s41, s41, 64
    s_and_b32 s41, s41, 1023
    v_mfma_f32_32x32x16_bf16 v[32:47], v[72:75], v[152:155], v[32:47]
    ds_read_b64_tr_b16 v[122:123], v98 offset:41984
    ds_read_b64_tr_b16 v[124:125], v99 offset:40960
    ds_read_b64_tr_b16 v[126:127], v99 offset:41984
    v_mfma_f32_32x32x16_bf16 v[48:63], v[76:79], v[152:155], v[48:63]
    ds_read_b128 v[148:151], v101 offset:0
    ds_read_b64_tr_b16 v[128:129], v96 offset:45056
    ds_read_b64_tr_b16 v[130:131], v96 offset:46080
    s_add_u32 s49, s33, s40
    s_add_u32 m0, s32, 57344
    s_nop 0
    buffer_load_dwordx4 v165, s[12:15], s49 offen lds
    v_mfma_f32_32x32x16_bf16 v[0:15], v[80:83], v[156:159], v[0:15]
    ds_read_b64_tr_b16 v[132:133], v97 offset:45056
    ds_read_b64_tr_b16 v[134:135], v97 offset:46080
    ds_read_b64_tr_b16 v[136:137], v98 offset:45056
    v_mfma_f32_32x32x16_bf16 v[16:31], v[84:87], v[156:159], v[16:31]
    ds_read_b64_tr_b16 v[138:139], v98 offset:46080
    ds_read_b64_tr_b16 v[140:141], v99 offset:45056
    ds_read_b64_tr_b16 v[142:143], v99 offset:46080
    s_add_u32 s49, s33, s40
    s_add_u32 s49, s49, 131072
    s_add_u32 m0, s32, 61440
    s_nop 0
    buffer_load_dwordx4 v165, s[12:15], s49 offen lds
    s_add_u32 s40, s40, 262144
    s_and_b32 s40, s40, 4194303
    v_mfma_f32_32x32x16_bf16 v[32:47], v[88:91], v[156:159], v[32:47]
    v_mfma_f32_32x32x16_bf16 v[48:63], v[92:95], v[156:159], v[48:63]
    s_waitcnt vmcnt(6) lgkmcnt(0)
    s_barrier
    v_mfma_f32_32x32x16_bf16 v[0:15], v[112:115], v[144:147], v[0:15]
    ds_read_b128 v[152:155], v102 offset:0
    ds_read_b64_tr_b16 v[64:65], v96 offset:49152
    ds_read_b64_tr_b16 v[66:67], v96 offset:50176
    v_mfma_f32_32x32x16_bf16 v[16:31], v[116:119], v[144:147], v[16:31]
    ds_read_b64_tr_b16 v[68:69], v97 offset:49152
    ds_read_b64_tr_b16 v[70:71], v97 offset:50176
    ds_read_b64_tr_b16 v[72:73], v98 offset:49152
    s_add_u32 s49, s34, s41
    s_mov_b32 m0, s36
    s_nop 0
    buffer_load_dwordx4 v108, s[8:11], s49 offen lds
    s_add_u32 s41, s41, 64
    s_and_b32 s41, s41, 1023
    v_mfma_f32_32x32x16_bf16 v[32:47], v[120:123], v[144:147], v[32:47]
    ds_read_b64_tr_b16 v[74:75], v98 offset:50176
    ds_read_b64_tr_b16 v[76:77], v99 offset:49152
    ds_read_b64_tr_b16 v[78:79], v99 offset:50176
    v_mfma_f32_32x32x16_bf16 v[48:63], v[124:127], v[144:147], v[48:63]
    ds_read_b128 v[156:159], v103 offset:0
    ds_read_b64_tr_b16 v[80:81], v96 offset:53248
    ds_read_b64_tr_b16 v[82:83], v96 offset:54272
    s_add_u32 s49, s33, s40
    s_add_u32 m0, s32, 40960
    s_nop 0
    buffer_load_dwordx4 v165, s[12:15], s49 offen lds
    v_mfma_f32_32x32x16_bf16 v[0:15], v[128:131], v[148:151], v[0:15]
    ds_read_b64_tr_b16 v[84:85], v97 offset:53248
    ds_read_b64_tr_b16 v[86:87], v97 offset:54272
    ds_read_b64_tr_b16 v[88:89], v98 offset:53248
    v_mfma_f32_32x32x16_bf16 v[16:31], v[132:135], v[148:151], v[16:31]
    ds_read_b64_tr_b16 v[90:91], v98 offset:54272
    ds_read_b64_tr_b16 v[92:93], v99 offset:53248
    ds_read_b64_tr_b16 v[94:95], v99 offset:54272
    s_add_u32 s49, s33, s40
    s_add_u32 s49, s49, 131072
    s_add_u32 m0, s32, 45056
    s_nop 0
    buffer_load_dwordx4 v165, s[12:15], s49 offen lds
    s_add_u32 s40, s40, 262144
    s_and_b32 s40, s40, 4194303
    v_mfma_f32_32x32x16_bf16 v[32:47], v[136:139], v[148:151], v[32:47]
    v_mfma_f32_32x32x16_bf16 v[48:63], v[140:143], v[148:151], v[48:63]
    s_waitcnt vmcnt(6) lgkmcnt(0)
    s_barrier
    v_mfma_f32_32x32x16_bf16 v[0:15], v[64:67], v[152:155], v[0:15]
    ds_read_b128 v[144:147], v104 offset:0
    ds_read_b64_tr_b16 v[112:113], v96 offset:24576
    ds_read_b64_tr_b16 v[114:115], v96 offset:25600
    v_mfma_f32_32x32x16_bf16 v[16:31], v[68:71], v[152:155], v[16:31]
    ds_read_b64_tr_b16 v[116:117], v97 offset:24576
    ds_read_b64_tr_b16 v[118:119], v97 offset:25600
    ds_read_b64_tr_b16 v[120:121], v98 offset:24576
    s_add_u32 s49, s34, s41
    s_mov_b32 m0, s37
    s_nop 0
    buffer_load_dwordx4 v108, s[8:11], s49 offen lds
    s_add_u32 s41, s41, 64
    s_and_b32 s41, s41, 1023
    v_mfma_f32_32x32x16_bf16 v[32:47], v[72:75], v[152:155], v[32:47]
    ds_read_b64_tr_b16 v[122:123], v98 offset:25600
    ds_read_b64_tr_b16 v[124:125], v99 offset:24576
    ds_read_b64_tr_b16 v[126:127], v99 offset:25600
    v_mfma_f32_32x32x16_bf16 v[48:63], v[76:79], v[152:155], v[48:63]
    ds_read_b128 v[148:151], v105 offset:0
    ds_read_b64_tr_b16 v[128:129], v96 offset:28672
    ds_read_b64_tr_b16 v[130:131], v96 offset:29696
    s_add_u32 s49, s33, s40
    s_add_u32 m0, s32, 49152
    s_nop 0
    buffer_load_dwordx4 v165, s[12:15], s49 offen lds
    v_mfma_f32_32x32x16_bf16 v[0:15], v[80:83], v[156:159], v[0:15]
    ds_read_b64_tr_b16 v[132:133], v97 offset:28672
    ds_read_b64_tr_b16 v[134:135], v97 offset:29696
    ds_read_b64_tr_b16 v[136:137], v98 offset:28672
    v_mfma_f32_32x32x16_bf16 v[16:31], v[84:87], v[156:159], v[16:31]
    ds_read_b64_tr_b16 v[138:139], v98 offset:29696
    ds_read_b64_tr_b16 v[140:141], v99 offset:28672
    ds_read_b64_tr_b16 v[142:143], v99 offset:29696
    s_add_u32 s49, s33, s40
    s_add_u32 s49, s49, 131072
    s_add_u32 m0, s32, 53248
    s_nop 0
    buffer_load_dwordx4 v165, s[12:15], s49 offen lds
    s_add_u32 s40, s40, 262144
    s_and_b32 s40, s40, 4194303
    v_mfma_f32_32x32x16_bf16 v[32:47], v[88:91], v[156:159], v[32:47]
    v_mfma_f32_32x32x16_bf16 v[48:63], v[92:95], v[156:159], v[48:63]
    s_waitcnt vmcnt(6) lgkmcnt(0)
    s_barrier
    v_mfma_f32_32x32x16_bf16 v[0:15], v[112:115], v[144:147], v[0:15]
    ds_read_b128 v[152:155], v106 offset:0
    ds_read_b64_tr_b16 v[64:65], v96 offset:57344
    ds_read_b64_tr_b16 v[66:67], v96 offset:58368
    v_mfma_f32_32x32x16_bf16 v[16:31], v[116:119], v[144:147], v[16:31]
    ds_read_b64_tr_b16 v[68:69], v97 offset:57344
    ds_read_b64_tr_b16 v[70:71], v97 offset:58368
    ds_read_b64_tr_b16 v[72:73], v98 offset:57344
    s_add_u32 s49, s34, s41
    s_mov_b32 m0, s38
    s_nop 0
    buffer_load_dwordx4 v108, s[8:11], s49 offen lds
    s_add_u32 s41, s41, 64
    s_and_b32 s41, s41, 1023
    v_mfma_f32_32x32x16_bf16 v[32:47], v[120:123], v[144:147], v[32:47]
    ds_read_b64_tr_b16 v[74:75], v98 offset:58368
    ds_read_b64_tr_b16 v[76:77], v99 offset:57344
    ds_read_b64_tr_b16 v[78:79], v99 offset:58368
    v_mfma_f32_32x32x16_bf16 v[48:63], v[124:127], v[144:147], v[48:63]
    ds_read_b128 v[156:159], v107 offset:0
    ds_read_b64_tr_b16 v[80:81], v96 offset:61440
    ds_read_b64_tr_b16 v[82:83], v96 offset:62464
    s_add_u32 s49, s33, s40
    s_add_u32 m0, s32, 24576
    s_nop 0
    buffer_load_dwordx4 v165, s[12:15], s49 offen lds
    v_mfma_f32_32x32x16_bf16 v[0:15], v[128:131], v[148:151], v[0:15]
    ds_read_b64_tr_b16 v[84:85], v97 offset:61440
    ds_read_b64_tr_b16 v[86:87], v97 offset:62464
    ds_read_b64_tr_b16 v[88:89], v98 offset:61440
    v_mfma_f32_32x32x16_bf16 v[16:31], v[132:135], v[148:151], v[16:31]
    ds_read_b64_tr_b16 v[90:91], v98 offset:62464
    ds_read_b64_tr_b16 v[92:93], v99 offset:61440
    ds_read_b64_tr_b16 v[94:95], v99 offset:62464
    s_add_u32 s49, s33, s40
    s_add_u32 s49, s49, 131072
    s_add_u32 m0, s32, 28672
    s_nop 0
    buffer_load_dwordx4 v165, s[12:15], s49 offen lds
    s_add_u32 s40, s40, 262144
    s_and_b32 s40, s40, 4194303
    v_mfma_f32_32x32x16_bf16 v[32:47], v[136:139], v[148:151], v[32:47]
    v_mfma_f32_32x32x16_bf16 v[48:63], v[140:143], v[148:151], v[48:63]
    s_waitcnt vmcnt(6) lgkmcnt(0)
    s_barrier
    v_mfma_f32_32x32x16_bf16 v[0:15], v[64:67], v[152:155], v[0:15]
    ds_read_b128 v[144:147], v100 offset:0
    ds_read_b64_tr_b16 v[112:113], v96 offset:40960
    ds_read_b64_tr_b16 v[114:115], v96 offset:41984
    v_mfma_f32_32x32x16_bf16 v[16:31], v[68:71], v[152:155], v[16:31]
    ds_read_b64_tr_b16 v[116:117], v97 offset:40960
    ds_read_b64_tr_b16 v[118:119], v97 offset:41984
    ds_read_b64_tr_b16 v[120:121], v98 offset:40960
    s_add_u32 s49, s34, s41
    s_mov_b32 m0, s39
    s_nop 0
    buffer_load_dwordx4 v108, s[8:11], s49 offen lds
    s_add_u32 s41, s41, 64
    s_and_b32 s41, s41, 1023
    v_mfma_f32_32x32x16_bf16 v[32:47], v[72:75], v[152:155], v[32:47]
    ds_read_b64_tr_b16 v[122:123], v98 offset:41984
    ds_read_b64_tr_b16 v[124:125], v99 offset:40960
    ds_read_b64_tr_b16 v[126:127], v99 offset:41984
    v_mfma_f32_32x32x16_bf16 v[48:63], v[76:79], v[152:155], v[48:63]
    ds_read_b128 v[148:151], v101 offset:0
    ds_read_b64_tr_b16 v[128:129], v96 offset:45056
    ds_read_b64_tr_b16 v[130:131], v96 offset:46080
    s_add_u32 s49, s33, s40
    s_add_u32 m0, s32, 57344
    s_nop 0
    buffer_load_dwordx4 v165, s[12:15], s49 offen lds
    v_mfma_f32_32x32x16_bf16 v[0:15], v[80:83], v[156:159], v[0:15]
    ds_read_b64_tr_b16 v[132:133], v97 offset:45056
    ds_read_b64_tr_b16 v[134:135], v97 offset:46080
    ds_read_b64_tr_b16 v[136:137], v98 offset:45056
    v_mfma_f32_32x32x16_bf16 v[16:31], v[84:87], v[156:159], v[16:31]
    ds_read_b64_tr_b16 v[138:139], v98 offset:46080
    ds_read_b64_tr_b16 v[140:141], v99 offset:45056
    ds_read_b64_tr_b16 v[142:143], v99 offset:46080
    s_add_u32 s49, s33, s40
    s_add_u32 s49, s49, 131072
    s_add_u32 m0, s32, 61440
    s_nop 0
    buffer_load_dwordx4 v165, s[12:15], s49 offen lds
    s_add_u32 s40, s40, 262144
    s_and_b32 s40, s40, 4194303
    v_mfma_f32_32x32x16_bf16 v[32:47], v[88:91], v[156:159], v[32:47]
    v_mfma_f32_32x32x16_bf16 v[48:63], v[92:95], v[156:159], v[48:63]
    s_waitcnt vmcnt(6) lgkmcnt(0)
    s_barrier
    v_mfma_f32_32x32x16_bf16 v[0:15], v[112:115], v[144:147], v[0:15]
    ds_read_b128 v[152:155], v102 offset:0
    ds_read_b64_tr_b16 v[64:65], v96 offset:49152
    ds_read_b64_tr_b16 v[66:67], v96 offset:50176
    v_mfma_f32_32x32x16_bf16 v[16:31], v[116:119], v[144:147], v[16:31]
    ds_read_b64_tr_b16 v[68:69], v97 offset:49152
    ds_read_b64_tr_b16 v[70:71], v97 offset:50176
    ds_read_b64_tr_b16 v[72:73], v98 offset:49152
    s_add_u32 m0, s46, 40960
    s_add_u32 s49, s48, 0
    buffer_load_dwordx4 v164, s[20:23], s49 offen nt lds
    v_mfma_f32_32x32x16_bf16 v[32:47], v[120:123], v[144:147], v[32:47]
    ds_read_b64_tr_b16 v[74:75], v98 offset:50176
    ds_read_b64_tr_b16 v[76:77], v99 offset:49152
    ds_read_b64_tr_b16 v[78:79], v99 offset:50176
    v_mfma_f32_32x32x16_bf16 v[48:63], v[124:127], v[144:147], v[48:63]
    ds_read_b128 v[156:159], v103 offset:0
    ds_read_b64_tr_b16 v[80:81], v96 offset:53248
    ds_read_b64_tr_b16 v[82:83], v96 offset:54272
    s_add_u32 m0, s46, 45056
    s_add_u32 s49, s48, 4096
    buffer_load_dwordx4 v164, s[20:23], s49 offen nt lds
    s_add_u32 s48, s48, 8192
    v_mfma_f32_32x32x16_bf16 v[0:15], v[128:131], v[148:151], v[0:15]
    ds_read_b64_tr_b16 v[84:85], v97 offset:53248
    ds_read_b64_tr_b16 v[86:87], v97 offset:54272
    ds_read_b64_tr_b16 v[88:89], v98 offset:53248
    v_mfma_f32_32x32x16_bf16 v[16:31], v[132:135], v[148:151], v[16:31]
    ds_read_b64_tr_b16 v[90:91], v98 offset:54272
    ds_read_b64_tr_b16 v[92:93], v99 offset:53248
    ds_read_b64_tr_b16 v[94:95], v99 offset:54272
    v_mfma_f32_32x32x16_bf16 v[32:47], v[136:139], v[148:151], v[32:47]
    v_mfma_f32_32x32x16_bf16 v[48:63], v[140:143], v[148:151], v[48:63]
    s_waitcnt vmcnt(5) lgkmcnt(0)
    s_barrier
    v_mfma_f32_32x32x16_bf16 v[0:15], v[64:67], v[152:155], v[0:15]
    ds_read_b128 v[144:147], v104 offset:0
    ds_read_b64_tr_b16 v[112:113], v96 offset:24576
    ds_read_b64_tr_b16 v[114:115], v96 offset:25600
    v_mfma_f32_32x32x16_bf16 v[16:31], v[68:71], v[152:155], v[16:31]
    ds_read_b64_tr_b16 v[116:117], v97 offset:24576
    ds_read_b64_tr_b16 v[118:119], v97 offset:25600
    ds_read_b64_tr_b16 v[120:121], v98 offset:24576
    s_add_u32 m0, s46, 16384
    s_add_u32 s49, s47, 0
    buffer_load_dwordx4 v163, s[16:19], s49 offen nt lds
    v_mfma_f32_32x32x16_bf16 v[32:47], v[72:75], v[152:155], v[32:47]
    ds_read_b64_tr_b16 v[122:123], v98 offset:25600
    ds_read_b64_tr_b16 v[124:125], v99 offset:24576
    ds_read_b64_tr_b16 v[126:127], v99 offset:25600
    v_mfma_f32_32x32x16_bf16 v[48:63], v[76:79], v[152:155], v[48:63]
    ds_read_b128 v[148:151], v105 offset:0
    ds_read_b64_tr_b16 v[128:129], v96 offset:28672
    ds_read_b64_tr_b16 v[130:131], v96 offset:29696
    s_add_u32 m0, s46, 20480
    s_add_u32 s49, s47, 4096
    buffer_load_dwordx4 v163, s[16:19], s49 offen nt lds
    s_add_u32 s47, s47, 8192
    v_mfma_f32_32x32x16_bf16 v[0:15], v[80:83], v[156:159], v[0:15]
    ds_read_b64_tr_b16 v[132:133], v97 offset:28672
    ds_read_b64_tr_b16 v[134:135], v97 offset:29696
    ds_read_b64_tr_b16 v[136:137], v98 offset:28672
    v_mfma_f32_32x32x16_bf16 v[16:31], v[84:87], v[156:159], v[16:31]
    ds_read_b64_tr_b16 v[138:139], v98 offset:29696
    ds_read_b64_tr_b16 v[140:141], v99 offset:28672
    ds_read_b64_tr_b16 v[142:143], v99 offset:29696
    s_add_u32 m0, s46, 49152
    s_add_u32 s49, s48, 0
    buffer_load_dwordx4 v164, s[20:23], s49 offen nt lds
    v_mfma_f32_32x32x16_bf16 v[32:47], v[88:91], v[156:159], v[32:47]
    v_mfma_f32_32x32x16_bf16 v[48:63], v[92:95], v[156:159], v[48:63]
    s_add_u32 m0, s46, 53248
    s_add_u32 s49, s48, 4096
    buffer_load_dwordx4 v164, s[20:23], s49 offen nt lds
    s_add_u32 s48, s48, 8192
    s_waitcnt vmcnt(6) lgkmcnt(0)
    s_barrier
    v_mfma_f32_32x32x16_bf16 v[0:15], v[112:115], v[144:147], v[0:15]
    ds_read_b128 v[152:155], v106 offset:0
    ds_read_b64_tr_b16 v[64:65], v96 offset:57344
    ds_read_b64_tr_b16 v[66:67], v96 offset:58368
    v_mfma_f32_32x32x16_bf16 v[16:31], v[116:119], v[144:147], v[16:31]
    ds_read_b64_tr_b16 v[68:69], v97 offset:57344
    ds_read_b64_tr_b16 v[70:71], v97 offset:58368
    ds_read_b64_tr_b16 v[72:73], v98 offset:57344
    v_mfma_f32_32x32x16_bf16 v[32:47], v[120:123], v[144:147], v[32:47]
    ds_read_b64_tr_b16 v[74:75], v98 offset:58368
    ds_read_b64_tr_b16 v[76:77], v99 offset:57344
    ds_read_b64_tr_b16 v[78:79], v99 offset:58368
    v_mfma_f32_32x32x16_bf16 v[48:63], v[124:127], v[144:147], v[48:63]
    ds_read_b128 v[156:159], v107 offset:0
    ds_read_b64_tr_b16 v[80:81], v96 offset:61440
    ds_read_b64_tr_b16 v[82:83], v96 offset:62464
    v_mfma_f32_32x32x16_bf16 v[0:15], v[128:131], v[148:151], v[0:15]
    ds_read_b64_tr_b16 v[84:85], v97 offset:61440
    ds_read_b64_tr_b16 v[86:87], v97 offset:62464
    ds_read_b64_tr_b16 v[88:89], v98 offset:61440
    v_mfma_f32_32x32x16_bf16 v[16:31], v[132:135], v[148:151], v[16:31]
    ds_read_b64_tr_b16 v[90:91], v98 offset:62464
    ds_read_b64_tr_b16 v[92:93], v99 offset:61440
    ds_read_b64_tr_b16 v[94:95], v99 offset:62464
    v_mfma_f32_32x32x16_bf16 v[32:47], v[136:139], v[148:151], v[32:47]
    v_mfma_f32_32x32x16_bf16 v[48:63], v[140:143], v[148:151], v[48:63]
    s_waitcnt lgkmcnt(0)
    s_barrier
    v_mfma_f32_32x32x16_bf16 v[0:15], v[64:67], v[152:155], v[0:15]
    v_mfma_f32_32x32x16_bf16 v[16:31], v[68:71], v[152:155], v[16:31]
    v_mfma_f32_32x32x16_bf16 v[32:47], v[72:75], v[152:155], v[32:47]
    v_mfma_f32_32x32x16_bf16 v[48:63], v[76:79], v[152:155], v[48:63]
    v_mfma_f32_32x32x16_bf16 v[0:15], v[80:83], v[156:159], v[0:15]
    v_mfma_f32_32x32x16_bf16 v[16:31], v[84:87], v[156:159], v[16:31]
    v_mfma_f32_32x32x16_bf16 v[32:47], v[88:91], v[156:159], v[32:47]
    v_mfma_f32_32x32x16_bf16 v[48:63], v[92:95], v[156:159], v[48:63]
    s_waitcnt lgkmcnt(0)
    s_nop 7
    v_cvt_pk_bf16_f32 v64, v0, v1
    v_cvt_pk_bf16_f32 v65, v2, v3
    v_cvt_pk_bf16_f32 v66, v4, v5
    v_cvt_pk_bf16_f32 v67, v6, v7
    v_cvt_pk_bf16_f32 v68, v8, v9
    v_cvt_pk_bf16_f32 v69, v10, v11
    v_cvt_pk_bf16_f32 v70, v12, v13
    v_cvt_pk_bf16_f32 v71, v14, v15
    v_cvt_pk_bf16_f32 v72, v16, v17
    v_cvt_pk_bf16_f32 v73, v18, v19
    v_cvt_pk_bf16_f32 v74, v20, v21
    v_cvt_pk_bf16_f32 v75, v22, v23
    v_cvt_pk_bf16_f32 v76, v24, v25
    v_cvt_pk_bf16_f32 v77, v26, v27
    v_cvt_pk_bf16_f32 v78, v28, v29
    v_cvt_pk_bf16_f32 v79, v30, v31
    v_cvt_pk_bf16_f32 v80, v32, v33
    v_cvt_pk_bf16_f32 v81, v34, v35
    v_cvt_pk_bf16_f32 v82, v36, v37
    v_cvt_pk_bf16_f32 v83, v38, v39
    v_cvt_pk_bf16_f32 v84, v40, v41
    v_cvt_pk_bf16_f32 v85, v42, v43
    v_cvt_pk_bf16_f32 v86, v44, v45
    v_cvt_pk_bf16_f32 v87, v46, v47
    v_cvt_pk_bf16_f32 v88, v48, v49
    v_cvt_pk_bf16_f32 v89, v50, v51
    v_cvt_pk_bf16_f32 v90, v52, v53
    v_cvt_pk_bf16_f32 v91, v54, v55
    v_cvt_pk_bf16_f32 v92, v56, v57
    v_cvt_pk_bf16_f32 v93, v58, v59
    v_cvt_pk_bf16_f32 v94, v60, v61
    v_cvt_pk_bf16_f32 v95, v62, v63
    v_and_b32 v8, 31, v166
    v_lshrrev_b32 v9, 5, v166
    v_bfe_u32 v10, v166, 4, 1
    v_bfe_u32 v11, v166, 2, 2
    v_and_b32 v12, 3, v166
    s_lshl_b32 s3, s29, 16
    v_and_b32 v13, 15, v8
    v_xor_b32 v13, v13, v9
    v_lshlrev_b32 v13, 4, v13
    v_lshl_add_u32 v13, v8, 8, v13
    v_add_u32 v13, s3, v13
    v_xor_b32 v144, 0, v13
    v_xor_b32 v145, 32, v13
    v_xor_b32 v146, 64, v13
    v_xor_b32 v147, 96, v13
    v_xor_b32 v148, 128, v13
    v_xor_b32 v149, 160, v13
    v_xor_b32 v150, 192, v13
    v_xor_b32 v151, 224, v13
    v_lshl_add_u32 v13, v9, 2, v11
    v_lshlrev_b32 v13, 8, v13
    v_lshl_add_u32 v13, v11, 6, v13
    v_lshl_add_u32 v13, v10, 5, v13
    v_lshl_add_u32 v13, v12, 3, v13
    v_add_u32 v13, s3, v13
    v_xor_b32 v152, 0, v13
    v_xor_b32 v153, 64, v13
    v_xor_b32 v154, 128, v13
    v_xor_b32 v155, 192, v13
    v_mov_b32 v156, 0xf149f2ca
    v_mov_b32 v157, 0xf149f2ca
    v_mov_b32 v158, 0
    v_mov_b32 v159, 0
    v_mov_b32 v160, 0
    s_waitcnt lgkmcnt(0)
    s_barrier
    s_barrier
    ds_read_b128 v[112:115], v144 offset:0
    ds_read_b128 v[116:119], v145 offset:0
    ds_read_b128 v[120:123], v146 offset:0
    ds_read_b128 v[124:127], v147 offset:0
    ds_read_b128 v[128:131], v148 offset:0
    ds_read_b128 v[132:135], v149 offset:0
    ds_read_b128 v[136:139], v150 offset:0
    ds_read_b128 v[140:143], v151 offset:0
    s_cmp_lg_u32 s68, 0
    s_cbranch_scc1 K1_SP160
    s_add_u32 m0, s46, 24576
    s_add_u32 s49, s47, 0
    buffer_load_dwordx4 v163, s[16:19], s49 offen nt lds
K1_SP160:
    s_waitcnt lgkmcnt(7)
    v_mfma_f32_32x32x16_bf16 v[96:111], v[112:115], v[64:67], 0
    ds_read_b64_tr_b16 v[112:113], v152 offset:32768
    ds_read_b64_tr_b16 v[114:115], v152 offset:34816
    s_cmp_lg_u32 s68, 1
    s_cbranch_scc1 K1_SP161
    s_add_u32 m0, s46, 24576
    s_add_u32 s49, s47, 0
    buffer_load_dwordx4 v163, s[16:19], s49 offen nt lds
K1_SP161:
    s_waitcnt lgkmcnt(8)
    v_mfma_f32_32x32x16_bf16 v[96:111], v[116:119], v[68:71], v[96:111]
    ds_read_b64_tr_b16 v[116:117], v153 offset:32768
    ds_read_b64_tr_b16 v[118:119], v153 offset:34816
    s_cmp_lg_u32 s68, 2
    s_cbranch_scc1 K1_SP162
    s_add_u32 m0, s46, 24576
    s_add_u32 s49, s47, 0
    buffer_load_dwordx4 v163, s[16:19], s49 offen nt lds
K1_SP162:
    s_waitcnt lgkmcnt(9)
    v_mfma_f32_32x32x16_bf16 v[96:111], v[120:123], v[72:75], v[96:111]
    ds_read_b64_tr_b16 v[120:121], v154 offset:32768
    ds_read_b64_tr_b16 v[122:123], v154 offset:34816
    s_cmp_lg_u32 s68, 3
    s_cbranch_scc1 K1_SP163
    s_add_u32 m0, s46, 24576
    s_add_u32 s49, s47, 0
    buffer_load_dwordx4 v163, s[16:19], s49 offen nt lds
K1_SP163:
    s_waitcnt lgkmcnt(10)
    v_mfma_f32_32x32x16_bf16 v[96:111], v[124:127], v[76:79], v[96:111]
    ds_read_b64_tr_b16 v[124:125], v155 offset:32768
    ds_read_b64_tr_b16 v[126:127], v155 offset:34816
    s_cmp_lg_u32 s68, 0
    s_cbranch_scc1 K1_SP164
    s_add_u32 m0, s46, 28672
    s_add_u32 s49, s47, 4096
    buffer_load_dwordx4 v163, s[16:19], s49 offen nt lds
    s_add_u32 s47, s47, 8192
K1_SP164:
    s_waitcnt lgkmcnt(11)
    v_mfma_f32_32x32x16_bf16 v[96:111], v[128:131], v[80:83], v[96:111]
    ds_read_b64_tr_b16 v[128:129], v152 offset:36864
    ds_read_b64_tr_b16 v[130:131], v152 offset:38912
    s_cmp_lg_u32 s68, 1
    s_cbranch_scc1 K1_SP165
    s_add_u32 m0, s46, 28672
    s_add_u32 s49, s47, 4096
    buffer_load_dwordx4 v163, s[16:19], s49 offen nt lds
    s_add_u32 s47, s47, 8192
K1_SP165:
    s_waitcnt lgkmcnt(12)
    v_mfma_f32_32x32x16_bf16 v[96:111], v[132:135], v[84:87], v[96:111]
    ds_read_b64_tr_b16 v[132:133], v153 offset:36864
    ds_read_b64_tr_b16 v[134:135], v153 offset:38912
    s_cmp_lg_u32 s68, 2
    s_cbranch_scc1 K1_SP166
    s_add_u32 m0, s46, 28672
    s_add_u32 s49, s47, 4096
    buffer_load_dwordx4 v163, s[16:19], s49 offen nt lds
    s_add_u32 s47, s47, 8192
K1_SP166:
    s_waitcnt lgkmcnt(13)
    v_mfma_f32_32x32x16_bf16 v[96:111], v[136:139], v[88:91], v[96:111]
    ds_read_b64_tr_b16 v[136:137], v154 offset:36864
    ds_read_b64_tr_b16 v[138:139], v154 offset:38912
    s_cmp_lg_u32 s68, 3
    s_cbranch_scc1 K1_SP167
    s_add_u32 m0, s46, 28672
    s_add_u32 s49, s47, 4096
    buffer_load_dwordx4 v163, s[16:19], s49 offen nt lds
    s_add_u32 s47, s47, 8192
K1_SP167:
    s_waitcnt lgkmcnt(14)
    v_mfma_f32_32x32x16_bf16 v[96:111], v[140:143], v[92:95], v[96:111]
    ds_read_b64_tr_b16 v[140:141], v155 offset:36864
    ds_read_b64_tr_b16 v[142:143], v155 offset:38912
    s_nop 9
    v_max3_f32 v161, v96, v97, v98
    v_max3_f32 v162, v99, v100, v101
    v_max3_f32 v161, v161, v102, v103
    v_max3_f32 v162, v162, v104, v105
    v_max3_f32 v161, v161, v106, v107
    v_max3_f32 v162, v162, v108, v109
    v_max3_f32 v161, v161, v110, v111
    v_max_f32 v161, v161, v162
    v_cmp_gt_f32 vcc, v161, v157
    s_cbranch_vccnz K1_SLOWr1p0
K1_RETr1p0:
    v_fma_f32 v96, v96, s31, v158
    v_fma_f32 v97, v97, s31, v158
    v_fma_f32 v98, v98, s31, v158
    v_fma_f32 v99, v99, s31, v158
    v_fma_f32 v100, v100, s31, v158
    v_fma_f32 v101, v101, s31, v158
    v_fma_f32 v102, v102, s31, v158
    v_fma_f32 v103, v103, s31, v158
    v_fma_f32 v104, v104, s31, v158
    v_fma_f32 v105, v105, s31, v158
    v_fma_f32 v106, v106, s31, v158
    v_fma_f32 v107, v107, s31, v158
    v_fma_f32 v108, v108, s31, v158
    v_fma_f32 v109, v109, s31, v158
    v_fma_f32 v110, v110, s31, v158
    v_fma_f32 v111, v111, s31, v158
    v_exp_f32 v96, v96
    v_exp_f32 v97, v97
    v_exp_f32 v98, v98
    v_exp_f32 v99, v99
    v_exp_f32 v100, v100
    v_exp_f32 v101, v101
    v_exp_f32 v102, v102
    v_exp_f32 v103, v103
    v_exp_f32 v104, v104
    v_exp_f32 v105, v105
    v_exp_f32 v106, v106
    v_exp_f32 v107, v107
    v_exp_f32 v108, v108
    v_exp_f32 v109, v109
    v_exp_f32 v110, v110
    v_exp_f32 v111, v111
    v_add_f32 v159, v159, v96
    v_add_f32 v160, v160, v97
    v_cvt_pk_bf16_f32 v96, v96, v97
    v_add_f32 v159, v159, v98
    v_add_f32 v160, v160, v99
    v_cvt_pk_bf16_f32 v97, v98, v99
    v_add_f32 v159, v159, v100
    v_add_f32 v160, v160, v101
    v_cvt_pk_bf16_f32 v98, v100, v101
    v_add_f32 v159, v159, v102
    v_add_f32 v160, v160, v103
    v_cvt_pk_bf16_f32 v99, v102, v103
    v_add_f32 v159, v159, v104
    v_add_f32 v160, v160, v105
    v_cvt_pk_bf16_f32 v100, v104, v105
    v_add_f32 v159, v159, v106
    v_add_f32 v160, v160, v107
    v_cvt_pk_bf16_f32 v101, v106, v107
    v_add_f32 v159, v159, v108
    v_add_f32 v160, v160, v109
    v_cvt_pk_bf16_f32 v102, v108, v109
    v_add_f32 v159, v159, v110
    v_add_f32 v160, v160, v111
    v_cvt_pk_bf16_f32 v103, v110, v111
    s_add_u32 m0, s46, 57344
    s_add_u32 s49, s48, 0
    buffer_load_dwordx4 v164, s[20:23], s49 offen nt lds
    s_add_u32 m0, s46, 61440
    s_add_u32 s49, s48, 4096
    buffer_load_dwordx4 v164, s[20:23], s49 offen nt lds
    s_add_u32 s48, s48, 8192
    s_waitcnt vmcnt(8) lgkmcnt(0)
    s_barrier
    s_cmp_lg_u32 s68, 0
    s_cbranch_scc1 K1_SP168
    s_add_u32 m0, s46, 0
    s_add_u32 s49, s47, 0
    buffer_load_dwordx4 v163, s[16:19], s49 offen nt lds
K1_SP168:
    v_mfma_f32_32x32x16_bf16 v[0:15], v[112:115], v[96:99], 0
    ds_read_b128 v[112:115], v144 offset:8192
    s_cmp_lg_u32 s68, 1
    s_cbranch_scc1 K1_SP169
    s_add_u32 m0, s46, 0
    s_add_u32 s49, s47, 0
    buffer_load_dwordx4 v163, s[16:19], s49 offen nt lds
K1_SP169:
    v_mfma_f32_32x32x16_bf16 v[16:31], v[116:119], v[96:99], 0
    ds_read_b128 v[116:119], v145 offset:8192
    s_cmp_lg_u32 s68, 2
    s_cbranch_scc1 K1_SP170
    s_add_u32 m0, s46, 0
    s_add_u32 s49, s47, 0
    buffer_load_dwordx4 v163, s[16:19], s49 offen nt lds
K1_SP170:
    v_mfma_f32_32x32x16_bf16 v[32:47], v[120:123], v[96:99], 0
    ds_read_b128 v[120:123], v146 offset:8192
    s_cmp_lg_u32 s68, 3
    s_cbranch_scc1 K1_SP171
    s_add_u32 m0, s46, 0
    s_add_u32 s49, s47, 0
    buffer_load_dwordx4 v163, s[16:19], s49 offen nt lds
K1_SP171:
    v_mfma_f32_32x32x16_bf16 v[48:63], v[124:127], v[96:99], 0
    ds_read_b128 v[124:127], v147 offset:8192
    s_cmp_lg_u32 s68, 0
    s_cbranch_scc1 K1_SP172
    s_add_u32 m0, s46, 4096
    s_add_u32 s49, s47, 4096
    buffer_load_dwordx4 v163, s[16:19], s49 offen nt lds
    s_add_u32 s47, s47, 8192
K1_SP172:
    v_mfma_f32_32x32x16_bf16 v[0:15], v[128:131], v[100:103], v[0:15]
    ds_read_b128 v[128:131], v148 offset:8192
    s_cmp_lg_u32 s68, 1
    s_cbranch_scc1 K1_SP173
    s_add_u32 m0, s46, 4096
    s_add_u32 s49, s47, 4096
    buffer_load_dwordx4 v163, s[16:19], s49 offen nt lds
    s_add_u32 s47, s47, 8192
K1_SP173:
    v_mfma_f32_32x32x16_bf16 v[16:31], v[132:135], v[100:103], v[16:31]
    ds_read_b128 v[132:135], v149 offset:8192
    s_cmp_lg_u32 s68, 2
    s_cbranch_scc1 K1_SP174
    s_add_u32 m0, s46, 4096
    s_add_u32 s49, s47, 4096
    buffer_load_dwordx4 v163, s[16:19], s49 offen nt lds
    s_add_u32 s47, s47, 8192
K1_SP174:
    v_mfma_f32_32x32x16_bf16 v[32:47], v[136:139], v[100:103], v[32:47]
    ds_read_b128 v[136:139], v150 offset:8192
    s_cmp_lg_u32 s68, 3
    s_cbranch_scc1 K1_SP175
    s_add_u32 m0, s46, 4096
    s_add_u32 s49, s47, 4096
    buffer_load_dwordx4 v163, s[16:19], s49 offen nt lds
    s_add_u32 s47, s47, 8192
K1_SP175:
    v_mfma_f32_32x32x16_bf16 v[48:63], v[140:143], v[100:103], v[48:63]
    ds_read_b128 v[140:143], v151 offset:8192
    s_cmp_lg_u32 s68, 0
    s_cbranch_scc1 K1_SP176
    s_add_u32 m0, s46, 32768
    s_add_u32 s49, s48, 0
    buffer_load_dwordx4 v164, s[20:23], s49 offen nt lds
K1_SP176:
    s_waitcnt lgkmcnt(7)
    v_mfma_f32_32x32x16_bf16 v[96:111], v[112:115], v[64:67], 0
    ds_read_b64_tr_b16 v[112:113], v152 offset:40960
    ds_read_b64_tr_b16 v[114:115], v152 offset:43008
    s_cmp_lg_u32 s68, 1
    s_cbranch_scc1 K1_SP177
    s_add_u32 m0, s46, 32768
    s_add_u32 s49, s48, 0
    buffer_load_dwordx4 v164, s[20:23], s49 offen nt lds
K1_SP177:
    s_waitcnt lgkmcnt(8)
    v_mfma_f32_32x32x16_bf16 v[96:111], v[116:119], v[68:71], v[96:111]
    ds_read_b64_tr_b16 v[116:117], v153 offset:40960
    ds_read_b64_tr_b16 v[118:119], v153 offset:43008
    s_cmp_lg_u32 s68, 2
    s_cbranch_scc1 K1_SP178
    s_add_u32 m0, s46, 32768
    s_add_u32 s49, s48, 0
    buffer_load_dwordx4 v164, s[20:23], s49 offen nt lds
K1_SP178:
    s_waitcnt lgkmcnt(9)
    v_mfma_f32_32x32x16_bf16 v[96:111], v[120:123], v[72:75], v[96:111]
    ds_read_b64_tr_b16 v[120:121], v154 offset:40960
    ds_read_b64_tr_b16 v[122:123], v154 offset:43008
    s_cmp_lg_u32 s68, 3
    s_cbranch_scc1 K1_SP179
    s_add_u32 m0, s46, 32768
    s_add_u32 s49, s48, 0
    buffer_load_dwordx4 v164, s[20:23], s49 offen nt lds
K1_SP179:
    s_waitcnt lgkmcnt(10)
    v_mfma_f32_32x32x16_bf16 v[96:111], v[124:127], v[76:79], v[96:111]
    ds_read_b64_tr_b16 v[124:125], v155 offset:40960
    ds_read_b64_tr_b16 v[126:127], v155 offset:43008
    s_cmp_lg_u32 s68, 0
    s_cbranch_scc1 K1_SP180
    s_add_u32 m0, s46, 36864
    s_add_u32 s49, s48, 4096
    buffer_load_dwordx4 v164, s[20:23], s49 offen nt lds
    s_add_u32 s48, s48, 8192
K1_SP180:
    s_waitcnt lgkmcnt(11)
    v_mfma_f32_32x32x16_bf16 v[96:111], v[128:131], v[80:83], v[96:111]
    ds_read_b64_tr_b16 v[128:129], v152 offset:45056
    ds_read_b64_tr_b16 v[130:131], v152 offset:47104
    s_cmp_lg_u32 s68, 1
    s_cbranch_scc1 K1_SP181
    s_add_u32 m0, s46, 36864
    s_add_u32 s49, s48, 4096
    buffer_load_dwordx4 v164, s[20:23], s49 offen nt lds
    s_add_u32 s48, s48, 8192
K1_SP181:
    s_waitcnt lgkmcnt(12)
    v_mfma_f32_32x32x16_bf16 v[96:111], v[132:135], v[84:87], v[96:111]
    ds_read_b64_tr_b16 v[132:133], v153 offset:45056
    ds_read_b64_tr_b16 v[134:135], v153 offset:47104
    s_cmp_lg_u32 s68, 2
    s_cbranch_scc1 K1_SP182
    s_add_u32 m0, s46, 36864
    s_add_u32 s49, s48, 4096
    buffer_load_dwordx4 v164, s[20:23], s49 offen nt lds
    s_add_u32 s48, s48, 8192
K1_SP182:
    s_waitcnt lgkmcnt(13)
    v_mfma_f32_32x32x16_bf16 v[96:111], v[136:139], v[88:91], v[96:111]
    ds_read_b64_tr_b16 v[136:137], v154 offset:45056
    ds_read_b64_tr_b16 v[138:139], v154 offset:47104
    s_cmp_lg_u32 s68, 3
    s_cbranch_scc1 K1_SP183
    s_add_u32 m0, s46, 36864
    s_add_u32 s49, s48, 4096
    buffer_load_dwordx4 v164, s[20:23], s49 offen nt lds
    s_add_u32 s48, s48, 8192
K1_SP183:
    s_waitcnt lgkmcnt(14)
    v_mfma_f32_32x32x16_bf16 v[96:111], v[140:143], v[92:95], v[96:111]
    ds_read_b64_tr_b16 v[140:141], v155 offset:45056
    ds_read_b64_tr_b16 v[142:143], v155 offset:47104
    s_nop 9
    v_max3_f32 v161, v96, v97, v98
    v_max3_f32 v162, v99, v100, v101
    v_max3_f32 v161, v161, v102, v103
    v_max3_f32 v162, v162, v104, v105
    v_max3_f32 v161, v161, v106, v107
    v_max3_f32 v162, v162, v108, v109
    v_max3_f32 v161, v161, v110, v111
    v_max_f32 v161, v161, v162
    v_cmp_gt_f32 vcc, v161, v157
    s_cbranch_vccnz K1_SLOWr1p1
K1_RETr1p1:
    v_fma_f32 v96, v96, s31, v158
    v_fma_f32 v97, v97, s31, v158
    v_fma_f32 v98, v98, s31, v158
    v_fma_f32 v99, v99, s31, v158
    v_fma_f32 v100, v100, s31, v158
    v_fma_f32 v101, v101, s31, v158
    v_fma_f32 v102, v102, s31, v158
    v_fma_f32 v103, v103, s31, v158
    v_fma_f32 v104, v104, s31, v158
    v_fma_f32 v105, v105, s31, v158
    v_fma_f32 v106, v106, s31, v158
    v_fma_f32 v107, v107, s31, v158
    v_fma_f32 v108, v108, s31, v158
    v_fma_f32 v109, v109, s31, v158
    v_fma_f32 v110, v110, s31, v158
    v_fma_f32 v111, v111, s31, v158
    v_exp_f32 v96, v96
    v_exp_f32 v97, v97
    v_exp_f32 v98, v98
    v_exp_f32 v99, v99
    v_exp_f32 v100, v100
    v_exp_f32 v101, v101
    v_exp_f32 v102, v102
    v_exp_f32 v103, v103
    v_exp_f32 v104, v104
    v_exp_f32 v105, v105
    v_exp_f32 v106, v106
    v_exp_f32 v107, v107
    v_exp_f32 v108, v108
    v_exp_f32 v109, v109
    v_exp_f32 v110, v110
    v_exp_f32 v111, v111
    v_add_f32 v159, v159, v96
    v_add_f32 v160, v160, v97
    v_cvt_pk_bf16_f32 v96, v96, v97
    v_add_f32 v159, v159, v98
    v_add_f32 v160, v160, v99
    v_cvt_pk_bf16_f32 v97, v98, v99
    v_add_f32 v159, v159, v100
    v_add_f32 v160, v160, v101
    v_cvt_pk_bf16_f32 v98, v100, v101
    v_add_f32 v159, v159, v102
    v_add_f32 v160, v160, v103
    v_cvt_pk_bf16_f32 v99, v102, v103
    v_add_f32 v159, v159, v104
    v_add_f32 v160, v160, v105
    v_cvt_pk_bf16_f32 v100, v104, v105
    v_add_f32 v159, v159, v106
    v_add_f32 v160, v160, v107
    v_cvt_pk_bf16_f32 v101, v106, v107
    v_add_f32 v159, v159, v108
    v_add_f32 v160, v160, v109
    v_cvt_pk_bf16_f32 v102, v108, v109
    v_add_f32 v159, v159, v110
    v_add_f32 v160, v160, v111
    v_cvt_pk_bf16_f32 v103, v110, v111
    s_waitcnt vmcnt(8) lgkmcnt(0)
    s_barrier
    s_cmp_lg_u32 s68, 0
    s_cbranch_scc1 K1_SP184
    s_add_u32 m0, s46, 8192
    s_add_u32 s49, s47, 0
    buffer_load_dwordx4 v163, s[16:19], s49 offen nt lds
K1_SP184:
    v_mfma_f32_32x32x16_bf16 v[0:15], v[112:115], v[96:99], v[0:15]
    ds_read_b128 v[112:115], v144 offset:16384
    s_cmp_lg_u32 s68, 1
    s_cbranch_scc1 K1_SP185
    s_add_u32 m0, s46, 8192
    s_add_u32 s49, s47, 0
    buffer_load_dwordx4 v163, s[16:19], s49 offen nt lds
K1_SP185:
    v_mfma_f32_32x32x16_bf16 v[16:31], v[116:119], v[96:99], v[16:31]
    ds_read_b128 v[116:119], v145 offset:16384
    s_cmp_lg_u32 s68, 2
    s_cbranch_scc1 K1_SP186
    s_add_u32 m0, s46, 8192
    s_add_u32 s49, s47, 0
    buffer_load_dwordx4 v163, s[16:19], s49 offen nt lds
K1_SP186:
    v_mfma_f32_32x32x16_bf16 v[32:47], v[120:123], v[96:99], v[32:47]
    ds_read_b128 v[120:123], v146 offset:16384
    s_cmp_lg_u32 s68, 3
    s_cbranch_scc1 K1_SP187
    s_add_u32 m0, s46, 8192
    s_add_u32 s49, s47, 0
    buffer_load_dwordx4 v163, s[16:19], s49 offen nt lds
K1_SP187:
    v_mfma_f32_32x32x16_bf16 v[48:63], v[124:127], v[96:99], v[48:63]
    ds_read_b128 v[124:127], v147 offset:16384
    s_cmp_lg_u32 s68, 0
    s_cbranch_scc1 K1_SP188
    s_add_u32 m0, s46, 12288
    s_add_u32 s49, s47, 4096
    buffer_load_dwordx4 v163, s[16:19], s49 offen nt lds
    s_add_u32 s47, s47, 8192
K1_SP188:
    v_mfma_f32_32x32x16_bf16 v[0:15], v[128:131], v[100:103], v[0:15]
    ds_read_b128 v[128:131], v148 offset:16384
    s_cmp_lg_u32 s68, 1
    s_cbranch_scc1 K1_SP189
    s_add_u32 m0, s46, 12288
    s_add_u32 s49, s47, 4096
    buffer_load_dwordx4 v163, s[16:19], s49 offen nt lds
    s_add_u32 s47, s47, 8192
K1_SP189:
    v_mfma_f32_32x32x16_bf16 v[16:31], v[132:135], v[100:103], v[16:31]
    ds_read_b128 v[132:135], v149 offset:16384
    s_cmp_lg_u32 s68, 2
    s_cbranch_scc1 K1_SP190
    s_add_u32 m0, s46, 12288
    s_add_u32 s49, s47, 4096
    buffer_load_dwordx4 v163, s[16:19], s49 offen nt lds
    s_add_u32 s47, s47, 8192
K1_SP190:
    v_mfma_f32_32x32x16_bf16 v[32:47], v[136:139], v[100:103], v[32:47]
    ds_read_b128 v[136:139], v150 offset:16384
    s_cmp_lg_u32 s68, 3
    s_cbranch_scc1 K1_SP191
    s_add_u32 m0, s46, 12288
    s_add_u32 s49, s47, 4096
    buffer_load_dwordx4 v163, s[16:19], s49 offen nt lds
    s_add_u32 s47, s47, 8192
K1_SP191:
    v_mfma_f32_32x32x16_bf16 v[48:63], v[140:143], v[100:103], v[48:63]
    ds_read_b128 v[140:143], v151 offset:16384
    s_cmp_lg_u32 s68, 0
    s_cbranch_scc1 K1_SP192
    s_add_u32 m0, s46, 40960
    s_add_u32 s49, s48, 0
    buffer_load_dwordx4 v164, s[20:23], s49 offen nt lds
K1_SP192:
    s_waitcnt lgkmcnt(7)
    v_mfma_f32_32x32x16_bf16 v[96:111], v[112:115], v[64:67], 0
    ds_read_b64_tr_b16 v[112:113], v152 offset:49152
    ds_read_b64_tr_b16 v[114:115], v152 offset:51200
    s_cmp_lg_u32 s68, 1
    s_cbranch_scc1 K1_SP193
    s_add_u32 m0, s46, 40960
    s_add_u32 s49, s48, 0
    buffer_load_dwordx4 v164, s[20:23], s49 offen nt lds
K1_SP193:
    s_waitcnt lgkmcnt(8)
    v_mfma_f32_32x32x16_bf16 v[96:111], v[116:119], v[68:71], v[96:111]
    ds_read_b64_tr_b16 v[116:117], v153 offset:49152
    ds_read_b64_tr_b16 v[118:119], v153 offset:51200
    s_cmp_lg_u32 s68, 2
    s_cbranch_scc1 K1_SP194
    s_add_u32 m0, s46, 40960
    s_add_u32 s49, s48, 0
    buffer_load_dwordx4 v164, s[20:23], s49 offen nt lds
K1_SP194:
    s_waitcnt lgkmcnt(9)
    v_mfma_f32_32x32x16_bf16 v[96:111], v[120:123], v[72:75], v[96:111]
    ds_read_b64_tr_b16 v[120:121], v154 offset:49152
    ds_read_b64_tr_b16 v[122:123], v154 offset:51200
    s_cmp_lg_u32 s68, 3
    s_cbranch_scc1 K1_SP195
    s_add_u32 m0, s46, 40960
    s_add_u32 s49, s48, 0
    buffer_load_dwordx4 v164, s[20:23], s49 offen nt lds
K1_SP195:
    s_waitcnt lgkmcnt(10)
    v_mfma_f32_32x32x16_bf16 v[96:111], v[124:127], v[76:79], v[96:111]
    ds_read_b64_tr_b16 v[124:125], v155 offset:49152
    ds_read_b64_tr_b16 v[126:127], v155 offset:51200
    s_cmp_lg_u32 s68, 0
    s_cbranch_scc1 K1_SP196
    s_add_u32 m0, s46, 45056
    s_add_u32 s49, s48, 4096
    buffer_load_dwordx4 v164, s[20:23], s49 offen nt lds
    s_add_u32 s48, s48, 8192
K1_SP196:
    s_waitcnt lgkmcnt(11)
    v_mfma_f32_32x32x16_bf16 v[96:111], v[128:131], v[80:83], v[96:111]
    ds_read_b64_tr_b16 v[128:129], v152 offset:53248
    ds_read_b64_tr_b16 v[130:131], v152 offset:55296
    s_cmp_lg_u32 s68, 1
    s_cbranch_scc1 K1_SP197
    s_add_u32 m0, s46, 45056
    s_add_u32 s49, s48, 4096
    buffer_load_dwordx4 v164, s[20:23], s49 offen nt lds
    s_add_u32 s48, s48, 8192
K1_SP197:
    s_waitcnt lgkmcnt(12)
    v_mfma_f32_32x32x16_bf16 v[96:111], v[132:135], v[84:87], v[96:111]
    ds_read_b64_tr_b16 v[132:133], v153 offset:53248
    ds_read_b64_tr_b16 v[134:135], v153 offset:55296
    s_cmp_lg_u32 s68, 2
    s_cbranch_scc1 K1_SP198
    s_add_u32 m0, s46, 45056
    s_add_u32 s49, s48, 4096
    buffer_load_dwordx4 v164, s[20:23], s49 offen nt lds
    s_add_u32 s48, s48, 8192
K1_SP198:
    s_waitcnt lgkmcnt(13)
    v_mfma_f32_32x32x16_bf16 v[96:111], v[136:139], v[88:91], v[96:111]
    ds_read_b64_tr_b16 v[136:137], v154 offset:53248
    ds_read_b64_tr_b16 v[138:139], v154 offset:55296
    s_cmp_lg_u32 s68, 3
    s_cbranch_scc1 K1_SP199
    s_add_u32 m0, s46, 45056
    s_add_u32 s49, s48, 4096
    buffer_load_dwordx4 v164, s[20:23], s49 offen nt lds
    s_add_u32 s48, s48, 8192
K1_SP199:
    s_waitcnt lgkmcnt(14)
    v_mfma_f32_32x32x16_bf16 v[96:111], v[140:143], v[92:95], v[96:111]
    ds_read_b64_tr_b16 v[140:141], v155 offset:53248
    ds_read_b64_tr_b16 v[142:143], v155 offset:55296
    s_nop 9
    v_max3_f32 v161, v96, v97, v98
    v_max3_f32 v162, v99, v100, v101
    v_max3_f32 v161, v161, v102, v103
    v_max3_f32 v162, v162, v104, v105
    v_max3_f32 v161, v161, v106, v107
    v_max3_f32 v162, v162, v108, v109
    v_max3_f32 v161, v161, v110, v111
    v_max_f32 v161, v161, v162
    v_cmp_gt_f32 vcc, v161, v157
    s_cbranch_vccnz K1_SLOWr1p2
K1_RETr1p2:
    v_fma_f32 v96, v96, s31, v158
    v_fma_f32 v97, v97, s31, v158
    v_fma_f32 v98, v98, s31, v158
    v_fma_f32 v99, v99, s31, v158
    v_fma_f32 v100, v100, s31, v158
    v_fma_f32 v101, v101, s31, v158
    v_fma_f32 v102, v102, s31, v158
    v_fma_f32 v103, v103, s31, v158
    v_fma_f32 v104, v104, s31, v158
    v_fma_f32 v105, v105, s31, v158
    v_fma_f32 v106, v106, s31, v158
    v_fma_f32 v107, v107, s31, v158
    v_fma_f32 v108, v108, s31, v158
    v_fma_f32 v109, v109, s31, v158
    v_fma_f32 v110, v110, s31, v158
    v_fma_f32 v111, v111, s31, v158
    v_exp_f32 v96, v96
    v_exp_f32 v97, v97
    v_exp_f32 v98, v98
    v_exp_f32 v99, v99
    v_exp_f32 v100, v100
    v_exp_f32 v101, v101
    v_exp_f32 v102, v102
    v_exp_f32 v103, v103
    v_exp_f32 v104, v104
    v_exp_f32 v105, v105
    v_exp_f32 v106, v106
    v_exp_f32 v107, v107
    v_exp_f32 v108, v108
    v_exp_f32 v109, v109
    v_exp_f32 v110, v110
    v_exp_f32 v111, v111
    v_add_f32 v159, v159, v96
    v_add_f32 v160, v160, v97
    v_cvt_pk_bf16_f32 v96, v96, v97
    v_add_f32 v159, v159, v98
    v_add_f32 v160, v160, v99
    v_cvt_pk_bf16_f32 v97, v98, v99
    v_add_f32 v159, v159, v100
    v_add_f32 v160, v160, v101
    v_cvt_pk_bf16_f32 v98, v100, v101
    v_add_f32 v159, v159, v102
    v_add_f32 v160, v160, v103
    v_cvt_pk_bf16_f32 v99, v102, v103
    v_add_f32 v159, v159, v104
    v_add_f32 v160, v160, v105
    v_cvt_pk_bf16_f32 v100, v104, v105
    v_add_f32 v159, v159, v106
    v_add_f32 v160, v160, v107
    v_cvt_pk_bf16_f32 v101, v106, v107
    v_add_f32 v159, v159, v108
    v_add_f32 v160, v160, v109
    v_cvt_pk_bf16_f32 v102, v108, v109
    v_add_f32 v159, v159, v110
    v_add_f32 v160, v160, v111
    v_cvt_pk_bf16_f32 v103, v110, v111
    s_waitcnt vmcnt(8) lgkmcnt(0)
    s_barrier
    s_cmp_lg_u32 s68, 0
    s_cbranch_scc1 K1_SP200
    s_add_u32 m0, s46, 16384
    s_add_u32 s49, s47, 0
    buffer_load_dwordx4 v163, s[16:19], s49 offen nt lds
K1_SP200:
    v_mfma_f32_32x32x16_bf16 v[0:15], v[112:115], v[96:99], v[0:15]
    ds_read_b128 v[112:115], v144 offset:24576
    s_cmp_lg_u32 s68, 1
    s_cbranch_scc1 K1_SP201
    s_add_u32 m0, s46, 16384
    s_add_u32 s49, s47, 0
    buffer_load_dwordx4 v163, s[16:19], s49 offen nt lds
K1_SP201:
    v_mfma_f32_32x32x16_bf16 v[16:31], v[116:119], v[96:99], v[16:31]
    ds_read_b128 v[116:119], v145 offset:24576
    s_cmp_lg_u32 s68, 2
    s_cbranch_scc1 K1_SP202
    s_add_u32 m0, s46, 16384
    s_add_u32 s49, s47, 0
    buffer_load_dwordx4 v163, s[16:19], s49 offen nt lds
K1_SP202:
    v_mfma_f32_32x32x16_bf16 v[32:47], v[120:123], v[96:99], v[32:47]
    ds_read_b128 v[120:123], v146 offset:24576
    s_cmp_lg_u32 s68, 3
    s_cbranch_scc1 K1_SP203
    s_add_u32 m0, s46, 16384
    s_add_u32 s49, s47, 0
    buffer_load_dwordx4 v163, s[16:19], s49 offen nt lds
K1_SP203:
    v_mfma_f32_32x32x16_bf16 v[48:63], v[124:127], v[96:99], v[48:63]
    ds_read_b128 v[124:127], v147 offset:24576
    s_cmp_lg_u32 s68, 0
    s_cbranch_scc1 K1_SP204
    s_add_u32 m0, s46, 20480
    s_add_u32 s49, s47, 4096
    buffer_load_dwordx4 v163, s[16:19], s49 offen nt lds
    s_add_u32 s47, s47, 8192
K1_SP204:
    v_mfma_f32_32x32x16_bf16 v[0:15], v[128:131], v[100:103], v[0:15]
    ds_read_b128 v[128:131], v148 offset:24576
    s_cmp_lg_u32 s68, 1
    s_cbranch_scc1 K1_SP205
    s_add_u32 m0, s46, 20480
    s_add_u32 s49, s47, 4096
    buffer_load_dwordx4 v163, s[16:19], s49 offen nt lds
    s_add_u32 s47, s47, 8192
K1_SP205:
    v_mfma_f32_32x32x16_bf16 v[16:31], v[132:135], v[100:103], v[16:31]
    ds_read_b128 v[132:135], v149 offset:24576
    s_cmp_lg_u32 s68, 2
    s_cbranch_scc1 K1_SP206
    s_add_u32 m0, s46, 20480
    s_add_u32 s49, s47, 4096
    buffer_load_dwordx4 v163, s[16:19], s49 offen nt lds
    s_add_u32 s47, s47, 8192
K1_SP206:
    v_mfma_f32_32x32x16_bf16 v[32:47], v[136:139], v[100:103], v[32:47]
    ds_read_b128 v[136:139], v150 offset:24576
    s_cmp_lg_u32 s68, 3
    s_cbranch_scc1 K1_SP207
    s_add_u32 m0, s46, 20480
    s_add_u32 s49, s47, 4096
    buffer_load_dwordx4 v163, s[16:19], s49 offen nt lds
    s_add_u32 s47, s47, 8192
K1_SP207:
    v_mfma_f32_32x32x16_bf16 v[48:63], v[140:143], v[100:103], v[48:63]
    ds_read_b128 v[140:143], v151 offset:24576
    s_cmp_lg_u32 s68, 0
    s_cbranch_scc1 K1_SP208
    s_add_u32 m0, s46, 49152
    s_add_u32 s49, s48, 0
    buffer_load_dwordx4 v164, s[20:23], s49 offen nt lds
K1_SP208:
    s_waitcnt lgkmcnt(7)
    v_mfma_f32_32x32x16_bf16 v[96:111], v[112:115], v[64:67], 0
    ds_read_b64_tr_b16 v[112:113], v152 offset:57344
    ds_read_b64_tr_b16 v[114:115], v152 offset:59392
    s_cmp_lg_u32 s68, 1
    s_cbranch_scc1 K1_SP209
    s_add_u32 m0, s46, 49152
    s_add_u32 s49, s48, 0
    buffer_load_dwordx4 v164, s[20:23], s49 offen nt lds
K1_SP209:
    s_waitcnt lgkmcnt(8)
    v_mfma_f32_32x32x16_bf16 v[96:111], v[116:119], v[68:71], v[96:111]
    ds_read_b64_tr_b16 v[116:117], v153 offset:57344
    ds_read_b64_tr_b16 v[118:119], v153 offset:59392
    s_cmp_lg_u32 s68, 2
    s_cbranch_scc1 K1_SP210
    s_add_u32 m0, s46, 49152
    s_add_u32 s49, s48, 0
    buffer_load_dwordx4 v164, s[20:23], s49 offen nt lds
K1_SP210:
    s_waitcnt lgkmcnt(9)
    v_mfma_f32_32x32x16_bf16 v[96:111], v[120:123], v[72:75], v[96:111]
    ds_read_b64_tr_b16 v[120:121], v154 offset:57344
    ds_read_b64_tr_b16 v[122:123], v154 offset:59392
    s_cmp_lg_u32 s68, 3
    s_cbranch_scc1 K1_SP211
    s_add_u32 m0, s46, 49152
    s_add_u32 s49, s48, 0
    buffer_load_dwordx4 v164, s[20:23], s49 offen nt lds
K1_SP211:
    s_waitcnt lgkmcnt(10)
    v_mfma_f32_32x32x16_bf16 v[96:111], v[124:127], v[76:79], v[96:111]
    ds_read_b64_tr_b16 v[124:125], v155 offset:57344
    ds_read_b64_tr_b16 v[126:127], v155 offset:59392
    s_cmp_lg_u32 s68, 0
    s_cbranch_scc1 K1_SP212
    s_add_u32 m0, s46, 53248
    s_add_u32 s49, s48, 4096
    buffer_load_dwordx4 v164, s[20:23], s49 offen nt lds
    s_add_u32 s48, s48, 8192
K1_SP212:
    s_waitcnt lgkmcnt(11)
    v_mfma_f32_32x32x16_bf16 v[96:111], v[128:131], v[80:83], v[96:111]
    ds_read_b64_tr_b16 v[128:129], v152 offset:61440
    ds_read_b64_tr_b16 v[130:131], v152 offset:63488
    s_cmp_lg_u32 s68, 1
    s_cbranch_scc1 K1_SP213
    s_add_u32 m0, s46, 53248
    s_add_u32 s49, s48, 4096
    buffer_load_dwordx4 v164, s[20:23], s49 offen nt lds
    s_add_u32 s48, s48, 8192
K1_SP213:
    s_waitcnt lgkmcnt(12)
    v_mfma_f32_32x32x16_bf16 v[96:111], v[132:135], v[84:87], v[96:111]
    ds_read_b64_tr_b16 v[132:133], v153 offset:61440
    ds_read_b64_tr_b16 v[134:135], v153 offset:63488
    s_cmp_lg_u32 s68, 2
    s_cbranch_scc1 K1_SP214
    s_add_u32 m0, s46, 53248
    s_add_u32 s49, s48, 4096
    buffer_load_dwordx4 v164, s[20:23], s49 offen nt lds
    s_add_u32 s48, s48, 8192
K1_SP214:
    s_waitcnt lgkmcnt(13)
    v_mfma_f32_32x32x16_bf16 v[96:111], v[136:139], v[88:91], v[96:111]
    ds_read_b64_tr_b16 v[136:137], v154 offset:61440
    ds_read_b64_tr_b16 v[138:139], v154 offset:63488
    s_cmp_lg_u32 s68, 3
    s_cbranch_scc1 K1_SP215
    s_add_u32 m0, s46, 53248
    s_add_u32 s49, s48, 4096
    buffer_load_dwordx4 v164, s[20:23], s49 offen nt lds
    s_add_u32 s48, s48, 8192
K1_SP215:
    s_waitcnt lgkmcnt(14)
    v_mfma_f32_32x32x16_bf16 v[96:111], v[140:143], v[92:95], v[96:111]
    ds_read_b64_tr_b16 v[140:141], v155 offset:61440
    ds_read_b64_tr_b16 v[142:143], v155 offset:63488
    s_nop 9
    v_max3_f32 v161, v96, v97, v98
    v_max3_f32 v162, v99, v100, v101
    v_max3_f32 v161, v161, v102, v103
    v_max3_f32 v162, v162, v104, v105
    v_max3_f32 v161, v161, v106, v107
    v_max3_f32 v162, v162, v108, v109
    v_max3_f32 v161, v161, v110, v111
    v_max_f32 v161, v161, v162
    v_cmp_gt_f32 vcc, v161, v157
    s_cbranch_vccnz K1_SLOWr1p3
K1_RETr1p3:
    v_fma_f32 v96, v96, s31, v158
    v_fma_f32 v97, v97, s31, v158
    v_fma_f32 v98, v98, s31, v158
    v_fma_f32 v99, v99, s31, v158
    v_fma_f32 v100, v100, s31, v158
    v_fma_f32 v101, v101, s31, v158
    v_fma_f32 v102, v102, s31, v158
    v_fma_f32 v103, v103, s31, v158
    v_fma_f32 v104, v104, s31, v158
    v_fma_f32 v105, v105, s31, v158
    v_fma_f32 v106, v106, s31, v158
    v_fma_f32 v107, v107, s31, v158
    v_fma_f32 v108, v108, s31, v158
    v_fma_f32 v109, v109, s31, v158
    v_fma_f32 v110, v110, s31, v158
    v_fma_f32 v111, v111, s31, v158
    v_exp_f32 v96, v96
    v_exp_f32 v97, v97
    v_exp_f32 v98, v98
    v_exp_f32 v99, v99
    v_exp_f32 v100, v100
    v_exp_f32 v101, v101
    v_exp_f32 v102, v102
    v_exp_f32 v103, v103
    v_exp_f32 v104, v104
    v_exp_f32 v105, v105
    v_exp_f32 v106, v106
    v_exp_f32 v107, v107
    v_exp_f32 v108, v108
    v_exp_f32 v109, v109
    v_exp_f32 v110, v110
    v_exp_f32 v111, v111
    v_add_f32 v159, v159, v96
    v_add_f32 v160, v160, v97
    v_cvt_pk_bf16_f32 v96, v96, v97
    v_add_f32 v159, v159, v98
    v_add_f32 v160, v160, v99
    v_cvt_pk_bf16_f32 v97, v98, v99
    v_add_f32 v159, v159, v100
    v_add_f32 v160, v160, v101
    v_cvt_pk_bf16_f32 v98, v100, v101
    v_add_f32 v159, v159, v102
    v_add_f32 v160, v160, v103
    v_cvt_pk_bf16_f32 v99, v102, v103
    v_add_f32 v159, v159, v104
    v_add_f32 v160, v160, v105
    v_cvt_pk_bf16_f32 v100, v104, v105
    v_add_f32 v159, v159, v106
    v_add_f32 v160, v160, v107
    v_cvt_pk_bf16_f32 v101, v106, v107
    v_add_f32 v159, v159, v108
    v_add_f32 v160, v160, v109
    v_cvt_pk_bf16_f32 v102, v108, v109
    v_add_f32 v159, v159, v110
    v_add_f32 v160, v160, v111
    v_cvt_pk_bf16_f32 v103, v110, v111
    s_waitcnt vmcnt(8) lgkmcnt(0)
    s_mov_b32 s50, 0
K1_LOOPr1:
    s_barrier
    s_cmp_lg_u32 s68, 0
    s_cbranch_scc1 K1_SP216
    s_add_u32 m0, s46, 24576
    s_add_u32 s49, s47, 0
    buffer_load_dwordx4 v163, s[16:19], s49 offen nt lds
K1_SP216:
    v_mfma_f32_32x32x16_bf16 v[0:15], v[112:115], v[96:99], v[0:15]
    ds_read_b128 v[112:115], v144 offset:0
    s_cmp_lg_u32 s68, 1
    s_cbranch_scc1 K1_SP217
    s_add_u32 m0, s46, 24576
    s_add_u32 s49, s47, 0
    buffer_load_dwordx4 v163, s[16:19], s49 offen nt lds
K1_SP217:
    v_mfma_f32_32x32x16_bf16 v[16:31], v[116:119], v[96:99], v[16:31]
    ds_read_b128 v[116:119], v145 offset:0
    s_cmp_lg_u32 s68, 2
    s_cbranch_scc1 K1_SP218
    s_add_u32 m0, s46, 24576
    s_add_u32 s49, s47, 0
    buffer_load_dwordx4 v163, s[16:19], s49 offen nt lds
K1_SP218:
    v_mfma_f32_32x32x16_bf16 v[32:47], v[120:123], v[96:99], v[32:47]
    ds_read_b128 v[120:123], v146 offset:0
    s_cmp_lg_u32 s68, 3
    s_cbranch_scc1 K1_SP219
    s_add_u32 m0, s46, 24576
    s_add_u32 s49, s47, 0
    buffer_load_dwordx4 v163, s[16:19], s49 offen nt lds
K1_SP219:
    v_mfma_f32_32x32x16_bf16 v[48:63], v[124:127], v[96:99], v[48:63]
    ds_read_b128 v[124:127], v147 offset:0
    s_cmp_lg_u32 s68, 0
    s_cbranch_scc1 K1_SP220
    s_add_u32 m0, s46, 28672
    s_add_u32 s49, s47, 4096
    buffer_load_dwordx4 v163, s[16:19], s49 offen nt lds
    s_add_u32 s47, s47, 8192
K1_SP220:
    v_mfma_f32_32x32x16_bf16 v[0:15], v[128:131], v[100:103], v[0:15]
    ds_read_b128 v[128:131], v148 offset:0
    s_cmp_lg_u32 s68, 1
    s_cbranch_scc1 K1_SP221
    s_add_u32 m0, s46, 28672
    s_add_u32 s49, s47, 4096
    buffer_load_dwordx4 v163, s[16:19], s49 offen nt lds
    s_add_u32 s47, s47, 8192
K1_SP221:
    v_mfma_f32_32x32x16_bf16 v[16:31], v[132:135], v[100:103], v[16:31]
    ds_read_b128 v[132:135], v149 offset:0
    s_cmp_lg_u32 s68, 2
    s_cbranch_scc1 K1_SP222
    s_add_u32 m0, s46, 28672
    s_add_u32 s49, s47, 4096
    buffer_load_dwordx4 v163, s[16:19], s49 offen nt lds
    s_add_u32 s47, s47, 8192
K1_SP222:
    v_mfma_f32_32x32x16_bf16 v[32:47], v[136:139], v[100:103], v[32:47]
    ds_read_b128 v[136:139], v150 offset:0
    s_cmp_lg_u32 s68, 3
    s_cbranch_scc1 K1_SP223
    s_add_u32 m0, s46, 28672
    s_add_u32 s49, s47, 4096
    buffer_load_dwordx4 v163, s[16:19], s49 offen nt lds
    s_add_u32 s47, s47, 8192
K1_SP223:
    v_mfma_f32_32x32x16_bf16 v[48:63], v[140:143], v[100:103], v[48:63]
    ds_read_b128 v[140:143], v151 offset:0
    s_cmp_lg_u32 s68, 0
    s_cbranch_scc1 K1_SP224
    s_add_u32 m0, s46, 57344
    s_add_u32 s49, s48, 0
    buffer_load_dwordx4 v164, s[20:23], s49 offen nt lds
K1_SP224:
    s_waitcnt lgkmcnt(7)
    v_mfma_f32_32x32x16_bf16 v[96:111], v[112:115], v[64:67], 0
    ds_read_b64_tr_b16 v[112:113], v152 offset:32768
    ds_read_b64_tr_b16 v[114:115], v152 offset:34816
    s_cmp_lg_u32 s68, 1
    s_cbranch_scc1 K1_SP225
    s_add_u32 m0, s46, 57344
    s_add_u32 s49, s48, 0
    buffer_load_dwordx4 v164, s[20:23], s49 offen nt lds
K1_SP225:
    s_waitcnt lgkmcnt(8)
    v_mfma_f32_32x32x16_bf16 v[96:111], v[116:119], v[68:71], v[96:111]
    ds_read_b64_tr_b16 v[116:117], v153 offset:32768
    ds_read_b64_tr_b16 v[118:119], v153 offset:34816
    s_cmp_lg_u32 s68, 2
    s_cbranch_scc1 K1_SP226
    s_add_u32 m0, s46, 57344
    s_add_u32 s49, s48, 0
    buffer_load_dwordx4 v164, s[20:23], s49 offen nt lds
K1_SP226:
    s_waitcnt lgkmcnt(9)
    v_mfma_f32_32x32x16_bf16 v[96:111], v[120:123], v[72:75], v[96:111]
    ds_read_b64_tr_b16 v[120:121], v154 offset:32768
    ds_read_b64_tr_b16 v[122:123], v154 offset:34816
    s_cmp_lg_u32 s68, 3
    s_cbranch_scc1 K1_SP227
    s_add_u32 m0, s46, 57344
    s_add_u32 s49, s48, 0
    buffer_load_dwordx4 v164, s[20:23], s49 offen nt lds
K1_SP227:
    s_waitcnt lgkmcnt(10)
    v_mfma_f32_32x32x16_bf16 v[96:111], v[124:127], v[76:79], v[96:111]
    ds_read_b64_tr_b16 v[124:125], v155 offset:32768
    ds_read_b64_tr_b16 v[126:127], v155 offset:34816
    s_cmp_lg_u32 s68, 0
    s_cbranch_scc1 K1_SP228
    s_add_u32 m0, s46, 61440
    s_add_u32 s49, s48, 4096
    buffer_load_dwordx4 v164, s[20:23], s49 offen nt lds
    s_add_u32 s48, s48, 8192
K1_SP228:
    s_waitcnt lgkmcnt(11)
    v_mfma_f32_32x32x16_bf16 v[96:111], v[128:131], v[80:83], v[96:111]
    ds_read_b64_tr_b16 v[128:129], v152 offset:36864
    ds_read_b64_tr_b16 v[130:131], v152 offset:38912
    s_cmp_lg_u32 s68, 1
    s_cbranch_scc1 K1_SP229
    s_add_u32 m0, s46, 61440
    s_add_u32 s49, s48, 4096
    buffer_load_dwordx4 v164, s[20:23], s49 offen nt lds
    s_add_u32 s48, s48, 8192
K1_SP229:
    s_waitcnt lgkmcnt(12)
    v_mfma_f32_32x32x16_bf16 v[96:111], v[132:135], v[84:87], v[96:111]
    ds_read_b64_tr_b16 v[132:133], v153 offset:36864
    ds_read_b64_tr_b16 v[134:135], v153 offset:38912
    s_cmp_lg_u32 s68, 2
    s_cbranch_scc1 K1_SP230
    s_add_u32 m0, s46, 61440
    s_add_u32 s49, s48, 4096
    buffer_load_dwordx4 v164, s[20:23], s49 offen nt lds
    s_add_u32 s48, s48, 8192
K1_SP230:
    s_waitcnt lgkmcnt(13)
    v_mfma_f32_32x32x16_bf16 v[96:111], v[136:139], v[88:91], v[96:111]
    ds_read_b64_tr_b16 v[136:137], v154 offset:36864
    ds_read_b64_tr_b16 v[138:139], v154 offset:38912
    s_cmp_lg_u32 s68, 3
    s_cbranch_scc1 K1_SP231
    s_add_u32 m0, s46, 61440
    s_add_u32 s49, s48, 4096
    buffer_load_dwordx4 v164, s[20:23], s49 offen nt lds
    s_add_u32 s48, s48, 8192
K1_SP231:
    s_waitcnt lgkmcnt(14)
    v_mfma_f32_32x32x16_bf16 v[96:111], v[140:143], v[92:95], v[96:111]
    ds_read_b64_tr_b16 v[140:141], v155 offset:36864
    ds_read_b64_tr_b16 v[142:143], v155 offset:38912
    s_nop 9
    v_max3_f32 v161, v96, v97, v98
    v_max3_f32 v162, v99, v100, v101
    v_max3_f32 v161, v161, v102, v103
    v_max3_f32 v162, v162, v104, v105
    v_max3_f32 v161, v161, v106, v107
    v_max3_f32 v162, v162, v108, v109
    v_max3_f32 v161, v161, v110, v111
    v_max_f32 v161, v161, v162
    v_cmp_gt_f32 vcc, v161, v157
    s_cbranch_vccnz K1_SLOWr1a0
K1_RETr1a0:
    v_fma_f32 v96, v96, s31, v158
    v_fma_f32 v97, v97, s31, v158
    v_fma_f32 v98, v98, s31, v158
    v_fma_f32 v99, v99, s31, v158
    v_fma_f32 v100, v100, s31, v158
    v_fma_f32 v101, v101, s31, v158
    v_fma_f32 v102, v102, s31, v158
    v_fma_f32 v103, v103, s31, v158
    v_fma_f32 v104, v104, s31, v158
    v_fma_f32 v105, v105, s31, v158
    v_fma_f32 v106, v106, s31, v158
    v_fma_f32 v107, v107, s31, v158
    v_fma_f32 v108, v108, s31, v158
    v_fma_f32 v109, v109, s31, v158
    v_fma_f32 v110, v110, s31, v158
    v_fma_f32 v111, v111, s31, v158
    v_exp_f32 v96, v96
    v_exp_f32 v97, v97
    v_exp_f32 v98, v98
    v_exp_f32 v99, v99
    v_exp_f32 v100, v100
    v_exp_f32 v101, v101
    v_exp_f32 v102, v102
    v_exp_f32 v103, v103
    v_exp_f32 v104, v104
    v_exp_f32 v105, v105
    v_exp_f32 v106, v106
    v_exp_f32 v107, v107
    v_exp_f32 v108, v108
    v_exp_f32 v109, v109
    v_exp_f32 v110, v110
    v_exp_f32 v111, v111
    v_add_f32 v159, v159, v96
    v_add_f32 v160, v160, v97
    v_cvt_pk_bf16_f32 v96, v96, v97
    v_add_f32 v159, v159, v98
    v_add_f32 v160, v160, v99
    v_cvt_pk_bf16_f32 v97, v98, v99
    v_add_f32 v159, v159, v100
    v_add_f32 v160, v160, v101
    v_cvt_pk_bf16_f32 v98, v100, v101
    v_add_f32 v159, v159, v102
    v_add_f32 v160, v160, v103
    v_cvt_pk_bf16_f32 v99, v102, v103
    v_add_f32 v159, v159, v104
    v_add_f32 v160, v160, v105
    v_cvt_pk_bf16_f32 v100, v104, v105
    v_add_f32 v159, v159, v106
    v_add_f32 v160, v160, v107
    v_cvt_pk_bf16_f32 v101, v106, v107
    v_add_f32 v159, v159, v108
    v_add_f32 v160, v160, v109
    v_cvt_pk_bf16_f32 v102, v108, v109
    v_add_f32 v159, v159, v110
    v_add_f32 v160, v160, v111
    v_cvt_pk_bf16_f32 v103, v110, v111
    s_waitcnt vmcnt(8) lgkmcnt(0)
    s_barrier
    s_cmp_lg_u32 s68, 0
    s_cbranch_scc1 K1_SP232
    s_add_u32 m0, s46, 0
    s_add_u32 s49, s47, 0
    buffer_load_dwordx4 v163, s[16:19], s49 offen nt lds
K1_SP232:
    v_mfma_f32_32x32x16_bf16 v[0:15], v[112:115], v[96:99], v[0:15]
    ds_read_b128 v[112:115], v144 offset:8192
    s_cmp_lg_u32 s68, 1
    s_cbranch_scc1 K1_SP233
    s_add_u32 m0, s46, 0
    s_add_u32 s49, s47, 0
    buffer_load_dwordx4 v163, s[16:19], s49 offen nt lds
K1_SP233:
    v_mfma_f32_32x32x16_bf16 v[16:31], v[116:119], v[96:99], v[16:31]
    ds_read_b128 v[116:119], v145 offset:8192
    s_cmp_lg_u32 s68, 2
    s_cbranch_scc1 K1_SP234
    s_add_u32 m0, s46, 0
    s_add_u32 s49, s47, 0
    buffer_load_dwordx4 v163, s[16:19], s49 offen nt lds
K1_SP234:
    v_mfma_f32_32x32x16_bf16 v[32:47], v[120:123], v[96:99], v[32:47]
    ds_read_b128 v[120:123], v146 offset:8192
    s_cmp_lg_u32 s68, 3
    s_cbranch_scc1 K1_SP235
    s_add_u32 m0, s46, 0
    s_add_u32 s49, s47, 0
    buffer_load_dwordx4 v163, s[16:19], s49 offen nt lds
K1_SP235:
    v_mfma_f32_32x32x16_bf16 v[48:63], v[124:127], v[96:99], v[48:63]
    ds_read_b128 v[124:127], v147 offset:8192
    s_cmp_lg_u32 s68, 0
    s_cbranch_scc1 K1_SP236
    s_add_u32 m0, s46, 4096
    s_add_u32 s49, s47, 4096
    buffer_load_dwordx4 v163, s[16:19], s49 offen nt lds
    s_add_u32 s47, s47, 8192
K1_SP236:
    v_mfma_f32_32x32x16_bf16 v[0:15], v[128:131], v[100:103], v[0:15]
    ds_read_b128 v[128:131], v148 offset:8192
    s_cmp_lg_u32 s68, 1
    s_cbranch_scc1 K1_SP237
    s_add_u32 m0, s46, 4096
    s_add_u32 s49, s47, 4096
    buffer_load_dwordx4 v163, s[16:19], s49 offen nt lds
    s_add_u32 s47, s47, 8192
K1_SP237:
    v_mfma_f32_32x32x16_bf16 v[16:31], v[132:135], v[100:103], v[16:31]
    ds_read_b128 v[132:135], v149 offset:8192
    s_cmp_lg_u32 s68, 2
    s_cbranch_scc1 K1_SP238
    s_add_u32 m0, s46, 4096
    s_add_u32 s49, s47, 4096
    buffer_load_dwordx4 v163, s[16:19], s49 offen nt lds
    s_add_u32 s47, s47, 8192
K1_SP238:
    v_mfma_f32_32x32x16_bf16 v[32:47], v[136:139], v[100:103], v[32:47]
    ds_read_b128 v[136:139], v150 offset:8192
    s_cmp_lg_u32 s68, 3
    s_cbranch_scc1 K1_SP239
    s_add_u32 m0, s46, 4096
    s_add_u32 s49, s47, 4096
    buffer_load_dwordx4 v163, s[16:19], s49 offen nt lds
    s_add_u32 s47, s47, 8192
K1_SP239:
    v_mfma_f32_32x32x16_bf16 v[48:63], v[140:143], v[100:103], v[48:63]
    ds_read_b128 v[140:143], v151 offset:8192
    s_cmp_lg_u32 s68, 0
    s_cbranch_scc1 K1_SP240
    s_add_u32 m0, s46, 32768
    s_add_u32 s49, s48, 0
    buffer_load_dwordx4 v164, s[20:23], s49 offen nt lds
K1_SP240:
    s_waitcnt lgkmcnt(7)
    v_mfma_f32_32x32x16_bf16 v[96:111], v[112:115], v[64:67], 0
    ds_read_b64_tr_b16 v[112:113], v152 offset:40960
    ds_read_b64_tr_b16 v[114:115], v152 offset:43008
    s_cmp_lg_u32 s68, 1
    s_cbranch_scc1 K1_SP241
    s_add_u32 m0, s46, 32768
    s_add_u32 s49, s48, 0
    buffer_load_dwordx4 v164, s[20:23], s49 offen nt lds
K1_SP241:
    s_waitcnt lgkmcnt(8)
    v_mfma_f32_32x32x16_bf16 v[96:111], v[116:119], v[68:71], v[96:111]
    ds_read_b64_tr_b16 v[116:117], v153 offset:40960
    ds_read_b64_tr_b16 v[118:119], v153 offset:43008
    s_cmp_lg_u32 s68, 2
    s_cbranch_scc1 K1_SP242
    s_add_u32 m0, s46, 32768
    s_add_u32 s49, s48, 0
    buffer_load_dwordx4 v164, s[20:23], s49 offen nt lds
K1_SP242:
    s_waitcnt lgkmcnt(9)
    v_mfma_f32_32x32x16_bf16 v[96:111], v[120:123], v[72:75], v[96:111]
    ds_read_b64_tr_b16 v[120:121], v154 offset:40960
    ds_read_b64_tr_b16 v[122:123], v154 offset:43008
    s_cmp_lg_u32 s68, 3
    s_cbranch_scc1 K1_SP243
    s_add_u32 m0, s46, 32768
    s_add_u32 s49, s48, 0
    buffer_load_dwordx4 v164, s[20:23], s49 offen nt lds
K1_SP243:
    s_waitcnt lgkmcnt(10)
    v_mfma_f32_32x32x16_bf16 v[96:111], v[124:127], v[76:79], v[96:111]
    ds_read_b64_tr_b16 v[124:125], v155 offset:40960
    ds_read_b64_tr_b16 v[126:127], v155 offset:43008
    s_cmp_lg_u32 s68, 0
    s_cbranch_scc1 K1_SP244
    s_add_u32 m0, s46, 36864
    s_add_u32 s49, s48, 4096
    buffer_load_dwordx4 v164, s[20:23], s49 offen nt lds
    s_add_u32 s48, s48, 8192
K1_SP244:
    s_waitcnt lgkmcnt(11)
    v_mfma_f32_32x32x16_bf16 v[96:111], v[128:131], v[80:83], v[96:111]
    ds_read_b64_tr_b16 v[128:129], v152 offset:45056
    ds_read_b64_tr_b16 v[130:131], v152 offset:47104
    s_cmp_lg_u32 s68, 1
    s_cbranch_scc1 K1_SP245
    s_add_u32 m0, s46, 36864
    s_add_u32 s49, s48, 4096
    buffer_load_dwordx4 v164, s[20:23], s49 offen nt lds
    s_add_u32 s48, s48, 8192
K1_SP245:
    s_waitcnt lgkmcnt(12)
    v_mfma_f32_32x32x16_bf16 v[96:111], v[132:135], v[84:87], v[96:111]
    ds_read_b64_tr_b16 v[132:133], v153 offset:45056
    ds_read_b64_tr_b16 v[134:135], v153 offset:47104
    s_cmp_lg_u32 s68, 2
    s_cbranch_scc1 K1_SP246
    s_add_u32 m0, s46, 36864
    s_add_u32 s49, s48, 4096
    buffer_load_dwordx4 v164, s[20:23], s49 offen nt lds
    s_add_u32 s48, s48, 8192
K1_SP246:
    s_waitcnt lgkmcnt(13)
    v_mfma_f32_32x32x16_bf16 v[96:111], v[136:139], v[88:91], v[96:111]
    ds_read_b64_tr_b16 v[136:137], v154 offset:45056
    ds_read_b64_tr_b16 v[138:139], v154 offset:47104
    s_cmp_lg_u32 s68, 3
    s_cbranch_scc1 K1_SP247
    s_add_u32 m0, s46, 36864
    s_add_u32 s49, s48, 4096
    buffer_load_dwordx4 v164, s[20:23], s49 offen nt lds
    s_add_u32 s48, s48, 8192
K1_SP247:
    s_waitcnt lgkmcnt(14)
    v_mfma_f32_32x32x16_bf16 v[96:111], v[140:143], v[92:95], v[96:111]
    ds_read_b64_tr_b16 v[140:141], v155 offset:45056
    ds_read_b64_tr_b16 v[142:143], v155 offset:47104
    s_nop 9
    v_max3_f32 v161, v96, v97, v98
    v_max3_f32 v162, v99, v100, v101
    v_max3_f32 v161, v161, v102, v103
    v_max3_f32 v162, v162, v104, v105
    v_max3_f32 v161, v161, v106, v107
    v_max3_f32 v162, v162, v108, v109
    v_max3_f32 v161, v161, v110, v111
    v_max_f32 v161, v161, v162
    v_cmp_gt_f32 vcc, v161, v157
    s_cbranch_vccnz K1_SLOWr1a1
K1_RETr1a1:
    v_fma_f32 v96, v96, s31, v158
    v_fma_f32 v97, v97, s31, v158
    v_fma_f32 v98, v98, s31, v158
    v_fma_f32 v99, v99, s31, v158
    v_fma_f32 v100, v100, s31, v158
    v_fma_f32 v101, v101, s31, v158
    v_fma_f32 v102, v102, s31, v158
    v_fma_f32 v103, v103, s31, v158
    v_fma_f32 v104, v104, s31, v158
    v_fma_f32 v105, v105, s31, v158
    v_fma_f32 v106, v106, s31, v158
    v_fma_f32 v107, v107, s31, v158
    v_fma_f32 v108, v108, s31, v158
    v_fma_f32 v109, v109, s31, v158
    v_fma_f32 v110, v110, s31, v158
    v_fma_f32 v111, v111, s31, v158
    v_exp_f32 v96, v96
    v_exp_f32 v97, v97
    v_exp_f32 v98, v98
    v_exp_f32 v99, v99
    v_exp_f32 v100, v100
    v_exp_f32 v101, v101
    v_exp_f32 v102, v102
    v_exp_f32 v103, v103
    v_exp_f32 v104, v104
    v_exp_f32 v105, v105
    v_exp_f32 v106, v106
    v_exp_f32 v107, v107
    v_exp_f32 v108, v108
    v_exp_f32 v109, v109
    v_exp_f32 v110, v110
    v_exp_f32 v111, v111
    v_add_f32 v159, v159, v96
    v_add_f32 v160, v160, v97
    v_cvt_pk_bf16_f32 v96, v96, v97
    v_add_f32 v159, v159, v98
    v_add_f32 v160, v160, v99
    v_cvt_pk_bf16_f32 v97, v98, v99
    v_add_f32 v159, v159, v100
    v_add_f32 v160, v160, v101
    v_cvt_pk_bf16_f32 v98, v100, v101
    v_add_f32 v159, v159, v102
    v_add_f32 v160, v160, v103
    v_cvt_pk_bf16_f32 v99, v102, v103
    v_add_f32 v159, v159, v104
    v_add_f32 v160, v160, v105
    v_cvt_pk_bf16_f32 v100, v104, v105
    v_add_f32 v159, v159, v106
    v_add_f32 v160, v160, v107
    v_cvt_pk_bf16_f32 v101, v106, v107
    v_add_f32 v159, v159, v108
    v_add_f32 v160, v160, v109
    v_cvt_pk_bf16_f32 v102, v108, v109
    v_add_f32 v159, v159, v110
    v_add_f32 v160, v160, v111
    v_cvt_pk_bf16_f32 v103, v110, v111
    s_waitcnt vmcnt(8) lgkmcnt(0)
    s_barrier
    s_cmp_lg_u32 s68, 0
    s_cbranch_scc1 K1_SP248
    s_add_u32 m0, s46, 8192
    s_add_u32 s49, s47, 0
    buffer_load_dwordx4 v163, s[16:19], s49 offen nt lds
K1_SP248:
    v_mfma_f32_32x32x16_bf16 v[0:15], v[112:115], v[96:99], v[0:15]
    ds_read_b128 v[112:115], v144 offset:16384
    s_cmp_lg_u32 s68, 1
    s_cbranch_scc1 K1_SP249
    s_add_u32 m0, s46, 8192
    s_add_u32 s49, s47, 0
    buffer_load_dwordx4 v163, s[16:19], s49 offen nt lds
K1_SP249:
    v_mfma_f32_32x32x16_bf16 v[16:31], v[116:119], v[96:99], v[16:31]
    ds_read_b128 v[116:119], v145 offset:16384
    s_cmp_lg_u32 s68, 2
    s_cbranch_scc1 K1_SP250
    s_add_u32 m0, s46, 8192
    s_add_u32 s49, s47, 0
    buffer_load_dwordx4 v163, s[16:19], s49 offen nt lds
K1_SP250:
    v_mfma_f32_32x32x16_bf16 v[32:47], v[120:123], v[96:99], v[32:47]
    ds_read_b128 v[120:123], v146 offset:16384
    s_cmp_lg_u32 s68, 3
    s_cbranch_scc1 K1_SP251
    s_add_u32 m0, s46, 8192
    s_add_u32 s49, s47, 0
    buffer_load_dwordx4 v163, s[16:19], s49 offen nt lds
K1_SP251:
    v_mfma_f32_32x32x16_bf16 v[48:63], v[124:127], v[96:99], v[48:63]
    ds_read_b128 v[124:127], v147 offset:16384
    s_cmp_lg_u32 s68, 0
    s_cbranch_scc1 K1_SP252
    s_add_u32 m0, s46, 12288
    s_add_u32 s49, s47, 4096
    buffer_load_dwordx4 v163, s[16:19], s49 offen nt lds
    s_add_u32 s47, s47, 8192
K1_SP252:
    v_mfma_f32_32x32x16_bf16 v[0:15], v[128:131], v[100:103], v[0:15]
    ds_read_b128 v[128:131], v148 offset:16384
    s_cmp_lg_u32 s68, 1
    s_cbranch_scc1 K1_SP253
    s_add_u32 m0, s46, 12288
    s_add_u32 s49, s47, 4096
    buffer_load_dwordx4 v163, s[16:19], s49 offen nt lds
    s_add_u32 s47, s47, 8192
K1_SP253:
    v_mfma_f32_32x32x16_bf16 v[16:31], v[132:135], v[100:103], v[16:31]
    ds_read_b128 v[132:135], v149 offset:16384
    s_cmp_lg_u32 s68, 2
    s_cbranch_scc1 K1_SP254
    s_add_u32 m0, s46, 12288
    s_add_u32 s49, s47, 4096
    buffer_load_dwordx4 v163, s[16:19], s49 offen nt lds
    s_add_u32 s47, s47, 8192
K1_SP254:
    v_mfma_f32_32x32x16_bf16 v[32:47], v[136:139], v[100:103], v[32:47]
    ds_read_b128 v[136:139], v150 offset:16384
    s_cmp_lg_u32 s68, 3
    s_cbranch_scc1 K1_SP255
    s_add_u32 m0, s46, 12288
    s_add_u32 s49, s47, 4096
    buffer_load_dwordx4 v163, s[16:19], s49 offen nt lds
    s_add_u32 s47, s47, 8192
K1_SP255:
    v_mfma_f32_32x32x16_bf16 v[48:63], v[140:143], v[100:103], v[48:63]
    ds_read_b128 v[140:143], v151 offset:16384
    s_cmp_lg_u32 s68, 0
    s_cbranch_scc1 K1_SP256
    s_add_u32 m0, s46, 40960
    s_add_u32 s49, s48, 0
    buffer_load_dwordx4 v164, s[20:23], s49 offen nt lds
K1_SP256:
    s_waitcnt lgkmcnt(7)
    v_mfma_f32_32x32x16_bf16 v[96:111], v[112:115], v[64:67], 0
    ds_read_b64_tr_b16 v[112:113], v152 offset:49152
    ds_read_b64_tr_b16 v[114:115], v152 offset:51200
    s_cmp_lg_u32 s68, 1
    s_cbranch_scc1 K1_SP257
    s_add_u32 m0, s46, 40960
    s_add_u32 s49, s48, 0
    buffer_load_dwordx4 v164, s[20:23], s49 offen nt lds
K1_SP257:
    s_waitcnt lgkmcnt(8)
    v_mfma_f32_32x32x16_bf16 v[96:111], v[116:119], v[68:71], v[96:111]
    ds_read_b64_tr_b16 v[116:117], v153 offset:49152
    ds_read_b64_tr_b16 v[118:119], v153 offset:51200
    s_cmp_lg_u32 s68, 2
    s_cbranch_scc1 K1_SP258
    s_add_u32 m0, s46, 40960
    s_add_u32 s49, s48, 0
    buffer_load_dwordx4 v164, s[20:23], s49 offen nt lds
K1_SP258:
    s_waitcnt lgkmcnt(9)
    v_mfma_f32_32x32x16_bf16 v[96:111], v[120:123], v[72:75], v[96:111]
    ds_read_b64_tr_b16 v[120:121], v154 offset:49152
    ds_read_b64_tr_b16 v[122:123], v154 offset:51200
    s_cmp_lg_u32 s68, 3
    s_cbranch_scc1 K1_SP259
    s_add_u32 m0, s46, 40960
    s_add_u32 s49, s48, 0
    buffer_load_dwordx4 v164, s[20:23], s49 offen nt lds
K1_SP259:
    s_waitcnt lgkmcnt(10)
    v_mfma_f32_32x32x16_bf16 v[96:111], v[124:127], v[76:79], v[96:111]
    ds_read_b64_tr_b16 v[124:125], v155 offset:49152
    ds_read_b64_tr_b16 v[126:127], v155 offset:51200
    s_cmp_lg_u32 s68, 0
    s_cbranch_scc1 K1_SP260
    s_add_u32 m0, s46, 45056
    s_add_u32 s49, s48, 4096
    buffer_load_dwordx4 v164, s[20:23], s49 offen nt lds
    s_add_u32 s48, s48, 8192
K1_SP260:
    s_waitcnt lgkmcnt(11)
    v_mfma_f32_32x32x16_bf16 v[96:111], v[128:131], v[80:83], v[96:111]
    ds_read_b64_tr_b16 v[128:129], v152 offset:53248
    ds_read_b64_tr_b16 v[130:131], v152 offset:55296
    s_cmp_lg_u32 s68, 1
    s_cbranch_scc1 K1_SP261
    s_add_u32 m0, s46, 45056
    s_add_u32 s49, s48, 4096
    buffer_load_dwordx4 v164, s[20:23], s49 offen nt lds
    s_add_u32 s48, s48, 8192
K1_SP261:
    s_waitcnt lgkmcnt(12)
    v_mfma_f32_32x32x16_bf16 v[96:111], v[132:135], v[84:87], v[96:111]
    ds_read_b64_tr_b16 v[132:133], v153 offset:53248
    ds_read_b64_tr_b16 v[134:135], v153 offset:55296
    s_cmp_lg_u32 s68, 2
    s_cbranch_scc1 K1_SP262
    s_add_u32 m0, s46, 45056
    s_add_u32 s49, s48, 4096
    buffer_load_dwordx4 v164, s[20:23], s49 offen nt lds
    s_add_u32 s48, s48, 8192
K1_SP262:
    s_waitcnt lgkmcnt(13)
    v_mfma_f32_32x32x16_bf16 v[96:111], v[136:139], v[88:91], v[96:111]
    ds_read_b64_tr_b16 v[136:137], v154 offset:53248
    ds_read_b64_tr_b16 v[138:139], v154 offset:55296
    s_cmp_lg_u32 s68, 3
    s_cbranch_scc1 K1_SP263
    s_add_u32 m0, s46, 45056
    s_add_u32 s49, s48, 4096
    buffer_load_dwordx4 v164, s[20:23], s49 offen nt lds
    s_add_u32 s48, s48, 8192
K1_SP263:
    s_waitcnt lgkmcnt(14)
    v_mfma_f32_32x32x16_bf16 v[96:111], v[140:143], v[92:95], v[96:111]
    ds_read_b64_tr_b16 v[140:141], v155 offset:53248
    ds_read_b64_tr_b16 v[142:143], v155 offset:55296
    s_nop 9
    v_max3_f32 v161, v96, v97, v98
    v_max3_f32 v162, v99, v100, v101
    v_max3_f32 v161, v161, v102, v103
    v_max3_f32 v162, v162, v104, v105
    v_max3_f32 v161, v161, v106, v107
    v_max3_f32 v162, v162, v108, v109
    v_max3_f32 v161, v161, v110, v111
    v_max_f32 v161, v161, v162
    v_cmp_gt_f32 vcc, v161, v157
    s_cbranch_vccnz K1_SLOWr1a2
K1_RETr1a2:
    v_fma_f32 v96, v96, s31, v158
    v_fma_f32 v97, v97, s31, v158
    v_fma_f32 v98, v98, s31, v158
    v_fma_f32 v99, v99, s31, v158
    v_fma_f32 v100, v100, s31, v158
    v_fma_f32 v101, v101, s31, v158
    v_fma_f32 v102, v102, s31, v158
    v_fma_f32 v103, v103, s31, v158
    v_fma_f32 v104, v104, s31, v158
    v_fma_f32 v105, v105, s31, v158
    v_fma_f32 v106, v106, s31, v158
    v_fma_f32 v107, v107, s31, v158
    v_fma_f32 v108, v108, s31, v158
    v_fma_f32 v109, v109, s31, v158
    v_fma_f32 v110, v110, s31, v158
    v_fma_f32 v111, v111, s31, v158
    v_exp_f32 v96, v96
    v_exp_f32 v97, v97
    v_exp_f32 v98, v98
    v_exp_f32 v99, v99
    v_exp_f32 v100, v100
    v_exp_f32 v101, v101
    v_exp_f32 v102, v102
    v_exp_f32 v103, v103
    v_exp_f32 v104, v104
    v_exp_f32 v105, v105
    v_exp_f32 v106, v106
    v_exp_f32 v107, v107
    v_exp_f32 v108, v108
    v_exp_f32 v109, v109
    v_exp_f32 v110, v110
    v_exp_f32 v111, v111
    v_add_f32 v159, v159, v96
    v_add_f32 v160, v160, v97
    v_cvt_pk_bf16_f32 v96, v96, v97
    v_add_f32 v159, v159, v98
    v_add_f32 v160, v160, v99
    v_cvt_pk_bf16_f32 v97, v98, v99
    v_add_f32 v159, v159, v100
    v_add_f32 v160, v160, v101
    v_cvt_pk_bf16_f32 v98, v100, v101
    v_add_f32 v159, v159, v102
    v_add_f32 v160, v160, v103
    v_cvt_pk_bf16_f32 v99, v102, v103
    v_add_f32 v159, v159, v104
    v_add_f32 v160, v160, v105
    v_cvt_pk_bf16_f32 v100, v104, v105
    v_add_f32 v159, v159, v106
    v_add_f32 v160, v160, v107
    v_cvt_pk_bf16_f32 v101, v106, v107
    v_add_f32 v159, v159, v108
    v_add_f32 v160, v160, v109
    v_cvt_pk_bf16_f32 v102, v108, v109
    v_add_f32 v159, v159, v110
    v_add_f32 v160, v160, v111
    v_cvt_pk_bf16_f32 v103, v110, v111
    s_waitcnt vmcnt(8) lgkmcnt(0)
    s_barrier
    s_cmp_lg_u32 s68, 0
    s_cbranch_scc1 K1_SP264
    s_add_u32 m0, s46, 16384
    s_add_u32 s49, s47, 0
    buffer_load_dwordx4 v163, s[16:19], s49 offen nt lds
K1_SP264:
    v_mfma_f32_32x32x16_bf16 v[0:15], v[112:115], v[96:99], v[0:15]
    ds_read_b128 v[112:115], v144 offset:24576
    s_cmp_lg_u32 s68, 1
    s_cbranch_scc1 K1_SP265
    s_add_u32 m0, s46, 16384
    s_add_u32 s49, s47, 0
    buffer_load_dwordx4 v163, s[16:19], s49 offen nt lds
K1_SP265:
    v_mfma_f32_32x32x16_bf16 v[16:31], v[116:119], v[96:99], v[16:31]
    ds_read_b128 v[116:119], v145 offset:24576
    s_cmp_lg_u32 s68, 2
    s_cbranch_scc1 K1_SP266
    s_add_u32 m0, s46, 16384
    s_add_u32 s49, s47, 0
    buffer_load_dwordx4 v163, s[16:19], s49 offen nt lds
K1_SP266:
    v_mfma_f32_32x32x16_bf16 v[32:47], v[120:123], v[96:99], v[32:47]
    ds_read_b128 v[120:123], v146 offset:24576
    s_cmp_lg_u32 s68, 3
    s_cbranch_scc1 K1_SP267
    s_add_u32 m0, s46, 16384
    s_add_u32 s49, s47, 0
    buffer_load_dwordx4 v163, s[16:19], s49 offen nt lds
K1_SP267:
    v_mfma_f32_32x32x16_bf16 v[48:63], v[124:127], v[96:99], v[48:63]
    ds_read_b128 v[124:127], v147 offset:24576
    s_cmp_lg_u32 s68, 0
    s_cbranch_scc1 K1_SP268
    s_add_u32 m0, s46, 20480
    s_add_u32 s49, s47, 4096
    buffer_load_dwordx4 v163, s[16:19], s49 offen nt lds
    s_add_u32 s47, s47, 8192
K1_SP268:
    v_mfma_f32_32x32x16_bf16 v[0:15], v[128:131], v[100:103], v[0:15]
    ds_read_b128 v[128:131], v148 offset:24576
    s_cmp_lg_u32 s68, 1
    s_cbranch_scc1 K1_SP269
    s_add_u32 m0, s46, 20480
    s_add_u32 s49, s47, 4096
    buffer_load_dwordx4 v163, s[16:19], s49 offen nt lds
    s_add_u32 s47, s47, 8192
K1_SP269:
    v_mfma_f32_32x32x16_bf16 v[16:31], v[132:135], v[100:103], v[16:31]
    ds_read_b128 v[132:135], v149 offset:24576
    s_cmp_lg_u32 s68, 2
    s_cbranch_scc1 K1_SP270
    s_add_u32 m0, s46, 20480
    s_add_u32 s49, s47, 4096
    buffer_load_dwordx4 v163, s[16:19], s49 offen nt lds
    s_add_u32 s47, s47, 8192
K1_SP270:
    v_mfma_f32_32x32x16_bf16 v[32:47], v[136:139], v[100:103], v[32:47]
    ds_read_b128 v[136:139], v150 offset:24576
    s_cmp_lg_u32 s68, 3
    s_cbranch_scc1 K1_SP271
    s_add_u32 m0, s46, 20480
    s_add_u32 s49, s47, 4096
    buffer_load_dwordx4 v163, s[16:19], s49 offen nt lds
    s_add_u32 s47, s47, 8192
K1_SP271:
    v_mfma_f32_32x32x16_bf16 v[48:63], v[140:143], v[100:103], v[48:63]
    ds_read_b128 v[140:143], v151 offset:24576
    s_cmp_lg_u32 s68, 0
    s_cbranch_scc1 K1_SP272
    s_add_u32 m0, s46, 49152
    s_add_u32 s49, s48, 0
    buffer_load_dwordx4 v164, s[20:23], s49 offen nt lds
K1_SP272:
    s_waitcnt lgkmcnt(7)
    v_mfma_f32_32x32x16_bf16 v[96:111], v[112:115], v[64:67], 0
    ds_read_b64_tr_b16 v[112:113], v152 offset:57344
    ds_read_b64_tr_b16 v[114:115], v152 offset:59392
    s_cmp_lg_u32 s68, 1
    s_cbranch_scc1 K1_SP273
    s_add_u32 m0, s46, 49152
    s_add_u32 s49, s48, 0
    buffer_load_dwordx4 v164, s[20:23], s49 offen nt lds
K1_SP273:
    s_waitcnt lgkmcnt(8)
    v_mfma_f32_32x32x16_bf16 v[96:111], v[116:119], v[68:71], v[96:111]
    ds_read_b64_tr_b16 v[116:117], v153 offset:57344
    ds_read_b64_tr_b16 v[118:119], v153 offset:59392
    s_cmp_lg_u32 s68, 2
    s_cbranch_scc1 K1_SP274
    s_add_u32 m0, s46, 49152
    s_add_u32 s49, s48, 0
    buffer_load_dwordx4 v164, s[20:23], s49 offen nt lds
K1_SP274:
    s_waitcnt lgkmcnt(9)
    v_mfma_f32_32x32x16_bf16 v[96:111], v[120:123], v[72:75], v[96:111]
    ds_read_b64_tr_b16 v[120:121], v154 offset:57344
    ds_read_b64_tr_b16 v[122:123], v154 offset:59392
    s_cmp_lg_u32 s68, 3
    s_cbranch_scc1 K1_SP275
    s_add_u32 m0, s46, 49152
    s_add_u32 s49, s48, 0
    buffer_load_dwordx4 v164, s[20:23], s49 offen nt lds
K1_SP275:
    s_waitcnt lgkmcnt(10)
    v_mfma_f32_32x32x16_bf16 v[96:111], v[124:127], v[76:79], v[96:111]
    ds_read_b64_tr_b16 v[124:125], v155 offset:57344
    ds_read_b64_tr_b16 v[126:127], v155 offset:59392
    s_cmp_lg_u32 s68, 0
    s_cbranch_scc1 K1_SP276
    s_add_u32 m0, s46, 53248
    s_add_u32 s49, s48, 4096
    buffer_load_dwordx4 v164, s[20:23], s49 offen nt lds
    s_add_u32 s48, s48, 8192
K1_SP276:
    s_waitcnt lgkmcnt(11)
    v_mfma_f32_32x32x16_bf16 v[96:111], v[128:131], v[80:83], v[96:111]
    ds_read_b64_tr_b16 v[128:129], v152 offset:61440
    ds_read_b64_tr_b16 v[130:131], v152 offset:63488
    s_cmp_lg_u32 s68, 1
    s_cbranch_scc1 K1_SP277
    s_add_u32 m0, s46, 53248
    s_add_u32 s49, s48, 4096
    buffer_load_dwordx4 v164, s[20:23], s49 offen nt lds
    s_add_u32 s48, s48, 8192
K1_SP277:
    s_waitcnt lgkmcnt(12)
    v_mfma_f32_32x32x16_bf16 v[96:111], v[132:135], v[84:87], v[96:111]
    ds_read_b64_tr_b16 v[132:133], v153 offset:61440
    ds_read_b64_tr_b16 v[134:135], v153 offset:63488
    s_cmp_lg_u32 s68, 2
    s_cbranch_scc1 K1_SP278
    s_add_u32 m0, s46, 53248
    s_add_u32 s49, s48, 4096
    buffer_load_dwordx4 v164, s[20:23], s49 offen nt lds
    s_add_u32 s48, s48, 8192
K1_SP278:
    s_waitcnt lgkmcnt(13)
    v_mfma_f32_32x32x16_bf16 v[96:111], v[136:139], v[88:91], v[96:111]
    ds_read_b64_tr_b16 v[136:137], v154 offset:61440
    ds_read_b64_tr_b16 v[138:139], v154 offset:63488
    s_cmp_lg_u32 s68, 3
    s_cbranch_scc1 K1_SP279
    s_add_u32 m0, s46, 53248
    s_add_u32 s49, s48, 4096
    buffer_load_dwordx4 v164, s[20:23], s49 offen nt lds
    s_add_u32 s48, s48, 8192
K1_SP279:
    s_waitcnt lgkmcnt(14)
    v_mfma_f32_32x32x16_bf16 v[96:111], v[140:143], v[92:95], v[96:111]
    ds_read_b64_tr_b16 v[140:141], v155 offset:61440
    ds_read_b64_tr_b16 v[142:143], v155 offset:63488
    s_nop 9
    v_max3_f32 v161, v96, v97, v98
    v_max3_f32 v162, v99, v100, v101
    v_max3_f32 v161, v161, v102, v103
    v_max3_f32 v162, v162, v104, v105
    v_max3_f32 v161, v161, v106, v107
    v_max3_f32 v162, v162, v108, v109
    v_max3_f32 v161, v161, v110, v111
    v_max_f32 v161, v161, v162
    v_cmp_gt_f32 vcc, v161, v157
    s_cbranch_vccnz K1_SLOWr1a3
K1_RETr1a3:
    v_fma_f32 v96, v96, s31, v158
    v_fma_f32 v97, v97, s31, v158
    v_fma_f32 v98, v98, s31, v158
    v_fma_f32 v99, v99, s31, v158
    v_fma_f32 v100, v100, s31, v158
    v_fma_f32 v101, v101, s31, v158
    v_fma_f32 v102, v102, s31, v158
    v_fma_f32 v103, v103, s31, v158
    v_fma_f32 v104, v104, s31, v158
    v_fma_f32 v105, v105, s31, v158
    v_fma_f32 v106, v106, s31, v158
    v_fma_f32 v107, v107, s31, v158
    v_fma_f32 v108, v108, s31, v158
    v_fma_f32 v109, v109, s31, v158
    v_fma_f32 v110, v110, s31, v158
    v_fma_f32 v111, v111, s31, v158
    v_exp_f32 v96, v96
    v_exp_f32 v97, v97
    v_exp_f32 v98, v98
    v_exp_f32 v99, v99
    v_exp_f32 v100, v100
    v_exp_f32 v101, v101
    v_exp_f32 v102, v102
    v_exp_f32 v103, v103
    v_exp_f32 v104, v104
    v_exp_f32 v105, v105
    v_exp_f32 v106, v106
    v_exp_f32 v107, v107
    v_exp_f32 v108, v108
    v_exp_f32 v109, v109
    v_exp_f32 v110, v110
    v_exp_f32 v111, v111
    v_add_f32 v159, v159, v96
    v_add_f32 v160, v160, v97
    v_cvt_pk_bf16_f32 v96, v96, v97
    v_add_f32 v159, v159, v98
    v_add_f32 v160, v160, v99
    v_cvt_pk_bf16_f32 v97, v98, v99
    v_add_f32 v159, v159, v100
    v_add_f32 v160, v160, v101
    v_cvt_pk_bf16_f32 v98, v100, v101
    v_add_f32 v159, v159, v102
    v_add_f32 v160, v160, v103
    v_cvt_pk_bf16_f32 v99, v102, v103
    v_add_f32 v159, v159, v104
    v_add_f32 v160, v160, v105
    v_cvt_pk_bf16_f32 v100, v104, v105
    v_add_f32 v159, v159, v106
    v_add_f32 v160, v160, v107
    v_cvt_pk_bf16_f32 v101, v106, v107
    v_add_f32 v159, v159, v108
    v_add_f32 v160, v160, v109
    v_cvt_pk_bf16_f32 v102, v108, v109
    v_add_f32 v159, v159, v110
    v_add_f32 v160, v160, v111
    v_cvt_pk_bf16_f32 v103, v110, v111
    s_waitcnt vmcnt(8) lgkmcnt(0)
    s_add_u32 s50, s50, 1
    s_cmp_lt_u32 s50, 6
    s_cbranch_scc1 K1_LOOPr1
    s_barrier
    s_cmp_lg_u32 s68, 0
    s_cbranch_scc1 K1_SP280
    s_add_u32 m0, s46, 24576
    s_add_u32 s49, s47, 0
    buffer_load_dwordx4 v163, s[16:19], s49 offen nt lds
K1_SP280:
    v_mfma_f32_32x32x16_bf16 v[0:15], v[112:115], v[96:99], v[0:15]
    ds_read_b128 v[112:115], v144 offset:0
    s_cmp_lg_u32 s68, 1
    s_cbranch_scc1 K1_SP281
    s_add_u32 m0, s46, 24576
    s_add_u32 s49, s47, 0
    buffer_load_dwordx4 v163, s[16:19], s49 offen nt lds
K1_SP281:
    v_mfma_f32_32x32x16_bf16 v[16:31], v[116:119], v[96:99], v[16:31]
    ds_read_b128 v[116:119], v145 offset:0
    s_cmp_lg_u32 s68, 2
    s_cbranch_scc1 K1_SP282
    s_add_u32 m0, s46, 24576
    s_add_u32 s49, s47, 0
    buffer_load_dwordx4 v163, s[16:19], s49 offen nt lds
K1_SP282:
    v_mfma_f32_32x32x16_bf16 v[32:47], v[120:123], v[96:99], v[32:47]
    ds_read_b128 v[120:123], v146 offset:0
    s_cmp_lg_u32 s68, 3
    s_cbranch_scc1 K1_SP283
    s_add_u32 m0, s46, 24576
    s_add_u32 s49, s47, 0
    buffer_load_dwordx4 v163, s[16:19], s49 offen nt lds
K1_SP283:
    v_mfma_f32_32x32x16_bf16 v[48:63], v[124:127], v[96:99], v[48:63]
    ds_read_b128 v[124:127], v147 offset:0
    s_cmp_lg_u32 s68, 0
    s_cbranch_scc1 K1_SP284
    s_add_u32 m0, s46, 28672
    s_add_u32 s49, s47, 4096
    buffer_load_dwordx4 v163, s[16:19], s49 offen nt lds
    s_add_u32 s47, s47, 8192
K1_SP284:
    v_mfma_f32_32x32x16_bf16 v[0:15], v[128:131], v[100:103], v[0:15]
    ds_read_b128 v[128:131], v148 offset:0
    s_cmp_lg_u32 s68, 1
    s_cbranch_scc1 K1_SP285
    s_add_u32 m0, s46, 28672
    s_add_u32 s49, s47, 4096
    buffer_load_dwordx4 v163, s[16:19], s49 offen nt lds
    s_add_u32 s47, s47, 8192
K1_SP285:
    v_mfma_f32_32x32x16_bf16 v[16:31], v[132:135], v[100:103], v[16:31]
    ds_read_b128 v[132:135], v149 offset:0
    s_cmp_lg_u32 s68, 2
    s_cbranch_scc1 K1_SP286
    s_add_u32 m0, s46, 28672
    s_add_u32 s49, s47, 4096
    buffer_load_dwordx4 v163, s[16:19], s49 offen nt lds
    s_add_u32 s47, s47, 8192
K1_SP286:
    v_mfma_f32_32x32x16_bf16 v[32:47], v[136:139], v[100:103], v[32:47]
    ds_read_b128 v[136:139], v150 offset:0
    s_cmp_lg_u32 s68, 3
    s_cbranch_scc1 K1_SP287
    s_add_u32 m0, s46, 28672
    s_add_u32 s49, s47, 4096
    buffer_load_dwordx4 v163, s[16:19], s49 offen nt lds
    s_add_u32 s47, s47, 8192
K1_SP287:
    v_mfma_f32_32x32x16_bf16 v[48:63], v[140:143], v[100:103], v[48:63]
    ds_read_b128 v[140:143], v151 offset:0
    s_cmp_lg_u32 s68, 0
    s_cbranch_scc1 K1_SP288
    s_add_u32 m0, s46, 57344
    s_add_u32 s49, s48, 0
    buffer_load_dwordx4 v164, s[20:23], s49 offen nt lds
K1_SP288:
    s_waitcnt lgkmcnt(7)
    v_mfma_f32_32x32x16_bf16 v[96:111], v[112:115], v[64:67], 0
    ds_read_b64_tr_b16 v[112:113], v152 offset:32768
    ds_read_b64_tr_b16 v[114:115], v152 offset:34816
    s_cmp_lg_u32 s68, 1
    s_cbranch_scc1 K1_SP289
    s_add_u32 m0, s46, 57344
    s_add_u32 s49, s48, 0
    buffer_load_dwordx4 v164, s[20:23], s49 offen nt lds
K1_SP289:
    s_waitcnt lgkmcnt(8)
    v_mfma_f32_32x32x16_bf16 v[96:111], v[116:119], v[68:71], v[96:111]
    ds_read_b64_tr_b16 v[116:117], v153 offset:32768
    ds_read_b64_tr_b16 v[118:119], v153 offset:34816
    s_cmp_lg_u32 s68, 2
    s_cbranch_scc1 K1_SP290
    s_add_u32 m0, s46, 57344
    s_add_u32 s49, s48, 0
    buffer_load_dwordx4 v164, s[20:23], s49 offen nt lds
K1_SP290:
    s_waitcnt lgkmcnt(9)
    v_mfma_f32_32x32x16_bf16 v[96:111], v[120:123], v[72:75], v[96:111]
    ds_read_b64_tr_b16 v[120:121], v154 offset:32768
    ds_read_b64_tr_b16 v[122:123], v154 offset:34816
    s_cmp_lg_u32 s68, 3
    s_cbranch_scc1 K1_SP291
    s_add_u32 m0, s46, 57344
    s_add_u32 s49, s48, 0
    buffer_load_dwordx4 v164, s[20:23], s49 offen nt lds
K1_SP291:
    s_waitcnt lgkmcnt(10)
    v_mfma_f32_32x32x16_bf16 v[96:111], v[124:127], v[76:79], v[96:111]
    ds_read_b64_tr_b16 v[124:125], v155 offset:32768
    ds_read_b64_tr_b16 v[126:127], v155 offset:34816
    s_cmp_lg_u32 s68, 0
    s_cbranch_scc1 K1_SP292
    s_add_u32 m0, s46, 61440
    s_add_u32 s49, s48, 4096
    buffer_load_dwordx4 v164, s[20:23], s49 offen nt lds
    s_add_u32 s48, s48, 8192
K1_SP292:
    s_waitcnt lgkmcnt(11)
    v_mfma_f32_32x32x16_bf16 v[96:111], v[128:131], v[80:83], v[96:111]
    ds_read_b64_tr_b16 v[128:129], v152 offset:36864
    ds_read_b64_tr_b16 v[130:131], v152 offset:38912
    s_cmp_lg_u32 s68, 1
    s_cbranch_scc1 K1_SP293
    s_add_u32 m0, s46, 61440
    s_add_u32 s49, s48, 4096
    buffer_load_dwordx4 v164, s[20:23], s49 offen nt lds
    s_add_u32 s48, s48, 8192
K1_SP293:
    s_waitcnt lgkmcnt(12)
    v_mfma_f32_32x32x16_bf16 v[96:111], v[132:135], v[84:87], v[96:111]
    ds_read_b64_tr_b16 v[132:133], v153 offset:36864
    ds_read_b64_tr_b16 v[134:135], v153 offset:38912
    s_cmp_lg_u32 s68, 2
    s_cbranch_scc1 K1_SP294
    s_add_u32 m0, s46, 61440
    s_add_u32 s49, s48, 4096
    buffer_load_dwordx4 v164, s[20:23], s49 offen nt lds
    s_add_u32 s48, s48, 8192
K1_SP294:
    s_waitcnt lgkmcnt(13)
    v_mfma_f32_32x32x16_bf16 v[96:111], v[136:139], v[88:91], v[96:111]
    ds_read_b64_tr_b16 v[136:137], v154 offset:36864
    ds_read_b64_tr_b16 v[138:139], v154 offset:38912
    s_cmp_lg_u32 s68, 3
    s_cbranch_scc1 K1_SP295
    s_add_u32 m0, s46, 61440
    s_add_u32 s49, s48, 4096
    buffer_load_dwordx4 v164, s[20:23], s49 offen nt lds
    s_add_u32 s48, s48, 8192
K1_SP295:
    s_waitcnt lgkmcnt(14)
    v_mfma_f32_32x32x16_bf16 v[96:111], v[140:143], v[92:95], v[96:111]
    ds_read_b64_tr_b16 v[140:141], v155 offset:36864
    ds_read_b64_tr_b16 v[142:143], v155 offset:38912
    s_nop 9
    v_max3_f32 v161, v96, v97, v98
    v_max3_f32 v162, v99, v100, v101
    v_max3_f32 v161, v161, v102, v103
    v_max3_f32 v162, v162, v104, v105
    v_max3_f32 v161, v161, v106, v107
    v_max3_f32 v162, v162, v108, v109
    v_max3_f32 v161, v161, v110, v111
    v_max_f32 v161, v161, v162
    v_cmp_gt_f32 vcc, v161, v157
    s_cbranch_vccnz K1_SLOWr1b0
K1_RETr1b0:
    v_fma_f32 v96, v96, s31, v158
    v_fma_f32 v97, v97, s31, v158
    v_fma_f32 v98, v98, s31, v158
    v_fma_f32 v99, v99, s31, v158
    v_fma_f32 v100, v100, s31, v158
    v_fma_f32 v101, v101, s31, v158
    v_fma_f32 v102, v102, s31, v158
    v_fma_f32 v103, v103, s31, v158
    v_fma_f32 v104, v104, s31, v158
    v_fma_f32 v105, v105, s31, v158
    v_fma_f32 v106, v106, s31, v158
    v_fma_f32 v107, v107, s31, v158
    v_fma_f32 v108, v108, s31, v158
    v_fma_f32 v109, v109, s31, v158
    v_fma_f32 v110, v110, s31, v158
    v_fma_f32 v111, v111, s31, v158
    v_exp_f32 v96, v96
    v_exp_f32 v97, v97
    v_exp_f32 v98, v98
    v_exp_f32 v99, v99
    v_exp_f32 v100, v100
    v_exp_f32 v101, v101
    v_exp_f32 v102, v102
    v_exp_f32 v103, v103
    v_exp_f32 v104, v104
    v_exp_f32 v105, v105
    v_exp_f32 v106, v106
    v_exp_f32 v107, v107
    v_exp_f32 v108, v108
    v_exp_f32 v109, v109
    v_exp_f32 v110, v110
    v_exp_f32 v111, v111
    v_add_f32 v159, v159, v96
    v_add_f32 v160, v160, v97
    v_cvt_pk_bf16_f32 v96, v96, v97
    v_add_f32 v159, v159, v98
    v_add_f32 v160, v160, v99
    v_cvt_pk_bf16_f32 v97, v98, v99
    v_add_f32 v159, v159, v100
    v_add_f32 v160, v160, v101
    v_cvt_pk_bf16_f32 v98, v100, v101
    v_add_f32 v159, v159, v102
    v_add_f32 v160, v160, v103
    v_cvt_pk_bf16_f32 v99, v102, v103
    v_add_f32 v159, v159, v104
    v_add_f32 v160, v160, v105
    v_cvt_pk_bf16_f32 v100, v104, v105
    v_add_f32 v159, v159, v106
    v_add_f32 v160, v160, v107
    v_cvt_pk_bf16_f32 v101, v106, v107
    v_add_f32 v159, v159, v108
    v_add_f32 v160, v160, v109
    v_cvt_pk_bf16_f32 v102, v108, v109
    v_add_f32 v159, v159, v110
    v_add_f32 v160, v160, v111
    v_cvt_pk_bf16_f32 v103, v110, v111
    s_waitcnt vmcnt(8) lgkmcnt(0)
    s_barrier
    s_cmp_lg_u32 s68, 0
    s_cbranch_scc1 K1_SP296
    s_lshl_b32 s49, s28, 12
    s_add_u32 s49, s49, 0
    s_add_u32 m0, s49, 131072
    s_nop 0
    buffer_load_dwordx4 v164, s[52:55], s49 offen lds
K1_SP296:
    v_mfma_f32_32x32x16_bf16 v[0:15], v[112:115], v[96:99], v[0:15]
    ds_read_b128 v[112:115], v144 offset:8192
    s_cmp_lg_u32 s68, 1
    s_cbranch_scc1 K1_SP297
    s_lshl_b32 s49, s28, 12
    s_add_u32 s49, s49, 0
    s_add_u32 m0, s49, 131072
    s_nop 0
    buffer_load_dwordx4 v164, s[52:55], s49 offen lds
K1_SP297:
    v_mfma_f32_32x32x16_bf16 v[16:31], v[116:119], v[96:99], v[16:31]
    ds_read_b128 v[116:119], v145 offset:8192
    s_cmp_lg_u32 s68, 2
    s_cbranch_scc1 K1_SP298
    s_lshl_b32 s49, s28, 12
    s_add_u32 s49, s49, 0
    s_add_u32 m0, s49, 131072
    s_nop 0
    buffer_load_dwordx4 v164, s[52:55], s49 offen lds
K1_SP298:
    v_mfma_f32_32x32x16_bf16 v[32:47], v[120:123], v[96:99], v[32:47]
    ds_read_b128 v[120:123], v146 offset:8192
    s_cmp_lg_u32 s68, 3
    s_cbranch_scc1 K1_SP299
    s_lshl_b32 s49, s28, 12
    s_add_u32 s49, s49, 0
    s_add_u32 m0, s49, 131072
    s_nop 0
    buffer_load_dwordx4 v164, s[52:55], s49 offen lds
K1_SP299:
    v_mfma_f32_32x32x16_bf16 v[48:63], v[124:127], v[96:99], v[48:63]
    ds_read_b128 v[124:127], v147 offset:8192
    s_cmp_lg_u32 s68, 0
    s_cbranch_scc1 K1_SP300
    s_lshl_b32 s49, s28, 12
    s_add_u32 s49, s49, 1024
    s_add_u32 m0, s49, 131072
    s_nop 0
    buffer_load_dwordx4 v164, s[52:55], s49 offen lds
K1_SP300:
    v_mfma_f32_32x32x16_bf16 v[0:15], v[128:131], v[100:103], v[0:15]
    ds_read_b128 v[128:131], v148 offset:8192
    s_cmp_lg_u32 s68, 1
    s_cbranch_scc1 K1_SP301
    s_lshl_b32 s49, s28, 12
    s_add_u32 s49, s49, 1024
    s_add_u32 m0, s49, 131072
    s_nop 0
    buffer_load_dwordx4 v164, s[52:55], s49 offen lds
K1_SP301:
    v_mfma_f32_32x32x16_bf16 v[16:31], v[132:135], v[100:103], v[16:31]
    ds_read_b128 v[132:135], v149 offset:8192
    s_cmp_lg_u32 s68, 2
    s_cbranch_scc1 K1_SP302
    s_lshl_b32 s49, s28, 12
    s_add_u32 s49, s49, 1024
    s_add_u32 m0, s49, 131072
    s_nop 0
    buffer_load_dwordx4 v164, s[52:55], s49 offen lds
K1_SP302:
    v_mfma_f32_32x32x16_bf16 v[32:47], v[136:139], v[100:103], v[32:47]
    ds_read_b128 v[136:139], v150 offset:8192
    s_cmp_lg_u32 s68, 3
    s_cbranch_scc1 K1_SP303
    s_lshl_b32 s49, s28, 12
    s_add_u32 s49, s49, 1024
    s_add_u32 m0, s49, 131072
    s_nop 0
    buffer_load_dwordx4 v164, s[52:55], s49 offen lds
K1_SP303:
    v_mfma_f32_32x32x16_bf16 v[48:63], v[140:143], v[100:103], v[48:63]
    ds_read_b128 v[140:143], v151 offset:8192
    s_cmp_lg_u32 s68, 0
    s_cbranch_scc1 K1_SP304
    s_lshl_b32 s49, s28, 12
    s_add_u32 s49, s49, 2048
    s_add_u32 m0, s49, 131072
    s_nop 0
    buffer_load_dwordx4 v164, s[52:55], s49 offen lds
K1_SP304:
    s_waitcnt lgkmcnt(7)
    v_mfma_f32_32x32x16_bf16 v[96:111], v[112:115], v[64:67], 0
    ds_read_b64_tr_b16 v[112:113], v152 offset:40960
    ds_read_b64_tr_b16 v[114:115], v152 offset:43008
    s_cmp_lg_u32 s68, 1
    s_cbranch_scc1 K1_SP305
    s_lshl_b32 s49, s28, 12
    s_add_u32 s49, s49, 2048
    s_add_u32 m0, s49, 131072
    s_nop 0
    buffer_load_dwordx4 v164, s[52:55], s49 offen lds
K1_SP305:
    s_waitcnt lgkmcnt(8)
    v_mfma_f32_32x32x16_bf16 v[96:111], v[116:119], v[68:71], v[96:111]
    ds_read_b64_tr_b16 v[116:117], v153 offset:40960
    ds_read_b64_tr_b16 v[118:119], v153 offset:43008
    s_cmp_lg_u32 s68, 2
    s_cbranch_scc1 K1_SP306
    s_lshl_b32 s49, s28, 12
    s_add_u32 s49, s49, 2048
    s_add_u32 m0, s49, 131072
    s_nop 0
    buffer_load_dwordx4 v164, s[52:55], s49 offen lds
K1_SP306:
    s_waitcnt lgkmcnt(9)
    v_mfma_f32_32x32x16_bf16 v[96:111], v[120:123], v[72:75], v[96:111]
    ds_read_b64_tr_b16 v[120:121], v154 offset:40960
    ds_read_b64_tr_b16 v[122:123], v154 offset:43008
    s_cmp_lg_u32 s68, 3
    s_cbranch_scc1 K1_SP307
    s_lshl_b32 s49, s28, 12
    s_add_u32 s49, s49, 2048
    s_add_u32 m0, s49, 131072
    s_nop 0
    buffer_load_dwordx4 v164, s[52:55], s49 offen lds
K1_SP307:
    s_waitcnt lgkmcnt(10)
    v_mfma_f32_32x32x16_bf16 v[96:111], v[124:127], v[76:79], v[96:111]
    ds_read_b64_tr_b16 v[124:125], v155 offset:40960
    ds_read_b64_tr_b16 v[126:127], v155 offset:43008
    s_cmp_lg_u32 s68, 0
    s_cbranch_scc1 K1_SP308
    s_lshl_b32 s49, s28, 12
    s_add_u32 s49, s49, 3072
    s_add_u32 m0, s49, 131072
    s_nop 0
    buffer_load_dwordx4 v164, s[52:55], s49 offen lds
K1_SP308:
    s_waitcnt lgkmcnt(11)
    v_mfma_f32_32x32x16_bf16 v[96:111], v[128:131], v[80:83], v[96:111]
    ds_read_b64_tr_b16 v[128:129], v152 offset:45056
    ds_read_b64_tr_b16 v[130:131], v152 offset:47104
    s_cmp_lg_u32 s68, 1
    s_cbranch_scc1 K1_SP309
    s_lshl_b32 s49, s28, 12
    s_add_u32 s49, s49, 3072
    s_add_u32 m0, s49, 131072
    s_nop 0
    buffer_load_dwordx4 v164, s[52:55], s49 offen lds
K1_SP309:
    s_waitcnt lgkmcnt(12)
    v_mfma_f32_32x32x16_bf16 v[96:111], v[132:135], v[84:87], v[96:111]
    ds_read_b64_tr_b16 v[132:133], v153 offset:45056
    ds_read_b64_tr_b16 v[134:135], v153 offset:47104
    s_cmp_lg_u32 s68, 2
    s_cbranch_scc1 K1_SP310
    s_lshl_b32 s49, s28, 12
    s_add_u32 s49, s49, 3072
    s_add_u32 m0, s49, 131072
    s_nop 0
    buffer_load_dwordx4 v164, s[52:55], s49 offen lds
K1_SP310:
    s_waitcnt lgkmcnt(13)
    v_mfma_f32_32x32x16_bf16 v[96:111], v[136:139], v[88:91], v[96:111]
    ds_read_b64_tr_b16 v[136:137], v154 offset:45056
    ds_read_b64_tr_b16 v[138:139], v154 offset:47104
    s_cmp_lg_u32 s68, 3
    s_cbranch_scc1 K1_SP311
    s_lshl_b32 s49, s28, 12
    s_add_u32 s49, s49, 3072
    s_add_u32 m0, s49, 131072
    s_nop 0
    buffer_load_dwordx4 v164, s[52:55], s49 offen lds
K1_SP311:
    s_waitcnt lgkmcnt(14)
    v_mfma_f32_32x32x16_bf16 v[96:111], v[140:143], v[92:95], v[96:111]
    ds_read_b64_tr_b16 v[140:141], v155 offset:45056
    ds_read_b64_tr_b16 v[142:143], v155 offset:47104
    s_nop 9
    v_max3_f32 v161, v96, v97, v98
    v_max3_f32 v162, v99, v100, v101
    v_max3_f32 v161, v161, v102, v103
    v_max3_f32 v162, v162, v104, v105
    v_max3_f32 v161, v161, v106, v107
    v_max3_f32 v162, v162, v108, v109
    v_max3_f32 v161, v161, v110, v111
    v_max_f32 v161, v161, v162
    v_cmp_gt_f32 vcc, v161, v157
    s_cbranch_vccnz K1_SLOWr1b1
K1_RETr1b1:
    v_fma_f32 v96, v96, s31, v158
    v_fma_f32 v97, v97, s31, v158
    v_fma_f32 v98, v98, s31, v158
    v_fma_f32 v99, v99, s31, v158
    v_fma_f32 v100, v100, s31, v158
    v_fma_f32 v101, v101, s31, v158
    v_fma_f32 v102, v102, s31, v158
    v_fma_f32 v103, v103, s31, v158
    v_fma_f32 v104, v104, s31, v158
    v_fma_f32 v105, v105, s31, v158
    v_fma_f32 v106, v106, s31, v158
    v_fma_f32 v107, v107, s31, v158
    v_fma_f32 v108, v108, s31, v158
    v_fma_f32 v109, v109, s31, v158
    v_fma_f32 v110, v110, s31, v158
    v_fma_f32 v111, v111, s31, v158
    v_exp_f32 v96, v96
    v_exp_f32 v97, v97
    v_exp_f32 v98, v98
    v_exp_f32 v99, v99
    v_exp_f32 v100, v100
    v_exp_f32 v101, v101
    v_exp_f32 v102, v102
    v_exp_f32 v103, v103
    v_exp_f32 v104, v104
    v_exp_f32 v105, v105
    v_exp_f32 v106, v106
    v_exp_f32 v107, v107
    v_exp_f32 v108, v108
    v_exp_f32 v109, v109
    v_exp_f32 v110, v110
    v_exp_f32 v111, v111
    v_add_f32 v159, v159, v96
    v_add_f32 v160, v160, v97
    v_cvt_pk_bf16_f32 v96, v96, v97
    v_add_f32 v159, v159, v98
    v_add_f32 v160, v160, v99
    v_cvt_pk_bf16_f32 v97, v98, v99
    v_add_f32 v159, v159, v100
    v_add_f32 v160, v160, v101
    v_cvt_pk_bf16_f32 v98, v100, v101
    v_add_f32 v159, v159, v102
    v_add_f32 v160, v160, v103
    v_cvt_pk_bf16_f32 v99, v102, v103
    v_add_f32 v159, v159, v104
    v_add_f32 v160, v160, v105
    v_cvt_pk_bf16_f32 v100, v104, v105
    v_add_f32 v159, v159, v106
    v_add_f32 v160, v160, v107
    v_cvt_pk_bf16_f32 v101, v106, v107
    v_add_f32 v159, v159, v108
    v_add_f32 v160, v160, v109
    v_cvt_pk_bf16_f32 v102, v108, v109
    v_add_f32 v159, v159, v110
    v_add_f32 v160, v160, v111
    v_cvt_pk_bf16_f32 v103, v110, v111
    s_waitcnt vmcnt(4) lgkmcnt(0)
    s_barrier
    v_mfma_f32_32x32x16_bf16 v[0:15], v[112:115], v[96:99], v[0:15]
    ds_read_b128 v[112:115], v144 offset:16384
    v_mfma_f32_32x32x16_bf16 v[16:31], v[116:119], v[96:99], v[16:31]
    ds_read_b128 v[116:119], v145 offset:16384
    v_mfma_f32_32x32x16_bf16 v[32:47], v[120:123], v[96:99], v[32:47]
    ds_read_b128 v[120:123], v146 offset:16384
    v_mfma_f32_32x32x16_bf16 v[48:63], v[124:127], v[96:99], v[48:63]
    ds_read_b128 v[124:127], v147 offset:16384
    v_mfma_f32_32x32x16_bf16 v[0:15], v[128:131], v[100:103], v[0:15]
    ds_read_b128 v[128:131], v148 offset:16384
    v_mfma_f32_32x32x16_bf16 v[16:31], v[132:135], v[100:103], v[16:31]
    ds_read_b128 v[132:135], v149 offset:16384
    v_mfma_f32_32x32x16_bf16 v[32:47], v[136:139], v[100:103], v[32:47]
    ds_read_b128 v[136:139], v150 offset:16384
    v_mfma_f32_32x32x16_bf16 v[48:63], v[140:143], v[100:103], v[48:63]
    ds_read_b128 v[140:143], v151 offset:16384
    s_waitcnt lgkmcnt(7)
    v_mfma_f32_32x32x16_bf16 v[96:111], v[112:115], v[64:67], 0
    ds_read_b64_tr_b16 v[112:113], v152 offset:49152
    ds_read_b64_tr_b16 v[114:115], v152 offset:51200
    s_waitcnt lgkmcnt(8)
    v_mfma_f32_32x32x16_bf16 v[96:111], v[116:119], v[68:71], v[96:111]
    ds_read_b64_tr_b16 v[116:117], v153 offset:49152
    ds_read_b64_tr_b16 v[118:119], v153 offset:51200
    s_waitcnt lgkmcnt(9)
    v_mfma_f32_32x32x16_bf16 v[96:111], v[120:123], v[72:75], v[96:111]
    ds_read_b64_tr_b16 v[120:121], v154 offset:49152
    ds_read_b64_tr_b16 v[122:123], v154 offset:51200
    s_waitcnt lgkmcnt(10)
    v_mfma_f32_32x32x16_bf16 v[96:111], v[124:127], v[76:79], v[96:111]
    ds_read_b64_tr_b16 v[124:125], v155 offset:49152
    ds_read_b64_tr_b16 v[126:127], v155 offset:51200
    s_waitcnt lgkmcnt(11)
    v_mfma_f32_32x32x16_bf16 v[96:111], v[128:131], v[80:83], v[96:111]
    ds_read_b64_tr_b16 v[128:129], v152 offset:53248
    ds_read_b64_tr_b16 v[130:131], v152 offset:55296
    s_waitcnt lgkmcnt(12)
    v_mfma_f32_32x32x16_bf16 v[96:111], v[132:135], v[84:87], v[96:111]
    ds_read_b64_tr_b16 v[132:133], v153 offset:53248
    ds_read_b64_tr_b16 v[134:135], v153 offset:55296
    s_waitcnt lgkmcnt(13)
    v_mfma_f32_32x32x16_bf16 v[96:111], v[136:139], v[88:91], v[96:111]
    ds_read_b64_tr_b16 v[136:137], v154 offset:53248
    ds_read_b64_tr_b16 v[138:139], v154 offset:55296
    s_waitcnt lgkmcnt(14)
    v_mfma_f32_32x32x16_bf16 v[96:111], v[140:143], v[92:95], v[96:111]
    ds_read_b64_tr_b16 v[140:141], v155 offset:53248
    ds_read_b64_tr_b16 v[142:143], v155 offset:55296
    s_nop 9
    v_max3_f32 v161, v96, v97, v98
    v_max3_f32 v162, v99, v100, v101
    v_max3_f32 v161, v161, v102, v103
    v_max3_f32 v162, v162, v104, v105
    v_max3_f32 v161, v161, v106, v107
    v_max3_f32 v162, v162, v108, v109
    v_max3_f32 v161, v161, v110, v111
    v_max_f32 v161, v161, v162
    v_cmp_gt_f32 vcc, v161, v157
    s_cbranch_vccnz K1_SLOWr1b2
K1_RETr1b2:
    v_fma_f32 v96, v96, s31, v158
    v_fma_f32 v97, v97, s31, v158
    v_fma_f32 v98, v98, s31, v158
    v_fma_f32 v99, v99, s31, v158
    v_fma_f32 v100, v100, s31, v158
    v_fma_f32 v101, v101, s31, v158
    v_fma_f32 v102, v102, s31, v158
    v_fma_f32 v103, v103, s31, v158
    v_fma_f32 v104, v104, s31, v158
    v_fma_f32 v105, v105, s31, v158
    v_fma_f32 v106, v106, s31, v158
    v_fma_f32 v107, v107, s31, v158
    v_fma_f32 v108, v108, s31, v158
    v_fma_f32 v109, v109, s31, v158
    v_fma_f32 v110, v110, s31, v158
    v_fma_f32 v111, v111, s31, v158
    v_exp_f32 v96, v96
    v_exp_f32 v97, v97
    v_exp_f32 v98, v98
    v_exp_f32 v99, v99
    v_exp_f32 v100, v100
    v_exp_f32 v101, v101
    v_exp_f32 v102, v102
    v_exp_f32 v103, v103
    v_exp_f32 v104, v104
    v_exp_f32 v105, v105
    v_exp_f32 v106, v106
    v_exp_f32 v107, v107
    v_exp_f32 v108, v108
    v_exp_f32 v109, v109
    v_exp_f32 v110, v110
    v_exp_f32 v111, v111
    v_add_f32 v159, v159, v96
    v_add_f32 v160, v160, v97
    v_cvt_pk_bf16_f32 v96, v96, v97
    v_add_f32 v159, v159, v98
    v_add_f32 v160, v160, v99
    v_cvt_pk_bf16_f32 v97, v98, v99
    v_add_f32 v159, v159, v100
    v_add_f32 v160, v160, v101
    v_cvt_pk_bf16_f32 v98, v100, v101
    v_add_f32 v159, v159, v102
    v_add_f32 v160, v160, v103
    v_cvt_pk_bf16_f32 v99, v102, v103
    v_add_f32 v159, v159, v104
    v_add_f32 v160, v160, v105
    v_cvt_pk_bf16_f32 v100, v104, v105
    v_add_f32 v159, v159, v106
    v_add_f32 v160, v160, v107
    v_cvt_pk_bf16_f32 v101, v106, v107
    v_add_f32 v159, v159, v108
    v_add_f32 v160, v160, v109
    v_cvt_pk_bf16_f32 v102, v108, v109
    v_add_f32 v159, v159, v110
    v_add_f32 v160, v160, v111
    v_cvt_pk_bf16_f32 v103, v110, v111
    s_waitcnt vmcnt(0) lgkmcnt(0)
    s_barrier
    v_mfma_f32_32x32x16_bf16 v[0:15], v[112:115], v[96:99], v[0:15]
    ds_read_b128 v[112:115], v144 offset:24576
    v_mfma_f32_32x32x16_bf16 v[16:31], v[116:119], v[96:99], v[16:31]
    ds_read_b128 v[116:119], v145 offset:24576
    v_mfma_f32_32x32x16_bf16 v[32:47], v[120:123], v[96:99], v[32:47]
    ds_read_b128 v[120:123], v146 offset:24576
    v_mfma_f32_32x32x16_bf16 v[48:63], v[124:127], v[96:99], v[48:63]
    ds_read_b128 v[124:127], v147 offset:24576
    v_mfma_f32_32x32x16_bf16 v[0:15], v[128:131], v[100:103], v[0:15]
    ds_read_b128 v[128:131], v148 offset:24576
    v_mfma_f32_32x32x16_bf16 v[16:31], v[132:135], v[100:103], v[16:31]
    ds_read_b128 v[132:135], v149 offset:24576
    v_mfma_f32_32x32x16_bf16 v[32:47], v[136:139], v[100:103], v[32:47]
    ds_read_b128 v[136:139], v150 offset:24576
    v_mfma_f32_32x32x16_bf16 v[48:63], v[140:143], v[100:103], v[48:63]
    ds_read_b128 v[140:143], v151 offset:24576
    s_waitcnt lgkmcnt(7)
    v_mfma_f32_32x32x16_bf16 v[96:111], v[112:115], v[64:67], 0
    ds_read_b64_tr_b16 v[112:113], v152 offset:57344
    ds_read_b64_tr_b16 v[114:115], v152 offset:59392
    s_waitcnt lgkmcnt(8)
    v_mfma_f32_32x32x16_bf16 v[96:111], v[116:119], v[68:71], v[96:111]
    ds_read_b64_tr_b16 v[116:117], v153 offset:57344
    ds_read_b64_tr_b16 v[118:119], v153 offset:59392
    s_waitcnt lgkmcnt(9)
    v_mfma_f32_32x32x16_bf16 v[96:111], v[120:123], v[72:75], v[96:111]
    ds_read_b64_tr_b16 v[120:121], v154 offset:57344
    ds_read_b64_tr_b16 v[122:123], v154 offset:59392
    s_waitcnt lgkmcnt(10)
    v_mfma_f32_32x32x16_bf16 v[96:111], v[124:127], v[76:79], v[96:111]
    ds_read_b64_tr_b16 v[124:125], v155 offset:57344
    ds_read_b64_tr_b16 v[126:127], v155 offset:59392
    s_waitcnt lgkmcnt(11)
    v_mfma_f32_32x32x16_bf16 v[96:111], v[128:131], v[80:83], v[96:111]
    ds_read_b64_tr_b16 v[128:129], v152 offset:61440
    ds_read_b64_tr_b16 v[130:131], v152 offset:63488
    s_waitcnt lgkmcnt(12)
    v_mfma_f32_32x32x16_bf16 v[96:111], v[132:135], v[84:87], v[96:111]
    ds_read_b64_tr_b16 v[132:133], v153 offset:61440
    ds_read_b64_tr_b16 v[134:135], v153 offset:63488
    s_waitcnt lgkmcnt(13)
    v_mfma_f32_32x32x16_bf16 v[96:111], v[136:139], v[88:91], v[96:111]
    ds_read_b64_tr_b16 v[136:137], v154 offset:61440
    ds_read_b64_tr_b16 v[138:139], v154 offset:63488
    s_waitcnt lgkmcnt(14)
    v_mfma_f32_32x32x16_bf16 v[96:111], v[140:143], v[92:95], v[96:111]
    ds_read_b64_tr_b16 v[140:141], v155 offset:61440
    ds_read_b64_tr_b16 v[142:143], v155 offset:63488
    s_nop 9
    v_max3_f32 v161, v96, v97, v98
    v_max3_f32 v162, v99, v100, v101
    v_max3_f32 v161, v161, v102, v103
    v_max3_f32 v162, v162, v104, v105
    v_max3_f32 v161, v161, v106, v107
    v_max3_f32 v162, v162, v108, v109
    v_max3_f32 v161, v161, v110, v111
    v_max_f32 v161, v161, v162
    v_cmp_gt_f32 vcc, v161, v157
    s_cbranch_vccnz K1_SLOWr1b3
K1_RETr1b3:
    v_fma_f32 v96, v96, s31, v158
    v_fma_f32 v97, v97, s31, v158
    v_fma_f32 v98, v98, s31, v158
    v_fma_f32 v99, v99, s31, v158
    v_fma_f32 v100, v100, s31, v158
    v_fma_f32 v101, v101, s31, v158
    v_fma_f32 v102, v102, s31, v158
    v_fma_f32 v103, v103, s31, v158
    v_fma_f32 v104, v104, s31, v158
    v_fma_f32 v105, v105, s31, v158
    v_fma_f32 v106, v106, s31, v158
    v_fma_f32 v107, v107, s31, v158
    v_fma_f32 v108, v108, s31, v158
    v_fma_f32 v109, v109, s31, v158
    v_fma_f32 v110, v110, s31, v158
    v_fma_f32 v111, v111, s31, v158
    v_exp_f32 v96, v96
    v_exp_f32 v97, v97
    v_exp_f32 v98, v98
    v_exp_f32 v99, v99
    v_exp_f32 v100, v100
    v_exp_f32 v101, v101
    v_exp_f32 v102, v102
    v_exp_f32 v103, v103
    v_exp_f32 v104, v104
    v_exp_f32 v105, v105
    v_exp_f32 v106, v106
    v_exp_f32 v107, v107
    v_exp_f32 v108, v108
    v_exp_f32 v109, v109
    v_exp_f32 v110, v110
    v_exp_f32 v111, v111
    v_add_f32 v159, v159, v96
    v_add_f32 v160, v160, v97
    v_cvt_pk_bf16_f32 v96, v96, v97
    v_add_f32 v159, v159, v98
    v_add_f32 v160, v160, v99
    v_cvt_pk_bf16_f32 v97, v98, v99
    v_add_f32 v159, v159, v100
    v_add_f32 v160, v160, v101
    v_cvt_pk_bf16_f32 v98, v100, v101
    v_add_f32 v159, v159, v102
    v_add_f32 v160, v160, v103
    v_cvt_pk_bf16_f32 v99, v102, v103
    v_add_f32 v159, v159, v104
    v_add_f32 v160, v160, v105
    v_cvt_pk_bf16_f32 v100, v104, v105
    v_add_f32 v159, v159, v106
    v_add_f32 v160, v160, v107
    v_cvt_pk_bf16_f32 v101, v106, v107
    v_add_f32 v159, v159, v108
    v_add_f32 v160, v160, v109
    v_cvt_pk_bf16_f32 v102, v108, v109
    v_add_f32 v159, v159, v110
    v_add_f32 v160, v160, v111
    v_cvt_pk_bf16_f32 v103, v110, v111
    s_waitcnt lgkmcnt(14)
    v_mfma_f32_32x32x16_bf16 v[0:15], v[112:115], v[96:99], v[0:15]
    s_waitcnt lgkmcnt(12)
    v_mfma_f32_32x32x16_bf16 v[16:31], v[116:119], v[96:99], v[16:31]
    s_waitcnt lgkmcnt(10)
    v_mfma_f32_32x32x16_bf16 v[32:47], v[120:123], v[96:99], v[32:47]
    s_waitcnt lgkmcnt(8)
    v_mfma_f32_32x32x16_bf16 v[48:63], v[124:127], v[96:99], v[48:63]
    s_waitcnt lgkmcnt(6)
    v_mfma_f32_32x32x16_bf16 v[0:15], v[128:131], v[100:103], v[0:15]
    s_waitcnt lgkmcnt(4)
    v_mfma_f32_32x32x16_bf16 v[16:31], v[132:135], v[100:103], v[16:31]
    s_waitcnt lgkmcnt(2)
    v_mfma_f32_32x32x16_bf16 v[32:47], v[136:139], v[100:103], v[32:47]
    s_waitcnt lgkmcnt(0)
    v_mfma_f32_32x32x16_bf16 v[48:63], v[140:143], v[100:103], v[48:63]
    s_waitcnt lgkmcnt(0)
    s_nop 10
    s_branch K1_EPI
K1_ROLE2:
    s_add_u32 s49, s34, s41
    s_mov_b32 m0, s36
    s_nop 0
    buffer_load_dwordx4 v108, s[8:11], s49 offen lds
    s_add_u32 s41, s41, 64
    s_and_b32 s41, s41, 1023
    s_add_u32 s49, s34, s41
    s_mov_b32 m0, s37
    s_nop 0
    buffer_load_dwordx4 v108, s[8:11], s49 offen lds
    s_add_u32 s41, s41, 64
    s_and_b32 s41, s41, 1023
    s_add_u32 s49, s34, s41
    s_mov_b32 m0, s38
    s_nop 0
    buffer_load_dwordx4 v108, s[8:11], s49 offen lds
    s_add_u32 s41, s41, 64
    s_and_b32 s41, s41, 1023
    s_add_u32 s49, s34, s41
    s_mov_b32 m0, s39
    s_nop 0
    buffer_load_dwordx4 v108, s[8:11], s49 offen lds
    s_add_u32 s41, s41, 64
    s_and_b32 s41, s41, 1023
    s_add_u32 m0, s69, 0
    s_add_u32 s49, s69, 0
    buffer_load_dwordx4 v163, s[16:19], s49 offen nt lds
    s_add_u32 m0, s69, 4096
    s_add_u32 s49, s69, 4096
    buffer_load_dwordx4 v163, s[16:19], s49 offen nt lds
    s_add_u32 m0, s69, 65536
    s_add_u32 s49, s69, 262144
    buffer_load_dwordx4 v163, s[16:19], s49 offen nt lds
    s_add_u32 m0, s69, 69632
    s_add_u32 s49, s69, 266240
    buffer_load_dwordx4 v163, s[16:19], s49 offen nt lds
    s_waitcnt vmcnt(6) lgkmcnt(0)
    s_barrier
    ds_read_b128 v[144:147], v100 offset:0
    ds_read_b64_tr_b16 v[112:113], v96 offset:40960
    ds_read_b64_tr_b16 v[114:115], v96 offset:41984
    ds_read_b64_tr_b16 v[116:117], v97 offset:40960
    ds_read_b64_tr_b16 v[118:119], v97 offset:41984
    ds_read_b64_tr_b16 v[120:121], v98 offset:40960
    ds_read_b64_tr_b16 v[122:123], v98 offset:41984
    ds_read_b64_tr_b16 v[124:125], v99 offset:40960
    ds_read_b64_tr_b16 v[126:127], v99 offset:41984
    ds_read_b128 v[148:151], v101 offset:0
    ds_read_b64_tr_b16 v[128:129], v96 offset:45056
    ds_read_b64_tr_b16 v[130:131], v96 offset:46080
    ds_read_b64_tr_b16 v[132:133], v97 offset:45056
    ds_read_b64_tr_b16 v[134:135], v97 offset:46080
    ds_read_b64_tr_b16 v[136:137], v98 offset:45056
    ds_read_b64_tr_b16 v[138:139], v98 offset:46080
    ds_read_b64_tr_b16 v[140:141], v99 offset:45056
    ds_read_b64_tr_b16 v[142:143], v99 offset:46080
    s_waitcnt lgkmcnt(0)
    s_barrier
    v_mfma_f32_32x32x16_bf16 v[0:15], v[112:115], v[144:147], 0
    ds_read_b128 v[152:155], v102 offset:0
    ds_read_b64_tr_b16 v[64:65], v96 offset:49152
    ds_read_b64_tr_b16 v[66:67], v96 offset:50176
    s_add_u32 s49, s34, s41
    s_mov_b32 m0, s36
    s_nop 0
    buffer_load_dwordx4 v108, s[8:11], s49 offen lds
    s_add_u32 s41, s41, 64
    s_and_b32 s41, s41, 1023
    v_mfma_f32_32x32x16_bf16 v[16:31], v[116:119], v[144:147], 0
    ds_read_b64_tr_b16 v[68:69], v97 offset:49152
    ds_read_b64_tr_b16 v[70:71], v97 offset:50176
    ds_read_b64_tr_b16 v[72:73], v98 offset:49152
    v_mfma_f32_32x32x16_bf16 v[32:47], v[120:123], v[144:147], 0
    ds_read_b64_tr_b16 v[74:75], v98 offset:50176
    ds_read_b64_tr_b16 v[76:77], v99 offset:49152
    ds_read_b64_tr_b16 v[78:79], v99 offset:50176
    s_add_u32 m0, s69, 32768
    s_add_u32 s49, s69, 0
    buffer_load_dwordx4 v164, s[20:23], s49 offen nt lds
    v_mfma_f32_32x32x16_bf16 v[48:63], v[124:127], v[144:147], 0
    ds_read_b128 v[156:159], v103 offset:0
    ds_read_b64_tr_b16 v[80:81], v96 offset:53248
    ds_read_b64_tr_b16 v[82:83], v96 offset:54272
    v_mfma_f32_32x32x16_bf16 v[0:15], v[128:131], v[148:151], v[0:15]
    ds_read_b64_tr_b16 v[84:85], v97 offset:53248
    ds_read_b64_tr_b16 v[86:87], v97 offset:54272
    ds_read_b64_tr_b16 v[88:89], v98 offset:53248
    v_mfma_f32_32x32x16_bf16 v[16:31], v[132:135], v[148:151], v[16:31]
    ds_read_b64_tr_b16 v[90:91], v98 offset:54272
    ds_read_b64_tr_b16 v[92:93], v99 offset:53248
    ds_read_b64_tr_b16 v[94:95], v99 offset:54272
    v_mfma_f32_32x32x16_bf16 v[32:47], v[136:139], v[148:151], v[32:47]
    v_mfma_f32_32x32x16_bf16 v[48:63], v[140:143], v[148:151], v[48:63]
    s_waitcnt vmcnt(7) lgkmcnt(0)
    s_barrier
    v_mfma_f32_32x32x16_bf16 v[0:15], v[64:67], v[152:155], v[0:15]
    ds_read_b128 v[144:147], v104 offset:0
    ds_read_b64_tr_b16 v[112:113], v96 offset:24576
    ds_read_b64_tr_b16 v[114:115], v96 offset:25600
    s_add_u32 s49, s34, s41
    s_mov_b32 m0, s37
    s_nop 0
    buffer_load_dwordx4 v108, s[8:11], s49 offen lds
    s_add_u32 s41, s41, 64
    s_and_b32 s41, s41, 1023
    v_mfma_f32_32x32x16_bf16 v[16:31], v[68:71], v[152:155], v[16:31]
    ds_read_b64_tr_b16 v[116:117], v97 offset:24576
    ds_read_b64_tr_b16 v[118:119], v97 offset:25600
    ds_read_b64_tr_b16 v[120:121], v98 offset:24576
    v_mfma_f32_32x32x16_bf16 v[32:47], v[72:75], v[152:155], v[32:47]
    ds_read_b64_tr_b16 v[122:123], v98 offset:25600
    ds_read_b64_tr_b16 v[124:125], v99 offset:24576
    ds_read_b64_tr_b16 v[126:127], v99 offset:25600
    s_add_u32 m0, s69, 36864
    s_add_u32 s49, s69, 4096
    buffer_load_dwordx4 v164, s[20:23], s49 offen nt lds
    v_mfma_f32_32x32x16_bf16 v[48:63], v[76:79], v[152:155], v[48:63]
    ds_read_b128 v[148:151], v105 offset:0
    ds_read_b64_tr_b16 v[128:129], v96 offset:28672
    ds_read_b64_tr_b16 v[130:131], v96 offset:29696
    v_mfma_f32_32x32x16_bf16 v[0:15], v[80:83], v[156:159], v[0:15]
    ds_read_b64_tr_b16 v[132:133], v97 offset:28672
    ds_read_b64_tr_b16 v[134:135], v97 offset:29696
    ds_read_b64_tr_b16 v[136:137], v98 offset:28672
    v_mfma_f32_32x32x16_bf16 v[16:31], v[84:87], v[156:159], v[16:31]
    ds_read_b64_tr_b16 v[138:139], v98 offset:29696
    ds_read_b64_tr_b16 v[140:141], v99 offset:28672
    ds_read_b64_tr_b16 v[142:143], v99 offset:29696
    v_mfma_f32_32x32x16_bf16 v[32:47], v[88:91], v[156:159], v[32:47]
    v_mfma_f32_32x32x16_bf16 v[48:63], v[92:95], v[156:159], v[48:63]
    s_waitcnt vmcnt(8) lgkmcnt(0)
    s_barrier
    v_mfma_f32_32x32x16_bf16 v[0:15], v[112:115], v[144:147], v[0:15]
    ds_read_b128 v[152:155], v106 offset:0
    ds_read_b64_tr_b16 v[64:65], v96 offset:57344
    ds_read_b64_tr_b16 v[66:67], v96 offset:58368
    s_add_u32 s49, s34, s41
    s_mov_b32 m0, s38
    s_nop 0
    buffer_load_dwordx4 v108, s[8:11], s49 offen lds
    s_add_u32 s41, s41, 64
    s_and_b32 s41, s41, 1023
    v_mfma_f32_32x32x16_bf16 v[16:31], v[116:119], v[144:147], v[16:31]
    ds_read_b64_tr_b16 v[68:69], v97 offset:57344
    ds_read_b64_tr_b16 v[70:71], v97 offset:58368
    ds_read_b64_tr_b16 v[72:73], v98 offset:57344
    v_mfma_f32_32x32x16_bf16 v[32:47], v[120:123], v[144:147], v[32:47]
    ds_read_b64_tr_b16 v[74:75], v98 offset:58368
    ds_read_b64_tr_b16 v[76:77], v99 offset:57344
    ds_read_b64_tr_b16 v[78:79], v99 offset:58368
    s_add_u32 m0, s69, 98304
    s_add_u32 s49, s69, 262144
    buffer_load_dwordx4 v164, s[20:23], s49 offen nt lds
    v_mfma_f32_32x32x16_bf16 v[48:63], v[124:127], v[144:147], v[48:63]
    ds_read_b128 v[156:159], v107 offset:0
    ds_read_b64_tr_b16 v[80:81], v96 offset:61440
    ds_read_b64_tr_b16 v[82:83], v96 offset:62464
    v_mfma_f32_32x32x16_bf16 v[0:15], v[128:131], v[148:151], v[0:15]
    ds_read_b64_tr_b16 v[84:85], v97 offset:61440
    ds_read_b64_tr_b16 v[86:87], v97 offset:62464
    ds_read_b64_tr_b16 v[88:89], v98 offset:61440
    v_mfma_f32_32x32x16_bf16 v[16:31], v[132:135], v[148:151], v[16:31]
    ds_read_b64_tr_b16 v[90:91], v98 offset:62464
    ds_read_b64_tr_b16 v[92:93], v99 offset:61440
    ds_read_b64_tr_b16 v[94:95], v99 offset:62464
    v_mfma_f32_32x32x16_bf16 v[32:47], v[136:139], v[148:151], v[32:47]
    v_mfma_f32_32x32x16_bf16 v[48:63], v[140:143], v[148:151], v[48:63]
    s_waitcnt vmcnt(5) lgkmcnt(0)
    s_barrier
    v_mfma_f32_32x32x16_bf16 v[0:15], v[64:67], v[152:155], v[0:15]
    ds_read_b128 v[144:147], v100 offset:0
    ds_read_b64_tr_b16 v[112:113], v96 offset:40960
    ds_read_b64_tr_b16 v[114:115], v96 offset:41984
    s_add_u32 s49, s34, s41
    s_mov_b32 m0, s39
    s_nop 0
    buffer_load_dwordx4 v108, s[8:11], s49 offen lds
    s_add_u32 s41, s41, 64
    s_and_b32 s41, s41, 1023
    v_mfma_f32_32x32x16_bf16 v[16:31], v[68:71], v[152:155], v[16:31]
    ds_read_b64_tr_b16 v[116:117], v97 offset:40960
    ds_read_b64_tr_b16 v[118:119], v97 offset:41984
    ds_read_b64_tr_b16 v[120:121], v98 offset:40960
    v_mfma_f32_32x32x16_bf16 v[32:47], v[72:75], v[152:155], v[32:47]
    ds_read_b64_tr_b16 v[122:123], v98 offset:41984
    ds_read_b64_tr_b16 v[124:125], v99 offset:40960
    ds_read_b64_tr_b16 v[126:127], v99 offset:41984
    s_add_u32 m0, s69, 102400
    s_add_u32 s49, s69, 266240
    buffer_load_dwordx4 v164, s[20:23], s49 offen nt lds
    v_mfma_f32_32x32x16_bf16 v[48:63], v[76:79], v[152:155], v[48:63]
    ds_read_b128 v[148:151], v101 offset:0
    ds_read_b64_tr_b16 v[128:129], v96 offset:45056
    ds_read_b64_tr_b16 v[130:131], v96 offset:46080
    v_mfma_f32_32x32x16_bf16 v[0:15], v[80:83], v[156:159], v[0:15]
    ds_read_b64_tr_b16 v[132:133], v97 offset:45056
    ds_read_b64_tr_b16 v[134:135], v97 offset:46080
    ds_read_b64_tr_b16 v[136:137], v98 offset:45056
    v_mfma_f32_32x32x16_bf16 v[16:31], v[84:87], v[156:159], v[16:31]
    ds_read_b64_tr_b16 v[138:139], v98 offset:46080
    ds_read_b64_tr_b16 v[140:141], v99 offset:45056
    ds_read_b64_tr_b16 v[142:143], v99 offset:46080
    v_mfma_f32_32x32x16_bf16 v[32:47], v[88:91], v[156:159], v[32:47]
    v_mfma_f32_32x32x16_bf16 v[48:63], v[92:95], v[156:159], v[48:63]
    s_waitcnt vmcnt(5) lgkmcnt(0)
    s_barrier
    v_mfma_f32_32x32x16_bf16 v[0:15], v[112:115], v[144:147], v[0:15]
    ds_read_b128 v[152:155], v102 offset:0
    ds_read_b64_tr_b16 v[64:65], v96 offset:49152
    ds_read_b64_tr_b16 v[66:67], v96 offset:50176
    s_add_u32 s49, s34, s41
    s_mov_b32 m0, s36
    s_nop 0
    buffer_load_dwordx4 v108, s[8:11], s49 offen lds
    s_add_u32 s41, s41, 64
    s_and_b32 s41, s41, 1023
    v_mfma_f32_32x32x16_bf16 v[16:31], v[116:119], v[144:147], v[16:31]
    ds_read_b64_tr_b16 v[68:69], v97 offset:49152
    ds_read_b64_tr_b16 v[70:71], v97 offset:50176
    ds_read_b64_tr_b16 v[72:73], v98 offset:49152
    v_mfma_f32_32x32x16_bf16 v[32:47], v[120:123], v[144:147], v[32:47]
    ds_read_b64_tr_b16 v[74:75], v98 offset:50176
    ds_read_b64_tr_b16 v[76:77], v99 offset:49152
    ds_read_b64_tr_b16 v[78:79], v99 offset:50176
    s_add_u32 m0, s69, 8192
    s_add_u32 s49, s69, 8192
    buffer_load_dwordx4 v163, s[16:19], s49 offen nt lds
    v_mfma_f32_32x32x16_bf16 v[48:63], v[124:127], v[144:147], v[48:63]
    ds_read_b128 v[156:159], v103 offset:0
    ds_read_b64_tr_b16 v[80:81], v96 offset:53248
    ds_read_b64_tr_b16 v[82:83], v96 offset:54272
    v_mfma_f32_32x32x16_bf16 v[0:15], v[128:131], v[148:151], v[0:15]
    ds_read_b64_tr_b16 v[84:85], v97 offset:53248
    ds_read_b64_tr_b16 v[86:87], v97 offset:54272
    ds_read_b64_tr_b16 v[88:89], v98 offset:53248
    v_mfma_f32_32x32x16_bf16 v[16:31], v[132:135], v[148:151], v[16:31]
    ds_read_b64_tr_b16 v[90:91], v98 offset:54272
    ds_read_b64_tr_b16 v[92:93], v99 offset:53248
    ds_read_b64_tr_b16 v[94:95], v99 offset:54272
    v_mfma_f32_32x32x16_bf16 v[32:47], v[136:139], v[148:151], v[32:47]
    v_mfma_f32_32x32x16_bf16 v[48:63], v[140:143], v[148:151], v[48:63]
    s_waitcnt vmcnt(5) lgkmcnt(0)
    s_barrier
    v_mfma_f32_32x32x16_bf16 v[0:15], v[64:67], v[152:155], v[0:15]
    ds_read_b128 v[144:147], v104 offset:0
    ds_read_b64_tr_b16 v[112:113], v96 offset:24576
    ds_read_b64_tr_b16 v[114:115], v96 offset:25600
    s_add_u32 s49, s34, s41
    s_mov_b32 m0, s37
    s_nop 0
    buffer_load_dwordx4 v108, s[8:11], s49 offen lds
    s_add_u32 s41, s41, 64
    s_and_b32 s41, s41, 1023
    v_mfma_f32_32x32x16_bf16 v[16:31], v[68:71], v[152:155], v[16:31]
    ds_read_b64_tr_b16 v[116:117], v97 offset:24576
    ds_read_b64_tr_b16 v[118:119], v97 offset:25600
    ds_read_b64_tr_b16 v[120:121], v98 offset:24576
    v_mfma_f32_32x32x16_bf16 v[32:47], v[72:75], v[152:155], v[32:47]
    ds_read_b64_tr_b16 v[122:123], v98 offset:25600
    ds_read_b64_tr_b16 v[124:125], v99 offset:24576
    ds_read_b64_tr_b16 v[126:127], v99 offset:25600
    s_add_u32 m0, s69, 12288
    s_add_u32 s49, s69, 12288
    buffer_load_dwordx4 v163, s[16:19], s49 offen nt lds
    v_mfma_f32_32x32x16_bf16 v[48:63], v[76:79], v[152:155], v[48:63]
    ds_read_b128 v[148:151], v105 offset:0
    ds_read_b64_tr_b16 v[128:129], v96 offset:28672
    ds_read_b64_tr_b16 v[130:131], v96 offset:29696
    v_mfma_f32_32x32x16_bf16 v[0:15], v[80:83], v[156:159], v[0:15]
    ds_read_b64_tr_b16 v[132:133], v97 offset:28672
    ds_read_b64_tr_b16 v[134:135], v97 offset:29696
    ds_read_b64_tr_b16 v[136:137], v98 offset:28672
    v_mfma_f32_32x32x16_bf16 v[16:31], v[84:87], v[156:159], v[16:31]
    ds_read_b64_tr_b16 v[138:139], v98 offset:29696
    ds_read_b64_tr_b16 v[140:141], v99 offset:28672
    ds_read_b64_tr_b16 v[142:143], v99 offset:29696
    v_mfma_f32_32x32x16_bf16 v[32:47], v[88:91], v[156:159], v[32:47]
    v_mfma_f32_32x32x16_bf16 v[48:63], v[92:95], v[156:159], v[48:63]
    s_waitcnt vmcnt(5) lgkmcnt(0)
    s_barrier
    v_mfma_f32_32x32x16_bf16 v[0:15], v[112:115], v[144:147], v[0:15]
    ds_read_b128 v[152:155], v106 offset:0
    ds_read_b64_tr_b16 v[64:65], v96 offset:57344
    ds_read_b64_tr_b16 v[66:67], v96 offset:58368
    s_add_u32 s49, s34, s41
    s_mov_b32 m0, s38
    s_nop 0
    buffer_load_dwordx4 v108, s[8:11], s49 offen lds
    s_add_u32 s41, s41, 64
    s_and_b32 s41, s41, 1023
    v_mfma_f32_32x32x16_bf16 v[16:31], v[116:119], v[144:147], v[16:31]
    ds_read_b64_tr_b16 v[68:69], v97 offset:57344
    ds_read_b64_tr_b16 v[70:71], v97 offset:58368
    ds_read_b64_tr_b16 v[72:73], v98 offset:57344
    v_mfma_f32_32x32x16_bf16 v[32:47], v[120:123], v[144:147], v[32:47]
    ds_read_b64_tr_b16 v[74:75], v98 offset:58368
    ds_read_b64_tr_b16 v[76:77], v99 offset:57344
    ds_read_b64_tr_b16 v[78:79], v99 offset:58368
    s_add_u32 m0, s69, 73728
    s_add_u32 s49, s69, 270336
    buffer_load_dwordx4 v163, s[16:19], s49 offen nt lds
    v_mfma_f32_32x32x16_bf16 v[48:63], v[124:127], v[144:147], v[48:63]
    ds_read_b128 v[156:159], v107 offset:0
    ds_read_b64_tr_b16 v[80:81], v96 offset:61440
    ds_read_b64_tr_b16 v[82:83], v96 offset:62464
    v_mfma_f32_32x32x16_bf16 v[0:15], v[128:131], v[148:151], v[0:15]
    ds_read_b64_tr_b16 v[84:85], v97 offset:61440
    ds_read_b64_tr_b16 v[86:87], v97 offset:62464
    ds_read_b64_tr_b16 v[88:89], v98 offset:61440
    v_mfma_f32_32x32x16_bf16 v[16:31], v[132:135], v[148:151], v[16:31]
    ds_read_b64_tr_b16 v[90:91], v98 offset:62464
    ds_read_b64_tr_b16 v[92:93], v99 offset:61440
    ds_read_b64_tr_b16 v[94:95], v99 offset:62464
    v_mfma_f32_32x32x16_bf16 v[32:47], v[136:139], v[148:151], v[32:47]
    v_mfma_f32_32x32x16_bf16 v[48:63], v[140:143], v[148:151], v[48:63]
    s_waitcnt vmcnt(5) lgkmcnt(0)
    s_barrier
    v_mfma_f32_32x32x16_bf16 v[0:15], v[64:67], v[152:155], v[0:15]
    ds_read_b128 v[144:147], v100 offset:0
    ds_read_b64_tr_b16 v[112:113], v96 offset:40960
    ds_read_b64_tr_b16 v[114:115], v96 offset:41984
    s_add_u32 s49, s34, s41
    s_mov_b32 m0, s39
    s_nop 0
    buffer_load_dwordx4 v108, s[8:11], s49 offen lds
    s_add_u32 s41, s41, 64
    s_and_b32 s41, s41, 1023
    v_mfma_f32_32x32x16_bf16 v[16:31], v[68:71], v[152:155], v[16:31]
    ds_read_b64_tr_b16 v[116:117], v97 offset:40960
    ds_read_b64_tr_b16 v[118:119], v97 offset:41984
    ds_read_b64_tr_b16 v[120:121], v98 offset:40960
    v_mfma_f32_32x32x16_bf16 v[32:47], v[72:75], v[152:155], v[32:47]
    ds_read_b64_tr_b16 v[122:123], v98 offset:41984
    ds_read_b64_tr_b16 v[124:125], v99 offset:40960
    ds_read_b64_tr_b16 v[126:127], v99 offset:41984
    s_add_u32 m0, s69, 77824
    s_add_u32 s49, s69, 274432
    buffer_load_dwordx4 v163, s[16:19], s49 offen nt lds
    v_mfma_f32_32x32x16_bf16 v[48:63], v[76:79], v[152:155], v[48:63]
    ds_read_b128 v[148:151], v101 offset:0
    ds_read_b64_tr_b16 v[128:129], v96 offset:45056
    ds_read_b64_tr_b16 v[130:131], v96 offset:46080
    v_mfma_f32_32x32x16_bf16 v[0:15], v[80:83], v[156:159], v[0:15]
    ds_read_b64_tr_b16 v[132:133], v97 offset:45056
    ds_read_b64_tr_b16 v[134:135], v97 offset:46080
    ds_read_b64_tr_b16 v[136:137], v98 offset:45056
    v_mfma_f32_32x32x16_bf16 v[16:31], v[84:87], v[156:159], v[16:31]
    ds_read_b64_tr_b16 v[138:139], v98 offset:46080
    ds_read_b64_tr_b16 v[140:141], v99 offset:45056
    ds_read_b64_tr_b16 v[142:143], v99 offset:46080
    v_mfma_f32_32x32x16_bf16 v[32:47], v[88:91], v[156:159], v[32:47]
    v_mfma_f32_32x32x16_bf16 v[48:63], v[92:95], v[156:159], v[48:63]
    s_waitcnt vmcnt(5) lgkmcnt(0)
    s_barrier
    v_mfma_f32_32x32x16_bf16 v[0:15], v[112:115], v[144:147], v[0:15]
    ds_read_b128 v[152:155], v102 offset:0
    ds_read_b64_tr_b16 v[64:65], v96 offset:49152
    ds_read_b64_tr_b16 v[66:67], v96 offset:50176
    s_add_u32 s49, s34, s41
    s_mov_b32 m0, s36
    s_nop 0
    buffer_load_dwordx4 v108, s[8:11], s49 offen lds
    s_add_u32 s41, s41, 64
    s_and_b32 s41, s41, 1023
    v_mfma_f32_32x32x16_bf16 v[16:31], v[116:119], v[144:147], v[16:31]
    ds_read_b64_tr_b16 v[68:69], v97 offset:49152
    ds_read_b64_tr_b16 v[70:71], v97 offset:50176
    ds_read_b64_tr_b16 v[72:73], v98 offset:49152
    v_mfma_f32_32x32x16_bf16 v[32:47], v[120:123], v[144:147], v[32:47]
    ds_read_b64_tr_b16 v[74:75], v98 offset:50176
    ds_read_b64_tr_b16 v[76:77], v99 offset:49152
    ds_read_b64_tr_b16 v[78:79], v99 offset:50176
    v_mfma_f32_32x32x16_bf16 v[48:63], v[124:127], v[144:147], v[48:63]
    ds_read_b128 v[156:159], v103 offset:0
    ds_read_b64_tr_b16 v[80:81], v96 offset:53248
    ds_read_b64_tr_b16 v[82:83], v96 offset:54272
    v_mfma_f32_32x32x16_bf16 v[0:15], v[128:131], v[148:151], v[0:15]
    ds_read_b64_tr_b16 v[84:85], v97 offset:53248
    ds_read_b64_tr_b16 v[86:87], v97 offset:54272
    ds_read_b64_tr_b16 v[88:89], v98 offset:53248
    v_mfma_f32_32x32x16_bf16 v[16:31], v[132:135], v[148:151], v[16:31]
    ds_read_b64_tr_b16 v[90:91], v98 offset:54272
    ds_read_b64_tr_b16 v[92:93], v99 offset:53248
    ds_read_b64_tr_b16 v[94:95], v99 offset:54272
    v_mfma_f32_32x32x16_bf16 v[32:47], v[136:139], v[148:151], v[32:47]
    v_mfma_f32_32x32x16_bf16 v[48:63], v[140:143], v[148:151], v[48:63]
    s_waitcnt vmcnt(4) lgkmcnt(0)
    s_barrier
    v_mfma_f32_32x32x16_bf16 v[0:15], v[64:67], v[152:155], v[0:15]
    ds_read_b128 v[144:147], v104 offset:0
    ds_read_b64_tr_b16 v[112:113], v96 offset:24576
    ds_read_b64_tr_b16 v[114:115], v96 offset:25600
    s_add_u32 s49, s34, s41
    s_mov_b32 m0, s37
    s_nop 0
    buffer_load_dwordx4 v108, s[8:11], s49 offen lds
    s_add_u32 s41, s41, 64
    s_and_b32 s41, s41, 1023
    v_mfma_f32_32x32x16_bf16 v[16:31], v[68:71], v[152:155], v[16:31]
    ds_read_b64_tr_b16 v[116:117], v97 offset:24576
    ds_read_b64_tr_b16 v[118:119], v97 offset:25600
    ds_read_b64_tr_b16 v[120:121], v98 offset:24576
    v_mfma_f32_32x32x16_bf16 v[32:47], v[72:75], v[152:155], v[32:47]
    ds_read_b64_tr_b16 v[122:123], v98 offset:25600
    ds_read_b64_tr_b16 v[124:125], v99 offset:24576
    ds_read_b64_tr_b16 v[126:127], v99 offset:25600
    v_mfma_f32_32x32x16_bf16 v[48:63], v[76:79], v[152:155], v[48:63]
    ds_read_b128 v[148:151], v105 offset:0
    ds_read_b64_tr_b16 v[128:129], v96 offset:28672
    ds_read_b64_tr_b16 v[130:131], v96 offset:29696
    v_mfma_f32_32x32x16_bf16 v[0:15], v[80:83], v[156:159], v[0:15]
    ds_read_b64_tr_b16 v[132:133], v97 offset:28672
    ds_read_b64_tr_b16 v[134:135], v97 offset:29696
    ds_read_b64_tr_b16 v[136:137], v98 offset:28672
    v_mfma_f32_32x32x16_bf16 v[16:31], v[84:87], v[156:159], v[16:31]
    ds_read_b64_tr_b16 v[138:139], v98 offset:29696
    ds_read_b64_tr_b16 v[140:141], v99 offset:28672
    ds_read_b64_tr_b16 v[142:143], v99 offset:29696
    v_mfma_f32_32x32x16_bf16 v[32:47], v[88:91], v[156:159], v[32:47]
    v_mfma_f32_32x32x16_bf16 v[48:63], v[92:95], v[156:159], v[48:63]
    s_waitcnt vmcnt(3) lgkmcnt(0)
    s_barrier
    v_mfma_f32_32x32x16_bf16 v[0:15], v[112:115], v[144:147], v[0:15]
    ds_read_b128 v[152:155], v106 offset:0
    ds_read_b64_tr_b16 v[64:65], v96 offset:57344
    ds_read_b64_tr_b16 v[66:67], v96 offset:58368
    s_add_u32 s49, s34, s41
    s_mov_b32 m0, s38
    s_nop 0
    buffer_load_dwordx4 v108, s[8:11], s49 offen lds
    s_add_u32 s41, s41, 64
    s_and_b32 s41, s41, 1023
    v_mfma_f32_32x32x16_bf16 v[16:31], v[116:119], v[144:147], v[16:31]
    ds_read_b64_tr_b16 v[68:69], v97 offset:57344
    ds_read_b64_tr_b16 v[70:71], v97 offset:58368
    ds_read_b64_tr_b16 v[72:73], v98 offset:57344
    v_mfma_f32_32x32x16_bf16 v[32:47], v[120:123], v[144:147], v[32:47]
    ds_read_b64_tr_b16 v[74:75], v98 offset:58368
    ds_read_b64_tr_b16 v[76:77], v99 offset:57344
    ds_read_b64_tr_b16 v[78:79], v99 offset:58368
    v_mfma_f32_32x32x16_bf16 v[48:63], v[124:127], v[144:147], v[48:63]
    ds_read_b128 v[156:159], v107 offset:0
    ds_read_b64_tr_b16 v[80:81], v96 offset:61440
    ds_read_b64_tr_b16 v[82:83], v96 offset:62464
    v_mfma_f32_32x32x16_bf16 v[0:15], v[128:131], v[148:151], v[0:15]
    ds_read_b64_tr_b16 v[84:85], v97 offset:61440
    ds_read_b64_tr_b16 v[86:87], v97 offset:62464
    ds_read_b64_tr_b16 v[88:89], v98 offset:61440
    v_mfma_f32_32x32x16_bf16 v[16:31], v[132:135], v[148:151], v[16:31]
    ds_read_b64_tr_b16 v[90:91], v98 offset:62464
    ds_read_b64_tr_b16 v[92:93], v99 offset:61440
    ds_read_b64_tr_b16 v[94:95], v99 offset:62464
    v_mfma_f32_32x32x16_bf16 v[32:47], v[136:139], v[148:151], v[32:47]
    v_mfma_f32_32x32x16_bf16 v[48:63], v[140:143], v[148:151], v[48:63]
    s_waitcnt vmcnt(2) lgkmcnt(0)
    s_barrier
    v_mfma_f32_32x32x16_bf16 v[0:15], v[64:67], v[152:155], v[0:15]
    ds_read_b128 v[144:147], v100 offset:0
    ds_read_b64_tr_b16 v[112:113], v96 offset:40960
    ds_read_b64_tr_b16 v[114:115], v96 offset:41984
    s_add_u32 s49, s34, s41
    s_mov_b32 m0, s39
    s_nop 0
    buffer_load_dwordx4 v108, s[8:11], s49 offen lds
    s_add_u32 s41, s41, 64
    s_and_b32 s41, s41, 1023
    v_mfma_f32_32x32x16_bf16 v[16:31], v[68:71], v[152:155], v[16:31]
    ds_read_b64_tr_b16 v[116:117], v97 offset:40960
    ds_read_b64_tr_b16 v[118:119], v97 offset:41984
    ds_read_b64_tr_b16 v[120:121], v98 offset:40960
    v_mfma_f32_32x32x16_bf16 v[32:47], v[72:75], v[152:155], v[32:47]
    ds_read_b64_tr_b16 v[122:123], v98 offset:41984
    ds_read_b64_tr_b16 v[124:125], v99 offset:40960
    ds_read_b64_tr_b16 v[126:127], v99 offset:41984
    v_mfma_f32_32x32x16_bf16 v[48:63], v[76:79], v[152:155], v[48:63]
    ds_read_b128 v[148:151], v101 offset:0
    ds_read_b64_tr_b16 v[128:129], v96 offset:45056
    ds_read_b64_tr_b16 v[130:131], v96 offset:46080
    v_mfma_f32_32x32x16_bf16 v[0:15], v[80:83], v[156:159], v[0:15]
    ds_read_b64_tr_b16 v[132:133], v97 offset:45056
    ds_read_b64_tr_b16 v[134:135], v97 offset:46080
    ds_read_b64_tr_b16 v[136:137], v98 offset:45056
    v_mfma_f32_32x32x16_bf16 v[16:31], v[84:87], v[156:159], v[16:31]
    ds_read_b64_tr_b16 v[138:139], v98 offset:46080
    ds_read_b64_tr_b16 v[140:141], v99 offset:45056
    ds_read_b64_tr_b16 v[142:143], v99 offset:46080
    v_mfma_f32_32x32x16_bf16 v[32:47], v[88:91], v[156:159], v[32:47]
    v_mfma_f32_32x32x16_bf16 v[48:63], v[92:95], v[156:159], v[48:63]
    s_waitcnt vmcnt(2) lgkmcnt(0)
    s_barrier
    v_mfma_f32_32x32x16_bf16 v[0:15], v[112:115], v[144:147], v[0:15]
    ds_read_b128 v[152:155], v102 offset:0
    ds_read_b64_tr_b16 v[64:65], v96 offset:49152
    ds_read_b64_tr_b16 v[66:67], v96 offset:50176
    v_mfma_f32_32x32x16_bf16 v[16:31], v[116:119], v[144:147], v[16:31]
    ds_read_b64_tr_b16 v[68:69], v97 offset:49152
    ds_read_b64_tr_b16 v[70:71], v97 offset:50176
    ds_read_b64_tr_b16 v[72:73], v98 offset:49152
    v_mfma_f32_32x32x16_bf16 v[32:47], v[120:123], v[144:147], v[32:47]
    ds_read_b64_tr_b16 v[74:75], v98 offset:50176
    ds_read_b64_tr_b16 v[76:77], v99 offset:49152
    ds_read_b64_tr_b16 v[78:79], v99 offset:50176
    v_mfma_f32_32x32x16_bf16 v[48:63], v[124:127], v[144:147], v[48:63]
    ds_read_b128 v[156:159], v103 offset:0
    ds_read_b64_tr_b16 v[80:81], v96 offset:53248
    ds_read_b64_tr_b16 v[82:83], v96 offset:54272
    v_mfma_f32_32x32x16_bf16 v[0:15], v[128:131], v[148:151], v[0:15]
    ds_read_b64_tr_b16 v[84:85], v97 offset:53248
    ds_read_b64_tr_b16 v[86:87], v97 offset:54272
    ds_read_b64_tr_b16 v[88:89], v98 offset:53248
    v_mfma_f32_32x32x16_bf16 v[16:31], v[132:135], v[148:151], v[16:31]
    ds_read_b64_tr_b16 v[90:91], v98 offset:54272
    ds_read_b64_tr_b16 v[92:93], v99 offset:53248
    ds_read_b64_tr_b16 v[94:95], v99 offset:54272
    v_mfma_f32_32x32x16_bf16 v[32:47], v[136:139], v[148:151], v[32:47]
    v_mfma_f32_32x32x16_bf16 v[48:63], v[140:143], v[148:151], v[48:63]
    s_waitcnt vmcnt(1) lgkmcnt(0)
    s_barrier
    v_mfma_f32_32x32x16_bf16 v[0:15], v[64:67], v[152:155], v[0:15]
    ds_read_b128 v[144:147], v104 offset:0
    ds_read_b64_tr_b16 v[112:113], v96 offset:24576
    ds_read_b64_tr_b16 v[114:115], v96 offset:25600
    v_mfma_f32_32x32x16_bf16 v[16:31], v[68:71], v[152:155], v[16:31]
    ds_read_b64_tr_b16 v[116:117], v97 offset:24576
    ds_read_b64_tr_b16 v[118:119], v97 offset:25600
    ds_read_b64_tr_b16 v[120:121], v98 offset:24576
    v_mfma_f32_32x32x16_bf16 v[32:47], v[72:75], v[152:155], v[32:47]
    ds_read_b64_tr_b16 v[122:123], v98 offset:25600
    ds_read_b64_tr_b16 v[124:125], v99 offset:24576
    ds_read_b64_tr_b16 v[126:127], v99 offset:25600
    v_mfma_f32_32x32x16_bf16 v[48:63], v[76:79], v[152:155], v[48:63]
    ds_read_b128 v[148:151], v105 offset:0
    ds_read_b64_tr_b16 v[128:129], v96 offset:28672
    ds_read_b64_tr_b16 v[130:131], v96 offset:29696
    v_mfma_f32_32x32x16_bf16 v[0:15], v[80:83], v[156:159], v[0:15]
    ds_read_b64_tr_b16 v[132:133], v97 offset:28672
    ds_read_b64_tr_b16 v[134:135], v97 offset:29696
    ds_read_b64_tr_b16 v[136:137], v98 offset:28672
    v_mfma_f32_32x32x16_bf16 v[16:31], v[84:87], v[156:159], v[16:31]
    ds_read_b64_tr_b16 v[138:139], v98 offset:29696
    ds_read_b64_tr_b16 v[140:141], v99 offset:28672
    ds_read_b64_tr_b16 v[142:143], v99 offset:29696
    v_mfma_f32_32x32x16_bf16 v[32:47], v[88:91], v[156:159], v[32:47]
    v_mfma_f32_32x32x16_bf16 v[48:63], v[92:95], v[156:159], v[48:63]
    s_waitcnt vmcnt(0) lgkmcnt(0)
    s_barrier
    v_mfma_f32_32x32x16_bf16 v[0:15], v[112:115], v[144:147], v[0:15]
    ds_read_b128 v[152:155], v106 offset:0
    ds_read_b64_tr_b16 v[64:65], v96 offset:57344
    ds_read_b64_tr_b16 v[66:67], v96 offset:58368
    v_mfma_f32_32x32x16_bf16 v[16:31], v[116:119], v[144:147], v[16:31]
    ds_read_b64_tr_b16 v[68:69], v97 offset:57344
    ds_read_b64_tr_b16 v[70:71], v97 offset:58368
    ds_read_b64_tr_b16 v[72:73], v98 offset:57344
    v_mfma_f32_32x32x16_bf16 v[32:47], v[120:123], v[144:147], v[32:47]
    ds_read_b64_tr_b16 v[74:75], v98 offset:58368
    ds_read_b64_tr_b16 v[76:77], v99 offset:57344
    ds_read_b64_tr_b16 v[78:79], v99 offset:58368
    v_mfma_f32_32x32x16_bf16 v[48:63], v[124:127], v[144:147], v[48:63]
    ds_read_b128 v[156:159], v107 offset:0
    ds_read_b64_tr_b16 v[80:81], v96 offset:61440
    ds_read_b64_tr_b16 v[82:83], v96 offset:62464
    v_mfma_f32_32x32x16_bf16 v[0:15], v[128:131], v[148:151], v[0:15]
    ds_read_b64_tr_b16 v[84:85], v97 offset:61440
    ds_read_b64_tr_b16 v[86:87], v97 offset:62464
    ds_read_b64_tr_b16 v[88:89], v98 offset:61440
    v_mfma_f32_32x32x16_bf16 v[16:31], v[132:135], v[148:151], v[16:31]
    ds_read_b64_tr_b16 v[90:91], v98 offset:62464
    ds_read_b64_tr_b16 v[92:93], v99 offset:61440
    ds_read_b64_tr_b16 v[94:95], v99 offset:62464
    v_mfma_f32_32x32x16_bf16 v[32:47], v[136:139], v[148:151], v[32:47]
    v_mfma_f32_32x32x16_bf16 v[48:63], v[140:143], v[148:151], v[48:63]
    s_waitcnt lgkmcnt(0)
    s_barrier
    v_mfma_f32_32x32x16_bf16 v[0:15], v[64:67], v[152:155], v[0:15]
    v_mfma_f32_32x32x16_bf16 v[16:31], v[68:71], v[152:155], v[16:31]
    v_mfma_f32_32x32x16_bf16 v[32:47], v[72:75], v[152:155], v[32:47]
    v_mfma_f32_32x32x16_bf16 v[48:63], v[76:79], v[152:155], v[48:63]
    v_mfma_f32_32x32x16_bf16 v[0:15], v[80:83], v[156:159], v[0:15]
    v_mfma_f32_32x32x16_bf16 v[16:31], v[84:87], v[156:159], v[16:31]
    v_mfma_f32_32x32x16_bf16 v[32:47], v[88:91], v[156:159], v[32:47]
    v_mfma_f32_32x32x16_bf16 v[48:63], v[92:95], v[156:159], v[48:63]
    s_waitcnt lgkmcnt(0)
    s_nop 7
    v_cvt_pk_bf16_f32 v64, v0, v1
    v_cvt_pk_bf16_f32 v65, v2, v3
    v_cvt_pk_bf16_f32 v66, v4, v5
    v_cvt_pk_bf16_f32 v67, v6, v7
    v_cvt_pk_bf16_f32 v68, v8, v9
    v_cvt_pk_bf16_f32 v69, v10, v11
    v_cvt_pk_bf16_f32 v70, v12, v13
    v_cvt_pk_bf16_f32 v71, v14, v15
    v_cvt_pk_bf16_f32 v72, v16, v17
    v_cvt_pk_bf16_f32 v73, v18, v19
    v_cvt_pk_bf16_f32 v74, v20, v21
    v_cvt_pk_bf16_f32 v75, v22, v23
    v_cvt_pk_bf16_f32 v76, v24, v25
    v_cvt_pk_bf16_f32 v77, v26, v27
    v_cvt_pk_bf16_f32 v78, v28, v29
    v_cvt_pk_bf16_f32 v79, v30, v31
    v_cvt_pk_bf16_f32 v80, v32, v33
    v_cvt_pk_bf16_f32 v81, v34, v35
    v_cvt_pk_bf16_f32 v82, v36, v37
    v_cvt_pk_bf16_f32 v83, v38, v39
    v_cvt_pk_bf16_f32 v84, v40, v41
    v_cvt_pk_bf16_f32 v85, v42, v43
    v_cvt_pk_bf16_f32 v86, v44, v45
    v_cvt_pk_bf16_f32 v87, v46, v47
    v_cvt_pk_bf16_f32 v88, v48, v49
    v_cvt_pk_bf16_f32 v89, v50, v51
    v_cvt_pk_bf16_f32 v90, v52, v53
    v_cvt_pk_bf16_f32 v91, v54, v55
    v_cvt_pk_bf16_f32 v92, v56, v57
    v_cvt_pk_bf16_f32 v93, v58, v59
    v_cvt_pk_bf16_f32 v94, v60, v61
    v_cvt_pk_bf16_f32 v95, v62, v63
    v_and_b32 v8, 31, v166
    v_lshrrev_b32 v9, 5, v166
    v_bfe_u32 v10, v166, 4, 1
    v_bfe_u32 v11, v166, 2, 2
    v_and_b32 v12, 3, v166
    s_lshl_b32 s3, s29, 16
    v_and_b32 v13, 15, v8
    v_xor_b32 v13, v13, v9
    v_lshlrev_b32 v13, 4, v13
    v_lshl_add_u32 v13, v8, 8, v13
    v_add_u32 v13, s3, v13
    v_xor_b32 v144, 0, v13
    v_xor_b32 v145, 32, v13
    v_xor_b32 v146, 64, v13
    v_xor_b32 v147, 96, v13
    v_xor_b32 v148, 128, v13
    v_xor_b32 v149, 160, v13
    v_xor_b32 v150, 192, v13
    v_xor_b32 v151, 224, v13
    v_lshl_add_u32 v13, v9, 2, v11
    v_lshlrev_b32 v13, 8, v13
    v_lshl_add_u32 v13, v11, 6, v13
    v_lshl_add_u32 v13, v10, 5, v13
    v_lshl_add_u32 v13, v12, 3, v13
    v_add_u32 v13, s3, v13
    v_xor_b32 v152, 0, v13
    v_xor_b32 v153, 64, v13
    v_xor_b32 v154, 128, v13
    v_xor_b32 v155, 192, v13
    v_mov_b32 v156, 0xf149f2ca
    v_mov_b32 v157, 0xf149f2ca
    v_mov_b32 v158, 0
    v_mov_b32 v159, 0
    v_mov_b32 v160, 0
    s_waitcnt vmcnt(0) lgkmcnt(0)
    s_barrier
    s_barrier
    ds_read_b128 v[112:115], v144 offset:0
    ds_read_b128 v[116:119], v145 offset:0
    ds_read_b128 v[120:123], v146 offset:0
    ds_read_b128 v[124:127], v147 offset:0
    ds_read_b128 v[128:131], v148 offset:0
    ds_read_b128 v[132:135], v149 offset:0
    ds_read_b128 v[136:139], v150 offset:0
    ds_read_b128 v[140:143], v151 offset:0
    s_waitcnt lgkmcnt(7)
    v_mfma_f32_32x32x16_bf16 v[96:111], v[112:115], v[64:67], 0
    ds_read_b64_tr_b16 v[112:113], v152 offset:32768
    ds_read_b64_tr_b16 v[114:115], v152 offset:34816
    s_waitcnt lgkmcnt(8)
    v_mfma_f32_32x32x16_bf16 v[96:111], v[116:119], v[68:71], v[96:111]
    ds_read_b64_tr_b16 v[116:117], v153 offset:32768
    ds_read_b64_tr_b16 v[118:119], v153 offset:34816
    s_waitcnt lgkmcnt(9)
    v_mfma_f32_32x32x16_bf16 v[96:111], v[120:123], v[72:75], v[96:111]
    ds_read_b64_tr_b16 v[120:121], v154 offset:32768
    ds_read_b64_tr_b16 v[122:123], v154 offset:34816
    s_waitcnt lgkmcnt(10)
    v_mfma_f32_32x32x16_bf16 v[96:111], v[124:127], v[76:79], v[96:111]
    ds_read_b64_tr_b16 v[124:125], v155 offset:32768
    ds_read_b64_tr_b16 v[126:127], v155 offset:34816
    s_waitcnt lgkmcnt(11)
    v_mfma_f32_32x32x16_bf16 v[96:111], v[128:131], v[80:83], v[96:111]
    ds_read_b64_tr_b16 v[128:129], v152 offset:36864
    ds_read_b64_tr_b16 v[130:131], v152 offset:38912
    s_waitcnt lgkmcnt(12)
    v_mfma_f32_32x32x16_bf16 v[96:111], v[132:135], v[84:87], v[96:111]
    ds_read_b64_tr_b16 v[132:133], v153 offset:36864
    ds_read_b64_tr_b16 v[134:135], v153 offset:38912
    s_waitcnt lgkmcnt(13)
    v_mfma_f32_32x32x16_bf16 v[96:111], v[136:139], v[88:91], v[96:111]
    ds_read_b64_tr_b16 v[136:137], v154 offset:36864
    ds_read_b64_tr_b16 v[138:139], v154 offset:38912
    s_waitcnt lgkmcnt(14)
    v_mfma_f32_32x32x16_bf16 v[96:111], v[140:143], v[92:95], v[96:111]
    ds_read_b64_tr_b16 v[140:141], v155 offset:36864
    ds_read_b64_tr_b16 v[142:143], v155 offset:38912
    s_waitcnt lgkmcnt(0)
    s_barrier
    s_nop 7
    v_max3_f32 v161, v96, v97, v98
    v_max3_f32 v162, v99, v100, v101
    v_max3_f32 v161, v161, v102, v103
    v_max3_f32 v162, v162, v104, v105
    v_max3_f32 v161, v161, v106, v107
    v_max3_f32 v162, v162, v108, v109
    v_max3_f32 v161, v161, v110, v111
    v_max_f32 v161, v161, v162
    v_cmp_gt_f32 vcc, v161, v157
    s_cbranch_vccnz K1_SLOWr2p1
K1_RETr2p1:
    v_fma_f32 v96, v96, s31, v158
    v_fma_f32 v97, v97, s31, v158
    v_fma_f32 v98, v98, s31, v158
    v_fma_f32 v99, v99, s31, v158
    v_fma_f32 v100, v100, s31, v158
    v_fma_f32 v101, v101, s31, v158
    v_fma_f32 v102, v102, s31, v158
    v_fma_f32 v103, v103, s31, v158
    v_fma_f32 v104, v104, s31, v158
    v_fma_f32 v105, v105, s31, v158
    v_fma_f32 v106, v106, s31, v158
    v_fma_f32 v107, v107, s31, v158
    v_fma_f32 v108, v108, s31, v158
    v_fma_f32 v109, v109, s31, v158
    v_fma_f32 v110, v110, s31, v158
    v_fma_f32 v111, v111, s31, v158
    v_exp_f32 v96, v96
    v_exp_f32 v97, v97
    v_exp_f32 v98, v98
    v_exp_f32 v99, v99
    v_exp_f32 v100, v100
    v_exp_f32 v101, v101
    v_exp_f32 v102, v102
    v_exp_f32 v103, v103
    v_exp_f32 v104, v104
    v_exp_f32 v105, v105
    v_exp_f32 v106, v106
    v_exp_f32 v107, v107
    v_exp_f32 v108, v108
    v_exp_f32 v109, v109
    v_exp_f32 v110, v110
    v_exp_f32 v111, v111
    v_add_f32 v159, v159, v96
    v_add_f32 v160, v160, v97
    v_cvt_pk_bf16_f32 v96, v96, v97
    v_add_f32 v159, v159, v98
    v_add_f32 v160, v160, v99
    v_cvt_pk_bf16_f32 v97, v98, v99
    v_add_f32 v159, v159, v100
    v_add_f32 v160, v160, v101
    v_cvt_pk_bf16_f32 v98, v100, v101
    v_add_f32 v159, v159, v102
    v_add_f32 v160, v160, v103
    v_cvt_pk_bf16_f32 v99, v102, v103
    v_add_f32 v159, v159, v104
    v_add_f32 v160, v160, v105
    v_cvt_pk_bf16_f32 v100, v104, v105
    v_add_f32 v159, v159, v106
    v_add_f32 v160, v160, v107
    v_cvt_pk_bf16_f32 v101, v106, v107
    v_add_f32 v159, v159, v108
    v_add_f32 v160, v160, v109
    v_cvt_pk_bf16_f32 v102, v108, v109
    v_add_f32 v159, v159, v110
    v_add_f32 v160, v160, v111
    v_cvt_pk_bf16_f32 v103, v110, v111
    v_mfma_f32_32x32x16_bf16 v[0:15], v[112:115], v[96:99], 0
    ds_read_b128 v[112:115], v144 offset:8192
    v_mfma_f32_32x32x16_bf16 v[16:31], v[116:119], v[96:99], 0
    ds_read_b128 v[116:119], v145 offset:8192
    v_mfma_f32_32x32x16_bf16 v[32:47], v[120:123], v[96:99], 0
    ds_read_b128 v[120:123], v146 offset:8192
    v_mfma_f32_32x32x16_bf16 v[48:63], v[124:127], v[96:99], 0
    ds_read_b128 v[124:127], v147 offset:8192
    v_mfma_f32_32x32x16_bf16 v[0:15], v[128:131], v[100:103], v[0:15]
    ds_read_b128 v[128:131], v148 offset:8192
    v_mfma_f32_32x32x16_bf16 v[16:31], v[132:135], v[100:103], v[16:31]
    ds_read_b128 v[132:135], v149 offset:8192
    v_mfma_f32_32x32x16_bf16 v[32:47], v[136:139], v[100:103], v[32:47]
    ds_read_b128 v[136:139], v150 offset:8192
    v_mfma_f32_32x32x16_bf16 v[48:63], v[140:143], v[100:103], v[48:63]
    ds_read_b128 v[140:143], v151 offset:8192
    s_waitcnt lgkmcnt(7)
    v_mfma_f32_32x32x16_bf16 v[96:111], v[112:115], v[64:67], 0
    ds_read_b64_tr_b16 v[112:113], v152 offset:40960
    ds_read_b64_tr_b16 v[114:115], v152 offset:43008
    s_waitcnt lgkmcnt(8)
    v_mfma_f32_32x32x16_bf16 v[96:111], v[116:119], v[68:71], v[96:111]
    ds_read_b64_tr_b16 v[116:117], v153 offset:40960
    ds_read_b64_tr_b16 v[118:119], v153 offset:43008
    s_waitcnt lgkmcnt(9)
    v_mfma_f32_32x32x16_bf16 v[96:111], v[120:123], v[72:75], v[96:111]
    ds_read_b64_tr_b16 v[120:121], v154 offset:40960
    ds_read_b64_tr_b16 v[122:123], v154 offset:43008
    s_waitcnt lgkmcnt(10)
    v_mfma_f32_32x32x16_bf16 v[96:111], v[124:127], v[76:79], v[96:111]
    ds_read_b64_tr_b16 v[124:125], v155 offset:40960
    ds_read_b64_tr_b16 v[126:127], v155 offset:43008
    s_waitcnt lgkmcnt(11)
    v_mfma_f32_32x32x16_bf16 v[96:111], v[128:131], v[80:83], v[96:111]
    ds_read_b64_tr_b16 v[128:129], v152 offset:45056
    ds_read_b64_tr_b16 v[130:131], v152 offset:47104
    s_waitcnt lgkmcnt(12)
    v_mfma_f32_32x32x16_bf16 v[96:111], v[132:135], v[84:87], v[96:111]
    ds_read_b64_tr_b16 v[132:133], v153 offset:45056
    ds_read_b64_tr_b16 v[134:135], v153 offset:47104
    s_waitcnt lgkmcnt(13)
    v_mfma_f32_32x32x16_bf16 v[96:111], v[136:139], v[88:91], v[96:111]
    ds_read_b64_tr_b16 v[136:137], v154 offset:45056
    ds_read_b64_tr_b16 v[138:139], v154 offset:47104
    s_waitcnt lgkmcnt(14)
    v_mfma_f32_32x32x16_bf16 v[96:111], v[140:143], v[92:95], v[96:111]
    ds_read_b64_tr_b16 v[140:141], v155 offset:45056
    ds_read_b64_tr_b16 v[142:143], v155 offset:47104
    s_waitcnt lgkmcnt(0)
    s_barrier
    s_nop 7
    v_max3_f32 v161, v96, v97, v98
    v_max3_f32 v162, v99, v100, v101
    v_max3_f32 v161, v161, v102, v103
    v_max3_f32 v162, v162, v104, v105
    v_max3_f32 v161, v161, v106, v107
    v_max3_f32 v162, v162, v108, v109
    v_max3_f32 v161, v161, v110, v111
    v_max_f32 v161, v161, v162
    v_cmp_gt_f32 vcc, v161, v157
    s_cbranch_vccnz K1_SLOWr2p2
K1_RETr2p2:
    v_fma_f32 v96, v96, s31, v158
    v_fma_f32 v97, v97, s31, v158
    v_fma_f32 v98, v98, s31, v158
    v_fma_f32 v99, v99, s31, v158
    v_fma_f32 v100, v100, s31, v158
    v_fma_f32 v101, v101, s31, v158
    v_fma_f32 v102, v102, s31, v158
    v_fma_f32 v103, v103, s31, v158
    v_fma_f32 v104, v104, s31, v158
    v_fma_f32 v105, v105, s31, v158
    v_fma_f32 v106, v106, s31, v158
    v_fma_f32 v107, v107, s31, v158
    v_fma_f32 v108, v108, s31, v158
    v_fma_f32 v109, v109, s31, v158
    v_fma_f32 v110, v110, s31, v158
    v_fma_f32 v111, v111, s31, v158
    v_exp_f32 v96, v96
    v_exp_f32 v97, v97
    v_exp_f32 v98, v98
    v_exp_f32 v99, v99
    v_exp_f32 v100, v100
    v_exp_f32 v101, v101
    v_exp_f32 v102, v102
    v_exp_f32 v103, v103
    v_exp_f32 v104, v104
    v_exp_f32 v105, v105
    v_exp_f32 v106, v106
    v_exp_f32 v107, v107
    v_exp_f32 v108, v108
    v_exp_f32 v109, v109
    v_exp_f32 v110, v110
    v_exp_f32 v111, v111
    v_add_f32 v159, v159, v96
    v_add_f32 v160, v160, v97
    v_cvt_pk_bf16_f32 v96, v96, v97
    v_add_f32 v159, v159, v98
    v_add_f32 v160, v160, v99
    v_cvt_pk_bf16_f32 v97, v98, v99
    v_add_f32 v159, v159, v100
    v_add_f32 v160, v160, v101
    v_cvt_pk_bf16_f32 v98, v100, v101
    v_add_f32 v159, v159, v102
    v_add_f32 v160, v160, v103
    v_cvt_pk_bf16_f32 v99, v102, v103
    v_add_f32 v159, v159, v104
    v_add_f32 v160, v160, v105
    v_cvt_pk_bf16_f32 v100, v104, v105
    v_add_f32 v159, v159, v106
    v_add_f32 v160, v160, v107
    v_cvt_pk_bf16_f32 v101, v106, v107
    v_add_f32 v159, v159, v108
    v_add_f32 v160, v160, v109
    v_cvt_pk_bf16_f32 v102, v108, v109
    v_add_f32 v159, v159, v110
    v_add_f32 v160, v160, v111
    v_cvt_pk_bf16_f32 v103, v110, v111
    v_mfma_f32_32x32x16_bf16 v[0:15], v[112:115], v[96:99], v[0:15]
    ds_read_b128 v[112:115], v144 offset:16384
    v_mfma_f32_32x32x16_bf16 v[16:31], v[116:119], v[96:99], v[16:31]
    ds_read_b128 v[116:119], v145 offset:16384
    v_mfma_f32_32x32x16_bf16 v[32:47], v[120:123], v[96:99], v[32:47]
    ds_read_b128 v[120:123], v146 offset:16384
    v_mfma_f32_32x32x16_bf16 v[48:63], v[124:127], v[96:99], v[48:63]
    ds_read_b128 v[124:127], v147 offset:16384
    v_mfma_f32_32x32x16_bf16 v[0:15], v[128:131], v[100:103], v[0:15]
    ds_read_b128 v[128:131], v148 offset:16384
    v_mfma_f32_32x32x16_bf16 v[16:31], v[132:135], v[100:103], v[16:31]
    ds_read_b128 v[132:135], v149 offset:16384
    v_mfma_f32_32x32x16_bf16 v[32:47], v[136:139], v[100:103], v[32:47]
    ds_read_b128 v[136:139], v150 offset:16384
    v_mfma_f32_32x32x16_bf16 v[48:63], v[140:143], v[100:103], v[48:63]
    ds_read_b128 v[140:143], v151 offset:16384
    s_waitcnt lgkmcnt(7)
    v_mfma_f32_32x32x16_bf16 v[96:111], v[112:115], v[64:67], 0
    ds_read_b64_tr_b16 v[112:113], v152 offset:49152
    ds_read_b64_tr_b16 v[114:115], v152 offset:51200
    s_waitcnt lgkmcnt(8)
    v_mfma_f32_32x32x16_bf16 v[96:111], v[116:119], v[68:71], v[96:111]
    ds_read_b64_tr_b16 v[116:117], v153 offset:49152
    ds_read_b64_tr_b16 v[118:119], v153 offset:51200
    s_waitcnt lgkmcnt(9)
    v_mfma_f32_32x32x16_bf16 v[96:111], v[120:123], v[72:75], v[96:111]
    ds_read_b64_tr_b16 v[120:121], v154 offset:49152
    ds_read_b64_tr_b16 v[122:123], v154 offset:51200
    s_waitcnt lgkmcnt(10)
    v_mfma_f32_32x32x16_bf16 v[96:111], v[124:127], v[76:79], v[96:111]
    ds_read_b64_tr_b16 v[124:125], v155 offset:49152
    ds_read_b64_tr_b16 v[126:127], v155 offset:51200
    s_waitcnt lgkmcnt(11)
    v_mfma_f32_32x32x16_bf16 v[96:111], v[128:131], v[80:83], v[96:111]
    ds_read_b64_tr_b16 v[128:129], v152 offset:53248
    ds_read_b64_tr_b16 v[130:131], v152 offset:55296
    s_waitcnt lgkmcnt(12)
    v_mfma_f32_32x32x16_bf16 v[96:111], v[132:135], v[84:87], v[96:111]
    ds_read_b64_tr_b16 v[132:133], v153 offset:53248
    ds_read_b64_tr_b16 v[134:135], v153 offset:55296
    s_waitcnt lgkmcnt(13)
    v_mfma_f32_32x32x16_bf16 v[96:111], v[136:139], v[88:91], v[96:111]
    ds_read_b64_tr_b16 v[136:137], v154 offset:53248
    ds_read_b64_tr_b16 v[138:139], v154 offset:55296
    s_waitcnt lgkmcnt(14)
    v_mfma_f32_32x32x16_bf16 v[96:111], v[140:143], v[92:95], v[96:111]
    ds_read_b64_tr_b16 v[140:141], v155 offset:53248
    ds_read_b64_tr_b16 v[142:143], v155 offset:55296
    s_waitcnt lgkmcnt(0)
    s_barrier
    s_nop 7
    v_max3_f32 v161, v96, v97, v98
    v_max3_f32 v162, v99, v100, v101
    v_max3_f32 v161, v161, v102, v103
    v_max3_f32 v162, v162, v104, v105
    v_max3_f32 v161, v161, v106, v107
    v_max3_f32 v162, v162, v108, v109
    v_max3_f32 v161, v161, v110, v111
    v_max_f32 v161, v161, v162
    v_cmp_gt_f32 vcc, v161, v157
    s_cbranch_vccnz K1_SLOWr2p3
K1_RETr2p3:
    v_fma_f32 v96, v96, s31, v158
    v_fma_f32 v97, v97, s31, v158
    v_fma_f32 v98, v98, s31, v158
    v_fma_f32 v99, v99, s31, v158
    v_fma_f32 v100, v100, s31, v158
    v_fma_f32 v101, v101, s31, v158
    v_fma_f32 v102, v102, s31, v158
    v_fma_f32 v103, v103, s31, v158
    v_fma_f32 v104, v104, s31, v158
    v_fma_f32 v105, v105, s31, v158
    v_fma_f32 v106, v106, s31, v158
    v_fma_f32 v107, v107, s31, v158
    v_fma_f32 v108, v108, s31, v158
    v_fma_f32 v109, v109, s31, v158
    v_fma_f32 v110, v110, s31, v158
    v_fma_f32 v111, v111, s31, v158
    v_exp_f32 v96, v96
    v_exp_f32 v97, v97
    v_exp_f32 v98, v98
    v_exp_f32 v99, v99
    v_exp_f32 v100, v100
    v_exp_f32 v101, v101
    v_exp_f32 v102, v102
    v_exp_f32 v103, v103
    v_exp_f32 v104, v104
    v_exp_f32 v105, v105
    v_exp_f32 v106, v106
    v_exp_f32 v107, v107
    v_exp_f32 v108, v108
    v_exp_f32 v109, v109
    v_exp_f32 v110, v110
    v_exp_f32 v111, v111
    v_add_f32 v159, v159, v96
    v_add_f32 v160, v160, v97
    v_cvt_pk_bf16_f32 v96, v96, v97
    v_add_f32 v159, v159, v98
    v_add_f32 v160, v160, v99
    v_cvt_pk_bf16_f32 v97, v98, v99
    v_add_f32 v159, v159, v100
    v_add_f32 v160, v160, v101
    v_cvt_pk_bf16_f32 v98, v100, v101
    v_add_f32 v159, v159, v102
    v_add_f32 v160, v160, v103
    v_cvt_pk_bf16_f32 v99, v102, v103
    v_add_f32 v159, v159, v104
    v_add_f32 v160, v160, v105
    v_cvt_pk_bf16_f32 v100, v104, v105
    v_add_f32 v159, v159, v106
    v_add_f32 v160, v160, v107
    v_cvt_pk_bf16_f32 v101, v106, v107
    v_add_f32 v159, v159, v108
    v_add_f32 v160, v160, v109
    v_cvt_pk_bf16_f32 v102, v108, v109
    v_add_f32 v159, v159, v110
    v_add_f32 v160, v160, v111
    v_cvt_pk_bf16_f32 v103, v110, v111
    v_mfma_f32_32x32x16_bf16 v[0:15], v[112:115], v[96:99], v[0:15]
    ds_read_b128 v[112:115], v144 offset:24576
    v_mfma_f32_32x32x16_bf16 v[16:31], v[116:119], v[96:99], v[16:31]
    ds_read_b128 v[116:119], v145 offset:24576
    v_mfma_f32_32x32x16_bf16 v[32:47], v[120:123], v[96:99], v[32:47]
    ds_read_b128 v[120:123], v146 offset:24576
    v_mfma_f32_32x32x16_bf16 v[48:63], v[124:127], v[96:99], v[48:63]
    ds_read_b128 v[124:127], v147 offset:24576
    v_mfma_f32_32x32x16_bf16 v[0:15], v[128:131], v[100:103], v[0:15]
    ds_read_b128 v[128:131], v148 offset:24576
    v_mfma_f32_32x32x16_bf16 v[16:31], v[132:135], v[100:103], v[16:31]
    ds_read_b128 v[132:135], v149 offset:24576
    v_mfma_f32_32x32x16_bf16 v[32:47], v[136:139], v[100:103], v[32:47]
    ds_read_b128 v[136:139], v150 offset:24576
    v_mfma_f32_32x32x16_bf16 v[48:63], v[140:143], v[100:103], v[48:63]
    ds_read_b128 v[140:143], v151 offset:24576
    s_waitcnt lgkmcnt(7)
    v_mfma_f32_32x32x16_bf16 v[96:111], v[112:115], v[64:67], 0
    ds_read_b64_tr_b16 v[112:113], v152 offset:57344
    ds_read_b64_tr_b16 v[114:115], v152 offset:59392
    s_waitcnt lgkmcnt(8)
    v_mfma_f32_32x32x16_bf16 v[96:111], v[116:119], v[68:71], v[96:111]
    ds_read_b64_tr_b16 v[116:117], v153 offset:57344
    ds_read_b64_tr_b16 v[118:119], v153 offset:59392
    s_waitcnt lgkmcnt(9)
    v_mfma_f32_32x32x16_bf16 v[96:111], v[120:123], v[72:75], v[96:111]
    ds_read_b64_tr_b16 v[120:121], v154 offset:57344
    ds_read_b64_tr_b16 v[122:123], v154 offset:59392
    s_waitcnt lgkmcnt(10)
    v_mfma_f32_32x32x16_bf16 v[96:111], v[124:127], v[76:79], v[96:111]
    ds_read_b64_tr_b16 v[124:125], v155 offset:57344
    ds_read_b64_tr_b16 v[126:127], v155 offset:59392
    s_waitcnt lgkmcnt(11)
    v_mfma_f32_32x32x16_bf16 v[96:111], v[128:131], v[80:83], v[96:111]
    ds_read_b64_tr_b16 v[128:129], v152 offset:61440
    ds_read_b64_tr_b16 v[130:131], v152 offset:63488
    s_waitcnt lgkmcnt(12)
    v_mfma_f32_32x32x16_bf16 v[96:111], v[132:135], v[84:87], v[96:111]
    ds_read_b64_tr_b16 v[132:133], v153 offset:61440
    ds_read_b64_tr_b16 v[134:135], v153 offset:63488
    s_waitcnt lgkmcnt(13)
    v_mfma_f32_32x32x16_bf16 v[96:111], v[136:139], v[88:91], v[96:111]
    ds_read_b64_tr_b16 v[136:137], v154 offset:61440
    ds_read_b64_tr_b16 v[138:139], v154 offset:63488
    s_waitcnt lgkmcnt(14)
    v_mfma_f32_32x32x16_bf16 v[96:111], v[140:143], v[92:95], v[96:111]
    ds_read_b64_tr_b16 v[140:141], v155 offset:61440
    ds_read_b64_tr_b16 v[142:143], v155 offset:63488
    s_waitcnt lgkmcnt(0)
    s_mov_b32 s50, 0
K1_LOOPr2:
    s_barrier
    s_nop 6
    v_max3_f32 v161, v96, v97, v98
    v_max3_f32 v162, v99, v100, v101
    v_max3_f32 v161, v161, v102, v103
    v_max3_f32 v162, v162, v104, v105
    v_max3_f32 v161, v161, v106, v107
    v_max3_f32 v162, v162, v108, v109
    v_max3_f32 v161, v161, v110, v111
    v_max_f32 v161, v161, v162
    v_cmp_gt_f32 vcc, v161, v157
    s_cbranch_vccnz K1_SLOWr2a0
K1_RETr2a0:
    v_fma_f32 v96, v96, s31, v158
    v_fma_f32 v97, v97, s31, v158
    v_fma_f32 v98, v98, s31, v158
    v_fma_f32 v99, v99, s31, v158
    v_fma_f32 v100, v100, s31, v158
    v_fma_f32 v101, v101, s31, v158
    v_fma_f32 v102, v102, s31, v158
    v_fma_f32 v103, v103, s31, v158
    v_fma_f32 v104, v104, s31, v158
    v_fma_f32 v105, v105, s31, v158
    v_fma_f32 v106, v106, s31, v158
    v_fma_f32 v107, v107, s31, v158
    v_fma_f32 v108, v108, s31, v158
    v_fma_f32 v109, v109, s31, v158
    v_fma_f32 v110, v110, s31, v158
    v_fma_f32 v111, v111, s31, v158
    v_exp_f32 v96, v96
    v_exp_f32 v97, v97
    v_exp_f32 v98, v98
    v_exp_f32 v99, v99
    v_exp_f32 v100, v100
    v_exp_f32 v101, v101
    v_exp_f32 v102, v102
    v_exp_f32 v103, v103
    v_exp_f32 v104, v104
    v_exp_f32 v105, v105
    v_exp_f32 v106, v106
    v_exp_f32 v107, v107
    v_exp_f32 v108, v108
    v_exp_f32 v109, v109
    v_exp_f32 v110, v110
    v_exp_f32 v111, v111
    v_add_f32 v159, v159, v96
    v_add_f32 v160, v160, v97
    v_cvt_pk_bf16_f32 v96, v96, v97
    v_add_f32 v159, v159, v98
    v_add_f32 v160, v160, v99
    v_cvt_pk_bf16_f32 v97, v98, v99
    v_add_f32 v159, v159, v100
    v_add_f32 v160, v160, v101
    v_cvt_pk_bf16_f32 v98, v100, v101
    v_add_f32 v159, v159, v102
    v_add_f32 v160, v160, v103
    v_cvt_pk_bf16_f32 v99, v102, v103
    v_add_f32 v159, v159, v104
    v_add_f32 v160, v160, v105
    v_cvt_pk_bf16_f32 v100, v104, v105
    v_add_f32 v159, v159, v106
    v_add_f32 v160, v160, v107
    v_cvt_pk_bf16_f32 v101, v106, v107
    v_add_f32 v159, v159, v108
    v_add_f32 v160, v160, v109
    v_cvt_pk_bf16_f32 v102, v108, v109
    v_add_f32 v159, v159, v110
    v_add_f32 v160, v160, v111
    v_cvt_pk_bf16_f32 v103, v110, v111
    v_mfma_f32_32x32x16_bf16 v[0:15], v[112:115], v[96:99], v[0:15]
    ds_read_b128 v[112:115], v144 offset:0
    v_mfma_f32_32x32x16_bf16 v[16:31], v[116:119], v[96:99], v[16:31]
    ds_read_b128 v[116:119], v145 offset:0
    v_mfma_f32_32x32x16_bf16 v[32:47], v[120:123], v[96:99], v[32:47]
    ds_read_b128 v[120:123], v146 offset:0
    v_mfma_f32_32x32x16_bf16 v[48:63], v[124:127], v[96:99], v[48:63]
    ds_read_b128 v[124:127], v147 offset:0
    v_mfma_f32_32x32x16_bf16 v[0:15], v[128:131], v[100:103], v[0:15]
    ds_read_b128 v[128:131], v148 offset:0
    v_mfma_f32_32x32x16_bf16 v[16:31], v[132:135], v[100:103], v[16:31]
    ds_read_b128 v[132:135], v149 offset:0
    v_mfma_f32_32x32x16_bf16 v[32:47], v[136:139], v[100:103], v[32:47]
    ds_read_b128 v[136:139], v150 offset:0
    v_mfma_f32_32x32x16_bf16 v[48:63], v[140:143], v[100:103], v[48:63]
    ds_read_b128 v[140:143], v151 offset:0
    s_waitcnt lgkmcnt(7)
    v_mfma_f32_32x32x16_bf16 v[96:111], v[112:115], v[64:67], 0
    ds_read_b64_tr_b16 v[112:113], v152 offset:32768
    ds_read_b64_tr_b16 v[114:115], v152 offset:34816
    s_waitcnt lgkmcnt(8)
    v_mfma_f32_32x32x16_bf16 v[96:111], v[116:119], v[68:71], v[96:111]
    ds_read_b64_tr_b16 v[116:117], v153 offset:32768
    ds_read_b64_tr_b16 v[118:119], v153 offset:34816
    s_waitcnt lgkmcnt(9)
    v_mfma_f32_32x32x16_bf16 v[96:111], v[120:123], v[72:75], v[96:111]
    ds_read_b64_tr_b16 v[120:121], v154 offset:32768
    ds_read_b64_tr_b16 v[122:123], v154 offset:34816
    s_waitcnt lgkmcnt(10)
    v_mfma_f32_32x32x16_bf16 v[96:111], v[124:127], v[76:79], v[96:111]
    ds_read_b64_tr_b16 v[124:125], v155 offset:32768
    ds_read_b64_tr_b16 v[126:127], v155 offset:34816
    s_waitcnt lgkmcnt(11)
    v_mfma_f32_32x32x16_bf16 v[96:111], v[128:131], v[80:83], v[96:111]
    ds_read_b64_tr_b16 v[128:129], v152 offset:36864
    ds_read_b64_tr_b16 v[130:131], v152 offset:38912
    s_waitcnt lgkmcnt(12)
    v_mfma_f32_32x32x16_bf16 v[96:111], v[132:135], v[84:87], v[96:111]
    ds_read_b64_tr_b16 v[132:133], v153 offset:36864
    ds_read_b64_tr_b16 v[134:135], v153 offset:38912
    s_waitcnt lgkmcnt(13)
    v_mfma_f32_32x32x16_bf16 v[96:111], v[136:139], v[88:91], v[96:111]
    ds_read_b64_tr_b16 v[136:137], v154 offset:36864
    ds_read_b64_tr_b16 v[138:139], v154 offset:38912
    s_waitcnt lgkmcnt(14)
    v_mfma_f32_32x32x16_bf16 v[96:111], v[140:143], v[92:95], v[96:111]
    ds_read_b64_tr_b16 v[140:141], v155 offset:36864
    ds_read_b64_tr_b16 v[142:143], v155 offset:38912
    s_waitcnt lgkmcnt(0)
    s_barrier
    s_nop 7
    v_max3_f32 v161, v96, v97, v98
    v_max3_f32 v162, v99, v100, v101
    v_max3_f32 v161, v161, v102, v103
    v_max3_f32 v162, v162, v104, v105
    v_max3_f32 v161, v161, v106, v107
    v_max3_f32 v162, v162, v108, v109
    v_max3_f32 v161, v161, v110, v111
    v_max_f32 v161, v161, v162
    v_cmp_gt_f32 vcc, v161, v157
    s_cbranch_vccnz K1_SLOWr2a1
K1_RETr2a1:
    v_fma_f32 v96, v96, s31, v158
    v_fma_f32 v97, v97, s31, v158
    v_fma_f32 v98, v98, s31, v158
    v_fma_f32 v99, v99, s31, v158
    v_fma_f32 v100, v100, s31, v158
    v_fma_f32 v101, v101, s31, v158
    v_fma_f32 v102, v102, s31, v158
    v_fma_f32 v103, v103, s31, v158
    v_fma_f32 v104, v104, s31, v158
    v_fma_f32 v105, v105, s31, v158
    v_fma_f32 v106, v106, s31, v158
    v_fma_f32 v107, v107, s31, v158
    v_fma_f32 v108, v108, s31, v158
    v_fma_f32 v109, v109, s31, v158
    v_fma_f32 v110, v110, s31, v158
    v_fma_f32 v111, v111, s31, v158
    v_exp_f32 v96, v96
    v_exp_f32 v97, v97
    v_exp_f32 v98, v98
    v_exp_f32 v99, v99
    v_exp_f32 v100, v100
    v_exp_f32 v101, v101
    v_exp_f32 v102, v102
    v_exp_f32 v103, v103
    v_exp_f32 v104, v104
    v_exp_f32 v105, v105
    v_exp_f32 v106, v106
    v_exp_f32 v107, v107
    v_exp_f32 v108, v108
    v_exp_f32 v109, v109
    v_exp_f32 v110, v110
    v_exp_f32 v111, v111
    v_add_f32 v159, v159, v96
    v_add_f32 v160, v160, v97
    v_cvt_pk_bf16_f32 v96, v96, v97
    v_add_f32 v159, v159, v98
    v_add_f32 v160, v160, v99
    v_cvt_pk_bf16_f32 v97, v98, v99
    v_add_f32 v159, v159, v100
    v_add_f32 v160, v160, v101
    v_cvt_pk_bf16_f32 v98, v100, v101
    v_add_f32 v159, v159, v102
    v_add_f32 v160, v160, v103
    v_cvt_pk_bf16_f32 v99, v102, v103
    v_add_f32 v159, v159, v104
    v_add_f32 v160, v160, v105
    v_cvt_pk_bf16_f32 v100, v104, v105
    v_add_f32 v159, v159, v106
    v_add_f32 v160, v160, v107
    v_cvt_pk_bf16_f32 v101, v106, v107
    v_add_f32 v159, v159, v108
    v_add_f32 v160, v160, v109
    v_cvt_pk_bf16_f32 v102, v108, v109
    v_add_f32 v159, v159, v110
    v_add_f32 v160, v160, v111
    v_cvt_pk_bf16_f32 v103, v110, v111
    v_mfma_f32_32x32x16_bf16 v[0:15], v[112:115], v[96:99], v[0:15]
    ds_read_b128 v[112:115], v144 offset:8192
    v_mfma_f32_32x32x16_bf16 v[16:31], v[116:119], v[96:99], v[16:31]
    ds_read_b128 v[116:119], v145 offset:8192
    v_mfma_f32_32x32x16_bf16 v[32:47], v[120:123], v[96:99], v[32:47]
    ds_read_b128 v[120:123], v146 offset:8192
    v_mfma_f32_32x32x16_bf16 v[48:63], v[124:127], v[96:99], v[48:63]
    ds_read_b128 v[124:127], v147 offset:8192
    v_mfma_f32_32x32x16_bf16 v[0:15], v[128:131], v[100:103], v[0:15]
    ds_read_b128 v[128:131], v148 offset:8192
    v_mfma_f32_32x32x16_bf16 v[16:31], v[132:135], v[100:103], v[16:31]
    ds_read_b128 v[132:135], v149 offset:8192
    v_mfma_f32_32x32x16_bf16 v[32:47], v[136:139], v[100:103], v[32:47]
    ds_read_b128 v[136:139], v150 offset:8192
    v_mfma_f32_32x32x16_bf16 v[48:63], v[140:143], v[100:103], v[48:63]
    ds_read_b128 v[140:143], v151 offset:8192
    s_waitcnt lgkmcnt(7)
    v_mfma_f32_32x32x16_bf16 v[96:111], v[112:115], v[64:67], 0
    ds_read_b64_tr_b16 v[112:113], v152 offset:40960
    ds_read_b64_tr_b16 v[114:115], v152 offset:43008
    s_waitcnt lgkmcnt(8)
    v_mfma_f32_32x32x16_bf16 v[96:111], v[116:119], v[68:71], v[96:111]
    ds_read_b64_tr_b16 v[116:117], v153 offset:40960
    ds_read_b64_tr_b16 v[118:119], v153 offset:43008
    s_waitcnt lgkmcnt(9)
    v_mfma_f32_32x32x16_bf16 v[96:111], v[120:123], v[72:75], v[96:111]
    ds_read_b64_tr_b16 v[120:121], v154 offset:40960
    ds_read_b64_tr_b16 v[122:123], v154 offset:43008
    s_waitcnt lgkmcnt(10)
    v_mfma_f32_32x32x16_bf16 v[96:111], v[124:127], v[76:79], v[96:111]
    ds_read_b64_tr_b16 v[124:125], v155 offset:40960
    ds_read_b64_tr_b16 v[126:127], v155 offset:43008
    s_waitcnt lgkmcnt(11)
    v_mfma_f32_32x32x16_bf16 v[96:111], v[128:131], v[80:83], v[96:111]
    ds_read_b64_tr_b16 v[128:129], v152 offset:45056
    ds_read_b64_tr_b16 v[130:131], v152 offset:47104
    s_waitcnt lgkmcnt(12)
    v_mfma_f32_32x32x16_bf16 v[96:111], v[132:135], v[84:87], v[96:111]
    ds_read_b64_tr_b16 v[132:133], v153 offset:45056
    ds_read_b64_tr_b16 v[134:135], v153 offset:47104
    s_waitcnt lgkmcnt(13)
    v_mfma_f32_32x32x16_bf16 v[96:111], v[136:139], v[88:91], v[96:111]
    ds_read_b64_tr_b16 v[136:137], v154 offset:45056
    ds_read_b64_tr_b16 v[138:139], v154 offset:47104
    s_waitcnt lgkmcnt(14)
    v_mfma_f32_32x32x16_bf16 v[96:111], v[140:143], v[92:95], v[96:111]
    ds_read_b64_tr_b16 v[140:141], v155 offset:45056
    ds_read_b64_tr_b16 v[142:143], v155 offset:47104
    s_waitcnt lgkmcnt(0)
    s_barrier
    s_nop 7
    v_max3_f32 v161, v96, v97, v98
    v_max3_f32 v162, v99, v100, v101
    v_max3_f32 v161, v161, v102, v103
    v_max3_f32 v162, v162, v104, v105
    v_max3_f32 v161, v161, v106, v107
    v_max3_f32 v162, v162, v108, v109
    v_max3_f32 v161, v161, v110, v111
    v_max_f32 v161, v161, v162
    v_cmp_gt_f32 vcc, v161, v157
    s_cbranch_vccnz K1_SLOWr2a2
K1_RETr2a2:
    v_fma_f32 v96, v96, s31, v158
    v_fma_f32 v97, v97, s31, v158
    v_fma_f32 v98, v98, s31, v158
    v_fma_f32 v99, v99, s31, v158
    v_fma_f32 v100, v100, s31, v158
    v_fma_f32 v101, v101, s31, v158
    v_fma_f32 v102, v102, s31, v158
    v_fma_f32 v103, v103, s31, v158
    v_fma_f32 v104, v104, s31, v158
    v_fma_f32 v105, v105, s31, v158
    v_fma_f32 v106, v106, s31, v158
    v_fma_f32 v107, v107, s31, v158
    v_fma_f32 v108, v108, s31, v158
    v_fma_f32 v109, v109, s31, v158
    v_fma_f32 v110, v110, s31, v158
    v_fma_f32 v111, v111, s31, v158
    v_exp_f32 v96, v96
    v_exp_f32 v97, v97
    v_exp_f32 v98, v98
    v_exp_f32 v99, v99
    v_exp_f32 v100, v100
    v_exp_f32 v101, v101
    v_exp_f32 v102, v102
    v_exp_f32 v103, v103
    v_exp_f32 v104, v104
    v_exp_f32 v105, v105
    v_exp_f32 v106, v106
    v_exp_f32 v107, v107
    v_exp_f32 v108, v108
    v_exp_f32 v109, v109
    v_exp_f32 v110, v110
    v_exp_f32 v111, v111
    v_add_f32 v159, v159, v96
    v_add_f32 v160, v160, v97
    v_cvt_pk_bf16_f32 v96, v96, v97
    v_add_f32 v159, v159, v98
    v_add_f32 v160, v160, v99
    v_cvt_pk_bf16_f32 v97, v98, v99
    v_add_f32 v159, v159, v100
    v_add_f32 v160, v160, v101
    v_cvt_pk_bf16_f32 v98, v100, v101
    v_add_f32 v159, v159, v102
    v_add_f32 v160, v160, v103
    v_cvt_pk_bf16_f32 v99, v102, v103
    v_add_f32 v159, v159, v104
    v_add_f32 v160, v160, v105
    v_cvt_pk_bf16_f32 v100, v104, v105
    v_add_f32 v159, v159, v106
    v_add_f32 v160, v160, v107
    v_cvt_pk_bf16_f32 v101, v106, v107
    v_add_f32 v159, v159, v108
    v_add_f32 v160, v160, v109
    v_cvt_pk_bf16_f32 v102, v108, v109
    v_add_f32 v159, v159, v110
    v_add_f32 v160, v160, v111
    v_cvt_pk_bf16_f32 v103, v110, v111
    v_mfma_f32_32x32x16_bf16 v[0:15], v[112:115], v[96:99], v[0:15]
    ds_read_b128 v[112:115], v144 offset:16384
    v_mfma_f32_32x32x16_bf16 v[16:31], v[116:119], v[96:99], v[16:31]
    ds_read_b128 v[116:119], v145 offset:16384
    v_mfma_f32_32x32x16_bf16 v[32:47], v[120:123], v[96:99], v[32:47]
    ds_read_b128 v[120:123], v146 offset:16384
    v_mfma_f32_32x32x16_bf16 v[48:63], v[124:127], v[96:99], v[48:63]
    ds_read_b128 v[124:127], v147 offset:16384
    v_mfma_f32_32x32x16_bf16 v[0:15], v[128:131], v[100:103], v[0:15]
    ds_read_b128 v[128:131], v148 offset:16384
    v_mfma_f32_32x32x16_bf16 v[16:31], v[132:135], v[100:103], v[16:31]
    ds_read_b128 v[132:135], v149 offset:16384
    v_mfma_f32_32x32x16_bf16 v[32:47], v[136:139], v[100:103], v[32:47]
    ds_read_b128 v[136:139], v150 offset:16384
    v_mfma_f32_32x32x16_bf16 v[48:63], v[140:143], v[100:103], v[48:63]
    ds_read_b128 v[140:143], v151 offset:16384
    s_waitcnt lgkmcnt(7)
    v_mfma_f32_32x32x16_bf16 v[96:111], v[112:115], v[64:67], 0
    ds_read_b64_tr_b16 v[112:113], v152 offset:49152
    ds_read_b64_tr_b16 v[114:115], v152 offset:51200
    s_waitcnt lgkmcnt(8)
    v_mfma_f32_32x32x16_bf16 v[96:111], v[116:119], v[68:71], v[96:111]
    ds_read_b64_tr_b16 v[116:117], v153 offset:49152
    ds_read_b64_tr_b16 v[118:119], v153 offset:51200
    s_waitcnt lgkmcnt(9)
    v_mfma_f32_32x32x16_bf16 v[96:111], v[120:123], v[72:75], v[96:111]
    ds_read_b64_tr_b16 v[120:121], v154 offset:49152
    ds_read_b64_tr_b16 v[122:123], v154 offset:51200
    s_waitcnt lgkmcnt(10)
    v_mfma_f32_32x32x16_bf16 v[96:111], v[124:127], v[76:79], v[96:111]
    ds_read_b64_tr_b16 v[124:125], v155 offset:49152
    ds_read_b64_tr_b16 v[126:127], v155 offset:51200
    s_waitcnt lgkmcnt(11)
    v_mfma_f32_32x32x16_bf16 v[96:111], v[128:131], v[80:83], v[96:111]
    ds_read_b64_tr_b16 v[128:129], v152 offset:53248
    ds_read_b64_tr_b16 v[130:131], v152 offset:55296
    s_waitcnt lgkmcnt(12)
    v_mfma_f32_32x32x16_bf16 v[96:111], v[132:135], v[84:87], v[96:111]
    ds_read_b64_tr_b16 v[132:133], v153 offset:53248
    ds_read_b64_tr_b16 v[134:135], v153 offset:55296
    s_waitcnt lgkmcnt(13)
    v_mfma_f32_32x32x16_bf16 v[96:111], v[136:139], v[88:91], v[96:111]
    ds_read_b64_tr_b16 v[136:137], v154 offset:53248
    ds_read_b64_tr_b16 v[138:139], v154 offset:55296
    s_waitcnt lgkmcnt(14)
    v_mfma_f32_32x32x16_bf16 v[96:111], v[140:143], v[92:95], v[96:111]
    ds_read_b64_tr_b16 v[140:141], v155 offset:53248
    ds_read_b64_tr_b16 v[142:143], v155 offset:55296
    s_waitcnt lgkmcnt(0)
    s_barrier
    s_nop 7
    v_max3_f32 v161, v96, v97, v98
    v_max3_f32 v162, v99, v100, v101
    v_max3_f32 v161, v161, v102, v103
    v_max3_f32 v162, v162, v104, v105
    v_max3_f32 v161, v161, v106, v107
    v_max3_f32 v162, v162, v108, v109
    v_max3_f32 v161, v161, v110, v111
    v_max_f32 v161, v161, v162
    v_cmp_gt_f32 vcc, v161, v157
    s_cbranch_vccnz K1_SLOWr2a3
K1_RETr2a3:
    v_fma_f32 v96, v96, s31, v158
    v_fma_f32 v97, v97, s31, v158
    v_fma_f32 v98, v98, s31, v158
    v_fma_f32 v99, v99, s31, v158
    v_fma_f32 v100, v100, s31, v158
    v_fma_f32 v101, v101, s31, v158
    v_fma_f32 v102, v102, s31, v158
    v_fma_f32 v103, v103, s31, v158
    v_fma_f32 v104, v104, s31, v158
    v_fma_f32 v105, v105, s31, v158
    v_fma_f32 v106, v106, s31, v158
    v_fma_f32 v107, v107, s31, v158
    v_fma_f32 v108, v108, s31, v158
    v_fma_f32 v109, v109, s31, v158
    v_fma_f32 v110, v110, s31, v158
    v_fma_f32 v111, v111, s31, v158
    v_exp_f32 v96, v96
    v_exp_f32 v97, v97
    v_exp_f32 v98, v98
    v_exp_f32 v99, v99
    v_exp_f32 v100, v100
    v_exp_f32 v101, v101
    v_exp_f32 v102, v102
    v_exp_f32 v103, v103
    v_exp_f32 v104, v104
    v_exp_f32 v105, v105
    v_exp_f32 v106, v106
    v_exp_f32 v107, v107
    v_exp_f32 v108, v108
    v_exp_f32 v109, v109
    v_exp_f32 v110, v110
    v_exp_f32 v111, v111
    v_add_f32 v159, v159, v96
    v_add_f32 v160, v160, v97
    v_cvt_pk_bf16_f32 v96, v96, v97
    v_add_f32 v159, v159, v98
    v_add_f32 v160, v160, v99
    v_cvt_pk_bf16_f32 v97, v98, v99
    v_add_f32 v159, v159, v100
    v_add_f32 v160, v160, v101
    v_cvt_pk_bf16_f32 v98, v100, v101
    v_add_f32 v159, v159, v102
    v_add_f32 v160, v160, v103
    v_cvt_pk_bf16_f32 v99, v102, v103
    v_add_f32 v159, v159, v104
    v_add_f32 v160, v160, v105
    v_cvt_pk_bf16_f32 v100, v104, v105
    v_add_f32 v159, v159, v106
    v_add_f32 v160, v160, v107
    v_cvt_pk_bf16_f32 v101, v106, v107
    v_add_f32 v159, v159, v108
    v_add_f32 v160, v160, v109
    v_cvt_pk_bf16_f32 v102, v108, v109
    v_add_f32 v159, v159, v110
    v_add_f32 v160, v160, v111
    v_cvt_pk_bf16_f32 v103, v110, v111
    v_mfma_f32_32x32x16_bf16 v[0:15], v[112:115], v[96:99], v[0:15]
    ds_read_b128 v[112:115], v144 offset:24576
    v_mfma_f32_32x32x16_bf16 v[16:31], v[116:119], v[96:99], v[16:31]
    ds_read_b128 v[116:119], v145 offset:24576
    v_mfma_f32_32x32x16_bf16 v[32:47], v[120:123], v[96:99], v[32:47]
    ds_read_b128 v[120:123], v146 offset:24576
    v_mfma_f32_32x32x16_bf16 v[48:63], v[124:127], v[96:99], v[48:63]
    ds_read_b128 v[124:127], v147 offset:24576
    v_mfma_f32_32x32x16_bf16 v[0:15], v[128:131], v[100:103], v[0:15]
    ds_read_b128 v[128:131], v148 offset:24576
    v_mfma_f32_32x32x16_bf16 v[16:31], v[132:135], v[100:103], v[16:31]
    ds_read_b128 v[132:135], v149 offset:24576
    v_mfma_f32_32x32x16_bf16 v[32:47], v[136:139], v[100:103], v[32:47]
    ds_read_b128 v[136:139], v150 offset:24576
    v_mfma_f32_32x32x16_bf16 v[48:63], v[140:143], v[100:103], v[48:63]
    ds_read_b128 v[140:143], v151 offset:24576
    s_waitcnt lgkmcnt(7)
    v_mfma_f32_32x32x16_bf16 v[96:111], v[112:115], v[64:67], 0
    ds_read_b64_tr_b16 v[112:113], v152 offset:57344
    ds_read_b64_tr_b16 v[114:115], v152 offset:59392
    s_waitcnt lgkmcnt(8)
    v_mfma_f32_32x32x16_bf16 v[96:111], v[116:119], v[68:71], v[96:111]
    ds_read_b64_tr_b16 v[116:117], v153 offset:57344
    ds_read_b64_tr_b16 v[118:119], v153 offset:59392
    s_waitcnt lgkmcnt(9)
    v_mfma_f32_32x32x16_bf16 v[96:111], v[120:123], v[72:75], v[96:111]
    ds_read_b64_tr_b16 v[120:121], v154 offset:57344
    ds_read_b64_tr_b16 v[122:123], v154 offset:59392
    s_waitcnt lgkmcnt(10)
    v_mfma_f32_32x32x16_bf16 v[96:111], v[124:127], v[76:79], v[96:111]
    ds_read_b64_tr_b16 v[124:125], v155 offset:57344
    ds_read_b64_tr_b16 v[126:127], v155 offset:59392
    s_waitcnt lgkmcnt(11)
    v_mfma_f32_32x32x16_bf16 v[96:111], v[128:131], v[80:83], v[96:111]
    ds_read_b64_tr_b16 v[128:129], v152 offset:61440
    ds_read_b64_tr_b16 v[130:131], v152 offset:63488
    s_waitcnt lgkmcnt(12)
    v_mfma_f32_32x32x16_bf16 v[96:111], v[132:135], v[84:87], v[96:111]
    ds_read_b64_tr_b16 v[132:133], v153 offset:61440
    ds_read_b64_tr_b16 v[134:135], v153 offset:63488
    s_waitcnt lgkmcnt(13)
    v_mfma_f32_32x32x16_bf16 v[96:111], v[136:139], v[88:91], v[96:111]
    ds_read_b64_tr_b16 v[136:137], v154 offset:61440
    ds_read_b64_tr_b16 v[138:139], v154 offset:63488
    s_waitcnt lgkmcnt(14)
    v_mfma_f32_32x32x16_bf16 v[96:111], v[140:143], v[92:95], v[96:111]
    ds_read_b64_tr_b16 v[140:141], v155 offset:61440
    ds_read_b64_tr_b16 v[142:143], v155 offset:63488
    s_waitcnt lgkmcnt(0)
    s_add_u32 s50, s50, 1
    s_cmp_lt_u32 s50, 6
    s_cbranch_scc1 K1_LOOPr2
    s_barrier
    s_nop 4
    v_max3_f32 v161, v96, v97, v98
    v_max3_f32 v162, v99, v100, v101
    v_max3_f32 v161, v161, v102, v103
    v_max3_f32 v162, v162, v104, v105
    v_max3_f32 v161, v161, v106, v107
    v_max3_f32 v162, v162, v108, v109
    v_max3_f32 v161, v161, v110, v111
    v_max_f32 v161, v161, v162
    v_cmp_gt_f32 vcc, v161, v157
    s_cbranch_vccnz K1_SLOWr2b0
K1_RETr2b0:
    v_fma_f32 v96, v96, s31, v158
    v_fma_f32 v97, v97, s31, v158
    v_fma_f32 v98, v98, s31, v158
    v_fma_f32 v99, v99, s31, v158
    v_fma_f32 v100, v100, s31, v158
    v_fma_f32 v101, v101, s31, v158
    v_fma_f32 v102, v102, s31, v158
    v_fma_f32 v103, v103, s31, v158
    v_fma_f32 v104, v104, s31, v158
    v_fma_f32 v105, v105, s31, v158
    v_fma_f32 v106, v106, s31, v158
    v_fma_f32 v107, v107, s31, v158
    v_fma_f32 v108, v108, s31, v158
    v_fma_f32 v109, v109, s31, v158
    v_fma_f32 v110, v110, s31, v158
    v_fma_f32 v111, v111, s31, v158
    v_exp_f32 v96, v96
    v_exp_f32 v97, v97
    v_exp_f32 v98, v98
    v_exp_f32 v99, v99
    v_exp_f32 v100, v100
    v_exp_f32 v101, v101
    v_exp_f32 v102, v102
    v_exp_f32 v103, v103
    v_exp_f32 v104, v104
    v_exp_f32 v105, v105
    v_exp_f32 v106, v106
    v_exp_f32 v107, v107
    v_exp_f32 v108, v108
    v_exp_f32 v109, v109
    v_exp_f32 v110, v110
    v_exp_f32 v111, v111
    v_add_f32 v159, v159, v96
    v_add_f32 v160, v160, v97
    v_cvt_pk_bf16_f32 v96, v96, v97
    v_add_f32 v159, v159, v98
    v_add_f32 v160, v160, v99
    v_cvt_pk_bf16_f32 v97, v98, v99
    v_add_f32 v159, v159, v100
    v_add_f32 v160, v160, v101
    v_cvt_pk_bf16_f32 v98, v100, v101
    v_add_f32 v159, v159, v102
    v_add_f32 v160, v160, v103
    v_cvt_pk_bf16_f32 v99, v102, v103
    v_add_f32 v159, v159, v104
    v_add_f32 v160, v160, v105
    v_cvt_pk_bf16_f32 v100, v104, v105
    v_add_f32 v159, v159, v106
    v_add_f32 v160, v160, v107
    v_cvt_pk_bf16_f32 v101, v106, v107
    v_add_f32 v159, v159, v108
    v_add_f32 v160, v160, v109
    v_cvt_pk_bf16_f32 v102, v108, v109
    v_add_f32 v159, v159, v110
    v_add_f32 v160, v160, v111
    v_cvt_pk_bf16_f32 v103, v110, v111
    v_mfma_f32_32x32x16_bf16 v[0:15], v[112:115], v[96:99], v[0:15]
    ds_read_b128 v[112:115], v144 offset:0
    v_mfma_f32_32x32x16_bf16 v[16:31], v[116:119], v[96:99], v[16:31]
    ds_read_b128 v[116:119], v145 offset:0
    v_mfma_f32_32x32x16_bf16 v[32:47], v[120:123], v[96:99], v[32:47]
    ds_read_b128 v[120:123], v146 offset:0
    v_mfma_f32_32x32x16_bf16 v[48:63], v[124:127], v[96:99], v[48:63]
    ds_read_b128 v[124:127], v147 offset:0
    v_mfma_f32_32x32x16_bf16 v[0:15], v[128:131], v[100:103], v[0:15]
    ds_read_b128 v[128:131], v148 offset:0
    v_mfma_f32_32x32x16_bf16 v[16:31], v[132:135], v[100:103], v[16:31]
    ds_read_b128 v[132:135], v149 offset:0
    v_mfma_f32_32x32x16_bf16 v[32:47], v[136:139], v[100:103], v[32:47]
    ds_read_b128 v[136:139], v150 offset:0
    v_mfma_f32_32x32x16_bf16 v[48:63], v[140:143], v[100:103], v[48:63]
    ds_read_b128 v[140:143], v151 offset:0
    s_waitcnt lgkmcnt(7)
    v_mfma_f32_32x32x16_bf16 v[96:111], v[112:115], v[64:67], 0
    ds_read_b64_tr_b16 v[112:113], v152 offset:32768
    ds_read_b64_tr_b16 v[114:115], v152 offset:34816
    s_waitcnt lgkmcnt(8)
    v_mfma_f32_32x32x16_bf16 v[96:111], v[116:119], v[68:71], v[96:111]
    ds_read_b64_tr_b16 v[116:117], v153 offset:32768
    ds_read_b64_tr_b16 v[118:119], v153 offset:34816
    s_waitcnt lgkmcnt(9)
    v_mfma_f32_32x32x16_bf16 v[96:111], v[120:123], v[72:75], v[96:111]
    ds_read_b64_tr_b16 v[120:121], v154 offset:32768
    ds_read_b64_tr_b16 v[122:123], v154 offset:34816
    s_waitcnt lgkmcnt(10)
    v_mfma_f32_32x32x16_bf16 v[96:111], v[124:127], v[76:79], v[96:111]
    ds_read_b64_tr_b16 v[124:125], v155 offset:32768
    ds_read_b64_tr_b16 v[126:127], v155 offset:34816
    s_waitcnt lgkmcnt(11)
    v_mfma_f32_32x32x16_bf16 v[96:111], v[128:131], v[80:83], v[96:111]
    ds_read_b64_tr_b16 v[128:129], v152 offset:36864
    ds_read_b64_tr_b16 v[130:131], v152 offset:38912
    s_waitcnt lgkmcnt(12)
    v_mfma_f32_32x32x16_bf16 v[96:111], v[132:135], v[84:87], v[96:111]
    ds_read_b64_tr_b16 v[132:133], v153 offset:36864
    ds_read_b64_tr_b16 v[134:135], v153 offset:38912
    s_waitcnt lgkmcnt(13)
    v_mfma_f32_32x32x16_bf16 v[96:111], v[136:139], v[88:91], v[96:111]
    ds_read_b64_tr_b16 v[136:137], v154 offset:36864
    ds_read_b64_tr_b16 v[138:139], v154 offset:38912
    s_waitcnt lgkmcnt(14)
    v_mfma_f32_32x32x16_bf16 v[96:111], v[140:143], v[92:95], v[96:111]
    ds_read_b64_tr_b16 v[140:141], v155 offset:36864
    ds_read_b64_tr_b16 v[142:143], v155 offset:38912
    s_waitcnt lgkmcnt(0)
    s_barrier
    s_nop 7
    v_max3_f32 v161, v96, v97, v98
    v_max3_f32 v162, v99, v100, v101
    v_max3_f32 v161, v161, v102, v103
    v_max3_f32 v162, v162, v104, v105
    v_max3_f32 v161, v161, v106, v107
    v_max3_f32 v162, v162, v108, v109
    v_max3_f32 v161, v161, v110, v111
    v_max_f32 v161, v161, v162
    v_cmp_gt_f32 vcc, v161, v157
    s_cbranch_vccnz K1_SLOWr2b1
K1_RETr2b1:
    v_fma_f32 v96, v96, s31, v158
    v_fma_f32 v97, v97, s31, v158
    v_fma_f32 v98, v98, s31, v158
    v_fma_f32 v99, v99, s31, v158
    v_fma_f32 v100, v100, s31, v158
    v_fma_f32 v101, v101, s31, v158
    v_fma_f32 v102, v102, s31, v158
    v_fma_f32 v103, v103, s31, v158
    v_fma_f32 v104, v104, s31, v158
    v_fma_f32 v105, v105, s31, v158
    v_fma_f32 v106, v106, s31, v158
    v_fma_f32 v107, v107, s31, v158
    v_fma_f32 v108, v108, s31, v158
    v_fma_f32 v109, v109, s31, v158
    v_fma_f32 v110, v110, s31, v158
    v_fma_f32 v111, v111, s31, v158
    v_exp_f32 v96, v96
    v_exp_f32 v97, v97
    v_exp_f32 v98, v98
    v_exp_f32 v99, v99
    v_exp_f32 v100, v100
    v_exp_f32 v101, v101
    v_exp_f32 v102, v102
    v_exp_f32 v103, v103
    v_exp_f32 v104, v104
    v_exp_f32 v105, v105
    v_exp_f32 v106, v106
    v_exp_f32 v107, v107
    v_exp_f32 v108, v108
    v_exp_f32 v109, v109
    v_exp_f32 v110, v110
    v_exp_f32 v111, v111
    v_add_f32 v159, v159, v96
    v_add_f32 v160, v160, v97
    v_cvt_pk_bf16_f32 v96, v96, v97
    v_add_f32 v159, v159, v98
    v_add_f32 v160, v160, v99
    v_cvt_pk_bf16_f32 v97, v98, v99
    v_add_f32 v159, v159, v100
    v_add_f32 v160, v160, v101
    v_cvt_pk_bf16_f32 v98, v100, v101
    v_add_f32 v159, v159, v102
    v_add_f32 v160, v160, v103
    v_cvt_pk_bf16_f32 v99, v102, v103
    v_add_f32 v159, v159, v104
    v_add_f32 v160, v160, v105
    v_cvt_pk_bf16_f32 v100, v104, v105
    v_add_f32 v159, v159, v106
    v_add_f32 v160, v160, v107
    v_cvt_pk_bf16_f32 v101, v106, v107
    v_add_f32 v159, v159, v108
    v_add_f32 v160, v160, v109
    v_cvt_pk_bf16_f32 v102, v108, v109
    v_add_f32 v159, v159, v110
    v_add_f32 v160, v160, v111
    v_cvt_pk_bf16_f32 v103, v110, v111
    v_mfma_f32_32x32x16_bf16 v[0:15], v[112:115], v[96:99], v[0:15]
    ds_read_b128 v[112:115], v144 offset:8192
    v_mfma_f32_32x32x16_bf16 v[16:31], v[116:119], v[96:99], v[16:31]
    ds_read_b128 v[116:119], v145 offset:8192
    v_mfma_f32_32x32x16_bf16 v[32:47], v[120:123], v[96:99], v[32:47]
    ds_read_b128 v[120:123], v146 offset:8192
    v_mfma_f32_32x32x16_bf16 v[48:63], v[124:127], v[96:99], v[48:63]
    ds_read_b128 v[124:127], v147 offset:8192
    v_mfma_f32_32x32x16_bf16 v[0:15], v[128:131], v[100:103], v[0:15]
    ds_read_b128 v[128:131], v148 offset:8192
    v_mfma_f32_32x32x16_bf16 v[16:31], v[132:135], v[100:103], v[16:31]
    ds_read_b128 v[132:135], v149 offset:8192
    v_mfma_f32_32x32x16_bf16 v[32:47], v[136:139], v[100:103], v[32:47]
    ds_read_b128 v[136:139], v150 offset:8192
    v_mfma_f32_32x32x16_bf16 v[48:63], v[140:143], v[100:103], v[48:63]
    ds_read_b128 v[140:143], v151 offset:8192
    s_waitcnt lgkmcnt(7)
    v_mfma_f32_32x32x16_bf16 v[96:111], v[112:115], v[64:67], 0
    ds_read_b64_tr_b16 v[112:113], v152 offset:40960
    ds_read_b64_tr_b16 v[114:115], v152 offset:43008
    s_waitcnt lgkmcnt(8)
    v_mfma_f32_32x32x16_bf16 v[96:111], v[116:119], v[68:71], v[96:111]
    ds_read_b64_tr_b16 v[116:117], v153 offset:40960
    ds_read_b64_tr_b16 v[118:119], v153 offset:43008
    s_waitcnt lgkmcnt(9)
    v_mfma_f32_32x32x16_bf16 v[96:111], v[120:123], v[72:75], v[96:111]
    ds_read_b64_tr_b16 v[120:121], v154 offset:40960
    ds_read_b64_tr_b16 v[122:123], v154 offset:43008
    s_waitcnt lgkmcnt(10)
    v_mfma_f32_32x32x16_bf16 v[96:111], v[124:127], v[76:79], v[96:111]
    ds_read_b64_tr_b16 v[124:125], v155 offset:40960
    ds_read_b64_tr_b16 v[126:127], v155 offset:43008
    s_waitcnt lgkmcnt(11)
    v_mfma_f32_32x32x16_bf16 v[96:111], v[128:131], v[80:83], v[96:111]
    ds_read_b64_tr_b16 v[128:129], v152 offset:45056
    ds_read_b64_tr_b16 v[130:131], v152 offset:47104
    s_waitcnt lgkmcnt(12)
    v_mfma_f32_32x32x16_bf16 v[96:111], v[132:135], v[84:87], v[96:111]
    ds_read_b64_tr_b16 v[132:133], v153 offset:45056
    ds_read_b64_tr_b16 v[134:135], v153 offset:47104
    s_waitcnt lgkmcnt(13)
    v_mfma_f32_32x32x16_bf16 v[96:111], v[136:139], v[88:91], v[96:111]
    ds_read_b64_tr_b16 v[136:137], v154 offset:45056
    ds_read_b64_tr_b16 v[138:139], v154 offset:47104
    s_waitcnt lgkmcnt(14)
    v_mfma_f32_32x32x16_bf16 v[96:111], v[140:143], v[92:95], v[96:111]
    ds_read_b64_tr_b16 v[140:141], v155 offset:45056
    ds_read_b64_tr_b16 v[142:143], v155 offset:47104
    s_waitcnt lgkmcnt(0)
    s_barrier
    s_nop 7
    v_max3_f32 v161, v96, v97, v98
    v_max3_f32 v162, v99, v100, v101
    v_max3_f32 v161, v161, v102, v103
    v_max3_f32 v162, v162, v104, v105
    v_max3_f32 v161, v161, v106, v107
    v_max3_f32 v162, v162, v108, v109
    v_max3_f32 v161, v161, v110, v111
    v_max_f32 v161, v161, v162
    v_cmp_gt_f32 vcc, v161, v157
    s_cbranch_vccnz K1_SLOWr2b2
K1_RETr2b2:
    v_fma_f32 v96, v96, s31, v158
    v_fma_f32 v97, v97, s31, v158
    v_fma_f32 v98, v98, s31, v158
    v_fma_f32 v99, v99, s31, v158
    v_fma_f32 v100, v100, s31, v158
    v_fma_f32 v101, v101, s31, v158
    v_fma_f32 v102, v102, s31, v158
    v_fma_f32 v103, v103, s31, v158
    v_fma_f32 v104, v104, s31, v158
    v_fma_f32 v105, v105, s31, v158
    v_fma_f32 v106, v106, s31, v158
    v_fma_f32 v107, v107, s31, v158
    v_fma_f32 v108, v108, s31, v158
    v_fma_f32 v109, v109, s31, v158
    v_fma_f32 v110, v110, s31, v158
    v_fma_f32 v111, v111, s31, v158
    v_exp_f32 v96, v96
    v_exp_f32 v97, v97
    v_exp_f32 v98, v98
    v_exp_f32 v99, v99
    v_exp_f32 v100, v100
    v_exp_f32 v101, v101
    v_exp_f32 v102, v102
    v_exp_f32 v103, v103
    v_exp_f32 v104, v104
    v_exp_f32 v105, v105
    v_exp_f32 v106, v106
    v_exp_f32 v107, v107
    v_exp_f32 v108, v108
    v_exp_f32 v109, v109
    v_exp_f32 v110, v110
    v_exp_f32 v111, v111
    v_add_f32 v159, v159, v96
    v_add_f32 v160, v160, v97
    v_cvt_pk_bf16_f32 v96, v96, v97
    v_add_f32 v159, v159, v98
    v_add_f32 v160, v160, v99
    v_cvt_pk_bf16_f32 v97, v98, v99
    v_add_f32 v159, v159, v100
    v_add_f32 v160, v160, v101
    v_cvt_pk_bf16_f32 v98, v100, v101
    v_add_f32 v159, v159, v102
    v_add_f32 v160, v160, v103
    v_cvt_pk_bf16_f32 v99, v102, v103
    v_add_f32 v159, v159, v104
    v_add_f32 v160, v160, v105
    v_cvt_pk_bf16_f32 v100, v104, v105
    v_add_f32 v159, v159, v106
    v_add_f32 v160, v160, v107
    v_cvt_pk_bf16_f32 v101, v106, v107
    v_add_f32 v159, v159, v108
    v_add_f32 v160, v160, v109
    v_cvt_pk_bf16_f32 v102, v108, v109
    v_add_f32 v159, v159, v110
    v_add_f32 v160, v160, v111
    v_cvt_pk_bf16_f32 v103, v110, v111
    v_mfma_f32_32x32x16_bf16 v[0:15], v[112:115], v[96:99], v[0:15]
    ds_read_b128 v[112:115], v144 offset:16384
    v_mfma_f32_32x32x16_bf16 v[16:31], v[116:119], v[96:99], v[16:31]
    ds_read_b128 v[116:119], v145 offset:16384
    v_mfma_f32_32x32x16_bf16 v[32:47], v[120:123], v[96:99], v[32:47]
    ds_read_b128 v[120:123], v146 offset:16384
    v_mfma_f32_32x32x16_bf16 v[48:63], v[124:127], v[96:99], v[48:63]
    ds_read_b128 v[124:127], v147 offset:16384
    v_mfma_f32_32x32x16_bf16 v[0:15], v[128:131], v[100:103], v[0:15]
    ds_read_b128 v[128:131], v148 offset:16384
    v_mfma_f32_32x32x16_bf16 v[16:31], v[132:135], v[100:103], v[16:31]
    ds_read_b128 v[132:135], v149 offset:16384
    v_mfma_f32_32x32x16_bf16 v[32:47], v[136:139], v[100:103], v[32:47]
    ds_read_b128 v[136:139], v150 offset:16384
    v_mfma_f32_32x32x16_bf16 v[48:63], v[140:143], v[100:103], v[48:63]
    ds_read_b128 v[140:143], v151 offset:16384
    s_waitcnt lgkmcnt(7)
    v_mfma_f32_32x32x16_bf16 v[96:111], v[112:115], v[64:67], 0
    ds_read_b64_tr_b16 v[112:113], v152 offset:49152
    ds_read_b64_tr_b16 v[114:115], v152 offset:51200
    s_waitcnt lgkmcnt(8)
    v_mfma_f32_32x32x16_bf16 v[96:111], v[116:119], v[68:71], v[96:111]
    ds_read_b64_tr_b16 v[116:117], v153 offset:49152
    ds_read_b64_tr_b16 v[118:119], v153 offset:51200
    s_waitcnt lgkmcnt(9)
    v_mfma_f32_32x32x16_bf16 v[96:111], v[120:123], v[72:75], v[96:111]
    ds_read_b64_tr_b16 v[120:121], v154 offset:49152
    ds_read_b64_tr_b16 v[122:123], v154 offset:51200
    s_waitcnt lgkmcnt(10)
    v_mfma_f32_32x32x16_bf16 v[96:111], v[124:127], v[76:79], v[96:111]
    ds_read_b64_tr_b16 v[124:125], v155 offset:49152
    ds_read_b64_tr_b16 v[126:127], v155 offset:51200
    s_waitcnt lgkmcnt(11)
    v_mfma_f32_32x32x16_bf16 v[96:111], v[128:131], v[80:83], v[96:111]
    ds_read_b64_tr_b16 v[128:129], v152 offset:53248
    ds_read_b64_tr_b16 v[130:131], v152 offset:55296
    s_waitcnt lgkmcnt(12)
    v_mfma_f32_32x32x16_bf16 v[96:111], v[132:135], v[84:87], v[96:111]
    ds_read_b64_tr_b16 v[132:133], v153 offset:53248
    ds_read_b64_tr_b16 v[134:135], v153 offset:55296
    s_waitcnt lgkmcnt(13)
    v_mfma_f32_32x32x16_bf16 v[96:111], v[136:139], v[88:91], v[96:111]
    ds_read_b64_tr_b16 v[136:137], v154 offset:53248
    ds_read_b64_tr_b16 v[138:139], v154 offset:55296
    s_waitcnt lgkmcnt(14)
    v_mfma_f32_32x32x16_bf16 v[96:111], v[140:143], v[92:95], v[96:111]
    ds_read_b64_tr_b16 v[140:141], v155 offset:53248
    ds_read_b64_tr_b16 v[142:143], v155 offset:55296
    s_waitcnt lgkmcnt(0)
    s_barrier
    s_nop 7
    v_max3_f32 v161, v96, v97, v98
    v_max3_f32 v162, v99, v100, v101
    v_max3_f32 v161, v161, v102, v103
    v_max3_f32 v162, v162, v104, v105
    v_max3_f32 v161, v161, v106, v107
    v_max3_f32 v162, v162, v108, v109
    v_max3_f32 v161, v161, v110, v111
    v_max_f32 v161, v161, v162
    v_cmp_gt_f32 vcc, v161, v157
    s_cbranch_vccnz K1_SLOWr2b3
K1_RETr2b3:
    v_fma_f32 v96, v96, s31, v158
    v_fma_f32 v97, v97, s31, v158
    v_fma_f32 v98, v98, s31, v158
    v_fma_f32 v99, v99, s31, v158
    v_fma_f32 v100, v100, s31, v158
    v_fma_f32 v101, v101, s31, v158
    v_fma_f32 v102, v102, s31, v158
    v_fma_f32 v103, v103, s31, v158
    v_fma_f32 v104, v104, s31, v158
    v_fma_f32 v105, v105, s31, v158
    v_fma_f32 v106, v106, s31, v158
    v_fma_f32 v107, v107, s31, v158
    v_fma_f32 v108, v108, s31, v158
    v_fma_f32 v109, v109, s31, v158
    v_fma_f32 v110, v110, s31, v158
    v_fma_f32 v111, v111, s31, v158
    v_exp_f32 v96, v96
    v_exp_f32 v97, v97
    v_exp_f32 v98, v98
    v_exp_f32 v99, v99
    v_exp_f32 v100, v100
    v_exp_f32 v101, v101
    v_exp_f32 v102, v102
    v_exp_f32 v103, v103
    v_exp_f32 v104, v104
    v_exp_f32 v105, v105
    v_exp_f32 v106, v106
    v_exp_f32 v107, v107
    v_exp_f32 v108, v108
    v_exp_f32 v109, v109
    v_exp_f32 v110, v110
    v_exp_f32 v111, v111
    v_add_f32 v159, v159, v96
    v_add_f32 v160, v160, v97
    v_cvt_pk_bf16_f32 v96, v96, v97
    v_add_f32 v159, v159, v98
    v_add_f32 v160, v160, v99
    v_cvt_pk_bf16_f32 v97, v98, v99
    v_add_f32 v159, v159, v100
    v_add_f32 v160, v160, v101
    v_cvt_pk_bf16_f32 v98, v100, v101
    v_add_f32 v159, v159, v102
    v_add_f32 v160, v160, v103
    v_cvt_pk_bf16_f32 v99, v102, v103
    v_add_f32 v159, v159, v104
    v_add_f32 v160, v160, v105
    v_cvt_pk_bf16_f32 v100, v104, v105
    v_add_f32 v159, v159, v106
    v_add_f32 v160, v160, v107
    v_cvt_pk_bf16_f32 v101, v106, v107
    v_add_f32 v159, v159, v108
    v_add_f32 v160, v160, v109
    v_cvt_pk_bf16_f32 v102, v108, v109
    v_add_f32 v159, v159, v110
    v_add_f32 v160, v160, v111
    v_cvt_pk_bf16_f32 v103, v110, v111
    v_mfma_f32_32x32x16_bf16 v[0:15], v[112:115], v[96:99], v[0:15]
    ds_read_b128 v[112:115], v144 offset:24576
    v_mfma_f32_32x32x16_bf16 v[16:31], v[116:119], v[96:99], v[16:31]
    ds_read_b128 v[116:119], v145 offset:24576
    v_mfma_f32_32x32x16_bf16 v[32:47], v[120:123], v[96:99], v[32:47]
    ds_read_b128 v[120:123], v146 offset:24576
    v_mfma_f32_32x32x16_bf16 v[48:63], v[124:127], v[96:99], v[48:63]
    ds_read_b128 v[124:127], v147 offset:24576
    v_mfma_f32_32x32x16_bf16 v[0:15], v[128:131], v[100:103], v[0:15]
    ds_read_b128 v[128:131], v148 offset:24576
    v_mfma_f32_32x32x16_bf16 v[16:31], v[132:135], v[100:103], v[16:31]
    ds_read_b128 v[132:135], v149 offset:24576
    v_mfma_f32_32x32x16_bf16 v[32:47], v[136:139], v[100:103], v[32:47]
    ds_read_b128 v[136:139], v150 offset:24576
    v_mfma_f32_32x32x16_bf16 v[48:63], v[140:143], v[100:103], v[48:63]
    ds_read_b128 v[140:143], v151 offset:24576
    s_waitcnt lgkmcnt(7)
    v_mfma_f32_32x32x16_bf16 v[96:111], v[112:115], v[64:67], 0
    ds_read_b64_tr_b16 v[112:113], v152 offset:57344
    ds_read_b64_tr_b16 v[114:115], v152 offset:59392
    s_waitcnt lgkmcnt(8)
    v_mfma_f32_32x32x16_bf16 v[96:111], v[116:119], v[68:71], v[96:111]
    ds_read_b64_tr_b16 v[116:117], v153 offset:57344
    ds_read_b64_tr_b16 v[118:119], v153 offset:59392
    s_waitcnt lgkmcnt(9)
    v_mfma_f32_32x32x16_bf16 v[96:111], v[120:123], v[72:75], v[96:111]
    ds_read_b64_tr_b16 v[120:121], v154 offset:57344
    ds_read_b64_tr_b16 v[122:123], v154 offset:59392
    s_waitcnt lgkmcnt(10)
    v_mfma_f32_32x32x16_bf16 v[96:111], v[124:127], v[76:79], v[96:111]
    ds_read_b64_tr_b16 v[124:125], v155 offset:57344
    ds_read_b64_tr_b16 v[126:127], v155 offset:59392
    s_waitcnt lgkmcnt(11)
    v_mfma_f32_32x32x16_bf16 v[96:111], v[128:131], v[80:83], v[96:111]
    ds_read_b64_tr_b16 v[128:129], v152 offset:61440
    ds_read_b64_tr_b16 v[130:131], v152 offset:63488
    s_waitcnt lgkmcnt(12)
    v_mfma_f32_32x32x16_bf16 v[96:111], v[132:135], v[84:87], v[96:111]
    ds_read_b64_tr_b16 v[132:133], v153 offset:61440
    ds_read_b64_tr_b16 v[134:135], v153 offset:63488
    s_waitcnt lgkmcnt(13)
    v_mfma_f32_32x32x16_bf16 v[96:111], v[136:139], v[88:91], v[96:111]
    ds_read_b64_tr_b16 v[136:137], v154 offset:61440
    ds_read_b64_tr_b16 v[138:139], v154 offset:63488
    s_waitcnt lgkmcnt(14)
    v_mfma_f32_32x32x16_bf16 v[96:111], v[140:143], v[92:95], v[96:111]
    ds_read_b64_tr_b16 v[140:141], v155 offset:61440
    ds_read_b64_tr_b16 v[142:143], v155 offset:63488
    s_nop 9
    v_max3_f32 v161, v96, v97, v98
    v_max3_f32 v162, v99, v100, v101
    v_max3_f32 v161, v161, v102, v103
    v_max3_f32 v162, v162, v104, v105
    v_max3_f32 v161, v161, v106, v107
    v_max3_f32 v162, v162, v108, v109
    v_max3_f32 v161, v161, v110, v111
    v_max_f32 v161, v161, v162
    v_cmp_gt_f32 vcc, v161, v157
    s_cbranch_vccnz K1_SLOWr2z
K1_RETr2z:
    v_fma_f32 v96, v96, s31, v158
    v_fma_f32 v97, v97, s31, v158
    v_fma_f32 v98, v98, s31, v158
    v_fma_f32 v99, v99, s31, v158
    v_fma_f32 v100, v100, s31, v158
    v_fma_f32 v101, v101, s31, v158
    v_fma_f32 v102, v102, s31, v158
    v_fma_f32 v103, v103, s31, v158
    v_fma_f32 v104, v104, s31, v158
    v_fma_f32 v105, v105, s31, v158
    v_fma_f32 v106, v106, s31, v158
    v_fma_f32 v107, v107, s31, v158
    v_fma_f32 v108, v108, s31, v158
    v_fma_f32 v109, v109, s31, v158
    v_fma_f32 v110, v110, s31, v158
    v_fma_f32 v111, v111, s31, v158
    v_exp_f32 v96, v96
    v_exp_f32 v97, v97
    v_exp_f32 v98, v98
    v_exp_f32 v99, v99
    v_exp_f32 v100, v100
    v_exp_f32 v101, v101
    v_exp_f32 v102, v102
    v_exp_f32 v103, v103
    v_exp_f32 v104, v104
    v_exp_f32 v105, v105
    v_exp_f32 v106, v106
    v_exp_f32 v107, v107
    v_exp_f32 v108, v108
    v_exp_f32 v109, v109
    v_exp_f32 v110, v110
    v_exp_f32 v111, v111
    v_add_f32 v159, v159, v96
    v_add_f32 v160, v160, v97
    v_cvt_pk_bf16_f32 v96, v96, v97
    v_add_f32 v159, v159, v98
    v_add_f32 v160, v160, v99
    v_cvt_pk_bf16_f32 v97, v98, v99
    v_add_f32 v159, v159, v100
    v_add_f32 v160, v160, v101
    v_cvt_pk_bf16_f32 v98, v100, v101
    v_add_f32 v159, v159, v102
    v_add_f32 v160, v160, v103
    v_cvt_pk_bf16_f32 v99, v102, v103
    v_add_f32 v159, v159, v104
    v_add_f32 v160, v160, v105
    v_cvt_pk_bf16_f32 v100, v104, v105
    v_add_f32 v159, v159, v106
    v_add_f32 v160, v160, v107
    v_cvt_pk_bf16_f32 v101, v106, v107
    v_add_f32 v159, v159, v108
    v_add_f32 v160, v160, v109
    v_cvt_pk_bf16_f32 v102, v108, v109
    v_add_f32 v159, v159, v110
    v_add_f32 v160, v160, v111
    v_cvt_pk_bf16_f32 v103, v110, v111
    s_waitcnt lgkmcnt(14)
    v_mfma_f32_32x32x16_bf16 v[0:15], v[112:115], v[96:99], v[0:15]
    s_waitcnt lgkmcnt(12)
    v_mfma_f32_32x32x16_bf16 v[16:31], v[116:119], v[96:99], v[16:31]
    s_waitcnt lgkmcnt(10)
    v_mfma_f32_32x32x16_bf16 v[32:47], v[120:123], v[96:99], v[32:47]
    s_waitcnt lgkmcnt(8)
    v_mfma_f32_32x32x16_bf16 v[48:63], v[124:127], v[96:99], v[48:63]
    s_waitcnt lgkmcnt(6)
    v_mfma_f32_32x32x16_bf16 v[0:15], v[128:131], v[100:103], v[0:15]
    s_waitcnt lgkmcnt(4)
    v_mfma_f32_32x32x16_bf16 v[16:31], v[132:135], v[100:103], v[16:31]
    s_waitcnt lgkmcnt(2)
    v_mfma_f32_32x32x16_bf16 v[32:47], v[136:139], v[100:103], v[32:47]
    s_waitcnt lgkmcnt(0)
    v_mfma_f32_32x32x16_bf16 v[48:63], v[140:143], v[100:103], v[48:63]
    s_waitcnt lgkmcnt(0)
    s_nop 10
K1_EPI:
    v_add_f32 v159, v159, v160
    v_mov_b32 v161, v159
    s_nop 1
    v_permlane32_swap_b32 v159, v161
    v_add_f32 v159, v159, v161
    v_rcp_f32 v159, v159
    v_lshlrev_b32 v162, 4, v166
    v_add_u32 v167, 4096, v162
    v_mul_f32 v0, v0, v159
    v_mul_f32 v1, v1, v159
    v_mul_f32 v2, v2, v159
    v_mul_f32 v3, v3, v159
    v_mul_f32 v4, v4, v159
    v_mul_f32 v5, v5, v159
    v_mul_f32 v6, v6, v159
    v_mul_f32 v7, v7, v159
    v_mul_f32 v8, v8, v159
    v_mul_f32 v9, v9, v159
    v_mul_f32 v10, v10, v159
    v_mul_f32 v11, v11, v159
    v_mul_f32 v12, v12, v159
    v_mul_f32 v13, v13, v159
    v_mul_f32 v14, v14, v159
    v_mul_f32 v15, v15, v159
    v_cvt_pk_bf16_f32 v112, v0, v1
    v_cvt_pk_bf16_f32 v113, v2, v3
    v_cvt_pk_bf16_f32 v114, v4, v5
    v_cvt_pk_bf16_f32 v115, v6, v7
    buffer_store_dwordx4 v[112:115], v162, s[24:27], 0 offen offset:0 sc0 sc1
    v_cvt_pk_bf16_f32 v116, v8, v9
    v_cvt_pk_bf16_f32 v117, v10, v11
    v_cvt_pk_bf16_f32 v118, v12, v13
    v_cvt_pk_bf16_f32 v119, v14, v15
    buffer_store_dwordx4 v[116:119], v162, s[24:27], 0 offen offset:1024 sc0 sc1
    v_mul_f32 v16, v16, v159
    v_mul_f32 v17, v17, v159
    v_mul_f32 v18, v18, v159
    v_mul_f32 v19, v19, v159
    v_mul_f32 v20, v20, v159
    v_mul_f32 v21, v21, v159
    v_mul_f32 v22, v22, v159
    v_mul_f32 v23, v23, v159
    v_mul_f32 v24, v24, v159
    v_mul_f32 v25, v25, v159
    v_mul_f32 v26, v26, v159
    v_mul_f32 v27, v27, v159
    v_mul_f32 v28, v28, v159
    v_mul_f32 v29, v29, v159
    v_mul_f32 v30, v30, v159
    v_mul_f32 v31, v31, v159
    v_cvt_pk_bf16_f32 v120, v16, v17
    v_cvt_pk_bf16_f32 v121, v18, v19
    v_cvt_pk_bf16_f32 v122, v20, v21
    v_cvt_pk_bf16_f32 v123, v22, v23
    buffer_store_dwordx4 v[120:123], v162, s[24:27], 0 offen offset:2048 sc0 sc1
    v_cvt_pk_bf16_f32 v124, v24, v25
    v_cvt_pk_bf16_f32 v125, v26, v27
    v_cvt_pk_bf16_f32 v126, v28, v29
    v_cvt_pk_bf16_f32 v127, v30, v31
    buffer_store_dwordx4 v[124:127], v162, s[24:27], 0 offen offset:3072 sc0 sc1
    v_mul_f32 v32, v32, v159
    v_mul_f32 v33, v33, v159
    v_mul_f32 v34, v34, v159
    v_mul_f32 v35, v35, v159
    v_mul_f32 v36, v36, v159
    v_mul_f32 v37, v37, v159
    v_mul_f32 v38, v38, v159
    v_mul_f32 v39, v39, v159
    v_mul_f32 v40, v40, v159
    v_mul_f32 v41, v41, v159
    v_mul_f32 v42, v42, v159
    v_mul_f32 v43, v43, v159
    v_mul_f32 v44, v44, v159
    v_mul_f32 v45, v45, v159
    v_mul_f32 v46, v46, v159
    v_mul_f32 v47, v47, v159
    v_cvt_pk_bf16_f32 v128, v32, v33
    v_cvt_pk_bf16_f32 v129, v34, v35
    v_cvt_pk_bf16_f32 v130, v36, v37
    v_cvt_pk_bf16_f32 v131, v38, v39
    buffer_store_dwordx4 v[128:131], v167, s[24:27], 0 offen offset:0 sc0 sc1
    v_cvt_pk_bf16_f32 v132, v40, v41
    v_cvt_pk_bf16_f32 v133, v42, v43
    v_cvt_pk_bf16_f32 v134, v44, v45
    v_cvt_pk_bf16_f32 v135, v46, v47
    buffer_store_dwordx4 v[132:135], v167, s[24:27], 0 offen offset:1024 sc0 sc1
    v_mul_f32 v48, v48, v159
    v_mul_f32 v49, v49, v159
    v_mul_f32 v50, v50, v159
    v_mul_f32 v51, v51, v159
    v_mul_f32 v52, v52, v159
    v_mul_f32 v53, v53, v159
    v_mul_f32 v54, v54, v159
    v_mul_f32 v55, v55, v159
    v_mul_f32 v56, v56, v159
    v_mul_f32 v57, v57, v159
    v_mul_f32 v58, v58, v159
    v_mul_f32 v59, v59, v159
    v_mul_f32 v60, v60, v159
    v_mul_f32 v61, v61, v159
    v_mul_f32 v62, v62, v159
    v_mul_f32 v63, v63, v159
    v_cvt_pk_bf16_f32 v136, v48, v49
    v_cvt_pk_bf16_f32 v137, v50, v51
    v_cvt_pk_bf16_f32 v138, v52, v53
    v_cvt_pk_bf16_f32 v139, v54, v55
    buffer_store_dwordx4 v[136:139], v167, s[24:27], 0 offen offset:2048 sc0 sc1
    v_cvt_pk_bf16_f32 v140, v56, v57
    v_cvt_pk_bf16_f32 v141, v58, v59
    v_cvt_pk_bf16_f32 v142, v60, v61
    v_cvt_pk_bf16_f32 v143, v62, v63
    buffer_store_dwordx4 v[140:143], v167, s[24:27], 0 offen offset:3072 sc0 sc1
    s_nop 0
K1_END:
    s_endpgm
K1_SLOWr0p0:
    v_mov_b32 v162, v161
    s_nop 1
    v_permlane32_swap_b32 v161, v162
    v_max3_f32 v161, v161, v162, v156
    v_sub_f32 v162, v156, v161
    v_mul_f32 v162, s31, v162
    v_exp_f32 v162, v162
    v_mov_b32 v156, v161
    v_add_f32 v157, s67, v161
    v_mul_f32 v158, s31, v161
    v_sub_f32 v158, 0, v158
    v_mul_f32 v159, v159, v162
    v_mul_f32 v160, v160, v162
    v_mul_f32 v0, v0, v162
    v_mul_f32 v1, v1, v162
    v_mul_f32 v2, v2, v162
    v_mul_f32 v3, v3, v162
    v_mul_f32 v4, v4, v162
    v_mul_f32 v5, v5, v162
    v_mul_f32 v6, v6, v162
    v_mul_f32 v7, v7, v162
    v_mul_f32 v8, v8, v162
    v_mul_f32 v9, v9, v162
    v_mul_f32 v10, v10, v162
    v_mul_f32 v11, v11, v162
    v_mul_f32 v12, v12, v162
    v_mul_f32 v13, v13, v162
    v_mul_f32 v14, v14, v162
    v_mul_f32 v15, v15, v162
    v_mul_f32 v16, v16, v162
    v_mul_f32 v17, v17, v162
    v_mul_f32 v18, v18, v162
    v_mul_f32 v19, v19, v162
    v_mul_f32 v20, v20, v162
    v_mul_f32 v21, v21, v162
    v_mul_f32 v22, v22, v162
    v_mul_f32 v23, v23, v162
    v_mul_f32 v24, v24, v162
    v_mul_f32 v25, v25, v162
    v_mul_f32 v26, v26, v162
    v_mul_f32 v27, v27, v162
    v_mul_f32 v28, v28, v162
    v_mul_f32 v29, v29, v162
    v_mul_f32 v30, v30, v162
    v_mul_f32 v31, v31, v162
    v_mul_f32 v32, v32, v162
    v_mul_f32 v33, v33, v162
    v_mul_f32 v34, v34, v162
    v_mul_f32 v35, v35, v162
    v_mul_f32 v36, v36, v162
    v_mul_f32 v37, v37, v162
    v_mul_f32 v38, v38, v162
    v_mul_f32 v39, v39, v162
    v_mul_f32 v40, v40, v162
    v_mul_f32 v41, v41, v162
    v_mul_f32 v42, v42, v162
    v_mul_f32 v43, v43, v162
    v_mul_f32 v44, v44, v162
    v_mul_f32 v45, v45, v162
    v_mul_f32 v46, v46, v162
    v_mul_f32 v47, v47, v162
    v_mul_f32 v48, v48, v162
    v_mul_f32 v49, v49, v162
    v_mul_f32 v50, v50, v162
    v_mul_f32 v51, v51, v162
    v_mul_f32 v52, v52, v162
    v_mul_f32 v53, v53, v162
    v_mul_f32 v54, v54, v162
    v_mul_f32 v55, v55, v162
    v_mul_f32 v56, v56, v162
    v_mul_f32 v57, v57, v162
    v_mul_f32 v58, v58, v162
    v_mul_f32 v59, v59, v162
    v_mul_f32 v60, v60, v162
    v_mul_f32 v61, v61, v162
    v_mul_f32 v62, v62, v162
    v_mul_f32 v63, v63, v162
    s_nop 1
    s_branch K1_RETr0p0
K1_SLOWr0p1:
    v_mov_b32 v162, v161
    s_nop 1
    v_permlane32_swap_b32 v161, v162
    v_max3_f32 v161, v161, v162, v156
    v_sub_f32 v162, v156, v161
    v_mul_f32 v162, s31, v162
    v_exp_f32 v162, v162
    v_mov_b32 v156, v161
    v_add_f32 v157, s67, v161
    v_mul_f32 v158, s31, v161
    v_sub_f32 v158, 0, v158
    v_mul_f32 v159, v159, v162
    v_mul_f32 v160, v160, v162
    v_mul_f32 v0, v0, v162
    v_mul_f32 v1, v1, v162
    v_mul_f32 v2, v2, v162
    v_mul_f32 v3, v3, v162
    v_mul_f32 v4, v4, v162
    v_mul_f32 v5, v5, v162
    v_mul_f32 v6, v6, v162
    v_mul_f32 v7, v7, v162
    v_mul_f32 v8, v8, v162
    v_mul_f32 v9, v9, v162
    v_mul_f32 v10, v10, v162
    v_mul_f32 v11, v11, v162
    v_mul_f32 v12, v12, v162
    v_mul_f32 v13, v13, v162
    v_mul_f32 v14, v14, v162
    v_mul_f32 v15, v15, v162
    v_mul_f32 v16, v16, v162
    v_mul_f32 v17, v17, v162
    v_mul_f32 v18, v18, v162
    v_mul_f32 v19, v19, v162
    v_mul_f32 v20, v20, v162
    v_mul_f32 v21, v21, v162
    v_mul_f32 v22, v22, v162
    v_mul_f32 v23, v23, v162
    v_mul_f32 v24, v24, v162
    v_mul_f32 v25, v25, v162
    v_mul_f32 v26, v26, v162
    v_mul_f32 v27, v27, v162
    v_mul_f32 v28, v28, v162
    v_mul_f32 v29, v29, v162
    v_mul_f32 v30, v30, v162
    v_mul_f32 v31, v31, v162
    v_mul_f32 v32, v32, v162
    v_mul_f32 v33, v33, v162
    v_mul_f32 v34, v34, v162
    v_mul_f32 v35, v35, v162
    v_mul_f32 v36, v36, v162
    v_mul_f32 v37, v37, v162
    v_mul_f32 v38, v38, v162
    v_mul_f32 v39, v39, v162
    v_mul_f32 v40, v40, v162
    v_mul_f32 v41, v41, v162
    v_mul_f32 v42, v42, v162
    v_mul_f32 v43, v43, v162
    v_mul_f32 v44, v44, v162
    v_mul_f32 v45, v45, v162
    v_mul_f32 v46, v46, v162
    v_mul_f32 v47, v47, v162
    v_mul_f32 v48, v48, v162
    v_mul_f32 v49, v49, v162
    v_mul_f32 v50, v50, v162
    v_mul_f32 v51, v51, v162
    v_mul_f32 v52, v52, v162
    v_mul_f32 v53, v53, v162
    v_mul_f32 v54, v54, v162
    v_mul_f32 v55, v55, v162
    v_mul_f32 v56, v56, v162
    v_mul_f32 v57, v57, v162
    v_mul_f32 v58, v58, v162
    v_mul_f32 v59, v59, v162
    v_mul_f32 v60, v60, v162
    v_mul_f32 v61, v61, v162
    v_mul_f32 v62, v62, v162
    v_mul_f32 v63, v63, v162
    s_nop 1
    s_branch K1_RETr0p1
K1_SLOWr0p2:
    v_mov_b32 v162, v161
    s_nop 1
    v_permlane32_swap_b32 v161, v162
    v_max3_f32 v161, v161, v162, v156
    v_sub_f32 v162, v156, v161
    v_mul_f32 v162, s31, v162
    v_exp_f32 v162, v162
    v_mov_b32 v156, v161
    v_add_f32 v157, s67, v161
    v_mul_f32 v158, s31, v161
    v_sub_f32 v158, 0, v158
    v_mul_f32 v159, v159, v162
    v_mul_f32 v160, v160, v162
    v_mul_f32 v0, v0, v162
    v_mul_f32 v1, v1, v162
    v_mul_f32 v2, v2, v162
    v_mul_f32 v3, v3, v162
    v_mul_f32 v4, v4, v162
    v_mul_f32 v5, v5, v162
    v_mul_f32 v6, v6, v162
    v_mul_f32 v7, v7, v162
    v_mul_f32 v8, v8, v162
    v_mul_f32 v9, v9, v162
    v_mul_f32 v10, v10, v162
    v_mul_f32 v11, v11, v162
    v_mul_f32 v12, v12, v162
    v_mul_f32 v13, v13, v162
    v_mul_f32 v14, v14, v162
    v_mul_f32 v15, v15, v162
    v_mul_f32 v16, v16, v162
    v_mul_f32 v17, v17, v162
    v_mul_f32 v18, v18, v162
    v_mul_f32 v19, v19, v162
    v_mul_f32 v20, v20, v162
    v_mul_f32 v21, v21, v162
    v_mul_f32 v22, v22, v162
    v_mul_f32 v23, v23, v162
    v_mul_f32 v24, v24, v162
    v_mul_f32 v25, v25, v162
    v_mul_f32 v26, v26, v162
    v_mul_f32 v27, v27, v162
    v_mul_f32 v28, v28, v162
    v_mul_f32 v29, v29, v162
    v_mul_f32 v30, v30, v162
    v_mul_f32 v31, v31, v162
    v_mul_f32 v32, v32, v162
    v_mul_f32 v33, v33, v162
    v_mul_f32 v34, v34, v162
    v_mul_f32 v35, v35, v162
    v_mul_f32 v36, v36, v162
    v_mul_f32 v37, v37, v162
    v_mul_f32 v38, v38, v162
    v_mul_f32 v39, v39, v162
    v_mul_f32 v40, v40, v162
    v_mul_f32 v41, v41, v162
    v_mul_f32 v42, v42, v162
    v_mul_f32 v43, v43, v162
    v_mul_f32 v44, v44, v162
    v_mul_f32 v45, v45, v162
    v_mul_f32 v46, v46, v162
    v_mul_f32 v47, v47, v162
    v_mul_f32 v48, v48, v162
    v_mul_f32 v49, v49, v162
    v_mul_f32 v50, v50, v162
    v_mul_f32 v51, v51, v162
    v_mul_f32 v52, v52, v162
    v_mul_f32 v53, v53, v162
    v_mul_f32 v54, v54, v162
    v_mul_f32 v55, v55, v162
    v_mul_f32 v56, v56, v162
    v_mul_f32 v57, v57, v162
    v_mul_f32 v58, v58, v162
    v_mul_f32 v59, v59, v162
    v_mul_f32 v60, v60, v162
    v_mul_f32 v61, v61, v162
    v_mul_f32 v62, v62, v162
    v_mul_f32 v63, v63, v162
    s_nop 1
    s_branch K1_RETr0p2
K1_SLOWr0p3:
    v_mov_b32 v162, v161
    s_nop 1
    v_permlane32_swap_b32 v161, v162
    v_max3_f32 v161, v161, v162, v156
    v_sub_f32 v162, v156, v161
    v_mul_f32 v162, s31, v162
    v_exp_f32 v162, v162
    v_mov_b32 v156, v161
    v_add_f32 v157, s67, v161
    v_mul_f32 v158, s31, v161
    v_sub_f32 v158, 0, v158
    v_mul_f32 v159, v159, v162
    v_mul_f32 v160, v160, v162
    v_mul_f32 v0, v0, v162
    v_mul_f32 v1, v1, v162
    v_mul_f32 v2, v2, v162
    v_mul_f32 v3, v3, v162
    v_mul_f32 v4, v4, v162
    v_mul_f32 v5, v5, v162
    v_mul_f32 v6, v6, v162
    v_mul_f32 v7, v7, v162
    v_mul_f32 v8, v8, v162
    v_mul_f32 v9, v9, v162
    v_mul_f32 v10, v10, v162
    v_mul_f32 v11, v11, v162
    v_mul_f32 v12, v12, v162
    v_mul_f32 v13, v13, v162
    v_mul_f32 v14, v14, v162
    v_mul_f32 v15, v15, v162
    v_mul_f32 v16, v16, v162
    v_mul_f32 v17, v17, v162
    v_mul_f32 v18, v18, v162
    v_mul_f32 v19, v19, v162
    v_mul_f32 v20, v20, v162
    v_mul_f32 v21, v21, v162
    v_mul_f32 v22, v22, v162
    v_mul_f32 v23, v23, v162
    v_mul_f32 v24, v24, v162
    v_mul_f32 v25, v25, v162
    v_mul_f32 v26, v26, v162
    v_mul_f32 v27, v27, v162
    v_mul_f32 v28, v28, v162
    v_mul_f32 v29, v29, v162
    v_mul_f32 v30, v30, v162
    v_mul_f32 v31, v31, v162
    v_mul_f32 v32, v32, v162
    v_mul_f32 v33, v33, v162
    v_mul_f32 v34, v34, v162
    v_mul_f32 v35, v35, v162
    v_mul_f32 v36, v36, v162
    v_mul_f32 v37, v37, v162
    v_mul_f32 v38, v38, v162
    v_mul_f32 v39, v39, v162
    v_mul_f32 v40, v40, v162
    v_mul_f32 v41, v41, v162
    v_mul_f32 v42, v42, v162
    v_mul_f32 v43, v43, v162
    v_mul_f32 v44, v44, v162
    v_mul_f32 v45, v45, v162
    v_mul_f32 v46, v46, v162
    v_mul_f32 v47, v47, v162
    v_mul_f32 v48, v48, v162
    v_mul_f32 v49, v49, v162
    v_mul_f32 v50, v50, v162
    v_mul_f32 v51, v51, v162
    v_mul_f32 v52, v52, v162
    v_mul_f32 v53, v53, v162
    v_mul_f32 v54, v54, v162
    v_mul_f32 v55, v55, v162
    v_mul_f32 v56, v56, v162
    v_mul_f32 v57, v57, v162
    v_mul_f32 v58, v58, v162
    v_mul_f32 v59, v59, v162
    v_mul_f32 v60, v60, v162
    v_mul_f32 v61, v61, v162
    v_mul_f32 v62, v62, v162
    v_mul_f32 v63, v63, v162
    s_nop 1
    s_branch K1_RETr0p3
K1_SLOWr0a0:
    v_mov_b32 v162, v161
    s_nop 1
    v_permlane32_swap_b32 v161, v162
    v_max3_f32 v161, v161, v162, v156
    v_sub_f32 v162, v156, v161
    v_mul_f32 v162, s31, v162
    v_exp_f32 v162, v162
    v_mov_b32 v156, v161
    v_add_f32 v157, s67, v161
    v_mul_f32 v158, s31, v161
    v_sub_f32 v158, 0, v158
    v_mul_f32 v159, v159, v162
    v_mul_f32 v160, v160, v162
    v_mul_f32 v0, v0, v162
    v_mul_f32 v1, v1, v162
    v_mul_f32 v2, v2, v162
    v_mul_f32 v3, v3, v162
    v_mul_f32 v4, v4, v162
    v_mul_f32 v5, v5, v162
    v_mul_f32 v6, v6, v162
    v_mul_f32 v7, v7, v162
    v_mul_f32 v8, v8, v162
    v_mul_f32 v9, v9, v162
    v_mul_f32 v10, v10, v162
    v_mul_f32 v11, v11, v162
    v_mul_f32 v12, v12, v162
    v_mul_f32 v13, v13, v162
    v_mul_f32 v14, v14, v162
    v_mul_f32 v15, v15, v162
    v_mul_f32 v16, v16, v162
    v_mul_f32 v17, v17, v162
    v_mul_f32 v18, v18, v162
    v_mul_f32 v19, v19, v162
    v_mul_f32 v20, v20, v162
    v_mul_f32 v21, v21, v162
    v_mul_f32 v22, v22, v162
    v_mul_f32 v23, v23, v162
    v_mul_f32 v24, v24, v162
    v_mul_f32 v25, v25, v162
    v_mul_f32 v26, v26, v162
    v_mul_f32 v27, v27, v162
    v_mul_f32 v28, v28, v162
    v_mul_f32 v29, v29, v162
    v_mul_f32 v30, v30, v162
    v_mul_f32 v31, v31, v162
    v_mul_f32 v32, v32, v162
    v_mul_f32 v33, v33, v162
    v_mul_f32 v34, v34, v162
    v_mul_f32 v35, v35, v162
    v_mul_f32 v36, v36, v162
    v_mul_f32 v37, v37, v162
    v_mul_f32 v38, v38, v162
    v_mul_f32 v39, v39, v162
    v_mul_f32 v40, v40, v162
    v_mul_f32 v41, v41, v162
    v_mul_f32 v42, v42, v162
    v_mul_f32 v43, v43, v162
    v_mul_f32 v44, v44, v162
    v_mul_f32 v45, v45, v162
    v_mul_f32 v46, v46, v162
    v_mul_f32 v47, v47, v162
    v_mul_f32 v48, v48, v162
    v_mul_f32 v49, v49, v162
    v_mul_f32 v50, v50, v162
    v_mul_f32 v51, v51, v162
    v_mul_f32 v52, v52, v162
    v_mul_f32 v53, v53, v162
    v_mul_f32 v54, v54, v162
    v_mul_f32 v55, v55, v162
    v_mul_f32 v56, v56, v162
    v_mul_f32 v57, v57, v162
    v_mul_f32 v58, v58, v162
    v_mul_f32 v59, v59, v162
    v_mul_f32 v60, v60, v162
    v_mul_f32 v61, v61, v162
    v_mul_f32 v62, v62, v162
    v_mul_f32 v63, v63, v162
    s_nop 1
    s_branch K1_RETr0a0
K1_SLOWr0a1:
    v_mov_b32 v162, v161
    s_nop 1
    v_permlane32_swap_b32 v161, v162
    v_max3_f32 v161, v161, v162, v156
    v_sub_f32 v162, v156, v161
    v_mul_f32 v162, s31, v162
    v_exp_f32 v162, v162
    v_mov_b32 v156, v161
    v_add_f32 v157, s67, v161
    v_mul_f32 v158, s31, v161
    v_sub_f32 v158, 0, v158
    v_mul_f32 v159, v159, v162
    v_mul_f32 v160, v160, v162
    v_mul_f32 v0, v0, v162
    v_mul_f32 v1, v1, v162
    v_mul_f32 v2, v2, v162
    v_mul_f32 v3, v3, v162
    v_mul_f32 v4, v4, v162
    v_mul_f32 v5, v5, v162
    v_mul_f32 v6, v6, v162
    v_mul_f32 v7, v7, v162
    v_mul_f32 v8, v8, v162
    v_mul_f32 v9, v9, v162
    v_mul_f32 v10, v10, v162
    v_mul_f32 v11, v11, v162
    v_mul_f32 v12, v12, v162
    v_mul_f32 v13, v13, v162
    v_mul_f32 v14, v14, v162
    v_mul_f32 v15, v15, v162
    v_mul_f32 v16, v16, v162
    v_mul_f32 v17, v17, v162
    v_mul_f32 v18, v18, v162
    v_mul_f32 v19, v19, v162
    v_mul_f32 v20, v20, v162
    v_mul_f32 v21, v21, v162
    v_mul_f32 v22, v22, v162
    v_mul_f32 v23, v23, v162
    v_mul_f32 v24, v24, v162
    v_mul_f32 v25, v25, v162
    v_mul_f32 v26, v26, v162
    v_mul_f32 v27, v27, v162
    v_mul_f32 v28, v28, v162
    v_mul_f32 v29, v29, v162
    v_mul_f32 v30, v30, v162
    v_mul_f32 v31, v31, v162
    v_mul_f32 v32, v32, v162
    v_mul_f32 v33, v33, v162
    v_mul_f32 v34, v34, v162
    v_mul_f32 v35, v35, v162
    v_mul_f32 v36, v36, v162
    v_mul_f32 v37, v37, v162
    v_mul_f32 v38, v38, v162
    v_mul_f32 v39, v39, v162
    v_mul_f32 v40, v40, v162
    v_mul_f32 v41, v41, v162
    v_mul_f32 v42, v42, v162
    v_mul_f32 v43, v43, v162
    v_mul_f32 v44, v44, v162
    v_mul_f32 v45, v45, v162
    v_mul_f32 v46, v46, v162
    v_mul_f32 v47, v47, v162
    v_mul_f32 v48, v48, v162
    v_mul_f32 v49, v49, v162
    v_mul_f32 v50, v50, v162
    v_mul_f32 v51, v51, v162
    v_mul_f32 v52, v52, v162
    v_mul_f32 v53, v53, v162
    v_mul_f32 v54, v54, v162
    v_mul_f32 v55, v55, v162
    v_mul_f32 v56, v56, v162
    v_mul_f32 v57, v57, v162
    v_mul_f32 v58, v58, v162
    v_mul_f32 v59, v59, v162
    v_mul_f32 v60, v60, v162
    v_mul_f32 v61, v61, v162
    v_mul_f32 v62, v62, v162
    v_mul_f32 v63, v63, v162
    s_nop 1
    s_branch K1_RETr0a1
K1_SLOWr0a2:
    v_mov_b32 v162, v161
    s_nop 1
    v_permlane32_swap_b32 v161, v162
    v_max3_f32 v161, v161, v162, v156
    v_sub_f32 v162, v156, v161
    v_mul_f32 v162, s31, v162
    v_exp_f32 v162, v162
    v_mov_b32 v156, v161
    v_add_f32 v157, s67, v161
    v_mul_f32 v158, s31, v161
    v_sub_f32 v158, 0, v158
    v_mul_f32 v159, v159, v162
    v_mul_f32 v160, v160, v162
    v_mul_f32 v0, v0, v162
    v_mul_f32 v1, v1, v162
    v_mul_f32 v2, v2, v162
    v_mul_f32 v3, v3, v162
    v_mul_f32 v4, v4, v162
    v_mul_f32 v5, v5, v162
    v_mul_f32 v6, v6, v162
    v_mul_f32 v7, v7, v162
    v_mul_f32 v8, v8, v162
    v_mul_f32 v9, v9, v162
    v_mul_f32 v10, v10, v162
    v_mul_f32 v11, v11, v162
    v_mul_f32 v12, v12, v162
    v_mul_f32 v13, v13, v162
    v_mul_f32 v14, v14, v162
    v_mul_f32 v15, v15, v162
    v_mul_f32 v16, v16, v162
    v_mul_f32 v17, v17, v162
    v_mul_f32 v18, v18, v162
    v_mul_f32 v19, v19, v162
    v_mul_f32 v20, v20, v162
    v_mul_f32 v21, v21, v162
    v_mul_f32 v22, v22, v162
    v_mul_f32 v23, v23, v162
    v_mul_f32 v24, v24, v162
    v_mul_f32 v25, v25, v162
    v_mul_f32 v26, v26, v162
    v_mul_f32 v27, v27, v162
    v_mul_f32 v28, v28, v162
    v_mul_f32 v29, v29, v162
    v_mul_f32 v30, v30, v162
    v_mul_f32 v31, v31, v162
    v_mul_f32 v32, v32, v162
    v_mul_f32 v33, v33, v162
    v_mul_f32 v34, v34, v162
    v_mul_f32 v35, v35, v162
    v_mul_f32 v36, v36, v162
    v_mul_f32 v37, v37, v162
    v_mul_f32 v38, v38, v162
    v_mul_f32 v39, v39, v162
    v_mul_f32 v40, v40, v162
    v_mul_f32 v41, v41, v162
    v_mul_f32 v42, v42, v162
    v_mul_f32 v43, v43, v162
    v_mul_f32 v44, v44, v162
    v_mul_f32 v45, v45, v162
    v_mul_f32 v46, v46, v162
    v_mul_f32 v47, v47, v162
    v_mul_f32 v48, v48, v162
    v_mul_f32 v49, v49, v162
    v_mul_f32 v50, v50, v162
    v_mul_f32 v51, v51, v162
    v_mul_f32 v52, v52, v162
    v_mul_f32 v53, v53, v162
    v_mul_f32 v54, v54, v162
    v_mul_f32 v55, v55, v162
    v_mul_f32 v56, v56, v162
    v_mul_f32 v57, v57, v162
    v_mul_f32 v58, v58, v162
    v_mul_f32 v59, v59, v162
    v_mul_f32 v60, v60, v162
    v_mul_f32 v61, v61, v162
    v_mul_f32 v62, v62, v162
    v_mul_f32 v63, v63, v162
    s_nop 1
    s_branch K1_RETr0a2
K1_SLOWr0a3:
    v_mov_b32 v162, v161
    s_nop 1
    v_permlane32_swap_b32 v161, v162
    v_max3_f32 v161, v161, v162, v156
    v_sub_f32 v162, v156, v161
    v_mul_f32 v162, s31, v162
    v_exp_f32 v162, v162
    v_mov_b32 v156, v161
    v_add_f32 v157, s67, v161
    v_mul_f32 v158, s31, v161
    v_sub_f32 v158, 0, v158
    v_mul_f32 v159, v159, v162
    v_mul_f32 v160, v160, v162
    v_mul_f32 v0, v0, v162
    v_mul_f32 v1, v1, v162
    v_mul_f32 v2, v2, v162
    v_mul_f32 v3, v3, v162
    v_mul_f32 v4, v4, v162
    v_mul_f32 v5, v5, v162
    v_mul_f32 v6, v6, v162
    v_mul_f32 v7, v7, v162
    v_mul_f32 v8, v8, v162
    v_mul_f32 v9, v9, v162
    v_mul_f32 v10, v10, v162
    v_mul_f32 v11, v11, v162
    v_mul_f32 v12, v12, v162
    v_mul_f32 v13, v13, v162
    v_mul_f32 v14, v14, v162
    v_mul_f32 v15, v15, v162
    v_mul_f32 v16, v16, v162
    v_mul_f32 v17, v17, v162
    v_mul_f32 v18, v18, v162
    v_mul_f32 v19, v19, v162
    v_mul_f32 v20, v20, v162
    v_mul_f32 v21, v21, v162
    v_mul_f32 v22, v22, v162
    v_mul_f32 v23, v23, v162
    v_mul_f32 v24, v24, v162
    v_mul_f32 v25, v25, v162
    v_mul_f32 v26, v26, v162
    v_mul_f32 v27, v27, v162
    v_mul_f32 v28, v28, v162
    v_mul_f32 v29, v29, v162
    v_mul_f32 v30, v30, v162
    v_mul_f32 v31, v31, v162
    v_mul_f32 v32, v32, v162
    v_mul_f32 v33, v33, v162
    v_mul_f32 v34, v34, v162
    v_mul_f32 v35, v35, v162
    v_mul_f32 v36, v36, v162
    v_mul_f32 v37, v37, v162
    v_mul_f32 v38, v38, v162
    v_mul_f32 v39, v39, v162
    v_mul_f32 v40, v40, v162
    v_mul_f32 v41, v41, v162
    v_mul_f32 v42, v42, v162
    v_mul_f32 v43, v43, v162
    v_mul_f32 v44, v44, v162
    v_mul_f32 v45, v45, v162
    v_mul_f32 v46, v46, v162
    v_mul_f32 v47, v47, v162
    v_mul_f32 v48, v48, v162
    v_mul_f32 v49, v49, v162
    v_mul_f32 v50, v50, v162
    v_mul_f32 v51, v51, v162
    v_mul_f32 v52, v52, v162
    v_mul_f32 v53, v53, v162
    v_mul_f32 v54, v54, v162
    v_mul_f32 v55, v55, v162
    v_mul_f32 v56, v56, v162
    v_mul_f32 v57, v57, v162
    v_mul_f32 v58, v58, v162
    v_mul_f32 v59, v59, v162
    v_mul_f32 v60, v60, v162
    v_mul_f32 v61, v61, v162
    v_mul_f32 v62, v62, v162
    v_mul_f32 v63, v63, v162
    s_nop 1
    s_branch K1_RETr0a3
K1_SLOWr0b0:
    v_mov_b32 v162, v161
    s_nop 1
    v_permlane32_swap_b32 v161, v162
    v_max3_f32 v161, v161, v162, v156
    v_sub_f32 v162, v156, v161
    v_mul_f32 v162, s31, v162
    v_exp_f32 v162, v162
    v_mov_b32 v156, v161
    v_add_f32 v157, s67, v161
    v_mul_f32 v158, s31, v161
    v_sub_f32 v158, 0, v158
    v_mul_f32 v159, v159, v162
    v_mul_f32 v160, v160, v162
    v_mul_f32 v0, v0, v162
    v_mul_f32 v1, v1, v162
    v_mul_f32 v2, v2, v162
    v_mul_f32 v3, v3, v162
    v_mul_f32 v4, v4, v162
    v_mul_f32 v5, v5, v162
    v_mul_f32 v6, v6, v162
    v_mul_f32 v7, v7, v162
    v_mul_f32 v8, v8, v162
    v_mul_f32 v9, v9, v162
    v_mul_f32 v10, v10, v162
    v_mul_f32 v11, v11, v162
    v_mul_f32 v12, v12, v162
    v_mul_f32 v13, v13, v162
    v_mul_f32 v14, v14, v162
    v_mul_f32 v15, v15, v162
    v_mul_f32 v16, v16, v162
    v_mul_f32 v17, v17, v162
    v_mul_f32 v18, v18, v162
    v_mul_f32 v19, v19, v162
    v_mul_f32 v20, v20, v162
    v_mul_f32 v21, v21, v162
    v_mul_f32 v22, v22, v162
    v_mul_f32 v23, v23, v162
    v_mul_f32 v24, v24, v162
    v_mul_f32 v25, v25, v162
    v_mul_f32 v26, v26, v162
    v_mul_f32 v27, v27, v162
    v_mul_f32 v28, v28, v162
    v_mul_f32 v29, v29, v162
    v_mul_f32 v30, v30, v162
    v_mul_f32 v31, v31, v162
    v_mul_f32 v32, v32, v162
    v_mul_f32 v33, v33, v162
    v_mul_f32 v34, v34, v162
    v_mul_f32 v35, v35, v162
    v_mul_f32 v36, v36, v162
    v_mul_f32 v37, v37, v162
    v_mul_f32 v38, v38, v162
    v_mul_f32 v39, v39, v162
    v_mul_f32 v40, v40, v162
    v_mul_f32 v41, v41, v162
    v_mul_f32 v42, v42, v162
    v_mul_f32 v43, v43, v162
    v_mul_f32 v44, v44, v162
    v_mul_f32 v45, v45, v162
    v_mul_f32 v46, v46, v162
    v_mul_f32 v47, v47, v162
    v_mul_f32 v48, v48, v162
    v_mul_f32 v49, v49, v162
    v_mul_f32 v50, v50, v162
    v_mul_f32 v51, v51, v162
    v_mul_f32 v52, v52, v162
    v_mul_f32 v53, v53, v162
    v_mul_f32 v54, v54, v162
    v_mul_f32 v55, v55, v162
    v_mul_f32 v56, v56, v162
    v_mul_f32 v57, v57, v162
    v_mul_f32 v58, v58, v162
    v_mul_f32 v59, v59, v162
    v_mul_f32 v60, v60, v162
    v_mul_f32 v61, v61, v162
    v_mul_f32 v62, v62, v162
    v_mul_f32 v63, v63, v162
    s_nop 1
    s_branch K1_RETr0b0
K1_SLOWr0b1:
    v_mov_b32 v162, v161
    s_nop 1
    v_permlane32_swap_b32 v161, v162
    v_max3_f32 v161, v161, v162, v156
    v_sub_f32 v162, v156, v161
    v_mul_f32 v162, s31, v162
    v_exp_f32 v162, v162
    v_mov_b32 v156, v161
    v_add_f32 v157, s67, v161
    v_mul_f32 v158, s31, v161
    v_sub_f32 v158, 0, v158
    v_mul_f32 v159, v159, v162
    v_mul_f32 v160, v160, v162
    v_mul_f32 v0, v0, v162
    v_mul_f32 v1, v1, v162
    v_mul_f32 v2, v2, v162
    v_mul_f32 v3, v3, v162
    v_mul_f32 v4, v4, v162
    v_mul_f32 v5, v5, v162
    v_mul_f32 v6, v6, v162
    v_mul_f32 v7, v7, v162
    v_mul_f32 v8, v8, v162
    v_mul_f32 v9, v9, v162
    v_mul_f32 v10, v10, v162
    v_mul_f32 v11, v11, v162
    v_mul_f32 v12, v12, v162
    v_mul_f32 v13, v13, v162
    v_mul_f32 v14, v14, v162
    v_mul_f32 v15, v15, v162
    v_mul_f32 v16, v16, v162
    v_mul_f32 v17, v17, v162
    v_mul_f32 v18, v18, v162
    v_mul_f32 v19, v19, v162
    v_mul_f32 v20, v20, v162
    v_mul_f32 v21, v21, v162
    v_mul_f32 v22, v22, v162
    v_mul_f32 v23, v23, v162
    v_mul_f32 v24, v24, v162
    v_mul_f32 v25, v25, v162
    v_mul_f32 v26, v26, v162
    v_mul_f32 v27, v27, v162
    v_mul_f32 v28, v28, v162
    v_mul_f32 v29, v29, v162
    v_mul_f32 v30, v30, v162
    v_mul_f32 v31, v31, v162
    v_mul_f32 v32, v32, v162
    v_mul_f32 v33, v33, v162
    v_mul_f32 v34, v34, v162
    v_mul_f32 v35, v35, v162
    v_mul_f32 v36, v36, v162
    v_mul_f32 v37, v37, v162
    v_mul_f32 v38, v38, v162
    v_mul_f32 v39, v39, v162
    v_mul_f32 v40, v40, v162
    v_mul_f32 v41, v41, v162
    v_mul_f32 v42, v42, v162
    v_mul_f32 v43, v43, v162
    v_mul_f32 v44, v44, v162
    v_mul_f32 v45, v45, v162
    v_mul_f32 v46, v46, v162
    v_mul_f32 v47, v47, v162
    v_mul_f32 v48, v48, v162
    v_mul_f32 v49, v49, v162
    v_mul_f32 v50, v50, v162
    v_mul_f32 v51, v51, v162
    v_mul_f32 v52, v52, v162
    v_mul_f32 v53, v53, v162
    v_mul_f32 v54, v54, v162
    v_mul_f32 v55, v55, v162
    v_mul_f32 v56, v56, v162
    v_mul_f32 v57, v57, v162
    v_mul_f32 v58, v58, v162
    v_mul_f32 v59, v59, v162
    v_mul_f32 v60, v60, v162
    v_mul_f32 v61, v61, v162
    v_mul_f32 v62, v62, v162
    v_mul_f32 v63, v63, v162
    s_nop 1
    s_branch K1_RETr0b1
K1_SLOWr0b2:
    v_mov_b32 v162, v161
    s_nop 1
    v_permlane32_swap_b32 v161, v162
    v_max3_f32 v161, v161, v162, v156
    v_sub_f32 v162, v156, v161
    v_mul_f32 v162, s31, v162
    v_exp_f32 v162, v162
    v_mov_b32 v156, v161
    v_add_f32 v157, s67, v161
    v_mul_f32 v158, s31, v161
    v_sub_f32 v158, 0, v158
    v_mul_f32 v159, v159, v162
    v_mul_f32 v160, v160, v162
    v_mul_f32 v0, v0, v162
    v_mul_f32 v1, v1, v162
    v_mul_f32 v2, v2, v162
    v_mul_f32 v3, v3, v162
    v_mul_f32 v4, v4, v162
    v_mul_f32 v5, v5, v162
    v_mul_f32 v6, v6, v162
    v_mul_f32 v7, v7, v162
    v_mul_f32 v8, v8, v162
    v_mul_f32 v9, v9, v162
    v_mul_f32 v10, v10, v162
    v_mul_f32 v11, v11, v162
    v_mul_f32 v12, v12, v162
    v_mul_f32 v13, v13, v162
    v_mul_f32 v14, v14, v162
    v_mul_f32 v15, v15, v162
    v_mul_f32 v16, v16, v162
    v_mul_f32 v17, v17, v162
    v_mul_f32 v18, v18, v162
    v_mul_f32 v19, v19, v162
    v_mul_f32 v20, v20, v162
    v_mul_f32 v21, v21, v162
    v_mul_f32 v22, v22, v162
    v_mul_f32 v23, v23, v162
    v_mul_f32 v24, v24, v162
    v_mul_f32 v25, v25, v162
    v_mul_f32 v26, v26, v162
    v_mul_f32 v27, v27, v162
    v_mul_f32 v28, v28, v162
    v_mul_f32 v29, v29, v162
    v_mul_f32 v30, v30, v162
    v_mul_f32 v31, v31, v162
    v_mul_f32 v32, v32, v162
    v_mul_f32 v33, v33, v162
    v_mul_f32 v34, v34, v162
    v_mul_f32 v35, v35, v162
    v_mul_f32 v36, v36, v162
    v_mul_f32 v37, v37, v162
    v_mul_f32 v38, v38, v162
    v_mul_f32 v39, v39, v162
    v_mul_f32 v40, v40, v162
    v_mul_f32 v41, v41, v162
    v_mul_f32 v42, v42, v162
    v_mul_f32 v43, v43, v162
    v_mul_f32 v44, v44, v162
    v_mul_f32 v45, v45, v162
    v_mul_f32 v46, v46, v162
    v_mul_f32 v47, v47, v162
    v_mul_f32 v48, v48, v162
    v_mul_f32 v49, v49, v162
    v_mul_f32 v50, v50, v162
    v_mul_f32 v51, v51, v162
    v_mul_f32 v52, v52, v162
    v_mul_f32 v53, v53, v162
    v_mul_f32 v54, v54, v162
    v_mul_f32 v55, v55, v162
    v_mul_f32 v56, v56, v162
    v_mul_f32 v57, v57, v162
    v_mul_f32 v58, v58, v162
    v_mul_f32 v59, v59, v162
    v_mul_f32 v60, v60, v162
    v_mul_f32 v61, v61, v162
    v_mul_f32 v62, v62, v162
    v_mul_f32 v63, v63, v162
    s_nop 1
    s_branch K1_RETr0b2
K1_SLOWr0b3:
    v_mov_b32 v162, v161
    s_nop 1
    v_permlane32_swap_b32 v161, v162
    v_max3_f32 v161, v161, v162, v156
    v_sub_f32 v162, v156, v161
    v_mul_f32 v162, s31, v162
    v_exp_f32 v162, v162
    v_mov_b32 v156, v161
    v_add_f32 v157, s67, v161
    v_mul_f32 v158, s31, v161
    v_sub_f32 v158, 0, v158
    v_mul_f32 v159, v159, v162
    v_mul_f32 v160, v160, v162
    v_mul_f32 v0, v0, v162
    v_mul_f32 v1, v1, v162
    v_mul_f32 v2, v2, v162
    v_mul_f32 v3, v3, v162
    v_mul_f32 v4, v4, v162
    v_mul_f32 v5, v5, v162
    v_mul_f32 v6, v6, v162
    v_mul_f32 v7, v7, v162
    v_mul_f32 v8, v8, v162
    v_mul_f32 v9, v9, v162
    v_mul_f32 v10, v10, v162
    v_mul_f32 v11, v11, v162
    v_mul_f32 v12, v12, v162
    v_mul_f32 v13, v13, v162
    v_mul_f32 v14, v14, v162
    v_mul_f32 v15, v15, v162
    v_mul_f32 v16, v16, v162
    v_mul_f32 v17, v17, v162
    v_mul_f32 v18, v18, v162
    v_mul_f32 v19, v19, v162
    v_mul_f32 v20, v20, v162
    v_mul_f32 v21, v21, v162
    v_mul_f32 v22, v22, v162
    v_mul_f32 v23, v23, v162
    v_mul_f32 v24, v24, v162
    v_mul_f32 v25, v25, v162
    v_mul_f32 v26, v26, v162
    v_mul_f32 v27, v27, v162
    v_mul_f32 v28, v28, v162
    v_mul_f32 v29, v29, v162
    v_mul_f32 v30, v30, v162
    v_mul_f32 v31, v31, v162
    v_mul_f32 v32, v32, v162
    v_mul_f32 v33, v33, v162
    v_mul_f32 v34, v34, v162
    v_mul_f32 v35, v35, v162
    v_mul_f32 v36, v36, v162
    v_mul_f32 v37, v37, v162
    v_mul_f32 v38, v38, v162
    v_mul_f32 v39, v39, v162
    v_mul_f32 v40, v40, v162
    v_mul_f32 v41, v41, v162
    v_mul_f32 v42, v42, v162
    v_mul_f32 v43, v43, v162
    v_mul_f32 v44, v44, v162
    v_mul_f32 v45, v45, v162
    v_mul_f32 v46, v46, v162
    v_mul_f32 v47, v47, v162
    v_mul_f32 v48, v48, v162
    v_mul_f32 v49, v49, v162
    v_mul_f32 v50, v50, v162
    v_mul_f32 v51, v51, v162
    v_mul_f32 v52, v52, v162
    v_mul_f32 v53, v53, v162
    v_mul_f32 v54, v54, v162
    v_mul_f32 v55, v55, v162
    v_mul_f32 v56, v56, v162
    v_mul_f32 v57, v57, v162
    v_mul_f32 v58, v58, v162
    v_mul_f32 v59, v59, v162
    v_mul_f32 v60, v60, v162
    v_mul_f32 v61, v61, v162
    v_mul_f32 v62, v62, v162
    v_mul_f32 v63, v63, v162
    s_nop 1
    s_branch K1_RETr0b3
K1_SLOWr1p0:
    v_mov_b32 v162, v161
    s_nop 1
    v_permlane32_swap_b32 v161, v162
    v_max3_f32 v161, v161, v162, v156
    v_sub_f32 v162, v156, v161
    v_mul_f32 v162, s31, v162
    v_exp_f32 v162, v162
    v_mov_b32 v156, v161
    v_add_f32 v157, s67, v161
    v_mul_f32 v158, s31, v161
    v_sub_f32 v158, 0, v158
    v_mul_f32 v159, v159, v162
    v_mul_f32 v160, v160, v162
    v_mul_f32 v0, v0, v162
    v_mul_f32 v1, v1, v162
    v_mul_f32 v2, v2, v162
    v_mul_f32 v3, v3, v162
    v_mul_f32 v4, v4, v162
    v_mul_f32 v5, v5, v162
    v_mul_f32 v6, v6, v162
    v_mul_f32 v7, v7, v162
    v_mul_f32 v8, v8, v162
    v_mul_f32 v9, v9, v162
    v_mul_f32 v10, v10, v162
    v_mul_f32 v11, v11, v162
    v_mul_f32 v12, v12, v162
    v_mul_f32 v13, v13, v162
    v_mul_f32 v14, v14, v162
    v_mul_f32 v15, v15, v162
    v_mul_f32 v16, v16, v162
    v_mul_f32 v17, v17, v162
    v_mul_f32 v18, v18, v162
    v_mul_f32 v19, v19, v162
    v_mul_f32 v20, v20, v162
    v_mul_f32 v21, v21, v162
    v_mul_f32 v22, v22, v162
    v_mul_f32 v23, v23, v162
    v_mul_f32 v24, v24, v162
    v_mul_f32 v25, v25, v162
    v_mul_f32 v26, v26, v162
    v_mul_f32 v27, v27, v162
    v_mul_f32 v28, v28, v162
    v_mul_f32 v29, v29, v162
    v_mul_f32 v30, v30, v162
    v_mul_f32 v31, v31, v162
    v_mul_f32 v32, v32, v162
    v_mul_f32 v33, v33, v162
    v_mul_f32 v34, v34, v162
    v_mul_f32 v35, v35, v162
    v_mul_f32 v36, v36, v162
    v_mul_f32 v37, v37, v162
    v_mul_f32 v38, v38, v162
    v_mul_f32 v39, v39, v162
    v_mul_f32 v40, v40, v162
    v_mul_f32 v41, v41, v162
    v_mul_f32 v42, v42, v162
    v_mul_f32 v43, v43, v162
    v_mul_f32 v44, v44, v162
    v_mul_f32 v45, v45, v162
    v_mul_f32 v46, v46, v162
    v_mul_f32 v47, v47, v162
    v_mul_f32 v48, v48, v162
    v_mul_f32 v49, v49, v162
    v_mul_f32 v50, v50, v162
    v_mul_f32 v51, v51, v162
    v_mul_f32 v52, v52, v162
    v_mul_f32 v53, v53, v162
    v_mul_f32 v54, v54, v162
    v_mul_f32 v55, v55, v162
    v_mul_f32 v56, v56, v162
    v_mul_f32 v57, v57, v162
    v_mul_f32 v58, v58, v162
    v_mul_f32 v59, v59, v162
    v_mul_f32 v60, v60, v162
    v_mul_f32 v61, v61, v162
    v_mul_f32 v62, v62, v162
    v_mul_f32 v63, v63, v162
    s_nop 1
    s_branch K1_RETr1p0
K1_SLOWr1p1:
    v_mov_b32 v162, v161
    s_nop 1
    v_permlane32_swap_b32 v161, v162
    v_max3_f32 v161, v161, v162, v156
    v_sub_f32 v162, v156, v161
    v_mul_f32 v162, s31, v162
    v_exp_f32 v162, v162
    v_mov_b32 v156, v161
    v_add_f32 v157, s67, v161
    v_mul_f32 v158, s31, v161
    v_sub_f32 v158, 0, v158
    v_mul_f32 v159, v159, v162
    v_mul_f32 v160, v160, v162
    v_mul_f32 v0, v0, v162
    v_mul_f32 v1, v1, v162
    v_mul_f32 v2, v2, v162
    v_mul_f32 v3, v3, v162
    v_mul_f32 v4, v4, v162
    v_mul_f32 v5, v5, v162
    v_mul_f32 v6, v6, v162
    v_mul_f32 v7, v7, v162
    v_mul_f32 v8, v8, v162
    v_mul_f32 v9, v9, v162
    v_mul_f32 v10, v10, v162
    v_mul_f32 v11, v11, v162
    v_mul_f32 v12, v12, v162
    v_mul_f32 v13, v13, v162
    v_mul_f32 v14, v14, v162
    v_mul_f32 v15, v15, v162
    v_mul_f32 v16, v16, v162
    v_mul_f32 v17, v17, v162
    v_mul_f32 v18, v18, v162
    v_mul_f32 v19, v19, v162
    v_mul_f32 v20, v20, v162
    v_mul_f32 v21, v21, v162
    v_mul_f32 v22, v22, v162
    v_mul_f32 v23, v23, v162
    v_mul_f32 v24, v24, v162
    v_mul_f32 v25, v25, v162
    v_mul_f32 v26, v26, v162
    v_mul_f32 v27, v27, v162
    v_mul_f32 v28, v28, v162
    v_mul_f32 v29, v29, v162
    v_mul_f32 v30, v30, v162
    v_mul_f32 v31, v31, v162
    v_mul_f32 v32, v32, v162
    v_mul_f32 v33, v33, v162
    v_mul_f32 v34, v34, v162
    v_mul_f32 v35, v35, v162
    v_mul_f32 v36, v36, v162
    v_mul_f32 v37, v37, v162
    v_mul_f32 v38, v38, v162
    v_mul_f32 v39, v39, v162
    v_mul_f32 v40, v40, v162
    v_mul_f32 v41, v41, v162
    v_mul_f32 v42, v42, v162
    v_mul_f32 v43, v43, v162
    v_mul_f32 v44, v44, v162
    v_mul_f32 v45, v45, v162
    v_mul_f32 v46, v46, v162
    v_mul_f32 v47, v47, v162
    v_mul_f32 v48, v48, v162
    v_mul_f32 v49, v49, v162
    v_mul_f32 v50, v50, v162
    v_mul_f32 v51, v51, v162
    v_mul_f32 v52, v52, v162
    v_mul_f32 v53, v53, v162
    v_mul_f32 v54, v54, v162
    v_mul_f32 v55, v55, v162
    v_mul_f32 v56, v56, v162
    v_mul_f32 v57, v57, v162
    v_mul_f32 v58, v58, v162
    v_mul_f32 v59, v59, v162
    v_mul_f32 v60, v60, v162
    v_mul_f32 v61, v61, v162
    v_mul_f32 v62, v62, v162
    v_mul_f32 v63, v63, v162
    s_nop 1
    s_branch K1_RETr1p1
K1_SLOWr1p2:
    v_mov_b32 v162, v161
    s_nop 1
    v_permlane32_swap_b32 v161, v162
    v_max3_f32 v161, v161, v162, v156
    v_sub_f32 v162, v156, v161
    v_mul_f32 v162, s31, v162
    v_exp_f32 v162, v162
    v_mov_b32 v156, v161
    v_add_f32 v157, s67, v161
    v_mul_f32 v158, s31, v161
    v_sub_f32 v158, 0, v158
    v_mul_f32 v159, v159, v162
    v_mul_f32 v160, v160, v162
    v_mul_f32 v0, v0, v162
    v_mul_f32 v1, v1, v162
    v_mul_f32 v2, v2, v162
    v_mul_f32 v3, v3, v162
    v_mul_f32 v4, v4, v162
    v_mul_f32 v5, v5, v162
    v_mul_f32 v6, v6, v162
    v_mul_f32 v7, v7, v162
    v_mul_f32 v8, v8, v162
    v_mul_f32 v9, v9, v162
    v_mul_f32 v10, v10, v162
    v_mul_f32 v11, v11, v162
    v_mul_f32 v12, v12, v162
    v_mul_f32 v13, v13, v162
    v_mul_f32 v14, v14, v162
    v_mul_f32 v15, v15, v162
    v_mul_f32 v16, v16, v162
    v_mul_f32 v17, v17, v162
    v_mul_f32 v18, v18, v162
    v_mul_f32 v19, v19, v162
    v_mul_f32 v20, v20, v162
    v_mul_f32 v21, v21, v162
    v_mul_f32 v22, v22, v162
    v_mul_f32 v23, v23, v162
    v_mul_f32 v24, v24, v162
    v_mul_f32 v25, v25, v162
    v_mul_f32 v26, v26, v162
    v_mul_f32 v27, v27, v162
    v_mul_f32 v28, v28, v162
    v_mul_f32 v29, v29, v162
    v_mul_f32 v30, v30, v162
    v_mul_f32 v31, v31, v162
    v_mul_f32 v32, v32, v162
    v_mul_f32 v33, v33, v162
    v_mul_f32 v34, v34, v162
    v_mul_f32 v35, v35, v162
    v_mul_f32 v36, v36, v162
    v_mul_f32 v37, v37, v162
    v_mul_f32 v38, v38, v162
    v_mul_f32 v39, v39, v162
    v_mul_f32 v40, v40, v162
    v_mul_f32 v41, v41, v162
    v_mul_f32 v42, v42, v162
    v_mul_f32 v43, v43, v162
    v_mul_f32 v44, v44, v162
    v_mul_f32 v45, v45, v162
    v_mul_f32 v46, v46, v162
    v_mul_f32 v47, v47, v162
    v_mul_f32 v48, v48, v162
    v_mul_f32 v49, v49, v162
    v_mul_f32 v50, v50, v162
    v_mul_f32 v51, v51, v162
    v_mul_f32 v52, v52, v162
    v_mul_f32 v53, v53, v162
    v_mul_f32 v54, v54, v162
    v_mul_f32 v55, v55, v162
    v_mul_f32 v56, v56, v162
    v_mul_f32 v57, v57, v162
    v_mul_f32 v58, v58, v162
    v_mul_f32 v59, v59, v162
    v_mul_f32 v60, v60, v162
    v_mul_f32 v61, v61, v162
    v_mul_f32 v62, v62, v162
    v_mul_f32 v63, v63, v162
    s_nop 1
    s_branch K1_RETr1p2
K1_SLOWr1p3:
    v_mov_b32 v162, v161
    s_nop 1
    v_permlane32_swap_b32 v161, v162
    v_max3_f32 v161, v161, v162, v156
    v_sub_f32 v162, v156, v161
    v_mul_f32 v162, s31, v162
    v_exp_f32 v162, v162
    v_mov_b32 v156, v161
    v_add_f32 v157, s67, v161
    v_mul_f32 v158, s31, v161
    v_sub_f32 v158, 0, v158
    v_mul_f32 v159, v159, v162
    v_mul_f32 v160, v160, v162
    v_mul_f32 v0, v0, v162
    v_mul_f32 v1, v1, v162
    v_mul_f32 v2, v2, v162
    v_mul_f32 v3, v3, v162
    v_mul_f32 v4, v4, v162
    v_mul_f32 v5, v5, v162
    v_mul_f32 v6, v6, v162
    v_mul_f32 v7, v7, v162
    v_mul_f32 v8, v8, v162
    v_mul_f32 v9, v9, v162
    v_mul_f32 v10, v10, v162
    v_mul_f32 v11, v11, v162
    v_mul_f32 v12, v12, v162
    v_mul_f32 v13, v13, v162
    v_mul_f32 v14, v14, v162
    v_mul_f32 v15, v15, v162
    v_mul_f32 v16, v16, v162
    v_mul_f32 v17, v17, v162
    v_mul_f32 v18, v18, v162
    v_mul_f32 v19, v19, v162
    v_mul_f32 v20, v20, v162
    v_mul_f32 v21, v21, v162
    v_mul_f32 v22, v22, v162
    v_mul_f32 v23, v23, v162
    v_mul_f32 v24, v24, v162
    v_mul_f32 v25, v25, v162
    v_mul_f32 v26, v26, v162
    v_mul_f32 v27, v27, v162
    v_mul_f32 v28, v28, v162
    v_mul_f32 v29, v29, v162
    v_mul_f32 v30, v30, v162
    v_mul_f32 v31, v31, v162
    v_mul_f32 v32, v32, v162
    v_mul_f32 v33, v33, v162
    v_mul_f32 v34, v34, v162
    v_mul_f32 v35, v35, v162
    v_mul_f32 v36, v36, v162
    v_mul_f32 v37, v37, v162
    v_mul_f32 v38, v38, v162
    v_mul_f32 v39, v39, v162
    v_mul_f32 v40, v40, v162
    v_mul_f32 v41, v41, v162
    v_mul_f32 v42, v42, v162
    v_mul_f32 v43, v43, v162
    v_mul_f32 v44, v44, v162
    v_mul_f32 v45, v45, v162
    v_mul_f32 v46, v46, v162
    v_mul_f32 v47, v47, v162
    v_mul_f32 v48, v48, v162
    v_mul_f32 v49, v49, v162
    v_mul_f32 v50, v50, v162
    v_mul_f32 v51, v51, v162
    v_mul_f32 v52, v52, v162
    v_mul_f32 v53, v53, v162
    v_mul_f32 v54, v54, v162
    v_mul_f32 v55, v55, v162
    v_mul_f32 v56, v56, v162
    v_mul_f32 v57, v57, v162
    v_mul_f32 v58, v58, v162
    v_mul_f32 v59, v59, v162
    v_mul_f32 v60, v60, v162
    v_mul_f32 v61, v61, v162
    v_mul_f32 v62, v62, v162
    v_mul_f32 v63, v63, v162
    s_nop 1
    s_branch K1_RETr1p3
K1_SLOWr1a0:
    v_mov_b32 v162, v161
    s_nop 1
    v_permlane32_swap_b32 v161, v162
    v_max3_f32 v161, v161, v162, v156
    v_sub_f32 v162, v156, v161
    v_mul_f32 v162, s31, v162
    v_exp_f32 v162, v162
    v_mov_b32 v156, v161
    v_add_f32 v157, s67, v161
    v_mul_f32 v158, s31, v161
    v_sub_f32 v158, 0, v158
    v_mul_f32 v159, v159, v162
    v_mul_f32 v160, v160, v162
    v_mul_f32 v0, v0, v162
    v_mul_f32 v1, v1, v162
    v_mul_f32 v2, v2, v162
    v_mul_f32 v3, v3, v162
    v_mul_f32 v4, v4, v162
    v_mul_f32 v5, v5, v162
    v_mul_f32 v6, v6, v162
    v_mul_f32 v7, v7, v162
    v_mul_f32 v8, v8, v162
    v_mul_f32 v9, v9, v162
    v_mul_f32 v10, v10, v162
    v_mul_f32 v11, v11, v162
    v_mul_f32 v12, v12, v162
    v_mul_f32 v13, v13, v162
    v_mul_f32 v14, v14, v162
    v_mul_f32 v15, v15, v162
    v_mul_f32 v16, v16, v162
    v_mul_f32 v17, v17, v162
    v_mul_f32 v18, v18, v162
    v_mul_f32 v19, v19, v162
    v_mul_f32 v20, v20, v162
    v_mul_f32 v21, v21, v162
    v_mul_f32 v22, v22, v162
    v_mul_f32 v23, v23, v162
    v_mul_f32 v24, v24, v162
    v_mul_f32 v25, v25, v162
    v_mul_f32 v26, v26, v162
    v_mul_f32 v27, v27, v162
    v_mul_f32 v28, v28, v162
    v_mul_f32 v29, v29, v162
    v_mul_f32 v30, v30, v162
    v_mul_f32 v31, v31, v162
    v_mul_f32 v32, v32, v162
    v_mul_f32 v33, v33, v162
    v_mul_f32 v34, v34, v162
    v_mul_f32 v35, v35, v162
    v_mul_f32 v36, v36, v162
    v_mul_f32 v37, v37, v162
    v_mul_f32 v38, v38, v162
    v_mul_f32 v39, v39, v162
    v_mul_f32 v40, v40, v162
    v_mul_f32 v41, v41, v162
    v_mul_f32 v42, v42, v162
    v_mul_f32 v43, v43, v162
    v_mul_f32 v44, v44, v162
    v_mul_f32 v45, v45, v162
    v_mul_f32 v46, v46, v162
    v_mul_f32 v47, v47, v162
    v_mul_f32 v48, v48, v162
    v_mul_f32 v49, v49, v162
    v_mul_f32 v50, v50, v162
    v_mul_f32 v51, v51, v162
    v_mul_f32 v52, v52, v162
    v_mul_f32 v53, v53, v162
    v_mul_f32 v54, v54, v162
    v_mul_f32 v55, v55, v162
    v_mul_f32 v56, v56, v162
    v_mul_f32 v57, v57, v162
    v_mul_f32 v58, v58, v162
    v_mul_f32 v59, v59, v162
    v_mul_f32 v60, v60, v162
    v_mul_f32 v61, v61, v162
    v_mul_f32 v62, v62, v162
    v_mul_f32 v63, v63, v162
    s_nop 1
    s_branch K1_RETr1a0
K1_SLOWr1a1:
    v_mov_b32 v162, v161
    s_nop 1
    v_permlane32_swap_b32 v161, v162
    v_max3_f32 v161, v161, v162, v156
    v_sub_f32 v162, v156, v161
    v_mul_f32 v162, s31, v162
    v_exp_f32 v162, v162
    v_mov_b32 v156, v161
    v_add_f32 v157, s67, v161
    v_mul_f32 v158, s31, v161
    v_sub_f32 v158, 0, v158
    v_mul_f32 v159, v159, v162
    v_mul_f32 v160, v160, v162
    v_mul_f32 v0, v0, v162
    v_mul_f32 v1, v1, v162
    v_mul_f32 v2, v2, v162
    v_mul_f32 v3, v3, v162
    v_mul_f32 v4, v4, v162
    v_mul_f32 v5, v5, v162
    v_mul_f32 v6, v6, v162
    v_mul_f32 v7, v7, v162
    v_mul_f32 v8, v8, v162
    v_mul_f32 v9, v9, v162
    v_mul_f32 v10, v10, v162
    v_mul_f32 v11, v11, v162
    v_mul_f32 v12, v12, v162
    v_mul_f32 v13, v13, v162
    v_mul_f32 v14, v14, v162
    v_mul_f32 v15, v15, v162
    v_mul_f32 v16, v16, v162
    v_mul_f32 v17, v17, v162
    v_mul_f32 v18, v18, v162
    v_mul_f32 v19, v19, v162
    v_mul_f32 v20, v20, v162
    v_mul_f32 v21, v21, v162
    v_mul_f32 v22, v22, v162
    v_mul_f32 v23, v23, v162
    v_mul_f32 v24, v24, v162
    v_mul_f32 v25, v25, v162
    v_mul_f32 v26, v26, v162
    v_mul_f32 v27, v27, v162
    v_mul_f32 v28, v28, v162
    v_mul_f32 v29, v29, v162
    v_mul_f32 v30, v30, v162
    v_mul_f32 v31, v31, v162
    v_mul_f32 v32, v32, v162
    v_mul_f32 v33, v33, v162
    v_mul_f32 v34, v34, v162
    v_mul_f32 v35, v35, v162
    v_mul_f32 v36, v36, v162
    v_mul_f32 v37, v37, v162
    v_mul_f32 v38, v38, v162
    v_mul_f32 v39, v39, v162
    v_mul_f32 v40, v40, v162
    v_mul_f32 v41, v41, v162
    v_mul_f32 v42, v42, v162
    v_mul_f32 v43, v43, v162
    v_mul_f32 v44, v44, v162
    v_mul_f32 v45, v45, v162
    v_mul_f32 v46, v46, v162
    v_mul_f32 v47, v47, v162
    v_mul_f32 v48, v48, v162
    v_mul_f32 v49, v49, v162
    v_mul_f32 v50, v50, v162
    v_mul_f32 v51, v51, v162
    v_mul_f32 v52, v52, v162
    v_mul_f32 v53, v53, v162
    v_mul_f32 v54, v54, v162
    v_mul_f32 v55, v55, v162
    v_mul_f32 v56, v56, v162
    v_mul_f32 v57, v57, v162
    v_mul_f32 v58, v58, v162
    v_mul_f32 v59, v59, v162
    v_mul_f32 v60, v60, v162
    v_mul_f32 v61, v61, v162
    v_mul_f32 v62, v62, v162
    v_mul_f32 v63, v63, v162
    s_nop 1
    s_branch K1_RETr1a1
K1_SLOWr1a2:
    v_mov_b32 v162, v161
    s_nop 1
    v_permlane32_swap_b32 v161, v162
    v_max3_f32 v161, v161, v162, v156
    v_sub_f32 v162, v156, v161
    v_mul_f32 v162, s31, v162
    v_exp_f32 v162, v162
    v_mov_b32 v156, v161
    v_add_f32 v157, s67, v161
    v_mul_f32 v158, s31, v161
    v_sub_f32 v158, 0, v158
    v_mul_f32 v159, v159, v162
    v_mul_f32 v160, v160, v162
    v_mul_f32 v0, v0, v162
    v_mul_f32 v1, v1, v162
    v_mul_f32 v2, v2, v162
    v_mul_f32 v3, v3, v162
    v_mul_f32 v4, v4, v162
    v_mul_f32 v5, v5, v162
    v_mul_f32 v6, v6, v162
    v_mul_f32 v7, v7, v162
    v_mul_f32 v8, v8, v162
    v_mul_f32 v9, v9, v162
    v_mul_f32 v10, v10, v162
    v_mul_f32 v11, v11, v162
    v_mul_f32 v12, v12, v162
    v_mul_f32 v13, v13, v162
    v_mul_f32 v14, v14, v162
    v_mul_f32 v15, v15, v162
    v_mul_f32 v16, v16, v162
    v_mul_f32 v17, v17, v162
    v_mul_f32 v18, v18, v162
    v_mul_f32 v19, v19, v162
    v_mul_f32 v20, v20, v162
    v_mul_f32 v21, v21, v162
    v_mul_f32 v22, v22, v162
    v_mul_f32 v23, v23, v162
    v_mul_f32 v24, v24, v162
    v_mul_f32 v25, v25, v162
    v_mul_f32 v26, v26, v162
    v_mul_f32 v27, v27, v162
    v_mul_f32 v28, v28, v162
    v_mul_f32 v29, v29, v162
    v_mul_f32 v30, v30, v162
    v_mul_f32 v31, v31, v162
    v_mul_f32 v32, v32, v162
    v_mul_f32 v33, v33, v162
    v_mul_f32 v34, v34, v162
    v_mul_f32 v35, v35, v162
    v_mul_f32 v36, v36, v162
    v_mul_f32 v37, v37, v162
    v_mul_f32 v38, v38, v162
    v_mul_f32 v39, v39, v162
    v_mul_f32 v40, v40, v162
    v_mul_f32 v41, v41, v162
    v_mul_f32 v42, v42, v162
    v_mul_f32 v43, v43, v162
    v_mul_f32 v44, v44, v162
    v_mul_f32 v45, v45, v162
    v_mul_f32 v46, v46, v162
    v_mul_f32 v47, v47, v162
    v_mul_f32 v48, v48, v162
    v_mul_f32 v49, v49, v162
    v_mul_f32 v50, v50, v162
    v_mul_f32 v51, v51, v162
    v_mul_f32 v52, v52, v162
    v_mul_f32 v53, v53, v162
    v_mul_f32 v54, v54, v162
    v_mul_f32 v55, v55, v162
    v_mul_f32 v56, v56, v162
    v_mul_f32 v57, v57, v162
    v_mul_f32 v58, v58, v162
    v_mul_f32 v59, v59, v162
    v_mul_f32 v60, v60, v162
    v_mul_f32 v61, v61, v162
    v_mul_f32 v62, v62, v162
    v_mul_f32 v63, v63, v162
    s_nop 1
    s_branch K1_RETr1a2
K1_SLOWr1a3:
    v_mov_b32 v162, v161
    s_nop 1
    v_permlane32_swap_b32 v161, v162
    v_max3_f32 v161, v161, v162, v156
    v_sub_f32 v162, v156, v161
    v_mul_f32 v162, s31, v162
    v_exp_f32 v162, v162
    v_mov_b32 v156, v161
    v_add_f32 v157, s67, v161
    v_mul_f32 v158, s31, v161
    v_sub_f32 v158, 0, v158
    v_mul_f32 v159, v159, v162
    v_mul_f32 v160, v160, v162
    v_mul_f32 v0, v0, v162
    v_mul_f32 v1, v1, v162
    v_mul_f32 v2, v2, v162
    v_mul_f32 v3, v3, v162
    v_mul_f32 v4, v4, v162
    v_mul_f32 v5, v5, v162
    v_mul_f32 v6, v6, v162
    v_mul_f32 v7, v7, v162
    v_mul_f32 v8, v8, v162
    v_mul_f32 v9, v9, v162
    v_mul_f32 v10, v10, v162
    v_mul_f32 v11, v11, v162
    v_mul_f32 v12, v12, v162
    v_mul_f32 v13, v13, v162
    v_mul_f32 v14, v14, v162
    v_mul_f32 v15, v15, v162
    v_mul_f32 v16, v16, v162
    v_mul_f32 v17, v17, v162
    v_mul_f32 v18, v18, v162
    v_mul_f32 v19, v19, v162
    v_mul_f32 v20, v20, v162
    v_mul_f32 v21, v21, v162
    v_mul_f32 v22, v22, v162
    v_mul_f32 v23, v23, v162
    v_mul_f32 v24, v24, v162
    v_mul_f32 v25, v25, v162
    v_mul_f32 v26, v26, v162
    v_mul_f32 v27, v27, v162
    v_mul_f32 v28, v28, v162
    v_mul_f32 v29, v29, v162
    v_mul_f32 v30, v30, v162
    v_mul_f32 v31, v31, v162
    v_mul_f32 v32, v32, v162
    v_mul_f32 v33, v33, v162
    v_mul_f32 v34, v34, v162
    v_mul_f32 v35, v35, v162
    v_mul_f32 v36, v36, v162
    v_mul_f32 v37, v37, v162
    v_mul_f32 v38, v38, v162
    v_mul_f32 v39, v39, v162
    v_mul_f32 v40, v40, v162
    v_mul_f32 v41, v41, v162
    v_mul_f32 v42, v42, v162
    v_mul_f32 v43, v43, v162
    v_mul_f32 v44, v44, v162
    v_mul_f32 v45, v45, v162
    v_mul_f32 v46, v46, v162
    v_mul_f32 v47, v47, v162
    v_mul_f32 v48, v48, v162
    v_mul_f32 v49, v49, v162
    v_mul_f32 v50, v50, v162
    v_mul_f32 v51, v51, v162
    v_mul_f32 v52, v52, v162
    v_mul_f32 v53, v53, v162
    v_mul_f32 v54, v54, v162
    v_mul_f32 v55, v55, v162
    v_mul_f32 v56, v56, v162
    v_mul_f32 v57, v57, v162
    v_mul_f32 v58, v58, v162
    v_mul_f32 v59, v59, v162
    v_mul_f32 v60, v60, v162
    v_mul_f32 v61, v61, v162
    v_mul_f32 v62, v62, v162
    v_mul_f32 v63, v63, v162
    s_nop 1
    s_branch K1_RETr1a3
K1_SLOWr1b0:
    v_mov_b32 v162, v161
    s_nop 1
    v_permlane32_swap_b32 v161, v162
    v_max3_f32 v161, v161, v162, v156
    v_sub_f32 v162, v156, v161
    v_mul_f32 v162, s31, v162
    v_exp_f32 v162, v162
    v_mov_b32 v156, v161
    v_add_f32 v157, s67, v161
    v_mul_f32 v158, s31, v161
    v_sub_f32 v158, 0, v158
    v_mul_f32 v159, v159, v162
    v_mul_f32 v160, v160, v162
    v_mul_f32 v0, v0, v162
    v_mul_f32 v1, v1, v162
    v_mul_f32 v2, v2, v162
    v_mul_f32 v3, v3, v162
    v_mul_f32 v4, v4, v162
    v_mul_f32 v5, v5, v162
    v_mul_f32 v6, v6, v162
    v_mul_f32 v7, v7, v162
    v_mul_f32 v8, v8, v162
    v_mul_f32 v9, v9, v162
    v_mul_f32 v10, v10, v162
    v_mul_f32 v11, v11, v162
    v_mul_f32 v12, v12, v162
    v_mul_f32 v13, v13, v162
    v_mul_f32 v14, v14, v162
    v_mul_f32 v15, v15, v162
    v_mul_f32 v16, v16, v162
    v_mul_f32 v17, v17, v162
    v_mul_f32 v18, v18, v162
    v_mul_f32 v19, v19, v162
    v_mul_f32 v20, v20, v162
    v_mul_f32 v21, v21, v162
    v_mul_f32 v22, v22, v162
    v_mul_f32 v23, v23, v162
    v_mul_f32 v24, v24, v162
    v_mul_f32 v25, v25, v162
    v_mul_f32 v26, v26, v162
    v_mul_f32 v27, v27, v162
    v_mul_f32 v28, v28, v162
    v_mul_f32 v29, v29, v162
    v_mul_f32 v30, v30, v162
    v_mul_f32 v31, v31, v162
    v_mul_f32 v32, v32, v162
    v_mul_f32 v33, v33, v162
    v_mul_f32 v34, v34, v162
    v_mul_f32 v35, v35, v162
    v_mul_f32 v36, v36, v162
    v_mul_f32 v37, v37, v162
    v_mul_f32 v38, v38, v162
    v_mul_f32 v39, v39, v162
    v_mul_f32 v40, v40, v162
    v_mul_f32 v41, v41, v162
    v_mul_f32 v42, v42, v162
    v_mul_f32 v43, v43, v162
    v_mul_f32 v44, v44, v162
    v_mul_f32 v45, v45, v162
    v_mul_f32 v46, v46, v162
    v_mul_f32 v47, v47, v162
    v_mul_f32 v48, v48, v162
    v_mul_f32 v49, v49, v162
    v_mul_f32 v50, v50, v162
    v_mul_f32 v51, v51, v162
    v_mul_f32 v52, v52, v162
    v_mul_f32 v53, v53, v162
    v_mul_f32 v54, v54, v162
    v_mul_f32 v55, v55, v162
    v_mul_f32 v56, v56, v162
    v_mul_f32 v57, v57, v162
    v_mul_f32 v58, v58, v162
    v_mul_f32 v59, v59, v162
    v_mul_f32 v60, v60, v162
    v_mul_f32 v61, v61, v162
    v_mul_f32 v62, v62, v162
    v_mul_f32 v63, v63, v162
    s_nop 1
    s_branch K1_RETr1b0
K1_SLOWr1b1:
    v_mov_b32 v162, v161
    s_nop 1
    v_permlane32_swap_b32 v161, v162
    v_max3_f32 v161, v161, v162, v156
    v_sub_f32 v162, v156, v161
    v_mul_f32 v162, s31, v162
    v_exp_f32 v162, v162
    v_mov_b32 v156, v161
    v_add_f32 v157, s67, v161
    v_mul_f32 v158, s31, v161
    v_sub_f32 v158, 0, v158
    v_mul_f32 v159, v159, v162
    v_mul_f32 v160, v160, v162
    v_mul_f32 v0, v0, v162
    v_mul_f32 v1, v1, v162
    v_mul_f32 v2, v2, v162
    v_mul_f32 v3, v3, v162
    v_mul_f32 v4, v4, v162
    v_mul_f32 v5, v5, v162
    v_mul_f32 v6, v6, v162
    v_mul_f32 v7, v7, v162
    v_mul_f32 v8, v8, v162
    v_mul_f32 v9, v9, v162
    v_mul_f32 v10, v10, v162
    v_mul_f32 v11, v11, v162
    v_mul_f32 v12, v12, v162
    v_mul_f32 v13, v13, v162
    v_mul_f32 v14, v14, v162
    v_mul_f32 v15, v15, v162
    v_mul_f32 v16, v16, v162
    v_mul_f32 v17, v17, v162
    v_mul_f32 v18, v18, v162
    v_mul_f32 v19, v19, v162
    v_mul_f32 v20, v20, v162
    v_mul_f32 v21, v21, v162
    v_mul_f32 v22, v22, v162
    v_mul_f32 v23, v23, v162
    v_mul_f32 v24, v24, v162
    v_mul_f32 v25, v25, v162
    v_mul_f32 v26, v26, v162
    v_mul_f32 v27, v27, v162
    v_mul_f32 v28, v28, v162
    v_mul_f32 v29, v29, v162
    v_mul_f32 v30, v30, v162
    v_mul_f32 v31, v31, v162
    v_mul_f32 v32, v32, v162
    v_mul_f32 v33, v33, v162
    v_mul_f32 v34, v34, v162
    v_mul_f32 v35, v35, v162
    v_mul_f32 v36, v36, v162
    v_mul_f32 v37, v37, v162
    v_mul_f32 v38, v38, v162
    v_mul_f32 v39, v39, v162
    v_mul_f32 v40, v40, v162
    v_mul_f32 v41, v41, v162
    v_mul_f32 v42, v42, v162
    v_mul_f32 v43, v43, v162
    v_mul_f32 v44, v44, v162
    v_mul_f32 v45, v45, v162
    v_mul_f32 v46, v46, v162
    v_mul_f32 v47, v47, v162
    v_mul_f32 v48, v48, v162
    v_mul_f32 v49, v49, v162
    v_mul_f32 v50, v50, v162
    v_mul_f32 v51, v51, v162
    v_mul_f32 v52, v52, v162
    v_mul_f32 v53, v53, v162
    v_mul_f32 v54, v54, v162
    v_mul_f32 v55, v55, v162
    v_mul_f32 v56, v56, v162
    v_mul_f32 v57, v57, v162
    v_mul_f32 v58, v58, v162
    v_mul_f32 v59, v59, v162
    v_mul_f32 v60, v60, v162
    v_mul_f32 v61, v61, v162
    v_mul_f32 v62, v62, v162
    v_mul_f32 v63, v63, v162
    s_nop 1
    s_branch K1_RETr1b1
K1_SLOWr1b2:
    v_mov_b32 v162, v161
    s_nop 1
    v_permlane32_swap_b32 v161, v162
    v_max3_f32 v161, v161, v162, v156
    v_sub_f32 v162, v156, v161
    v_mul_f32 v162, s31, v162
    v_exp_f32 v162, v162
    v_mov_b32 v156, v161
    v_add_f32 v157, s67, v161
    v_mul_f32 v158, s31, v161
    v_sub_f32 v158, 0, v158
    v_mul_f32 v159, v159, v162
    v_mul_f32 v160, v160, v162
    v_mul_f32 v0, v0, v162
    v_mul_f32 v1, v1, v162
    v_mul_f32 v2, v2, v162
    v_mul_f32 v3, v3, v162
    v_mul_f32 v4, v4, v162
    v_mul_f32 v5, v5, v162
    v_mul_f32 v6, v6, v162
    v_mul_f32 v7, v7, v162
    v_mul_f32 v8, v8, v162
    v_mul_f32 v9, v9, v162
    v_mul_f32 v10, v10, v162
    v_mul_f32 v11, v11, v162
    v_mul_f32 v12, v12, v162
    v_mul_f32 v13, v13, v162
    v_mul_f32 v14, v14, v162
    v_mul_f32 v15, v15, v162
    v_mul_f32 v16, v16, v162
    v_mul_f32 v17, v17, v162
    v_mul_f32 v18, v18, v162
    v_mul_f32 v19, v19, v162
    v_mul_f32 v20, v20, v162
    v_mul_f32 v21, v21, v162
    v_mul_f32 v22, v22, v162
    v_mul_f32 v23, v23, v162
    v_mul_f32 v24, v24, v162
    v_mul_f32 v25, v25, v162
    v_mul_f32 v26, v26, v162
    v_mul_f32 v27, v27, v162
    v_mul_f32 v28, v28, v162
    v_mul_f32 v29, v29, v162
    v_mul_f32 v30, v30, v162
    v_mul_f32 v31, v31, v162
    v_mul_f32 v32, v32, v162
    v_mul_f32 v33, v33, v162
    v_mul_f32 v34, v34, v162
    v_mul_f32 v35, v35, v162
    v_mul_f32 v36, v36, v162
    v_mul_f32 v37, v37, v162
    v_mul_f32 v38, v38, v162
    v_mul_f32 v39, v39, v162
    v_mul_f32 v40, v40, v162
    v_mul_f32 v41, v41, v162
    v_mul_f32 v42, v42, v162
    v_mul_f32 v43, v43, v162
    v_mul_f32 v44, v44, v162
    v_mul_f32 v45, v45, v162
    v_mul_f32 v46, v46, v162
    v_mul_f32 v47, v47, v162
    v_mul_f32 v48, v48, v162
    v_mul_f32 v49, v49, v162
    v_mul_f32 v50, v50, v162
    v_mul_f32 v51, v51, v162
    v_mul_f32 v52, v52, v162
    v_mul_f32 v53, v53, v162
    v_mul_f32 v54, v54, v162
    v_mul_f32 v55, v55, v162
    v_mul_f32 v56, v56, v162
    v_mul_f32 v57, v57, v162
    v_mul_f32 v58, v58, v162
    v_mul_f32 v59, v59, v162
    v_mul_f32 v60, v60, v162
    v_mul_f32 v61, v61, v162
    v_mul_f32 v62, v62, v162
    v_mul_f32 v63, v63, v162
    s_nop 1
    s_branch K1_RETr1b2
K1_SLOWr1b3:
    v_mov_b32 v162, v161
    s_nop 1
    v_permlane32_swap_b32 v161, v162
    v_max3_f32 v161, v161, v162, v156
    v_sub_f32 v162, v156, v161
    v_mul_f32 v162, s31, v162
    v_exp_f32 v162, v162
    v_mov_b32 v156, v161
    v_add_f32 v157, s67, v161
    v_mul_f32 v158, s31, v161
    v_sub_f32 v158, 0, v158
    v_mul_f32 v159, v159, v162
    v_mul_f32 v160, v160, v162
    v_mul_f32 v0, v0, v162
    v_mul_f32 v1, v1, v162
    v_mul_f32 v2, v2, v162
    v_mul_f32 v3, v3, v162
    v_mul_f32 v4, v4, v162
    v_mul_f32 v5, v5, v162
    v_mul_f32 v6, v6, v162
    v_mul_f32 v7, v7, v162
    v_mul_f32 v8, v8, v162
    v_mul_f32 v9, v9, v162
    v_mul_f32 v10, v10, v162
    v_mul_f32 v11, v11, v162
    v_mul_f32 v12, v12, v162
    v_mul_f32 v13, v13, v162
    v_mul_f32 v14, v14, v162
    v_mul_f32 v15, v15, v162
    v_mul_f32 v16, v16, v162
    v_mul_f32 v17, v17, v162
    v_mul_f32 v18, v18, v162
    v_mul_f32 v19, v19, v162
    v_mul_f32 v20, v20, v162
    v_mul_f32 v21, v21, v162
    v_mul_f32 v22, v22, v162
    v_mul_f32 v23, v23, v162
    v_mul_f32 v24, v24, v162
    v_mul_f32 v25, v25, v162
    v_mul_f32 v26, v26, v162
    v_mul_f32 v27, v27, v162
    v_mul_f32 v28, v28, v162
    v_mul_f32 v29, v29, v162
    v_mul_f32 v30, v30, v162
    v_mul_f32 v31, v31, v162
    v_mul_f32 v32, v32, v162
    v_mul_f32 v33, v33, v162
    v_mul_f32 v34, v34, v162
    v_mul_f32 v35, v35, v162
    v_mul_f32 v36, v36, v162
    v_mul_f32 v37, v37, v162
    v_mul_f32 v38, v38, v162
    v_mul_f32 v39, v39, v162
    v_mul_f32 v40, v40, v162
    v_mul_f32 v41, v41, v162
    v_mul_f32 v42, v42, v162
    v_mul_f32 v43, v43, v162
    v_mul_f32 v44, v44, v162
    v_mul_f32 v45, v45, v162
    v_mul_f32 v46, v46, v162
    v_mul_f32 v47, v47, v162
    v_mul_f32 v48, v48, v162
    v_mul_f32 v49, v49, v162
    v_mul_f32 v50, v50, v162
    v_mul_f32 v51, v51, v162
    v_mul_f32 v52, v52, v162
    v_mul_f32 v53, v53, v162
    v_mul_f32 v54, v54, v162
    v_mul_f32 v55, v55, v162
    v_mul_f32 v56, v56, v162
    v_mul_f32 v57, v57, v162
    v_mul_f32 v58, v58, v162
    v_mul_f32 v59, v59, v162
    v_mul_f32 v60, v60, v162
    v_mul_f32 v61, v61, v162
    v_mul_f32 v62, v62, v162
    v_mul_f32 v63, v63, v162
    s_nop 1
    s_branch K1_RETr1b3
K1_SLOWr2p1:
    v_mov_b32 v162, v161
    s_nop 1
    v_permlane32_swap_b32 v161, v162
    v_max3_f32 v161, v161, v162, v156
    v_sub_f32 v162, v156, v161
    v_mul_f32 v162, s31, v162
    v_exp_f32 v162, v162
    v_mov_b32 v156, v161
    v_add_f32 v157, s67, v161
    v_mul_f32 v158, s31, v161
    v_sub_f32 v158, 0, v158
    v_mul_f32 v159, v159, v162
    v_mul_f32 v160, v160, v162
    v_mul_f32 v0, v0, v162
    v_mul_f32 v1, v1, v162
    v_mul_f32 v2, v2, v162
    v_mul_f32 v3, v3, v162
    v_mul_f32 v4, v4, v162
    v_mul_f32 v5, v5, v162
    v_mul_f32 v6, v6, v162
    v_mul_f32 v7, v7, v162
    v_mul_f32 v8, v8, v162
    v_mul_f32 v9, v9, v162
    v_mul_f32 v10, v10, v162
    v_mul_f32 v11, v11, v162
    v_mul_f32 v12, v12, v162
    v_mul_f32 v13, v13, v162
    v_mul_f32 v14, v14, v162
    v_mul_f32 v15, v15, v162
    v_mul_f32 v16, v16, v162
    v_mul_f32 v17, v17, v162
    v_mul_f32 v18, v18, v162
    v_mul_f32 v19, v19, v162
    v_mul_f32 v20, v20, v162
    v_mul_f32 v21, v21, v162
    v_mul_f32 v22, v22, v162
    v_mul_f32 v23, v23, v162
    v_mul_f32 v24, v24, v162
    v_mul_f32 v25, v25, v162
    v_mul_f32 v26, v26, v162
    v_mul_f32 v27, v27, v162
    v_mul_f32 v28, v28, v162
    v_mul_f32 v29, v29, v162
    v_mul_f32 v30, v30, v162
    v_mul_f32 v31, v31, v162
    v_mul_f32 v32, v32, v162
    v_mul_f32 v33, v33, v162
    v_mul_f32 v34, v34, v162
    v_mul_f32 v35, v35, v162
    v_mul_f32 v36, v36, v162
    v_mul_f32 v37, v37, v162
    v_mul_f32 v38, v38, v162
    v_mul_f32 v39, v39, v162
    v_mul_f32 v40, v40, v162
    v_mul_f32 v41, v41, v162
    v_mul_f32 v42, v42, v162
    v_mul_f32 v43, v43, v162
    v_mul_f32 v44, v44, v162
    v_mul_f32 v45, v45, v162
    v_mul_f32 v46, v46, v162
    v_mul_f32 v47, v47, v162
    v_mul_f32 v48, v48, v162
    v_mul_f32 v49, v49, v162
    v_mul_f32 v50, v50, v162
    v_mul_f32 v51, v51, v162
    v_mul_f32 v52, v52, v162
    v_mul_f32 v53, v53, v162
    v_mul_f32 v54, v54, v162
    v_mul_f32 v55, v55, v162
    v_mul_f32 v56, v56, v162
    v_mul_f32 v57, v57, v162
    v_mul_f32 v58, v58, v162
    v_mul_f32 v59, v59, v162
    v_mul_f32 v60, v60, v162
    v_mul_f32 v61, v61, v162
    v_mul_f32 v62, v62, v162
    v_mul_f32 v63, v63, v162
    s_nop 1
    s_branch K1_RETr2p1
K1_SLOWr2p2:
    v_mov_b32 v162, v161
    s_nop 1
    v_permlane32_swap_b32 v161, v162
    v_max3_f32 v161, v161, v162, v156
    v_sub_f32 v162, v156, v161
    v_mul_f32 v162, s31, v162
    v_exp_f32 v162, v162
    v_mov_b32 v156, v161
    v_add_f32 v157, s67, v161
    v_mul_f32 v158, s31, v161
    v_sub_f32 v158, 0, v158
    v_mul_f32 v159, v159, v162
    v_mul_f32 v160, v160, v162
    v_mul_f32 v0, v0, v162
    v_mul_f32 v1, v1, v162
    v_mul_f32 v2, v2, v162
    v_mul_f32 v3, v3, v162
    v_mul_f32 v4, v4, v162
    v_mul_f32 v5, v5, v162
    v_mul_f32 v6, v6, v162
    v_mul_f32 v7, v7, v162
    v_mul_f32 v8, v8, v162
    v_mul_f32 v9, v9, v162
    v_mul_f32 v10, v10, v162
    v_mul_f32 v11, v11, v162
    v_mul_f32 v12, v12, v162
    v_mul_f32 v13, v13, v162
    v_mul_f32 v14, v14, v162
    v_mul_f32 v15, v15, v162
    v_mul_f32 v16, v16, v162
    v_mul_f32 v17, v17, v162
    v_mul_f32 v18, v18, v162
    v_mul_f32 v19, v19, v162
    v_mul_f32 v20, v20, v162
    v_mul_f32 v21, v21, v162
    v_mul_f32 v22, v22, v162
    v_mul_f32 v23, v23, v162
    v_mul_f32 v24, v24, v162
    v_mul_f32 v25, v25, v162
    v_mul_f32 v26, v26, v162
    v_mul_f32 v27, v27, v162
    v_mul_f32 v28, v28, v162
    v_mul_f32 v29, v29, v162
    v_mul_f32 v30, v30, v162
    v_mul_f32 v31, v31, v162
    v_mul_f32 v32, v32, v162
    v_mul_f32 v33, v33, v162
    v_mul_f32 v34, v34, v162
    v_mul_f32 v35, v35, v162
    v_mul_f32 v36, v36, v162
    v_mul_f32 v37, v37, v162
    v_mul_f32 v38, v38, v162
    v_mul_f32 v39, v39, v162
    v_mul_f32 v40, v40, v162
    v_mul_f32 v41, v41, v162
    v_mul_f32 v42, v42, v162
    v_mul_f32 v43, v43, v162
    v_mul_f32 v44, v44, v162
    v_mul_f32 v45, v45, v162
    v_mul_f32 v46, v46, v162
    v_mul_f32 v47, v47, v162
    v_mul_f32 v48, v48, v162
    v_mul_f32 v49, v49, v162
    v_mul_f32 v50, v50, v162
    v_mul_f32 v51, v51, v162
    v_mul_f32 v52, v52, v162
    v_mul_f32 v53, v53, v162
    v_mul_f32 v54, v54, v162
    v_mul_f32 v55, v55, v162
    v_mul_f32 v56, v56, v162
    v_mul_f32 v57, v57, v162
    v_mul_f32 v58, v58, v162
    v_mul_f32 v59, v59, v162
    v_mul_f32 v60, v60, v162
    v_mul_f32 v61, v61, v162
    v_mul_f32 v62, v62, v162
    v_mul_f32 v63, v63, v162
    s_nop 1
    s_branch K1_RETr2p2
K1_SLOWr2p3:
    v_mov_b32 v162, v161
    s_nop 1
    v_permlane32_swap_b32 v161, v162
    v_max3_f32 v161, v161, v162, v156
    v_sub_f32 v162, v156, v161
    v_mul_f32 v162, s31, v162
    v_exp_f32 v162, v162
    v_mov_b32 v156, v161
    v_add_f32 v157, s67, v161
    v_mul_f32 v158, s31, v161
    v_sub_f32 v158, 0, v158
    v_mul_f32 v159, v159, v162
    v_mul_f32 v160, v160, v162
    v_mul_f32 v0, v0, v162
    v_mul_f32 v1, v1, v162
    v_mul_f32 v2, v2, v162
    v_mul_f32 v3, v3, v162
    v_mul_f32 v4, v4, v162
    v_mul_f32 v5, v5, v162
    v_mul_f32 v6, v6, v162
    v_mul_f32 v7, v7, v162
    v_mul_f32 v8, v8, v162
    v_mul_f32 v9, v9, v162
    v_mul_f32 v10, v10, v162
    v_mul_f32 v11, v11, v162
    v_mul_f32 v12, v12, v162
    v_mul_f32 v13, v13, v162
    v_mul_f32 v14, v14, v162
    v_mul_f32 v15, v15, v162
    v_mul_f32 v16, v16, v162
    v_mul_f32 v17, v17, v162
    v_mul_f32 v18, v18, v162
    v_mul_f32 v19, v19, v162
    v_mul_f32 v20, v20, v162
    v_mul_f32 v21, v21, v162
    v_mul_f32 v22, v22, v162
    v_mul_f32 v23, v23, v162
    v_mul_f32 v24, v24, v162
    v_mul_f32 v25, v25, v162
    v_mul_f32 v26, v26, v162
    v_mul_f32 v27, v27, v162
    v_mul_f32 v28, v28, v162
    v_mul_f32 v29, v29, v162
    v_mul_f32 v30, v30, v162
    v_mul_f32 v31, v31, v162
    v_mul_f32 v32, v32, v162
    v_mul_f32 v33, v33, v162
    v_mul_f32 v34, v34, v162
    v_mul_f32 v35, v35, v162
    v_mul_f32 v36, v36, v162
    v_mul_f32 v37, v37, v162
    v_mul_f32 v38, v38, v162
    v_mul_f32 v39, v39, v162
    v_mul_f32 v40, v40, v162
    v_mul_f32 v41, v41, v162
    v_mul_f32 v42, v42, v162
    v_mul_f32 v43, v43, v162
    v_mul_f32 v44, v44, v162
    v_mul_f32 v45, v45, v162
    v_mul_f32 v46, v46, v162
    v_mul_f32 v47, v47, v162
    v_mul_f32 v48, v48, v162
    v_mul_f32 v49, v49, v162
    v_mul_f32 v50, v50, v162
    v_mul_f32 v51, v51, v162
    v_mul_f32 v52, v52, v162
    v_mul_f32 v53, v53, v162
    v_mul_f32 v54, v54, v162
    v_mul_f32 v55, v55, v162
    v_mul_f32 v56, v56, v162
    v_mul_f32 v57, v57, v162
    v_mul_f32 v58, v58, v162
    v_mul_f32 v59, v59, v162
    v_mul_f32 v60, v60, v162
    v_mul_f32 v61, v61, v162
    v_mul_f32 v62, v62, v162
    v_mul_f32 v63, v63, v162
    s_nop 1
    s_branch K1_RETr2p3
K1_SLOWr2a0:
    v_mov_b32 v162, v161
    s_nop 1
    v_permlane32_swap_b32 v161, v162
    v_max3_f32 v161, v161, v162, v156
    v_sub_f32 v162, v156, v161
    v_mul_f32 v162, s31, v162
    v_exp_f32 v162, v162
    v_mov_b32 v156, v161
    v_add_f32 v157, s67, v161
    v_mul_f32 v158, s31, v161
    v_sub_f32 v158, 0, v158
    v_mul_f32 v159, v159, v162
    v_mul_f32 v160, v160, v162
    v_mul_f32 v0, v0, v162
    v_mul_f32 v1, v1, v162
    v_mul_f32 v2, v2, v162
    v_mul_f32 v3, v3, v162
    v_mul_f32 v4, v4, v162
    v_mul_f32 v5, v5, v162
    v_mul_f32 v6, v6, v162
    v_mul_f32 v7, v7, v162
    v_mul_f32 v8, v8, v162
    v_mul_f32 v9, v9, v162
    v_mul_f32 v10, v10, v162
    v_mul_f32 v11, v11, v162
    v_mul_f32 v12, v12, v162
    v_mul_f32 v13, v13, v162
    v_mul_f32 v14, v14, v162
    v_mul_f32 v15, v15, v162
    v_mul_f32 v16, v16, v162
    v_mul_f32 v17, v17, v162
    v_mul_f32 v18, v18, v162
    v_mul_f32 v19, v19, v162
    v_mul_f32 v20, v20, v162
    v_mul_f32 v21, v21, v162
    v_mul_f32 v22, v22, v162
    v_mul_f32 v23, v23, v162
    v_mul_f32 v24, v24, v162
    v_mul_f32 v25, v25, v162
    v_mul_f32 v26, v26, v162
    v_mul_f32 v27, v27, v162
    v_mul_f32 v28, v28, v162
    v_mul_f32 v29, v29, v162
    v_mul_f32 v30, v30, v162
    v_mul_f32 v31, v31, v162
    v_mul_f32 v32, v32, v162
    v_mul_f32 v33, v33, v162
    v_mul_f32 v34, v34, v162
    v_mul_f32 v35, v35, v162
    v_mul_f32 v36, v36, v162
    v_mul_f32 v37, v37, v162
    v_mul_f32 v38, v38, v162
    v_mul_f32 v39, v39, v162
    v_mul_f32 v40, v40, v162
    v_mul_f32 v41, v41, v162
    v_mul_f32 v42, v42, v162
    v_mul_f32 v43, v43, v162
    v_mul_f32 v44, v44, v162
    v_mul_f32 v45, v45, v162
    v_mul_f32 v46, v46, v162
    v_mul_f32 v47, v47, v162
    v_mul_f32 v48, v48, v162
    v_mul_f32 v49, v49, v162
    v_mul_f32 v50, v50, v162
    v_mul_f32 v51, v51, v162
    v_mul_f32 v52, v52, v162
    v_mul_f32 v53, v53, v162
    v_mul_f32 v54, v54, v162
    v_mul_f32 v55, v55, v162
    v_mul_f32 v56, v56, v162
    v_mul_f32 v57, v57, v162
    v_mul_f32 v58, v58, v162
    v_mul_f32 v59, v59, v162
    v_mul_f32 v60, v60, v162
    v_mul_f32 v61, v61, v162
    v_mul_f32 v62, v62, v162
    v_mul_f32 v63, v63, v162
    s_nop 1
    s_branch K1_RETr2a0
K1_SLOWr2a1:
    v_mov_b32 v162, v161
    s_nop 1
    v_permlane32_swap_b32 v161, v162
    v_max3_f32 v161, v161, v162, v156
    v_sub_f32 v162, v156, v161
    v_mul_f32 v162, s31, v162
    v_exp_f32 v162, v162
    v_mov_b32 v156, v161
    v_add_f32 v157, s67, v161
    v_mul_f32 v158, s31, v161
    v_sub_f32 v158, 0, v158
    v_mul_f32 v159, v159, v162
    v_mul_f32 v160, v160, v162
    v_mul_f32 v0, v0, v162
    v_mul_f32 v1, v1, v162
    v_mul_f32 v2, v2, v162
    v_mul_f32 v3, v3, v162
    v_mul_f32 v4, v4, v162
    v_mul_f32 v5, v5, v162
    v_mul_f32 v6, v6, v162
    v_mul_f32 v7, v7, v162
    v_mul_f32 v8, v8, v162
    v_mul_f32 v9, v9, v162
    v_mul_f32 v10, v10, v162
    v_mul_f32 v11, v11, v162
    v_mul_f32 v12, v12, v162
    v_mul_f32 v13, v13, v162
    v_mul_f32 v14, v14, v162
    v_mul_f32 v15, v15, v162
    v_mul_f32 v16, v16, v162
    v_mul_f32 v17, v17, v162
    v_mul_f32 v18, v18, v162
    v_mul_f32 v19, v19, v162
    v_mul_f32 v20, v20, v162
    v_mul_f32 v21, v21, v162
    v_mul_f32 v22, v22, v162
    v_mul_f32 v23, v23, v162
    v_mul_f32 v24, v24, v162
    v_mul_f32 v25, v25, v162
    v_mul_f32 v26, v26, v162
    v_mul_f32 v27, v27, v162
    v_mul_f32 v28, v28, v162
    v_mul_f32 v29, v29, v162
    v_mul_f32 v30, v30, v162
    v_mul_f32 v31, v31, v162
    v_mul_f32 v32, v32, v162
    v_mul_f32 v33, v33, v162
    v_mul_f32 v34, v34, v162
    v_mul_f32 v35, v35, v162
    v_mul_f32 v36, v36, v162
    v_mul_f32 v37, v37, v162
    v_mul_f32 v38, v38, v162
    v_mul_f32 v39, v39, v162
    v_mul_f32 v40, v40, v162
    v_mul_f32 v41, v41, v162
    v_mul_f32 v42, v42, v162
    v_mul_f32 v43, v43, v162
    v_mul_f32 v44, v44, v162
    v_mul_f32 v45, v45, v162
    v_mul_f32 v46, v46, v162
    v_mul_f32 v47, v47, v162
    v_mul_f32 v48, v48, v162
    v_mul_f32 v49, v49, v162
    v_mul_f32 v50, v50, v162
    v_mul_f32 v51, v51, v162
    v_mul_f32 v52, v52, v162
    v_mul_f32 v53, v53, v162
    v_mul_f32 v54, v54, v162
    v_mul_f32 v55, v55, v162
    v_mul_f32 v56, v56, v162
    v_mul_f32 v57, v57, v162
    v_mul_f32 v58, v58, v162
    v_mul_f32 v59, v59, v162
    v_mul_f32 v60, v60, v162
    v_mul_f32 v61, v61, v162
    v_mul_f32 v62, v62, v162
    v_mul_f32 v63, v63, v162
    s_nop 1
    s_branch K1_RETr2a1
K1_SLOWr2a2:
    v_mov_b32 v162, v161
    s_nop 1
    v_permlane32_swap_b32 v161, v162
    v_max3_f32 v161, v161, v162, v156
    v_sub_f32 v162, v156, v161
    v_mul_f32 v162, s31, v162
    v_exp_f32 v162, v162
    v_mov_b32 v156, v161
    v_add_f32 v157, s67, v161
    v_mul_f32 v158, s31, v161
    v_sub_f32 v158, 0, v158
    v_mul_f32 v159, v159, v162
    v_mul_f32 v160, v160, v162
    v_mul_f32 v0, v0, v162
    v_mul_f32 v1, v1, v162
    v_mul_f32 v2, v2, v162
    v_mul_f32 v3, v3, v162
    v_mul_f32 v4, v4, v162
    v_mul_f32 v5, v5, v162
    v_mul_f32 v6, v6, v162
    v_mul_f32 v7, v7, v162
    v_mul_f32 v8, v8, v162
    v_mul_f32 v9, v9, v162
    v_mul_f32 v10, v10, v162
    v_mul_f32 v11, v11, v162
    v_mul_f32 v12, v12, v162
    v_mul_f32 v13, v13, v162
    v_mul_f32 v14, v14, v162
    v_mul_f32 v15, v15, v162
    v_mul_f32 v16, v16, v162
    v_mul_f32 v17, v17, v162
    v_mul_f32 v18, v18, v162
    v_mul_f32 v19, v19, v162
    v_mul_f32 v20, v20, v162
    v_mul_f32 v21, v21, v162
    v_mul_f32 v22, v22, v162
    v_mul_f32 v23, v23, v162
    v_mul_f32 v24, v24, v162
    v_mul_f32 v25, v25, v162
    v_mul_f32 v26, v26, v162
    v_mul_f32 v27, v27, v162
    v_mul_f32 v28, v28, v162
    v_mul_f32 v29, v29, v162
    v_mul_f32 v30, v30, v162
    v_mul_f32 v31, v31, v162
    v_mul_f32 v32, v32, v162
    v_mul_f32 v33, v33, v162
    v_mul_f32 v34, v34, v162
    v_mul_f32 v35, v35, v162
    v_mul_f32 v36, v36, v162
    v_mul_f32 v37, v37, v162
    v_mul_f32 v38, v38, v162
    v_mul_f32 v39, v39, v162
    v_mul_f32 v40, v40, v162
    v_mul_f32 v41, v41, v162
    v_mul_f32 v42, v42, v162
    v_mul_f32 v43, v43, v162
    v_mul_f32 v44, v44, v162
    v_mul_f32 v45, v45, v162
    v_mul_f32 v46, v46, v162
    v_mul_f32 v47, v47, v162
    v_mul_f32 v48, v48, v162
    v_mul_f32 v49, v49, v162
    v_mul_f32 v50, v50, v162
    v_mul_f32 v51, v51, v162
    v_mul_f32 v52, v52, v162
    v_mul_f32 v53, v53, v162
    v_mul_f32 v54, v54, v162
    v_mul_f32 v55, v55, v162
    v_mul_f32 v56, v56, v162
    v_mul_f32 v57, v57, v162
    v_mul_f32 v58, v58, v162
    v_mul_f32 v59, v59, v162
    v_mul_f32 v60, v60, v162
    v_mul_f32 v61, v61, v162
    v_mul_f32 v62, v62, v162
    v_mul_f32 v63, v63, v162
    s_nop 1
    s_branch K1_RETr2a2
K1_SLOWr2a3:
    v_mov_b32 v162, v161
    s_nop 1
    v_permlane32_swap_b32 v161, v162
    v_max3_f32 v161, v161, v162, v156
    v_sub_f32 v162, v156, v161
    v_mul_f32 v162, s31, v162
    v_exp_f32 v162, v162
    v_mov_b32 v156, v161
    v_add_f32 v157, s67, v161
    v_mul_f32 v158, s31, v161
    v_sub_f32 v158, 0, v158
    v_mul_f32 v159, v159, v162
    v_mul_f32 v160, v160, v162
    v_mul_f32 v0, v0, v162
    v_mul_f32 v1, v1, v162
    v_mul_f32 v2, v2, v162
    v_mul_f32 v3, v3, v162
    v_mul_f32 v4, v4, v162
    v_mul_f32 v5, v5, v162
    v_mul_f32 v6, v6, v162
    v_mul_f32 v7, v7, v162
    v_mul_f32 v8, v8, v162
    v_mul_f32 v9, v9, v162
    v_mul_f32 v10, v10, v162
    v_mul_f32 v11, v11, v162
    v_mul_f32 v12, v12, v162
    v_mul_f32 v13, v13, v162
    v_mul_f32 v14, v14, v162
    v_mul_f32 v15, v15, v162
    v_mul_f32 v16, v16, v162
    v_mul_f32 v17, v17, v162
    v_mul_f32 v18, v18, v162
    v_mul_f32 v19, v19, v162
    v_mul_f32 v20, v20, v162
    v_mul_f32 v21, v21, v162
    v_mul_f32 v22, v22, v162
    v_mul_f32 v23, v23, v162
    v_mul_f32 v24, v24, v162
    v_mul_f32 v25, v25, v162
    v_mul_f32 v26, v26, v162
    v_mul_f32 v27, v27, v162
    v_mul_f32 v28, v28, v162
    v_mul_f32 v29, v29, v162
    v_mul_f32 v30, v30, v162
    v_mul_f32 v31, v31, v162
    v_mul_f32 v32, v32, v162
    v_mul_f32 v33, v33, v162
    v_mul_f32 v34, v34, v162
    v_mul_f32 v35, v35, v162
    v_mul_f32 v36, v36, v162
    v_mul_f32 v37, v37, v162
    v_mul_f32 v38, v38, v162
    v_mul_f32 v39, v39, v162
    v_mul_f32 v40, v40, v162
    v_mul_f32 v41, v41, v162
    v_mul_f32 v42, v42, v162
    v_mul_f32 v43, v43, v162
    v_mul_f32 v44, v44, v162
    v_mul_f32 v45, v45, v162
    v_mul_f32 v46, v46, v162
    v_mul_f32 v47, v47, v162
    v_mul_f32 v48, v48, v162
    v_mul_f32 v49, v49, v162
    v_mul_f32 v50, v50, v162
    v_mul_f32 v51, v51, v162
    v_mul_f32 v52, v52, v162
    v_mul_f32 v53, v53, v162
    v_mul_f32 v54, v54, v162
    v_mul_f32 v55, v55, v162
    v_mul_f32 v56, v56, v162
    v_mul_f32 v57, v57, v162
    v_mul_f32 v58, v58, v162
    v_mul_f32 v59, v59, v162
    v_mul_f32 v60, v60, v162
    v_mul_f32 v61, v61, v162
    v_mul_f32 v62, v62, v162
    v_mul_f32 v63, v63, v162
    s_nop 1
    s_branch K1_RETr2a3
K1_SLOWr2b0:
    v_mov_b32 v162, v161
    s_nop 1
    v_permlane32_swap_b32 v161, v162
    v_max3_f32 v161, v161, v162, v156
    v_sub_f32 v162, v156, v161
    v_mul_f32 v162, s31, v162
    v_exp_f32 v162, v162
    v_mov_b32 v156, v161
    v_add_f32 v157, s67, v161
    v_mul_f32 v158, s31, v161
    v_sub_f32 v158, 0, v158
    v_mul_f32 v159, v159, v162
    v_mul_f32 v160, v160, v162
    v_mul_f32 v0, v0, v162
    v_mul_f32 v1, v1, v162
    v_mul_f32 v2, v2, v162
    v_mul_f32 v3, v3, v162
    v_mul_f32 v4, v4, v162
    v_mul_f32 v5, v5, v162
    v_mul_f32 v6, v6, v162
    v_mul_f32 v7, v7, v162
    v_mul_f32 v8, v8, v162
    v_mul_f32 v9, v9, v162
    v_mul_f32 v10, v10, v162
    v_mul_f32 v11, v11, v162
    v_mul_f32 v12, v12, v162
    v_mul_f32 v13, v13, v162
    v_mul_f32 v14, v14, v162
    v_mul_f32 v15, v15, v162
    v_mul_f32 v16, v16, v162
    v_mul_f32 v17, v17, v162
    v_mul_f32 v18, v18, v162
    v_mul_f32 v19, v19, v162
    v_mul_f32 v20, v20, v162
    v_mul_f32 v21, v21, v162
    v_mul_f32 v22, v22, v162
    v_mul_f32 v23, v23, v162
    v_mul_f32 v24, v24, v162
    v_mul_f32 v25, v25, v162
    v_mul_f32 v26, v26, v162
    v_mul_f32 v27, v27, v162
    v_mul_f32 v28, v28, v162
    v_mul_f32 v29, v29, v162
    v_mul_f32 v30, v30, v162
    v_mul_f32 v31, v31, v162
    v_mul_f32 v32, v32, v162
    v_mul_f32 v33, v33, v162
    v_mul_f32 v34, v34, v162
    v_mul_f32 v35, v35, v162
    v_mul_f32 v36, v36, v162
    v_mul_f32 v37, v37, v162
    v_mul_f32 v38, v38, v162
    v_mul_f32 v39, v39, v162
    v_mul_f32 v40, v40, v162
    v_mul_f32 v41, v41, v162
    v_mul_f32 v42, v42, v162
    v_mul_f32 v43, v43, v162
    v_mul_f32 v44, v44, v162
    v_mul_f32 v45, v45, v162
    v_mul_f32 v46, v46, v162
    v_mul_f32 v47, v47, v162
    v_mul_f32 v48, v48, v162
    v_mul_f32 v49, v49, v162
    v_mul_f32 v50, v50, v162
    v_mul_f32 v51, v51, v162
    v_mul_f32 v52, v52, v162
    v_mul_f32 v53, v53, v162
    v_mul_f32 v54, v54, v162
    v_mul_f32 v55, v55, v162
    v_mul_f32 v56, v56, v162
    v_mul_f32 v57, v57, v162
    v_mul_f32 v58, v58, v162
    v_mul_f32 v59, v59, v162
    v_mul_f32 v60, v60, v162
    v_mul_f32 v61, v61, v162
    v_mul_f32 v62, v62, v162
    v_mul_f32 v63, v63, v162
    s_nop 1
    s_branch K1_RETr2b0
K1_SLOWr2b1:
    v_mov_b32 v162, v161
    s_nop 1
    v_permlane32_swap_b32 v161, v162
    v_max3_f32 v161, v161, v162, v156
    v_sub_f32 v162, v156, v161
    v_mul_f32 v162, s31, v162
    v_exp_f32 v162, v162
    v_mov_b32 v156, v161
    v_add_f32 v157, s67, v161
    v_mul_f32 v158, s31, v161
    v_sub_f32 v158, 0, v158
    v_mul_f32 v159, v159, v162
    v_mul_f32 v160, v160, v162
    v_mul_f32 v0, v0, v162
    v_mul_f32 v1, v1, v162
    v_mul_f32 v2, v2, v162
    v_mul_f32 v3, v3, v162
    v_mul_f32 v4, v4, v162
    v_mul_f32 v5, v5, v162
    v_mul_f32 v6, v6, v162
    v_mul_f32 v7, v7, v162
    v_mul_f32 v8, v8, v162
    v_mul_f32 v9, v9, v162
    v_mul_f32 v10, v10, v162
    v_mul_f32 v11, v11, v162
    v_mul_f32 v12, v12, v162
    v_mul_f32 v13, v13, v162
    v_mul_f32 v14, v14, v162
    v_mul_f32 v15, v15, v162
    v_mul_f32 v16, v16, v162
    v_mul_f32 v17, v17, v162
    v_mul_f32 v18, v18, v162
    v_mul_f32 v19, v19, v162
    v_mul_f32 v20, v20, v162
    v_mul_f32 v21, v21, v162
    v_mul_f32 v22, v22, v162
    v_mul_f32 v23, v23, v162
    v_mul_f32 v24, v24, v162
    v_mul_f32 v25, v25, v162
    v_mul_f32 v26, v26, v162
    v_mul_f32 v27, v27, v162
    v_mul_f32 v28, v28, v162
    v_mul_f32 v29, v29, v162
    v_mul_f32 v30, v30, v162
    v_mul_f32 v31, v31, v162
    v_mul_f32 v32, v32, v162
    v_mul_f32 v33, v33, v162
    v_mul_f32 v34, v34, v162
    v_mul_f32 v35, v35, v162
    v_mul_f32 v36, v36, v162
    v_mul_f32 v37, v37, v162
    v_mul_f32 v38, v38, v162
    v_mul_f32 v39, v39, v162
    v_mul_f32 v40, v40, v162
    v_mul_f32 v41, v41, v162
    v_mul_f32 v42, v42, v162
    v_mul_f32 v43, v43, v162
    v_mul_f32 v44, v44, v162
    v_mul_f32 v45, v45, v162
    v_mul_f32 v46, v46, v162
    v_mul_f32 v47, v47, v162
    v_mul_f32 v48, v48, v162
    v_mul_f32 v49, v49, v162
    v_mul_f32 v50, v50, v162
    v_mul_f32 v51, v51, v162
    v_mul_f32 v52, v52, v162
    v_mul_f32 v53, v53, v162
    v_mul_f32 v54, v54, v162
    v_mul_f32 v55, v55, v162
    v_mul_f32 v56, v56, v162
    v_mul_f32 v57, v57, v162
    v_mul_f32 v58, v58, v162
    v_mul_f32 v59, v59, v162
    v_mul_f32 v60, v60, v162
    v_mul_f32 v61, v61, v162
    v_mul_f32 v62, v62, v162
    v_mul_f32 v63, v63, v162
    s_nop 1
    s_branch K1_RETr2b1
K1_SLOWr2b2:
    v_mov_b32 v162, v161
    s_nop 1
    v_permlane32_swap_b32 v161, v162
    v_max3_f32 v161, v161, v162, v156
    v_sub_f32 v162, v156, v161
    v_mul_f32 v162, s31, v162
    v_exp_f32 v162, v162
    v_mov_b32 v156, v161
    v_add_f32 v157, s67, v161
    v_mul_f32 v158, s31, v161
    v_sub_f32 v158, 0, v158
    v_mul_f32 v159, v159, v162
    v_mul_f32 v160, v160, v162
    v_mul_f32 v0, v0, v162
    v_mul_f32 v1, v1, v162
    v_mul_f32 v2, v2, v162
    v_mul_f32 v3, v3, v162
    v_mul_f32 v4, v4, v162
    v_mul_f32 v5, v5, v162
    v_mul_f32 v6, v6, v162
    v_mul_f32 v7, v7, v162
    v_mul_f32 v8, v8, v162
    v_mul_f32 v9, v9, v162
    v_mul_f32 v10, v10, v162
    v_mul_f32 v11, v11, v162
    v_mul_f32 v12, v12, v162
    v_mul_f32 v13, v13, v162
    v_mul_f32 v14, v14, v162
    v_mul_f32 v15, v15, v162
    v_mul_f32 v16, v16, v162
    v_mul_f32 v17, v17, v162
    v_mul_f32 v18, v18, v162
    v_mul_f32 v19, v19, v162
    v_mul_f32 v20, v20, v162
    v_mul_f32 v21, v21, v162
    v_mul_f32 v22, v22, v162
    v_mul_f32 v23, v23, v162
    v_mul_f32 v24, v24, v162
    v_mul_f32 v25, v25, v162
    v_mul_f32 v26, v26, v162
    v_mul_f32 v27, v27, v162
    v_mul_f32 v28, v28, v162
    v_mul_f32 v29, v29, v162
    v_mul_f32 v30, v30, v162
    v_mul_f32 v31, v31, v162
    v_mul_f32 v32, v32, v162
    v_mul_f32 v33, v33, v162
    v_mul_f32 v34, v34, v162
    v_mul_f32 v35, v35, v162
    v_mul_f32 v36, v36, v162
    v_mul_f32 v37, v37, v162
    v_mul_f32 v38, v38, v162
    v_mul_f32 v39, v39, v162
    v_mul_f32 v40, v40, v162
    v_mul_f32 v41, v41, v162
    v_mul_f32 v42, v42, v162
    v_mul_f32 v43, v43, v162
    v_mul_f32 v44, v44, v162
    v_mul_f32 v45, v45, v162
    v_mul_f32 v46, v46, v162
    v_mul_f32 v47, v47, v162
    v_mul_f32 v48, v48, v162
    v_mul_f32 v49, v49, v162
    v_mul_f32 v50, v50, v162
    v_mul_f32 v51, v51, v162
    v_mul_f32 v52, v52, v162
    v_mul_f32 v53, v53, v162
    v_mul_f32 v54, v54, v162
    v_mul_f32 v55, v55, v162
    v_mul_f32 v56, v56, v162
    v_mul_f32 v57, v57, v162
    v_mul_f32 v58, v58, v162
    v_mul_f32 v59, v59, v162
    v_mul_f32 v60, v60, v162
    v_mul_f32 v61, v61, v162
    v_mul_f32 v62, v62, v162
    v_mul_f32 v63, v63, v162
    s_nop 1
    s_branch K1_RETr2b2
K1_SLOWr2b3:
    v_mov_b32 v162, v161
    s_nop 1
    v_permlane32_swap_b32 v161, v162
    v_max3_f32 v161, v161, v162, v156
    v_sub_f32 v162, v156, v161
    v_mul_f32 v162, s31, v162
    v_exp_f32 v162, v162
    v_mov_b32 v156, v161
    v_add_f32 v157, s67, v161
    v_mul_f32 v158, s31, v161
    v_sub_f32 v158, 0, v158
    v_mul_f32 v159, v159, v162
    v_mul_f32 v160, v160, v162
    v_mul_f32 v0, v0, v162
    v_mul_f32 v1, v1, v162
    v_mul_f32 v2, v2, v162
    v_mul_f32 v3, v3, v162
    v_mul_f32 v4, v4, v162
    v_mul_f32 v5, v5, v162
    v_mul_f32 v6, v6, v162
    v_mul_f32 v7, v7, v162
    v_mul_f32 v8, v8, v162
    v_mul_f32 v9, v9, v162
    v_mul_f32 v10, v10, v162
    v_mul_f32 v11, v11, v162
    v_mul_f32 v12, v12, v162
    v_mul_f32 v13, v13, v162
    v_mul_f32 v14, v14, v162
    v_mul_f32 v15, v15, v162
    v_mul_f32 v16, v16, v162
    v_mul_f32 v17, v17, v162
    v_mul_f32 v18, v18, v162
    v_mul_f32 v19, v19, v162
    v_mul_f32 v20, v20, v162
    v_mul_f32 v21, v21, v162
    v_mul_f32 v22, v22, v162
    v_mul_f32 v23, v23, v162
    v_mul_f32 v24, v24, v162
    v_mul_f32 v25, v25, v162
    v_mul_f32 v26, v26, v162
    v_mul_f32 v27, v27, v162
    v_mul_f32 v28, v28, v162
    v_mul_f32 v29, v29, v162
    v_mul_f32 v30, v30, v162
    v_mul_f32 v31, v31, v162
    v_mul_f32 v32, v32, v162
    v_mul_f32 v33, v33, v162
    v_mul_f32 v34, v34, v162
    v_mul_f32 v35, v35, v162
    v_mul_f32 v36, v36, v162
    v_mul_f32 v37, v37, v162
    v_mul_f32 v38, v38, v162
    v_mul_f32 v39, v39, v162
    v_mul_f32 v40, v40, v162
    v_mul_f32 v41, v41, v162
    v_mul_f32 v42, v42, v162
    v_mul_f32 v43, v43, v162
    v_mul_f32 v44, v44, v162
    v_mul_f32 v45, v45, v162
    v_mul_f32 v46, v46, v162
    v_mul_f32 v47, v47, v162
    v_mul_f32 v48, v48, v162
    v_mul_f32 v49, v49, v162
    v_mul_f32 v50, v50, v162
    v_mul_f32 v51, v51, v162
    v_mul_f32 v52, v52, v162
    v_mul_f32 v53, v53, v162
    v_mul_f32 v54, v54, v162
    v_mul_f32 v55, v55, v162
    v_mul_f32 v56, v56, v162
    v_mul_f32 v57, v57, v162
    v_mul_f32 v58, v58, v162
    v_mul_f32 v59, v59, v162
    v_mul_f32 v60, v60, v162
    v_mul_f32 v61, v61, v162
    v_mul_f32 v62, v62, v162
    v_mul_f32 v63, v63, v162
    s_nop 1
    s_branch K1_RETr2b3
K1_SLOWr2z:
    v_mov_b32 v162, v161
    s_nop 1
    v_permlane32_swap_b32 v161, v162
    v_max3_f32 v161, v161, v162, v156
    v_sub_f32 v162, v156, v161
    v_mul_f32 v162, s31, v162
    v_exp_f32 v162, v162
    v_mov_b32 v156, v161
    v_add_f32 v157, s67, v161
    v_mul_f32 v158, s31, v161
    v_sub_f32 v158, 0, v158
    v_mul_f32 v159, v159, v162
    v_mul_f32 v160, v160, v162
    v_mul_f32 v0, v0, v162
    v_mul_f32 v1, v1, v162
    v_mul_f32 v2, v2, v162
    v_mul_f32 v3, v3, v162
    v_mul_f32 v4, v4, v162
    v_mul_f32 v5, v5, v162
    v_mul_f32 v6, v6, v162
    v_mul_f32 v7, v7, v162
    v_mul_f32 v8, v8, v162
    v_mul_f32 v9, v9, v162
    v_mul_f32 v10, v10, v162
    v_mul_f32 v11, v11, v162
    v_mul_f32 v12, v12, v162
    v_mul_f32 v13, v13, v162
    v_mul_f32 v14, v14, v162
    v_mul_f32 v15, v15, v162
    v_mul_f32 v16, v16, v162
    v_mul_f32 v17, v17, v162
    v_mul_f32 v18, v18, v162
    v_mul_f32 v19, v19, v162
    v_mul_f32 v20, v20, v162
    v_mul_f32 v21, v21, v162
    v_mul_f32 v22, v22, v162
    v_mul_f32 v23, v23, v162
    v_mul_f32 v24, v24, v162
    v_mul_f32 v25, v25, v162
    v_mul_f32 v26, v26, v162
    v_mul_f32 v27, v27, v162
    v_mul_f32 v28, v28, v162
    v_mul_f32 v29, v29, v162
    v_mul_f32 v30, v30, v162
    v_mul_f32 v31, v31, v162
    v_mul_f32 v32, v32, v162
    v_mul_f32 v33, v33, v162
    v_mul_f32 v34, v34, v162
    v_mul_f32 v35, v35, v162
    v_mul_f32 v36, v36, v162
    v_mul_f32 v37, v37, v162
    v_mul_f32 v38, v38, v162
    v_mul_f32 v39, v39, v162
    v_mul_f32 v40, v40, v162
    v_mul_f32 v41, v41, v162
    v_mul_f32 v42, v42, v162
    v_mul_f32 v43, v43, v162
    v_mul_f32 v44, v44, v162
    v_mul_f32 v45, v45, v162
    v_mul_f32 v46, v46, v162
    v_mul_f32 v47, v47, v162
    v_mul_f32 v48, v48, v162
    v_mul_f32 v49, v49, v162
    v_mul_f32 v50, v50, v162
    v_mul_f32 v51, v51, v162
    v_mul_f32 v52, v52, v162
    v_mul_f32 v53, v53, v162
    v_mul_f32 v54, v54, v162
    v_mul_f32 v55, v55, v162
    v_mul_f32 v56, v56, v162
    v_mul_f32 v57, v57, v162
    v_mul_f32 v58, v58, v162
    v_mul_f32 v59, v59, v162
    v_mul_f32 v60, v60, v162
    v_mul_f32 v61, v61, v162
    v_mul_f32 v62, v62, v162
    v_mul_f32 v63, v63, v162
    s_nop 1
    s_branch K1_RETr2z
.globl oproj_kernel
.p2align 8
.type oproj_kernel,@function
oproj_kernel:
    s_cmp_ge_u32 s2, 256
    s_cbranch_scc1 K2_END
    s_and_b32 s3, s2, 7
    s_lshr_b32 s4, s2, 3
    s_and_b32 s21, s3, 1
    s_lshr_b32 s5, s3, 1
    s_lshl_b32 s5, s5, 1
    s_and_b32 s6, s4, 1
    s_add_u32 s22, s5, s6
    s_bfe_u32 s23, s4, 0x10001
    s_lshr_b32 s24, s4, 2
    s_mul_i32 s5, s21, 40
    s_add_u32 s6, s0, s5
    s_addc_u32 s7, s1, 0
    s_load_dwordx2 s[30:31], s[6:7], 32
    s_load_dwordx2 s[32:33], s[0:1], 80
    s_load_dwordx2 s[34:35], s[0:1], 96
    v_and_b32 v212, 63, v0
    v_lshrrev_b32 v213, 6, v0
    s_nop 0
    v_readfirstlane_b32 s20, v213
    s_waitcnt lgkmcnt(0)
    s_lshl_b32 s3, s21, 3
    s_add_u32 s3, s3, s22
    s_mul_i32 s3, s3, 6
    s_mul_i32 s4, s23, 3
    s_add_u32 s3, s3, s4
    s_lshl_b32 s3, s3, 18
    s_add_u32 s8, s34, s3
    s_addc_u32 s9, s35, 0
    s_mov_b32 s10, 786432
    s_mov_b32 s11, 0x00020000
    s_lshl_b32 s3, s24, 7
    s_add_u32 s12, s30, s3
    s_addc_u32 s13, s31, 0
    s_sub_u32 s14, 4194304, s3
    s_mov_b32 s15, 0x00020000
    s_mul_i32 s3, s22, 192
    s_mul_i32 s4, s23, 96
    s_add_u32 s3, s3, s4
    s_lshl_b32 s3, s3, 11
    s_lshl_b32 s4, s21, 10
    s_add_u32 s3, s3, s4
    s_lshl_b32 s4, s24, 7
    s_add_u32 s3, s3, s4
    s_add_u32 s16, s32, s3
    s_addc_u32 s17, s33, 0
    s_sub_u32 s18, 3145728, s3
    s_mov_b32 s19, 0x00020000
    s_lshl_b32 s25, s20, 14
    s_lshl_b32 s26, s20, 19
    s_lshl_b32 s28, s20, 15
    v_bfe_u32 v213, v212, 4, 1
    v_lshlrev_b32 v213, 1, v213
    v_and_b32 v214, 7, v212
    v_xor_b32 v213, v213, v214
    v_lshlrev_b32 v213, 4, v213
    v_lshrrev_b32 v214, 3, v212
    v_lshl_add_u32 v210, v214, 10, v213
    v_lshlrev_b32 v211, 4, v212
    v_lshrrev_b32 v213, 5, v212
    v_bfe_u32 v214, v212, 2, 2
    v_lshl_add_u32 v213, v213, 2, v214
    v_lshlrev_b32 v213, 7, v213
    v_lshrrev_b32 v214, 1, v214
    v_lshl_add_u32 v213, v214, 5, v213
    v_bfe_u32 v214, v212, 4, 1
    v_lshl_add_u32 v213, v214, 4, v213
    v_and_b32 v214, 1, v212
    v_lshl_add_u32 v213, v214, 6, v213
    v_bfe_u32 v214, v212, 1, 1
    v_lshl_add_u32 v213, v214, 3, v213
    v_add_u32 v208, s25, v213
    v_xor_b32 v209, 32, v208
    s_lshr_b32 s3, s2, 3
    s_and_b32 s3, s3, 3
    s_mul_i32 s3, s3, 0
    s_mul_i32 s4, s24, 0
    s_add_u32 s3, s3, s4
    s_and_b32 s3, s3, 15
    s_lshl_b32 s36, s3, 11
    s_lshl_b32 s37, s3, 15
    s_add_u32 s38, s26, s37
    s_add_u32 s39, s28, s36
    s_add_u32 s36, s36, 2048
    s_and_b32 s36, s36, 32767
    s_add_u32 s37, s37, 32768
    s_and_b32 s37, s37, 524287
    s_add_u32 m0, s25, 0
    s_add_u32 s27, s38, 0
    buffer_load_dwordx4 v210, s[12:15], s27 offen lds
    s_add_u32 m0, s25, 1024
    s_add_u32 s27, s38, 8192
    buffer_load_dwordx4 v210, s[12:15], s27 offen lds
    s_add_u32 m0, s25, 2048
    s_add_u32 s27, s38, 16384
    buffer_load_dwordx4 v210, s[12:15], s27 offen lds
    s_add_u32 m0, s25, 3072
    s_add_u32 s27, s38, 24576
    buffer_load_dwordx4 v210, s[12:15], s27 offen lds
    s_add_u32 s27, s39, 0
    buffer_load_dwordx4 v[96:99], v211, s[8:11], s27 offen offset:0
    buffer_load_dwordx4 v[100:103], v211, s[8:11], s27 offen offset:1024
    s_add_u32 s27, s39, 262144
    buffer_load_dwordx4 v[104:107], v211, s[8:11], s27 offen offset:0
    buffer_load_dwordx4 v[108:111], v211, s[8:11], s27 offen offset:1024
    s_add_u32 s27, s39, 524288
    buffer_load_dwordx4 v[112:115], v211, s[8:11], s27 offen offset:0
    buffer_load_dwordx4 v[116:119], v211, s[8:11], s27 offen offset:1024
    s_add_u32 s38, s26, s37
    s_add_u32 s39, s28, s36
    s_add_u32 s36, s36, 2048
    s_and_b32 s36, s36, 32767
    s_add_u32 s37, s37, 32768
    s_and_b32 s37, s37, 524287
    s_add_u32 m0, s25, 4096
    s_add_u32 s27, s38, 0
    buffer_load_dwordx4 v210, s[12:15], s27 offen lds
    s_add_u32 m0, s25, 5120
    s_add_u32 s27, s38, 8192
    buffer_load_dwordx4 v210, s[12:15], s27 offen lds
    s_add_u32 m0, s25, 6144
    s_add_u32 s27, s38, 16384
    buffer_load_dwordx4 v210, s[12:15], s27 offen lds
    s_add_u32 m0, s25, 7168
    s_add_u32 s27, s38, 24576
    buffer_load_dwordx4 v210, s[12:15], s27 offen lds
    s_add_u32 s27, s39, 0
    buffer_load_dwordx4 v[120:123], v211, s[8:11], s27 offen offset:0
    buffer_load_dwordx4 v[124:127], v211, s[8:11], s27 offen offset:1024
    s_add_u32 s27, s39, 262144
    buffer_load_dwordx4 v[128:131], v211, s[8:11], s27 offen offset:0
    buffer_load_dwordx4 v[132:135], v211, s[8:11], s27 offen offset:1024
    s_add_u32 s27, s39, 524288
    buffer_load_dwordx4 v[136:139], v211, s[8:11], s27 offen offset:0
    buffer_load_dwordx4 v[140:143], v211, s[8:11], s27 offen offset:1024
    s_add_u32 s38, s26, s37
    s_add_u32 s39, s28, s36
    s_add_u32 s36, s36, 2048
    s_and_b32 s36, s36, 32767
    s_add_u32 s37, s37, 32768
    s_and_b32 s37, s37, 524287
    s_add_u32 m0, s25, 8192
    s_add_u32 s27, s38, 0
    buffer_load_dwordx4 v210, s[12:15], s27 offen lds
    s_add_u32 m0, s25, 9216
    s_add_u32 s27, s38, 8192
    buffer_load_dwordx4 v210, s[12:15], s27 offen lds
    s_add_u32 m0, s25, 10240
    s_add_u32 s27, s38, 16384
    buffer_load_dwordx4 v210, s[12:15], s27 offen lds
    s_add_u32 m0, s25, 11264
    s_add_u32 s27, s38, 24576
    buffer_load_dwordx4 v210, s[12:15], s27 offen lds
    s_add_u32 s27, s39, 0
    buffer_load_dwordx4 v[144:147], v211, s[8:11], s27 offen offset:0
    buffer_load_dwordx4 v[148:151], v211, s[8:11], s27 offen offset:1024
    s_add_u32 s27, s39, 262144
    buffer_load_dwordx4 v[152:155], v211, s[8:11], s27 offen offset:0
    buffer_load_dwordx4 v[156:159], v211, s[8:11], s27 offen offset:1024
    s_add_u32 s27, s39, 524288
    buffer_load_dwordx4 v[160:163], v211, s[8:11], s27 offen offset:0
    buffer_load_dwordx4 v[164:167], v211, s[8:11], s27 offen offset:1024
    s_add_u32 s38, s26, s37
    s_add_u32 s39, s28, s36
    s_add_u32 s36, s36, 2048
    s_and_b32 s36, s36, 32767
    s_add_u32 s37, s37, 32768
    s_and_b32 s37, s37, 524287
    s_add_u32 m0, s25, 12288
    s_add_u32 s27, s38, 0
    buffer_load_dwordx4 v210, s[12:15], s27 offen lds
    s_add_u32 m0, s25, 13312
    s_add_u32 s27, s38, 8192
    buffer_load_dwordx4 v210, s[12:15], s27 offen lds
    s_add_u32 m0, s25, 14336
    s_add_u32 s27, s38, 16384
    buffer_load_dwordx4 v210, s[12:15], s27 offen lds
    s_add_u32 m0, s25, 15360
    s_add_u32 s27, s38, 24576
    buffer_load_dwordx4 v210, s[12:15], s27 offen lds
    s_add_u32 s27, s39, 0
    buffer_load_dwordx4 v[168:171], v211, s[8:11], s27 offen offset:0
    buffer_load_dwordx4 v[172:175], v211, s[8:11], s27 offen offset:1024
    s_add_u32 s27, s39, 262144
    buffer_load_dwordx4 v[176:179], v211, s[8:11], s27 offen offset:0
    buffer_load_dwordx4 v[180:183], v211, s[8:11], s27 offen offset:1024
    s_add_u32 s27, s39, 524288
    buffer_load_dwordx4 v[184:187], v211, s[8:11], s27 offen offset:0
    buffer_load_dwordx4 v[188:191], v211, s[8:11], s27 offen offset:1024
    s_waitcnt vmcnt(30)
    ds_read_b64_tr_b16 v[192:193], v208 offset:0
    ds_read_b64_tr_b16 v[194:195], v208 offset:1024
    ds_read_b64_tr_b16 v[200:201], v209 offset:0
    ds_read_b64_tr_b16 v[202:203], v209 offset:1024
    ds_read_b64_tr_b16 v[196:197], v208 offset:2048
    ds_read_b64_tr_b16 v[198:199], v208 offset:3072
    ds_read_b64_tr_b16 v[204:205], v209 offset:2048
    ds_read_b64_tr_b16 v[206:207], v209 offset:3072
    s_waitcnt lgkmcnt(4)
    v_mfma_f32_32x32x16_bf16 v[0:15], v[192:195], v[96:99], 0
    v_mfma_f32_32x32x16_bf16 v[16:31], v[200:203], v[96:99], 0
    v_mfma_f32_32x32x16_bf16 v[32:47], v[192:195], v[104:107], 0
    v_mfma_f32_32x32x16_bf16 v[48:63], v[200:203], v[104:107], 0
    v_mfma_f32_32x32x16_bf16 v[64:79], v[192:195], v[112:115], 0
    v_mfma_f32_32x32x16_bf16 v[80:95], v[200:203], v[112:115], 0
    s_waitcnt lgkmcnt(0)
    v_mfma_f32_32x32x16_bf16 v[0:15], v[196:199], v[100:103], v[0:15]
    v_mfma_f32_32x32x16_bf16 v[16:31], v[204:207], v[100:103], v[16:31]
    v_mfma_f32_32x32x16_bf16 v[32:47], v[196:199], v[108:111], v[32:47]
    v_mfma_f32_32x32x16_bf16 v[48:63], v[204:207], v[108:111], v[48:63]
    v_mfma_f32_32x32x16_bf16 v[64:79], v[196:199], v[116:119], v[64:79]
    v_mfma_f32_32x32x16_bf16 v[80:95], v[204:207], v[116:119], v[80:95]
    s_add_u32 s38, s26, s37
    s_add_u32 s39, s28, s36
    s_add_u32 s36, s36, 2048
    s_and_b32 s36, s36, 32767
    s_add_u32 s37, s37, 32768
    s_and_b32 s37, s37, 524287
    s_add_u32 m0, s25, 0
    s_add_u32 s27, s38, 0
    buffer_load_dwordx4 v210, s[12:15], s27 offen lds
    s_add_u32 m0, s25, 1024
    s_add_u32 s27, s38, 8192
    buffer_load_dwordx4 v210, s[12:15], s27 offen lds
    s_add_u32 m0, s25, 2048
    s_add_u32 s27, s38, 16384
    buffer_load_dwordx4 v210, s[12:15], s27 offen lds
    s_add_u32 m0, s25, 3072
    s_add_u32 s27, s38, 24576
    buffer_load_dwordx4 v210, s[12:15], s27 offen lds
    s_add_u32 s27, s39, 0
    buffer_load_dwordx4 v[96:99], v211, s[8:11], s27 offen offset:0
    buffer_load_dwordx4 v[100:103], v211, s[8:11], s27 offen offset:1024
    s_add_u32 s27, s39, 262144
    buffer_load_dwordx4 v[104:107], v211, s[8:11], s27 offen offset:0
    buffer_load_dwordx4 v[108:111], v211, s[8:11], s27 offen offset:1024
    s_add_u32 s27, s39, 524288
    buffer_load_dwordx4 v[112:115], v211, s[8:11], s27 offen offset:0
    buffer_load_dwordx4 v[116:119], v211, s[8:11], s27 offen offset:1024
    s_waitcnt vmcnt(30)
    ds_read_b64_tr_b16 v[192:193], v208 offset:4096
    ds_read_b64_tr_b16 v[194:195], v208 offset:5120
    ds_read_b64_tr_b16 v[200:201], v209 offset:4096
    ds_read_b64_tr_b16 v[202:203], v209 offset:5120
    ds_read_b64_tr_b16 v[196:197], v208 offset:6144
    ds_read_b64_tr_b16 v[198:199], v208 offset:7168
    ds_read_b64_tr_b16 v[204:205], v209 offset:6144
    ds_read_b64_tr_b16 v[206:207], v209 offset:7168
    s_waitcnt lgkmcnt(4)
    v_mfma_f32_32x32x16_bf16 v[0:15], v[192:195], v[120:123], v[0:15]
    v_mfma_f32_32x32x16_bf16 v[16:31], v[200:203], v[120:123], v[16:31]
    v_mfma_f32_32x32x16_bf16 v[32:47], v[192:195], v[128:131], v[32:47]
    v_mfma_f32_32x32x16_bf16 v[48:63], v[200:203], v[128:131], v[48:63]
    v_mfma_f32_32x32x16_bf16 v[64:79], v[192:195], v[136:139], v[64:79]
    v_mfma_f32_32x32x16_bf16 v[80:95], v[200:203], v[136:139], v[80:95]
    s_waitcnt lgkmcnt(0)
    v_mfma_f32_32x32x16_bf16 v[0:15], v[196:199], v[124:127], v[0:15]
    v_mfma_f32_32x32x16_bf16 v[16:31], v[204:207], v[124:127], v[16:31]
    v_mfma_f32_32x32x16_bf16 v[32:47], v[196:199], v[132:135], v[32:47]
    v_mfma_f32_32x32x16_bf16 v[48:63], v[204:207], v[132:135], v[48:63]
    v_mfma_f32_32x32x16_bf16 v[64:79], v[196:199], v[140:143], v[64:79]
    v_mfma_f32_32x32x16_bf16 v[80:95], v[204:207], v[140:143], v[80:95]
    s_add_u32 s38, s26, s37
    s_add_u32 s39, s28, s36
    s_add_u32 s36, s36, 2048
    s_and_b32 s36, s36, 32767
    s_add_u32 s37, s37, 32768
    s_and_b32 s37, s37, 524287
    s_add_u32 m0, s25, 4096
    s_add_u32 s27, s38, 0
    buffer_load_dwordx4 v210, s[12:15], s27 offen lds
    s_add_u32 m0, s25, 5120
    s_add_u32 s27, s38, 8192
    buffer_load_dwordx4 v210, s[12:15], s27 offen lds
    s_add_u32 m0, s25, 6144
    s_add_u32 s27, s38, 16384
    buffer_load_dwordx4 v210, s[12:15], s27 offen lds
    s_add_u32 m0, s25, 7168
    s_add_u32 s27, s38, 24576
    buffer_load_dwordx4 v210, s[12:15], s27 offen lds
    s_add_u32 s27, s39, 0
    buffer_load_dwordx4 v[120:123], v211, s[8:11], s27 offen offset:0
    buffer_load_dwordx4 v[124:127], v211, s[8:11], s27 offen offset:1024
    s_add_u32 s27, s39, 262144
    buffer_load_dwordx4 v[128:131], v211, s[8:11], s27 offen offset:0
    buffer_load_dwordx4 v[132:135], v211, s[8:11], s27 offen offset:1024
    s_add_u32 s27, s39, 524288
    buffer_load_dwordx4 v[136:139], v211, s[8:11], s27 offen offset:0
    buffer_load_dwordx4 v[140:143], v211, s[8:11], s27 offen offset:1024
    s_waitcnt vmcnt(30)
    ds_read_b64_tr_b16 v[192:193], v208 offset:8192
    ds_read_b64_tr_b16 v[194:195], v208 offset:9216
    ds_read_b64_tr_b16 v[200:201], v209 offset:8192
    ds_read_b64_tr_b16 v[202:203], v209 offset:9216
    ds_read_b64_tr_b16 v[196:197], v208 offset:10240
    ds_read_b64_tr_b16 v[198:199], v208 offset:11264
    ds_read_b64_tr_b16 v[204:205], v209 offset:10240
    ds_read_b64_tr_b16 v[206:207], v209 offset:11264
    s_waitcnt lgkmcnt(4)
    v_mfma_f32_32x32x16_bf16 v[0:15], v[192:195], v[144:147], v[0:15]
    v_mfma_f32_32x32x16_bf16 v[16:31], v[200:203], v[144:147], v[16:31]
    v_mfma_f32_32x32x16_bf16 v[32:47], v[192:195], v[152:155], v[32:47]
    v_mfma_f32_32x32x16_bf16 v[48:63], v[200:203], v[152:155], v[48:63]
    v_mfma_f32_32x32x16_bf16 v[64:79], v[192:195], v[160:163], v[64:79]
    v_mfma_f32_32x32x16_bf16 v[80:95], v[200:203], v[160:163], v[80:95]
    s_waitcnt lgkmcnt(0)
    v_mfma_f32_32x32x16_bf16 v[0:15], v[196:199], v[148:151], v[0:15]
    v_mfma_f32_32x32x16_bf16 v[16:31], v[204:207], v[148:151], v[16:31]
    v_mfma_f32_32x32x16_bf16 v[32:47], v[196:199], v[156:159], v[32:47]
    v_mfma_f32_32x32x16_bf16 v[48:63], v[204:207], v[156:159], v[48:63]
    v_mfma_f32_32x32x16_bf16 v[64:79], v[196:199], v[164:167], v[64:79]
    v_mfma_f32_32x32x16_bf16 v[80:95], v[204:207], v[164:167], v[80:95]
    s_add_u32 s38, s26, s37
    s_add_u32 s39, s28, s36
    s_add_u32 s36, s36, 2048
    s_and_b32 s36, s36, 32767
    s_add_u32 s37, s37, 32768
    s_and_b32 s37, s37, 524287
    s_add_u32 m0, s25, 8192
    s_add_u32 s27, s38, 0
    buffer_load_dwordx4 v210, s[12:15], s27 offen lds
    s_add_u32 m0, s25, 9216
    s_add_u32 s27, s38, 8192
    buffer_load_dwordx4 v210, s[12:15], s27 offen lds
    s_add_u32 m0, s25, 10240
    s_add_u32 s27, s38, 16384
    buffer_load_dwordx4 v210, s[12:15], s27 offen lds
    s_add_u32 m0, s25, 11264
    s_add_u32 s27, s38, 24576
    buffer_load_dwordx4 v210, s[12:15], s27 offen lds
    s_add_u32 s27, s39, 0
    buffer_load_dwordx4 v[144:147], v211, s[8:11], s27 offen offset:0
    buffer_load_dwordx4 v[148:151], v211, s[8:11], s27 offen offset:1024
    s_add_u32 s27, s39, 262144
    buffer_load_dwordx4 v[152:155], v211, s[8:11], s27 offen offset:0
    buffer_load_dwordx4 v[156:159], v211, s[8:11], s27 offen offset:1024
    s_add_u32 s27, s39, 524288
    buffer_load_dwordx4 v[160:163], v211, s[8:11], s27 offen offset:0
    buffer_load_dwordx4 v[164:167], v211, s[8:11], s27 offen offset:1024
    s_waitcnt vmcnt(30)
    ds_read_b64_tr_b16 v[192:193], v208 offset:12288
    ds_read_b64_tr_b16 v[194:195], v208 offset:13312
    ds_read_b64_tr_b16 v[200:201], v209 offset:12288
    ds_read_b64_tr_b16 v[202:203], v209 offset:13312
    ds_read_b64_tr_b16 v[196:197], v208 offset:14336
    ds_read_b64_tr_b16 v[198:199], v208 offset:15360
    ds_read_b64_tr_b16 v[204:205], v209 offset:14336
    ds_read_b64_tr_b16 v[206:207], v209 offset:15360
    s_waitcnt lgkmcnt(4)
    v_mfma_f32_32x32x16_bf16 v[0:15], v[192:195], v[168:171], v[0:15]
    v_mfma_f32_32x32x16_bf16 v[16:31], v[200:203], v[168:171], v[16:31]
    v_mfma_f32_32x32x16_bf16 v[32:47], v[192:195], v[176:179], v[32:47]
    v_mfma_f32_32x32x16_bf16 v[48:63], v[200:203], v[176:179], v[48:63]
    v_mfma_f32_32x32x16_bf16 v[64:79], v[192:195], v[184:187], v[64:79]
    v_mfma_f32_32x32x16_bf16 v[80:95], v[200:203], v[184:187], v[80:95]
    s_waitcnt lgkmcnt(0)
    v_mfma_f32_32x32x16_bf16 v[0:15], v[196:199], v[172:175], v[0:15]
    v_mfma_f32_32x32x16_bf16 v[16:31], v[204:207], v[172:175], v[16:31]
    v_mfma_f32_32x32x16_bf16 v[32:47], v[196:199], v[180:183], v[32:47]
    v_mfma_f32_32x32x16_bf16 v[48:63], v[204:207], v[180:183], v[48:63]
    v_mfma_f32_32x32x16_bf16 v[64:79], v[196:199], v[188:191], v[64:79]
    v_mfma_f32_32x32x16_bf16 v[80:95], v[204:207], v[188:191], v[80:95]
    s_add_u32 s38, s26, s37
    s_add_u32 s39, s28, s36
    s_add_u32 s36, s36, 2048
    s_and_b32 s36, s36, 32767
    s_add_u32 s37, s37, 32768
    s_and_b32 s37, s37, 524287
    s_add_u32 m0, s25, 12288
    s_add_u32 s27, s38, 0
    buffer_load_dwordx4 v210, s[12:15], s27 offen lds
    s_add_u32 m0, s25, 13312
    s_add_u32 s27, s38, 8192
    buffer_load_dwordx4 v210, s[12:15], s27 offen lds
    s_add_u32 m0, s25, 14336
    s_add_u32 s27, s38, 16384
    buffer_load_dwordx4 v210, s[12:15], s27 offen lds
    s_add_u32 m0, s25, 15360
    s_add_u32 s27, s38, 24576
    buffer_load_dwordx4 v210, s[12:15], s27 offen lds
    s_add_u32 s27, s39, 0
    buffer_load_dwordx4 v[168:171], v211, s[8:11], s27 offen offset:0
    buffer_load_dwordx4 v[172:175], v211, s[8:11], s27 offen offset:1024
    s_add_u32 s27, s39, 262144
    buffer_load_dwordx4 v[176:179], v211, s[8:11], s27 offen offset:0
    buffer_load_dwordx4 v[180:183], v211, s[8:11], s27 offen offset:1024
    s_add_u32 s27, s39, 524288
    buffer_load_dwordx4 v[184:187], v211, s[8:11], s27 offen offset:0
    buffer_load_dwordx4 v[188:191], v211, s[8:11], s27 offen offset:1024
    s_waitcnt vmcnt(30)
    ds_read_b64_tr_b16 v[192:193], v208 offset:0
    ds_read_b64_tr_b16 v[194:195], v208 offset:1024
    ds_read_b64_tr_b16 v[200:201], v209 offset:0
    ds_read_b64_tr_b16 v[202:203], v209 offset:1024
    ds_read_b64_tr_b16 v[196:197], v208 offset:2048
    ds_read_b64_tr_b16 v[198:199], v208 offset:3072
    ds_read_b64_tr_b16 v[204:205], v209 offset:2048
    ds_read_b64_tr_b16 v[206:207], v209 offset:3072
    s_waitcnt lgkmcnt(4)
    v_mfma_f32_32x32x16_bf16 v[0:15], v[192:195], v[96:99], v[0:15]
    v_mfma_f32_32x32x16_bf16 v[16:31], v[200:203], v[96:99], v[16:31]
    v_mfma_f32_32x32x16_bf16 v[32:47], v[192:195], v[104:107], v[32:47]
    v_mfma_f32_32x32x16_bf16 v[48:63], v[200:203], v[104:107], v[48:63]
    v_mfma_f32_32x32x16_bf16 v[64:79], v[192:195], v[112:115], v[64:79]
    v_mfma_f32_32x32x16_bf16 v[80:95], v[200:203], v[112:115], v[80:95]
    s_waitcnt lgkmcnt(0)
    v_mfma_f32_32x32x16_bf16 v[0:15], v[196:199], v[100:103], v[0:15]
    v_mfma_f32_32x32x16_bf16 v[16:31], v[204:207], v[100:103], v[16:31]
    v_mfma_f32_32x32x16_bf16 v[32:47], v[196:199], v[108:111], v[32:47]
    v_mfma_f32_32x32x16_bf16 v[48:63], v[204:207], v[108:111], v[48:63]
    v_mfma_f32_32x32x16_bf16 v[64:79], v[196:199], v[116:119], v[64:79]
    v_mfma_f32_32x32x16_bf16 v[80:95], v[204:207], v[116:119], v[80:95]
    s_add_u32 s38, s26, s37
    s_add_u32 s39, s28, s36
    s_add_u32 s36, s36, 2048
    s_and_b32 s36, s36, 32767
    s_add_u32 s37, s37, 32768
    s_and_b32 s37, s37, 524287
    s_add_u32 m0, s25, 0
    s_add_u32 s27, s38, 0
    buffer_load_dwordx4 v210, s[12:15], s27 offen lds
    s_add_u32 m0, s25, 1024
    s_add_u32 s27, s38, 8192
    buffer_load_dwordx4 v210, s[12:15], s27 offen lds
    s_add_u32 m0, s25, 2048
    s_add_u32 s27, s38, 16384
    buffer_load_dwordx4 v210, s[12:15], s27 offen lds
    s_add_u32 m0, s25, 3072
    s_add_u32 s27, s38, 24576
    buffer_load_dwordx4 v210, s[12:15], s27 offen lds
    s_add_u32 s27, s39, 0
    buffer_load_dwordx4 v[96:99], v211, s[8:11], s27 offen offset:0
    buffer_load_dwordx4 v[100:103], v211, s[8:11], s27 offen offset:1024
    s_add_u32 s27, s39, 262144
    buffer_load_dwordx4 v[104:107], v211, s[8:11], s27 offen offset:0
    buffer_load_dwordx4 v[108:111], v211, s[8:11], s27 offen offset:1024
    s_add_u32 s27, s39, 524288
    buffer_load_dwordx4 v[112:115], v211, s[8:11], s27 offen offset:0
    buffer_load_dwordx4 v[116:119], v211, s[8:11], s27 offen offset:1024
    s_waitcnt vmcnt(30)
    ds_read_b64_tr_b16 v[192:193], v208 offset:4096
    ds_read_b64_tr_b16 v[194:195], v208 offset:5120
    ds_read_b64_tr_b16 v[200:201], v209 offset:4096
    ds_read_b64_tr_b16 v[202:203], v209 offset:5120
    ds_read_b64_tr_b16 v[196:197], v208 offset:6144
    ds_read_b64_tr_b16 v[198:199], v208 offset:7168
    ds_read_b64_tr_b16 v[204:205], v209 offset:6144
    ds_read_b64_tr_b16 v[206:207], v209 offset:7168
    s_waitcnt lgkmcnt(4)
    v_mfma_f32_32x32x16_bf16 v[0:15], v[192:195], v[120:123], v[0:15]
    v_mfma_f32_32x32x16_bf16 v[16:31], v[200:203], v[120:123], v[16:31]
    v_mfma_f32_32x32x16_bf16 v[32:47], v[192:195], v[128:131], v[32:47]
    v_mfma_f32_32x32x16_bf16 v[48:63], v[200:203], v[128:131], v[48:63]
    v_mfma_f32_32x32x16_bf16 v[64:79], v[192:195], v[136:139], v[64:79]
    v_mfma_f32_32x32x16_bf16 v[80:95], v[200:203], v[136:139], v[80:95]
    s_waitcnt lgkmcnt(0)
    v_mfma_f32_32x32x16_bf16 v[0:15], v[196:199], v[124:127], v[0:15]
    v_mfma_f32_32x32x16_bf16 v[16:31], v[204:207], v[124:127], v[16:31]
    v_mfma_f32_32x32x16_bf16 v[32:47], v[196:199], v[132:135], v[32:47]
    v_mfma_f32_32x32x16_bf16 v[48:63], v[204:207], v[132:135], v[48:63]
    v_mfma_f32_32x32x16_bf16 v[64:79], v[196:199], v[140:143], v[64:79]
    v_mfma_f32_32x32x16_bf16 v[80:95], v[204:207], v[140:143], v[80:95]
    s_add_u32 s38, s26, s37
    s_add_u32 s39, s28, s36
    s_add_u32 s36, s36, 2048
    s_and_b32 s36, s36, 32767
    s_add_u32 s37, s37, 32768
    s_and_b32 s37, s37, 524287
    s_add_u32 m0, s25, 4096
    s_add_u32 s27, s38, 0
    buffer_load_dwordx4 v210, s[12:15], s27 offen lds
    s_add_u32 m0, s25, 5120
    s_add_u32 s27, s38, 8192
    buffer_load_dwordx4 v210, s[12:15], s27 offen lds
    s_add_u32 m0, s25, 6144
    s_add_u32 s27, s38, 16384
    buffer_load_dwordx4 v210, s[12:15], s27 offen lds
    s_add_u32 m0, s25, 7168
    s_add_u32 s27, s38, 24576
    buffer_load_dwordx4 v210, s[12:15], s27 offen lds
    s_add_u32 s27, s39, 0
    buffer_load_dwordx4 v[120:123], v211, s[8:11], s27 offen offset:0
    buffer_load_dwordx4 v[124:127], v211, s[8:11], s27 offen offset:1024
    s_add_u32 s27, s39, 262144
    buffer_load_dwordx4 v[128:131], v211, s[8:11], s27 offen offset:0
    buffer_load_dwordx4 v[132:135], v211, s[8:11], s27 offen offset:1024
    s_add_u32 s27, s39, 524288
    buffer_load_dwordx4 v[136:139], v211, s[8:11], s27 offen offset:0
    buffer_load_dwordx4 v[140:143], v211, s[8:11], s27 offen offset:1024
    s_waitcnt vmcnt(30)
    ds_read_b64_tr_b16 v[192:193], v208 offset:8192
    ds_read_b64_tr_b16 v[194:195], v208 offset:9216
    ds_read_b64_tr_b16 v[200:201], v209 offset:8192
    ds_read_b64_tr_b16 v[202:203], v209 offset:9216
    ds_read_b64_tr_b16 v[196:197], v208 offset:10240
    ds_read_b64_tr_b16 v[198:199], v208 offset:11264
    ds_read_b64_tr_b16 v[204:205], v209 offset:10240
    ds_read_b64_tr_b16 v[206:207], v209 offset:11264
    s_waitcnt lgkmcnt(4)
    v_mfma_f32_32x32x16_bf16 v[0:15], v[192:195], v[144:147], v[0:15]
    v_mfma_f32_32x32x16_bf16 v[16:31], v[200:203], v[144:147], v[16:31]
    v_mfma_f32_32x32x16_bf16 v[32:47], v[192:195], v[152:155], v[32:47]
    v_mfma_f32_32x32x16_bf16 v[48:63], v[200:203], v[152:155], v[48:63]
    v_mfma_f32_32x32x16_bf16 v[64:79], v[192:195], v[160:163], v[64:79]
    v_mfma_f32_32x32x16_bf16 v[80:95], v[200:203], v[160:163], v[80:95]
    s_waitcnt lgkmcnt(0)
    v_mfma_f32_32x32x16_bf16 v[0:15], v[196:199], v[148:151], v[0:15]
    v_mfma_f32_32x32x16_bf16 v[16:31], v[204:207], v[148:151], v[16:31]
    v_mfma_f32_32x32x16_bf16 v[32:47], v[196:199], v[156:159], v[32:47]
    v_mfma_f32_32x32x16_bf16 v[48:63], v[204:207], v[156:159], v[48:63]
    v_mfma_f32_32x32x16_bf16 v[64:79], v[196:199], v[164:167], v[64:79]
    v_mfma_f32_32x32x16_bf16 v[80:95], v[204:207], v[164:167], v[80:95]
    s_add_u32 s38, s26, s37
    s_add_u32 s39, s28, s36
    s_add_u32 s36, s36, 2048
    s_and_b32 s36, s36, 32767
    s_add_u32 s37, s37, 32768
    s_and_b32 s37, s37, 524287
    s_add_u32 m0, s25, 8192
    s_add_u32 s27, s38, 0
    buffer_load_dwordx4 v210, s[12:15], s27 offen lds
    s_add_u32 m0, s25, 9216
    s_add_u32 s27, s38, 8192
    buffer_load_dwordx4 v210, s[12:15], s27 offen lds
    s_add_u32 m0, s25, 10240
    s_add_u32 s27, s38, 16384
    buffer_load_dwordx4 v210, s[12:15], s27 offen lds
    s_add_u32 m0, s25, 11264
    s_add_u32 s27, s38, 24576
    buffer_load_dwordx4 v210, s[12:15], s27 offen lds
    s_add_u32 s27, s39, 0
    buffer_load_dwordx4 v[144:147], v211, s[8:11], s27 offen offset:0
    buffer_load_dwordx4 v[148:151], v211, s[8:11], s27 offen offset:1024
    s_add_u32 s27, s39, 262144
    buffer_load_dwordx4 v[152:155], v211, s[8:11], s27 offen offset:0
    buffer_load_dwordx4 v[156:159], v211, s[8:11], s27 offen offset:1024
    s_add_u32 s27, s39, 524288
    buffer_load_dwordx4 v[160:163], v211, s[8:11], s27 offen offset:0
    buffer_load_dwordx4 v[164:167], v211, s[8:11], s27 offen offset:1024
    s_waitcnt vmcnt(30)
    ds_read_b64_tr_b16 v[192:193], v208 offset:12288
    ds_read_b64_tr_b16 v[194:195], v208 offset:13312
    ds_read_b64_tr_b16 v[200:201], v209 offset:12288
    ds_read_b64_tr_b16 v[202:203], v209 offset:13312
    ds_read_b64_tr_b16 v[196:197], v208 offset:14336
    ds_read_b64_tr_b16 v[198:199], v208 offset:15360
    ds_read_b64_tr_b16 v[204:205], v209 offset:14336
    ds_read_b64_tr_b16 v[206:207], v209 offset:15360
    s_waitcnt lgkmcnt(4)
    v_mfma_f32_32x32x16_bf16 v[0:15], v[192:195], v[168:171], v[0:15]
    v_mfma_f32_32x32x16_bf16 v[16:31], v[200:203], v[168:171], v[16:31]
    v_mfma_f32_32x32x16_bf16 v[32:47], v[192:195], v[176:179], v[32:47]
    v_mfma_f32_32x32x16_bf16 v[48:63], v[200:203], v[176:179], v[48:63]
    v_mfma_f32_32x32x16_bf16 v[64:79], v[192:195], v[184:187], v[64:79]
    v_mfma_f32_32x32x16_bf16 v[80:95], v[200:203], v[184:187], v[80:95]
    s_waitcnt lgkmcnt(0)
    v_mfma_f32_32x32x16_bf16 v[0:15], v[196:199], v[172:175], v[0:15]
    v_mfma_f32_32x32x16_bf16 v[16:31], v[204:207], v[172:175], v[16:31]
    v_mfma_f32_32x32x16_bf16 v[32:47], v[196:199], v[180:183], v[32:47]
    v_mfma_f32_32x32x16_bf16 v[48:63], v[204:207], v[180:183], v[48:63]
    v_mfma_f32_32x32x16_bf16 v[64:79], v[196:199], v[188:191], v[64:79]
    v_mfma_f32_32x32x16_bf16 v[80:95], v[204:207], v[188:191], v[80:95]
    s_add_u32 s38, s26, s37
    s_add_u32 s39, s28, s36
    s_add_u32 s36, s36, 2048
    s_and_b32 s36, s36, 32767
    s_add_u32 s37, s37, 32768
    s_and_b32 s37, s37, 524287
    s_add_u32 m0, s25, 12288
    s_add_u32 s27, s38, 0
    buffer_load_dwordx4 v210, s[12:15], s27 offen lds
    s_add_u32 m0, s25, 13312
    s_add_u32 s27, s38, 8192
    buffer_load_dwordx4 v210, s[12:15], s27 offen lds
    s_add_u32 m0, s25, 14336
    s_add_u32 s27, s38, 16384
    buffer_load_dwordx4 v210, s[12:15], s27 offen lds
    s_add_u32 m0, s25, 15360
    s_add_u32 s27, s38, 24576
    buffer_load_dwordx4 v210, s[12:15], s27 offen lds
    s_add_u32 s27, s39, 0
    buffer_load_dwordx4 v[168:171], v211, s[8:11], s27 offen offset:0
    buffer_load_dwordx4 v[172:175], v211, s[8:11], s27 offen offset:1024
    s_add_u32 s27, s39, 262144
    buffer_load_dwordx4 v[176:179], v211, s[8:11], s27 offen offset:0
    buffer_load_dwordx4 v[180:183], v211, s[8:11], s27 offen offset:1024
    s_add_u32 s27, s39, 524288
    buffer_load_dwordx4 v[184:187], v211, s[8:11], s27 offen offset:0
    buffer_load_dwordx4 v[188:191], v211, s[8:11], s27 offen offset:1024
    s_waitcnt vmcnt(30)
    ds_read_b64_tr_b16 v[192:193], v208 offset:0
    ds_read_b64_tr_b16 v[194:195], v208 offset:1024
    ds_read_b64_tr_b16 v[200:201], v209 offset:0
    ds_read_b64_tr_b16 v[202:203], v209 offset:1024
    ds_read_b64_tr_b16 v[196:197], v208 offset:2048
    ds_read_b64_tr_b16 v[198:199], v208 offset:3072
    ds_read_b64_tr_b16 v[204:205], v209 offset:2048
    ds_read_b64_tr_b16 v[206:207], v209 offset:3072
    s_waitcnt lgkmcnt(4)
    v_mfma_f32_32x32x16_bf16 v[0:15], v[192:195], v[96:99], v[0:15]
    v_mfma_f32_32x32x16_bf16 v[16:31], v[200:203], v[96:99], v[16:31]
    v_mfma_f32_32x32x16_bf16 v[32:47], v[192:195], v[104:107], v[32:47]
    v_mfma_f32_32x32x16_bf16 v[48:63], v[200:203], v[104:107], v[48:63]
    v_mfma_f32_32x32x16_bf16 v[64:79], v[192:195], v[112:115], v[64:79]
    v_mfma_f32_32x32x16_bf16 v[80:95], v[200:203], v[112:115], v[80:95]
    s_waitcnt lgkmcnt(0)
    v_mfma_f32_32x32x16_bf16 v[0:15], v[196:199], v[100:103], v[0:15]
    v_mfma_f32_32x32x16_bf16 v[16:31], v[204:207], v[100:103], v[16:31]
    v_mfma_f32_32x32x16_bf16 v[32:47], v[196:199], v[108:111], v[32:47]
    v_mfma_f32_32x32x16_bf16 v[48:63], v[204:207], v[108:111], v[48:63]
    v_mfma_f32_32x32x16_bf16 v[64:79], v[196:199], v[116:119], v[64:79]
    v_mfma_f32_32x32x16_bf16 v[80:95], v[204:207], v[116:119], v[80:95]
    s_add_u32 s38, s26, s37
    s_add_u32 s39, s28, s36
    s_add_u32 s36, s36, 2048
    s_and_b32 s36, s36, 32767
    s_add_u32 s37, s37, 32768
    s_and_b32 s37, s37, 524287
    s_add_u32 m0, s25, 0
    s_add_u32 s27, s38, 0
    buffer_load_dwordx4 v210, s[12:15], s27 offen lds
    s_add_u32 m0, s25, 1024
    s_add_u32 s27, s38, 8192
    buffer_load_dwordx4 v210, s[12:15], s27 offen lds
    s_add_u32 m0, s25, 2048
    s_add_u32 s27, s38, 16384
    buffer_load_dwordx4 v210, s[12:15], s27 offen lds
    s_add_u32 m0, s25, 3072
    s_add_u32 s27, s38, 24576
    buffer_load_dwordx4 v210, s[12:15], s27 offen lds
    s_add_u32 s27, s39, 0
    buffer_load_dwordx4 v[96:99], v211, s[8:11], s27 offen offset:0
    buffer_load_dwordx4 v[100:103], v211, s[8:11], s27 offen offset:1024
    s_add_u32 s27, s39, 262144
    buffer_load_dwordx4 v[104:107], v211, s[8:11], s27 offen offset:0
    buffer_load_dwordx4 v[108:111], v211, s[8:11], s27 offen offset:1024
    s_add_u32 s27, s39, 524288
    buffer_load_dwordx4 v[112:115], v211, s[8:11], s27 offen offset:0
    buffer_load_dwordx4 v[116:119], v211, s[8:11], s27 offen offset:1024
    s_waitcnt vmcnt(30)
    ds_read_b64_tr_b16 v[192:193], v208 offset:4096
    ds_read_b64_tr_b16 v[194:195], v208 offset:5120
    ds_read_b64_tr_b16 v[200:201], v209 offset:4096
    ds_read_b64_tr_b16 v[202:203], v209 offset:5120
    ds_read_b64_tr_b16 v[196:197], v208 offset:6144
    ds_read_b64_tr_b16 v[198:199], v208 offset:7168
    ds_read_b64_tr_b16 v[204:205], v209 offset:6144
    ds_read_b64_tr_b16 v[206:207], v209 offset:7168
    s_waitcnt lgkmcnt(4)
    v_mfma_f32_32x32x16_bf16 v[0:15], v[192:195], v[120:123], v[0:15]
    v_mfma_f32_32x32x16_bf16 v[16:31], v[200:203], v[120:123], v[16:31]
    v_mfma_f32_32x32x16_bf16 v[32:47], v[192:195], v[128:131], v[32:47]
    v_mfma_f32_32x32x16_bf16 v[48:63], v[200:203], v[128:131], v[48:63]
    v_mfma_f32_32x32x16_bf16 v[64:79], v[192:195], v[136:139], v[64:79]
    v_mfma_f32_32x32x16_bf16 v[80:95], v[200:203], v[136:139], v[80:95]
    s_waitcnt lgkmcnt(0)
    v_mfma_f32_32x32x16_bf16 v[0:15], v[196:199], v[124:127], v[0:15]
    v_mfma_f32_32x32x16_bf16 v[16:31], v[204:207], v[124:127], v[16:31]
    v_mfma_f32_32x32x16_bf16 v[32:47], v[196:199], v[132:135], v[32:47]
    v_mfma_f32_32x32x16_bf16 v[48:63], v[204:207], v[132:135], v[48:63]
    v_mfma_f32_32x32x16_bf16 v[64:79], v[196:199], v[140:143], v[64:79]
    v_mfma_f32_32x32x16_bf16 v[80:95], v[204:207], v[140:143], v[80:95]
    s_add_u32 s38, s26, s37
    s_add_u32 s39, s28, s36
    s_add_u32 s36, s36, 2048
    s_and_b32 s36, s36, 32767
    s_add_u32 s37, s37, 32768
    s_and_b32 s37, s37, 524287
    s_add_u32 m0, s25, 4096
    s_add_u32 s27, s38, 0
    buffer_load_dwordx4 v210, s[12:15], s27 offen lds
    s_add_u32 m0, s25, 5120
    s_add_u32 s27, s38, 8192
    buffer_load_dwordx4 v210, s[12:15], s27 offen lds
    s_add_u32 m0, s25, 6144
    s_add_u32 s27, s38, 16384
    buffer_load_dwordx4 v210, s[12:15], s27 offen lds
    s_add_u32 m0, s25, 7168
    s_add_u32 s27, s38, 24576
    buffer_load_dwordx4 v210, s[12:15], s27 offen lds
    s_add_u32 s27, s39, 0
    buffer_load_dwordx4 v[120:123], v211, s[8:11], s27 offen offset:0
    buffer_load_dwordx4 v[124:127], v211, s[8:11], s27 offen offset:1024
    s_add_u32 s27, s39, 262144
    buffer_load_dwordx4 v[128:131], v211, s[8:11], s27 offen offset:0
    buffer_load_dwordx4 v[132:135], v211, s[8:11], s27 offen offset:1024
    s_add_u32 s27, s39, 524288
    buffer_load_dwordx4 v[136:139], v211, s[8:11], s27 offen offset:0
    buffer_load_dwordx4 v[140:143], v211, s[8:11], s27 offen offset:1024
    s_waitcnt vmcnt(30)
    ds_read_b64_tr_b16 v[192:193], v208 offset:8192
    ds_read_b64_tr_b16 v[194:195], v208 offset:9216
    ds_read_b64_tr_b16 v[200:201], v209 offset:8192
    ds_read_b64_tr_b16 v[202:203], v209 offset:9216
    ds_read_b64_tr_b16 v[196:197], v208 offset:10240
    ds_read_b64_tr_b16 v[198:199], v208 offset:11264
    ds_read_b64_tr_b16 v[204:205], v209 offset:10240
    ds_read_b64_tr_b16 v[206:207], v209 offset:11264
    s_waitcnt lgkmcnt(4)
    v_mfma_f32_32x32x16_bf16 v[0:15], v[192:195], v[144:147], v[0:15]
    v_mfma_f32_32x32x16_bf16 v[16:31], v[200:203], v[144:147], v[16:31]
    v_mfma_f32_32x32x16_bf16 v[32:47], v[192:195], v[152:155], v[32:47]
    v_mfma_f32_32x32x16_bf16 v[48:63], v[200:203], v[152:155], v[48:63]
    v_mfma_f32_32x32x16_bf16 v[64:79], v[192:195], v[160:163], v[64:79]
    v_mfma_f32_32x32x16_bf16 v[80:95], v[200:203], v[160:163], v[80:95]
    s_waitcnt lgkmcnt(0)
    v_mfma_f32_32x32x16_bf16 v[0:15], v[196:199], v[148:151], v[0:15]
    v_mfma_f32_32x32x16_bf16 v[16:31], v[204:207], v[148:151], v[16:31]
    v_mfma_f32_32x32x16_bf16 v[32:47], v[196:199], v[156:159], v[32:47]
    v_mfma_f32_32x32x16_bf16 v[48:63], v[204:207], v[156:159], v[48:63]
    v_mfma_f32_32x32x16_bf16 v[64:79], v[196:199], v[164:167], v[64:79]
    v_mfma_f32_32x32x16_bf16 v[80:95], v[204:207], v[164:167], v[80:95]
    s_add_u32 s38, s26, s37
    s_add_u32 s39, s28, s36
    s_add_u32 s36, s36, 2048
    s_and_b32 s36, s36, 32767
    s_add_u32 s37, s37, 32768
    s_and_b32 s37, s37, 524287
    s_add_u32 m0, s25, 8192
    s_add_u32 s27, s38, 0
    buffer_load_dwordx4 v210, s[12:15], s27 offen lds
    s_add_u32 m0, s25, 9216
    s_add_u32 s27, s38, 8192
    buffer_load_dwordx4 v210, s[12:15], s27 offen lds
    s_add_u32 m0, s25, 10240
    s_add_u32 s27, s38, 16384
    buffer_load_dwordx4 v210, s[12:15], s27 offen lds
    s_add_u32 m0, s25, 11264
    s_add_u32 s27, s38, 24576
    buffer_load_dwordx4 v210, s[12:15], s27 offen lds
    s_add_u32 s27, s39, 0
    buffer_load_dwordx4 v[144:147], v211, s[8:11], s27 offen offset:0
    buffer_load_dwordx4 v[148:151], v211, s[8:11], s27 offen offset:1024
    s_add_u32 s27, s39, 262144
    buffer_load_dwordx4 v[152:155], v211, s[8:11], s27 offen offset:0
    buffer_load_dwordx4 v[156:159], v211, s[8:11], s27 offen offset:1024
    s_add_u32 s27, s39, 524288
    buffer_load_dwordx4 v[160:163], v211, s[8:11], s27 offen offset:0
    buffer_load_dwordx4 v[164:167], v211, s[8:11], s27 offen offset:1024
    s_waitcnt vmcnt(30)
    ds_read_b64_tr_b16 v[192:193], v208 offset:12288
    ds_read_b64_tr_b16 v[194:195], v208 offset:13312
    ds_read_b64_tr_b16 v[200:201], v209 offset:12288
    ds_read_b64_tr_b16 v[202:203], v209 offset:13312
    ds_read_b64_tr_b16 v[196:197], v208 offset:14336
    ds_read_b64_tr_b16 v[198:199], v208 offset:15360
    ds_read_b64_tr_b16 v[204:205], v209 offset:14336
    ds_read_b64_tr_b16 v[206:207], v209 offset:15360
    s_waitcnt lgkmcnt(4)
    v_mfma_f32_32x32x16_bf16 v[0:15], v[192:195], v[168:171], v[0:15]
    v_mfma_f32_32x32x16_bf16 v[16:31], v[200:203], v[168:171], v[16:31]
    v_mfma_f32_32x32x16_bf16 v[32:47], v[192:195], v[176:179], v[32:47]
    v_mfma_f32_32x32x16_bf16 v[48:63], v[200:203], v[176:179], v[48:63]
    v_mfma_f32_32x32x16_bf16 v[64:79], v[192:195], v[184:187], v[64:79]
    v_mfma_f32_32x32x16_bf16 v[80:95], v[200:203], v[184:187], v[80:95]
    s_waitcnt lgkmcnt(0)
    v_mfma_f32_32x32x16_bf16 v[0:15], v[196:199], v[172:175], v[0:15]
    v_mfma_f32_32x32x16_bf16 v[16:31], v[204:207], v[172:175], v[16:31]
    v_mfma_f32_32x32x16_bf16 v[32:47], v[196:199], v[180:183], v[32:47]
    v_mfma_f32_32x32x16_bf16 v[48:63], v[204:207], v[180:183], v[48:63]
    v_mfma_f32_32x32x16_bf16 v[64:79], v[196:199], v[188:191], v[64:79]
    v_mfma_f32_32x32x16_bf16 v[80:95], v[204:207], v[188:191], v[80:95]
    s_add_u32 s38, s26, s37
    s_add_u32 s39, s28, s36
    s_add_u32 s36, s36, 2048
    s_and_b32 s36, s36, 32767
    s_add_u32 s37, s37, 32768
    s_and_b32 s37, s37, 524287
    s_add_u32 m0, s25, 12288
    s_add_u32 s27, s38, 0
    buffer_load_dwordx4 v210, s[12:15], s27 offen lds
    s_add_u32 m0, s25, 13312
    s_add_u32 s27, s38, 8192
    buffer_load_dwordx4 v210, s[12:15], s27 offen lds
    s_add_u32 m0, s25, 14336
    s_add_u32 s27, s38, 16384
    buffer_load_dwordx4 v210, s[12:15], s27 offen lds
    s_add_u32 m0, s25, 15360
    s_add_u32 s27, s38, 24576
    buffer_load_dwordx4 v210, s[12:15], s27 offen lds
    s_add_u32 s27, s39, 0
    buffer_load_dwordx4 v[168:171], v211, s[8:11], s27 offen offset:0
    buffer_load_dwordx4 v[172:175], v211, s[8:11], s27 offen offset:1024
    s_add_u32 s27, s39, 262144
    buffer_load_dwordx4 v[176:179], v211, s[8:11], s27 offen offset:0
    buffer_load_dwordx4 v[180:183], v211, s[8:11], s27 offen offset:1024
    s_add_u32 s27, s39, 524288
    buffer_load_dwordx4 v[184:187], v211, s[8:11], s27 offen offset:0
    buffer_load_dwordx4 v[188:191], v211, s[8:11], s27 offen offset:1024
    s_waitcnt vmcnt(30)
    ds_read_b64_tr_b16 v[192:193], v208 offset:0
    ds_read_b64_tr_b16 v[194:195], v208 offset:1024
    ds_read_b64_tr_b16 v[200:201], v209 offset:0
    ds_read_b64_tr_b16 v[202:203], v209 offset:1024
    ds_read_b64_tr_b16 v[196:197], v208 offset:2048
    ds_read_b64_tr_b16 v[198:199], v208 offset:3072
    ds_read_b64_tr_b16 v[204:205], v209 offset:2048
    ds_read_b64_tr_b16 v[206:207], v209 offset:3072
    s_waitcnt lgkmcnt(4)
    v_mfma_f32_32x32x16_bf16 v[0:15], v[192:195], v[96:99], v[0:15]
    v_mfma_f32_32x32x16_bf16 v[16:31], v[200:203], v[96:99], v[16:31]
    v_mfma_f32_32x32x16_bf16 v[32:47], v[192:195], v[104:107], v[32:47]
    v_mfma_f32_32x32x16_bf16 v[48:63], v[200:203], v[104:107], v[48:63]
    v_mfma_f32_32x32x16_bf16 v[64:79], v[192:195], v[112:115], v[64:79]
    v_mfma_f32_32x32x16_bf16 v[80:95], v[200:203], v[112:115], v[80:95]
    s_waitcnt lgkmcnt(0)
    v_mfma_f32_32x32x16_bf16 v[0:15], v[196:199], v[100:103], v[0:15]
    v_mfma_f32_32x32x16_bf16 v[16:31], v[204:207], v[100:103], v[16:31]
    v_mfma_f32_32x32x16_bf16 v[32:47], v[196:199], v[108:111], v[32:47]
    v_mfma_f32_32x32x16_bf16 v[48:63], v[204:207], v[108:111], v[48:63]
    v_mfma_f32_32x32x16_bf16 v[64:79], v[196:199], v[116:119], v[64:79]
    v_mfma_f32_32x32x16_bf16 v[80:95], v[204:207], v[116:119], v[80:95]
    s_waitcnt vmcnt(20)
    ds_read_b64_tr_b16 v[192:193], v208 offset:4096
    ds_read_b64_tr_b16 v[194:195], v208 offset:5120
    ds_read_b64_tr_b16 v[200:201], v209 offset:4096
    ds_read_b64_tr_b16 v[202:203], v209 offset:5120
    ds_read_b64_tr_b16 v[196:197], v208 offset:6144
    ds_read_b64_tr_b16 v[198:199], v208 offset:7168
    ds_read_b64_tr_b16 v[204:205], v209 offset:6144
    ds_read_b64_tr_b16 v[206:207], v209 offset:7168
    s_waitcnt lgkmcnt(4)
    v_mfma_f32_32x32x16_bf16 v[0:15], v[192:195], v[120:123], v[0:15]
    v_mfma_f32_32x32x16_bf16 v[16:31], v[200:203], v[120:123], v[16:31]
    v_mfma_f32_32x32x16_bf16 v[32:47], v[192:195], v[128:131], v[32:47]
    v_mfma_f32_32x32x16_bf16 v[48:63], v[200:203], v[128:131], v[48:63]
    v_mfma_f32_32x32x16_bf16 v[64:79], v[192:195], v[136:139], v[64:79]
    v_mfma_f32_32x32x16_bf16 v[80:95], v[200:203], v[136:139], v[80:95]
    s_waitcnt lgkmcnt(0)
    v_mfma_f32_32x32x16_bf16 v[0:15], v[196:199], v[124:127], v[0:15]
    v_mfma_f32_32x32x16_bf16 v[16:31], v[204:207], v[124:127], v[16:31]
    v_mfma_f32_32x32x16_bf16 v[32:47], v[196:199], v[132:135], v[32:47]
    v_mfma_f32_32x32x16_bf16 v[48:63], v[204:207], v[132:135], v[48:63]
    v_mfma_f32_32x32x16_bf16 v[64:79], v[196:199], v[140:143], v[64:79]
    v_mfma_f32_32x32x16_bf16 v[80:95], v[204:207], v[140:143], v[80:95]
    s_waitcnt vmcnt(10)
    ds_read_b64_tr_b16 v[192:193], v208 offset:8192
    ds_read_b64_tr_b16 v[194:195], v208 offset:9216
    ds_read_b64_tr_b16 v[200:201], v209 offset:8192
    ds_read_b64_tr_b16 v[202:203], v209 offset:9216
    ds_read_b64_tr_b16 v[196:197], v208 offset:10240
    ds_read_b64_tr_b16 v[198:199], v208 offset:11264
    ds_read_b64_tr_b16 v[204:205], v209 offset:10240
    ds_read_b64_tr_b16 v[206:207], v209 offset:11264
    s_waitcnt lgkmcnt(4)
    v_mfma_f32_32x32x16_bf16 v[0:15], v[192:195], v[144:147], v[0:15]
    v_mfma_f32_32x32x16_bf16 v[16:31], v[200:203], v[144:147], v[16:31]
    v_mfma_f32_32x32x16_bf16 v[32:47], v[192:195], v[152:155], v[32:47]
    v_mfma_f32_32x32x16_bf16 v[48:63], v[200:203], v[152:155], v[48:63]
    v_mfma_f32_32x32x16_bf16 v[64:79], v[192:195], v[160:163], v[64:79]
    v_mfma_f32_32x32x16_bf16 v[80:95], v[200:203], v[160:163], v[80:95]
    s_waitcnt lgkmcnt(0)
    v_mfma_f32_32x32x16_bf16 v[0:15], v[196:199], v[148:151], v[0:15]
    v_mfma_f32_32x32x16_bf16 v[16:31], v[204:207], v[148:151], v[16:31]
    v_mfma_f32_32x32x16_bf16 v[32:47], v[196:199], v[156:159], v[32:47]
    v_mfma_f32_32x32x16_bf16 v[48:63], v[204:207], v[156:159], v[48:63]
    v_mfma_f32_32x32x16_bf16 v[64:79], v[196:199], v[164:167], v[64:79]
    v_mfma_f32_32x32x16_bf16 v[80:95], v[204:207], v[164:167], v[80:95]
    s_waitcnt vmcnt(0)
    ds_read_b64_tr_b16 v[192:193], v208 offset:12288
    ds_read_b64_tr_b16 v[194:195], v208 offset:13312
    ds_read_b64_tr_b16 v[200:201], v209 offset:12288
    ds_read_b64_tr_b16 v[202:203], v209 offset:13312
    ds_read_b64_tr_b16 v[196:197], v208 offset:14336
    ds_read_b64_tr_b16 v[198:199], v208 offset:15360
    ds_read_b64_tr_b16 v[204:205], v209 offset:14336
    ds_read_b64_tr_b16 v[206:207], v209 offset:15360
    s_waitcnt lgkmcnt(4)
    v_mfma_f32_32x32x16_bf16 v[0:15], v[192:195], v[168:171], v[0:15]
    v_mfma_f32_32x32x16_bf16 v[16:31], v[200:203], v[168:171], v[16:31]
    v_mfma_f32_32x32x16_bf16 v[32:47], v[192:195], v[176:179], v[32:47]
    v_mfma_f32_32x32x16_bf16 v[48:63], v[200:203], v[176:179], v[48:63]
    v_mfma_f32_32x32x16_bf16 v[64:79], v[192:195], v[184:187], v[64:79]
    v_mfma_f32_32x32x16_bf16 v[80:95], v[200:203], v[184:187], v[80:95]
    s_waitcnt lgkmcnt(0)
    v_mfma_f32_32x32x16_bf16 v[0:15], v[196:199], v[172:175], v[0:15]
    v_mfma_f32_32x32x16_bf16 v[16:31], v[204:207], v[172:175], v[16:31]
    v_mfma_f32_32x32x16_bf16 v[32:47], v[196:199], v[180:183], v[32:47]
    v_mfma_f32_32x32x16_bf16 v[48:63], v[204:207], v[180:183], v[48:63]
    v_mfma_f32_32x32x16_bf16 v[64:79], v[196:199], v[188:191], v[64:79]
    v_mfma_f32_32x32x16_bf16 v[80:95], v[204:207], v[188:191], v[80:95]
    s_barrier
    v_lshlrev_b32 v216, 4, v212
    s_mul_i32 s3, s20, 12288
    v_add_u32 v213, s3, v216
    s_xor_b32 s4, s20, 4
    s_mul_i32 s4, s4, 12288
    v_add_u32 v214, s4, v216
    s_cmp_lt_u32 s20, 4
    s_cbranch_scc0 K2_P1B
    s_nop 0
    ds_write_b128 v213, v[48:51] offset:0
    ds_write_b128 v213, v[52:55] offset:1024
    ds_write_b128 v213, v[56:59] offset:2048
    ds_write_b128 v213, v[60:63] offset:3072
    ds_write_b128 v213, v[64:67] offset:4096
    ds_write_b128 v213, v[68:71] offset:5120
    ds_write_b128 v213, v[72:75] offset:6144
    ds_write_b128 v213, v[76:79] offset:7168
    ds_write_b128 v213, v[80:83] offset:8192
    ds_write_b128 v213, v[84:87] offset:9216
    ds_write_b128 v213, v[88:91] offset:10240
    ds_write_b128 v213, v[92:95] offset:11264
    s_branch K2_P1C
K2_P1B:
    ds_write_b128 v213, v[0:3] offset:0
    ds_write_b128 v213, v[4:7] offset:1024
    ds_write_b128 v213, v[8:11] offset:2048
    ds_write_b128 v213, v[12:15] offset:3072
    ds_write_b128 v213, v[16:19] offset:4096
    ds_write_b128 v213, v[20:23] offset:5120
    ds_write_b128 v213, v[24:27] offset:6144
    ds_write_b128 v213, v[28:31] offset:7168
    ds_write_b128 v213, v[32:35] offset:8192
    ds_write_b128 v213, v[36:39] offset:9216
    ds_write_b128 v213, v[40:43] offset:10240
    ds_write_b128 v213, v[44:47] offset:11264
    v_mov_b32 v0, v48
    v_mov_b32 v1, v49
    v_mov_b32 v2, v50
    v_mov_b32 v3, v51
    v_mov_b32 v4, v52
    v_mov_b32 v5, v53
    v_mov_b32 v6, v54
    v_mov_b32 v7, v55
    v_mov_b32 v8, v56
    v_mov_b32 v9, v57
    v_mov_b32 v10, v58
    v_mov_b32 v11, v59
    v_mov_b32 v12, v60
    v_mov_b32 v13, v61
    v_mov_b32 v14, v62
    v_mov_b32 v15, v63
    v_mov_b32 v16, v64
    v_mov_b32 v17, v65
    v_mov_b32 v18, v66
    v_mov_b32 v19, v67
    v_mov_b32 v20, v68
    v_mov_b32 v21, v69
    v_mov_b32 v22, v70
    v_mov_b32 v23, v71
    v_mov_b32 v24, v72
    v_mov_b32 v25, v73
    v_mov_b32 v26, v74
    v_mov_b32 v27, v75
    v_mov_b32 v28, v76
    v_mov_b32 v29, v77
    v_mov_b32 v30, v78
    v_mov_b32 v31, v79
    v_mov_b32 v32, v80
    v_mov_b32 v33, v81
    v_mov_b32 v34, v82
    v_mov_b32 v35, v83
    v_mov_b32 v36, v84
    v_mov_b32 v37, v85
    v_mov_b32 v38, v86
    v_mov_b32 v39, v87
    v_mov_b32 v40, v88
    v_mov_b32 v41, v89
    v_mov_b32 v42, v90
    v_mov_b32 v43, v91
    v_mov_b32 v44, v92
    v_mov_b32 v45, v93
    v_mov_b32 v46, v94
    v_mov_b32 v47, v95
    s_nop 1
K2_P1C:
    s_waitcnt lgkmcnt(0)
    s_barrier
    ds_read_b128 v[96:99], v214 offset:0
    ds_read_b128 v[100:103], v214 offset:1024
    ds_read_b128 v[104:107], v214 offset:2048
    ds_read_b128 v[108:111], v214 offset:3072
    ds_read_b128 v[112:115], v214 offset:4096
    ds_read_b128 v[116:119], v214 offset:5120
    ds_read_b128 v[120:123], v214 offset:6144
    ds_read_b128 v[124:127], v214 offset:7168
    ds_read_b128 v[128:131], v214 offset:8192
    ds_read_b128 v[132:135], v214 offset:9216
    ds_read_b128 v[136:139], v214 offset:10240
    ds_read_b128 v[140:143], v214 offset:11264
    s_waitcnt lgkmcnt(0)
    v_add_f32 v0, v0, v96
    v_add_f32 v1, v1, v97
    v_add_f32 v2, v2, v98
    v_add_f32 v3, v3, v99
    v_add_f32 v4, v4, v100
    v_add_f32 v5, v5, v101
    v_add_f32 v6, v6, v102
    v_add_f32 v7, v7, v103
    v_add_f32 v8, v8, v104
    v_add_f32 v9, v9, v105
    v_add_f32 v10, v10, v106
    v_add_f32 v11, v11, v107
    v_add_f32 v12, v12, v108
    v_add_f32 v13, v13, v109
    v_add_f32 v14, v14, v110
    v_add_f32 v15, v15, v111
    v_add_f32 v16, v16, v112
    v_add_f32 v17, v17, v113
    v_add_f32 v18, v18, v114
    v_add_f32 v19, v19, v115
    v_add_f32 v20, v20, v116
    v_add_f32 v21, v21, v117
    v_add_f32 v22, v22, v118
    v_add_f32 v23, v23, v119
    v_add_f32 v24, v24, v120
    v_add_f32 v25, v25, v121
    v_add_f32 v26, v26, v122
    v_add_f32 v27, v27, v123
    v_add_f32 v28, v28, v124
    v_add_f32 v29, v29, v125
    v_add_f32 v30, v30, v126
    v_add_f32 v31, v31, v127
    v_add_f32 v32, v32, v128
    v_add_f32 v33, v33, v129
    v_add_f32 v34, v34, v130
    v_add_f32 v35, v35, v131
    v_add_f32 v36, v36, v132
    v_add_f32 v37, v37, v133
    v_add_f32 v38, v38, v134
    v_add_f32 v39, v39, v135
    v_add_f32 v40, v40, v136
    v_add_f32 v41, v41, v137
    v_add_f32 v42, v42, v138
    v_add_f32 v43, v43, v139
    v_add_f32 v44, v44, v140
    v_add_f32 v45, v45, v141
    v_add_f32 v46, v46, v142
    v_add_f32 v47, v47, v143
    s_barrier
    ds_write_b128 v213, v[0:3] offset:0
    ds_write_b128 v213, v[4:7] offset:1024
    ds_write_b128 v213, v[8:11] offset:2048
    ds_write_b128 v213, v[12:15] offset:3072
    ds_write_b128 v213, v[16:19] offset:4096
    ds_write_b128 v213, v[20:23] offset:5120
    ds_write_b128 v213, v[24:27] offset:6144
    ds_write_b128 v213, v[28:31] offset:7168
    ds_write_b128 v213, v[32:35] offset:8192
    ds_write_b128 v213, v[36:39] offset:9216
    ds_write_b128 v213, v[40:43] offset:10240
    ds_write_b128 v213, v[44:47] offset:11264
    s_waitcnt lgkmcnt(0)
    s_barrier
    s_and_b32 s3, s20, 3
    s_cmp_eq_u32 s3, 3
    s_cbranch_scc1 K2_END
    s_and_b32 s4, s20, 4
    s_mul_i32 s4, s4, 12288
    s_lshl_b32 s5, s3, 12
    s_add_u32 s4, s4, s5
    v_add_u32 v214, s4, v216
    ds_read_b128 v[96:99], v214 offset:0
    ds_read_b128 v[100:103], v214 offset:1024
    ds_read_b128 v[104:107], v214 offset:2048
    ds_read_b128 v[108:111], v214 offset:3072
    ds_read_b128 v[112:115], v214 offset:12288
    ds_read_b128 v[116:119], v214 offset:13312
    ds_read_b128 v[120:123], v214 offset:14336
    ds_read_b128 v[124:127], v214 offset:15360
    ds_read_b128 v[128:131], v214 offset:24576
    ds_read_b128 v[132:135], v214 offset:25600
    ds_read_b128 v[136:139], v214 offset:26624
    ds_read_b128 v[140:143], v214 offset:27648
    ds_read_b128 v[144:147], v214 offset:36864
    ds_read_b128 v[148:151], v214 offset:37888
    ds_read_b128 v[152:155], v214 offset:38912
    ds_read_b128 v[156:159], v214 offset:39936
    s_waitcnt lgkmcnt(0)
    v_add_f32 v96, v96, v112
    v_add_f32 v128, v128, v144
    v_add_f32 v96, v96, v128
    v_add_f32 v97, v97, v113
    v_add_f32 v129, v129, v145
    v_add_f32 v97, v97, v129
    v_add_f32 v98, v98, v114
    v_add_f32 v130, v130, v146
    v_add_f32 v98, v98, v130
    v_add_f32 v99, v99, v115
    v_add_f32 v131, v131, v147
    v_add_f32 v99, v99, v131
    v_add_f32 v100, v100, v116
    v_add_f32 v132, v132, v148
    v_add_f32 v100, v100, v132
    v_add_f32 v101, v101, v117
    v_add_f32 v133, v133, v149
    v_add_f32 v101, v101, v133
    v_add_f32 v102, v102, v118
    v_add_f32 v134, v134, v150
    v_add_f32 v102, v102, v134
    v_add_f32 v103, v103, v119
    v_add_f32 v135, v135, v151
    v_add_f32 v103, v103, v135
    v_add_f32 v104, v104, v120
    v_add_f32 v136, v136, v152
    v_add_f32 v104, v104, v136
    v_add_f32 v105, v105, v121
    v_add_f32 v137, v137, v153
    v_add_f32 v105, v105, v137
    v_add_f32 v106, v106, v122
    v_add_f32 v138, v138, v154
    v_add_f32 v106, v106, v138
    v_add_f32 v107, v107, v123
    v_add_f32 v139, v139, v155
    v_add_f32 v107, v107, v139
    v_add_f32 v108, v108, v124
    v_add_f32 v140, v140, v156
    v_add_f32 v108, v108, v140
    v_add_f32 v109, v109, v125
    v_add_f32 v141, v141, v157
    v_add_f32 v109, v109, v141
    v_add_f32 v110, v110, v126
    v_add_f32 v142, v142, v158
    v_add_f32 v110, v110, v142
    v_add_f32 v111, v111, v127
    v_add_f32 v143, v143, v159
    v_add_f32 v111, v111, v143
    v_cvt_pk_bf16_f32 v160, v96, v97
    v_cvt_pk_bf16_f32 v161, v98, v99
    v_cvt_pk_bf16_f32 v162, v100, v101
    v_cvt_pk_bf16_f32 v163, v102, v103
    v_cvt_pk_bf16_f32 v164, v104, v105
    v_cvt_pk_bf16_f32 v165, v106, v107
    v_cvt_pk_bf16_f32 v166, v108, v109
    v_cvt_pk_bf16_f32 v167, v110, v111
    s_lshr_b32 s4, s20, 2
    s_mul_i32 s4, s4, 3
    s_add_u32 s4, s4, s3
    s_lshr_b32 s5, s4, 1
    s_and_b32 s6, s4, 1
    s_lshl_b32 s5, s5, 16
    s_lshl_b32 s6, s6, 5
    s_add_u32 s5, s5, s6
    v_and_b32 v213, 31, v212
    v_lshlrev_b32 v213, 11, v213
    v_lshrrev_b32 v214, 5, v212
    v_lshl_add_u32 v213, v214, 6, v213
    buffer_store_dwordx4 v[160:163], v213, s[16:19], s5 offen offset:0 nt
    buffer_store_dwordx4 v[164:167], v213, s[16:19], s5 offen offset:16 nt
K2_END:
    s_endpgm
.section .rodata,"a"
.p2align 6
.amdhsa_kernel attn_kernel
  .amdhsa_next_free_vgpr 168
  .amdhsa_next_free_sgpr 100
  .amdhsa_accum_offset 168
  .amdhsa_group_segment_fixed_size 0
  .amdhsa_kernarg_size 104
  .amdhsa_user_sgpr_count 2
  .amdhsa_user_sgpr_kernarg_segment_ptr 1
  .amdhsa_system_sgpr_workgroup_id_x 1
.end_amdhsa_kernel

.section .rodata,"a"
.p2align 6
.amdhsa_kernel oproj_kernel
  .amdhsa_next_free_vgpr 220
  .amdhsa_next_free_sgpr 100
  .amdhsa_accum_offset 220
  .amdhsa_group_segment_fixed_size 0
  .amdhsa_kernarg_size 104
  .amdhsa_user_sgpr_count 2
  .amdhsa_user_sgpr_kernarg_segment_ptr 1
  .amdhsa_system_sgpr_workgroup_id_x 1
.end_amdhsa_kernel
```
